```python
import torch

def _softmax(x, axis=-1):
    return torch.softmax(x, dim=axis)

def _gelu(x):
    return torch.nn.functional.gelu(x, approximate='tanh')

def _silu(x):
    return torch.nn.functional.silu(x)

def _sigmoid(x):
    return torch.sigmoid(x)

def _layernorm(x, axis=-1, eps=1e-05):
    m = x.mean(dim=axis, keepdim=True)
    v = x.var(dim=axis, keepdim=True, unbiased=False)
    return (x - m) / torch.sqrt(v + eps)

def _scatter_add(tgt, idx, src, axis=0):
    return tgt.clone().index_add_(axis, idx, src)

def _segment_sum(src, seg, n):
    out = torch.zeros((n,) + src.shape[1:], dtype=src.dtype)
    return out.index_add_(0, seg, src)

def _pad(x, pw):
    flat = tuple((v for pair in reversed(pw) for v in pair))
    return torch.nn.functional.pad(x, flat)
kernel_name = 'adaLN_cond__sliding_block_cached__glu_gated_reglu__prompt'

def setup_inputs():

    _w = lambda a: (lambda t: t.to(torch.bfloat16) if t.is_floating_point() else t)(torch.as_tensor(a))

    def _A_setup():
        B, Sq, D = (1, 2048, 640)
        Hq, Hkv, Sk, Dh = (32, 32, 2048, 192)
        assert Hq % Hkv == 0, (Hq, Hkv)
        return {'x': _w((lambda *s: torch.randn(*s, dtype=torch.bfloat16) * 0.05)(B, Sq, D)), 'k_cache': _w((lambda *s: torch.randn(*s, dtype=torch.bfloat16) * 1.6)(B, Hkv, Sk, Dh)), 'v_cache': _w((lambda *s: torch.randn(*s, dtype=torch.bfloat16) * 0.8)(B, Hkv, Sk, Dh)), 'wq': _w((lambda *s: torch.randn(*s, dtype=torch.bfloat16) * 1.6)(D, Hq * Dh) * D ** (-0.5)), 'wo': _w((lambda *s: torch.randn(*s, dtype=torch.bfloat16) * 0.8)(Hq * Dh, D) * (Hq * Dh) ** (-0.5))}
    _A_in = _A_setup()

    def _B_setup():
        B, S, D, F = (1, 2048, 640, 1536)
        return {'x': _w((lambda *s: torch.randn(*s, dtype=torch.bfloat16) * 0.05)(B, S, D)), 'W_gate': _w((lambda *s: torch.randn(*s, dtype=torch.bfloat16) * 0.4)(D, F) * (2.0 / D) ** 0.5), 'W_up': _w((lambda *s: torch.randn(*s, dtype=torch.bfloat16) * 0.4)(D, F) * (2.0 / D) ** 0.5), 'W_down': _w((lambda *s: torch.randn(*s, dtype=torch.bfloat16) * 0.4)(F, D) * (1.0 / F) ** 0.5)}
    _B_in = _B_setup()
    return {'A_x': _A_in['x'], 'A_k_cache': _A_in['k_cache'], 'A_v_cache': _A_in['v_cache'], 'A_wq': _A_in['wq'], 'A_wo': _A_in['wo'], 'B_x': _B_in['x'], 'B_W_gate': _B_in['W_gate'], 'B_W_up': _B_in['W_up'], 'B_W_down': _B_in['W_down'], 'c': _w((lambda *s: torch.randn(*s, dtype=torch.bfloat16) * 0.2)(1, 640) * 8.0), 'w_mod': _w((lambda *s: torch.randn(*s, dtype=torch.bfloat16) * 0.2)(640, 6 * 640) * 640 ** (-0.5) * 8.0)}

def reference(A_x, A_k_cache, A_v_cache, A_wq, A_wo, B_x, B_W_gate, B_W_up, B_W_down, c, w_mod):

    def _A_ref(x, k_cache, v_cache, wq, wo):
        B, Sq, D = x.shape
        Hq, Dh = (32, 192)
        Hkv, Sk = (k_cache.shape[1], k_cache.shape[2])
        W = min(4096, max(256, Sk // 4))
        rep = Hq // Hkv
        q = (lambda x, *d: x.permute(*d))((x @ wq).reshape(B, Sq, Hq, Dh), 0, 2, 1, 3)
        k = (lambda x, n, axis: torch.repeat_interleave(x, n, dim=axis))(k_cache[:, :, Sk - W:, :], rep, axis=1)
        v = (lambda x, n, axis: torch.repeat_interleave(x, n, dim=axis))(v_cache[:, :, Sk - W:, :], rep, axis=1)
        scores = torch.einsum('bhqd,bhkd->bhqk', q, k) * Dh ** (-0.5)
        p = _softmax(scores, axis=-1)
        o = torch.einsum('bhqk,bhkd->bhqd', p, v)
        return (lambda x, *d: x.permute(*d))(o, 0, 2, 1, 3).reshape(B, Sq, Hq * Dh) @ wo

    def _B_ref(x, W_gate, W_up, W_down):
        gate = torch.einsum('bsd,df->bsf', x, W_gate)
        up = torch.einsum('bsd,df->bsf', x, W_up)
        gate = gate * (lambda x, dt: x.to(dt))(gate > 0, gate.dtype)
        h = gate * up
        return torch.einsum('bsf,fd->bsd', h, W_down)
    x = A_x
    mod = (_silu(c) @ w_mod).reshape(c.shape[0], 6, 1, -1)
    sa, ca, ga, sb, cb, gb = (mod[:, 0].clone(), mod[:, 1].clone(), mod[:, 2].clone(), mod[:, 3].clone(), mod[:, 4].clone(), mod[:, 5].clone())
    h = _layernorm(x, axis=-1) * (1 + ca) + sa
    x = x + ga * _A_ref(h, A_k_cache, A_v_cache, A_wq, A_wo)
    h = _layernorm(x, axis=-1) * (1 + cb) + sb
    x = x + gb * _B_ref(h, B_W_gate, B_W_up, B_W_down)
    return x
```

```asm
; @launch kernel=k0_kernel grid=(240,1,1) block=(256,1,1) lds=1024
; @launch kernel=k1_kernel grid=(256,1,1) block=(256,1,1) lds=6144
; @launch kernel=k2_kernel grid=(256,1,1) block=(256,1,1) lds=159744
.amdgcn_target "amdgcn-amd-amdhsa--gfx950"
.text
.globl k0_kernel
.p2align 8
.type k0_kernel,@function
k0_kernel:
  s_load_dwordx4 s[4:7], s[0:1], 72
  s_load_dwordx2 s[8:9], s[0:1], 104
  s_load_dwordx2 s[10:11], s[0:1], 24
  s_cmp_ge_u32 s2, 240
  s_cbranch_scc1 L_end_k0_kernel
  s_getpc_b64 s[40:41]
L_sp_k0:
  s_sub_u32 s40, s40, L_sp_k0-k0_kernel
  s_subb_u32 s41, s41, 0
  v_lshlrev_b32 v8, 7, v0
  s_mov_b32 s42, L_code_end-k0_kernel-4
  v_min_u32 v8, s42, v8
  global_load_dword v9, v8, s[40:41]
  s_waitcnt lgkmcnt(0)
  s_mov_b32 s12, s4
  s_mov_b32 s13, s5
  s_mov_b32 s14, 0x500
  s_mov_b32 s15, 0x20000
  s_mov_b32 s16, s6
  s_mov_b32 s17, s7
  s_mov_b32 s18, 0x4b0000
  s_mov_b32 s19, 0x20000
  s_mov_b32 s20, s8
  s_mov_b32 s21, s9
  s_mov_b32 s22, 0xf000
  s_mov_b32 s23, 0x20000
  s_mov_b32 s44, s10
  s_mov_b32 s45, s11
  s_mov_b32 s46, 0x3c0000
  s_mov_b32 s47, 0x20000
  s_cmp_lg_u32 s2, 0
  s_cbranch_scc1 L_k0_noz
  s_add_u32 s48, s8, 0x20000
  s_addc_u32 s49, s9, 0
  s_mov_b32 s50, 0x3000
  s_mov_b32 s51, 0x20000
  v_mov_b32 v52, 0
  v_mov_b32 v53, 0
  v_mov_b32 v54, 0
  v_mov_b32 v55, 0
  v_lshlrev_b32 v51, 4, v0
  buffer_store_dwordx4 v[52:55], v51, s[48:51], 0 offen
  v_add_u32 v51, 4096, v51
  buffer_store_dwordx4 v[52:55], v51, s[48:51], 0 offen
  v_add_u32 v51, 4096, v51
  buffer_store_dwordx4 v[52:55], v51, s[48:51], 0 offen
L_k0_noz:
  v_lshrrev_b32 v1, 6, v0
  v_and_b32 v2, 63, v0
  v_readfirstlane_b32 s24, v1
  v_lshrrev_b32 v3, 4, v2
  v_and_b32 v4, 15, v2
  s_lshr_b32 s25, s2, 2
  s_and_b32 s26, s2, 3
  s_mul_i32 s27, s26, 160
  s_mul_i32 s28, s24, 40
  s_add_u32 s27, s27, s28
  v_lshlrev_b32 v5, 1, v3
  s_lshl_b32 s28, s27, 1
  buffer_load_ushort v10, v5, s[12:15], s28 offen offset:0
  buffer_load_ushort v11, v5, s[12:15], s28 offen offset:8
  buffer_load_ushort v12, v5, s[12:15], s28 offen offset:16
  buffer_load_ushort v13, v5, s[12:15], s28 offen offset:24
  buffer_load_ushort v14, v5, s[12:15], s28 offen offset:32
  buffer_load_ushort v15, v5, s[12:15], s28 offen offset:40
  buffer_load_ushort v16, v5, s[12:15], s28 offen offset:48
  buffer_load_ushort v17, v5, s[12:15], s28 offen offset:56
  buffer_load_ushort v18, v5, s[12:15], s28 offen offset:64
  buffer_load_ushort v19, v5, s[12:15], s28 offen offset:72
  s_mov_b32 s30, 7680
  v_mul_lo_u32 v6, s30, v3
  v_lshlrev_b32 v7, 3, v4
  v_add_u32 v6, v6, v7
  s_mul_i32 s29, s27, 7680
  s_lshl_b32 s31, s25, 7
  s_add_u32 s29, s29, s31
  buffer_load_dwordx2 v[20:21], v6, s[16:19], s29 offen
  s_add_u32 s29, s29, 30720
  buffer_load_dwordx2 v[22:23], v6, s[16:19], s29 offen
  s_add_u32 s29, s29, 30720
  buffer_load_dwordx2 v[24:25], v6, s[16:19], s29 offen
  s_add_u32 s29, s29, 30720
  buffer_load_dwordx2 v[26:27], v6, s[16:19], s29 offen
  s_add_u32 s29, s29, 30720
  buffer_load_dwordx2 v[28:29], v6, s[16:19], s29 offen
  s_add_u32 s29, s29, 30720
  buffer_load_dwordx2 v[30:31], v6, s[16:19], s29 offen
  s_add_u32 s29, s29, 30720
  buffer_load_dwordx2 v[32:33], v6, s[16:19], s29 offen
  s_add_u32 s29, s29, 30720
  buffer_load_dwordx2 v[34:35], v6, s[16:19], s29 offen
  s_add_u32 s29, s29, 30720
  buffer_load_dwordx2 v[36:37], v6, s[16:19], s29 offen
  s_add_u32 s29, s29, 30720
  buffer_load_dwordx2 v[38:39], v6, s[16:19], s29 offen
  s_lshl_b32 s36, s2, 2
  s_add_u32 s36, s36, s24
  s_mul_i32 s36, s36, 4096
  v_lshlrev_b32 v62, 7, v2
  v_cmp_gt_u32 vcc, 32, v2
  v_mov_b32 v63, 0x7ff00000
  s_nop 0
  v_cndmask_b32 v62, v63, v62, vcc
  buffer_load_dword v63, v62, s[44:47], s36 offen
  s_getpc_b64 s[60:61]
  s_add_u32 s60, s60, L_desc_k1_kernel@rel32@lo+4
  s_addc_u32 s61, s61, L_desc_k1_kernel@rel32@hi+12
  s_load_dword s62, s[60:61], 0
  s_getpc_b64 s[60:61]
  s_add_u32 s60, s60, L_desc_k2_kernel@rel32@lo+4
  s_addc_u32 s61, s61, L_desc_k2_kernel@rel32@hi+12
  s_load_dword s63, s[60:61], 0
  s_waitcnt vmcnt(11)
  s_mov_b32 s32, 0xbfb8aa3b
  v_lshlrev_b32 v10, 16, v10
  v_lshlrev_b32 v11, 16, v11
  v_lshlrev_b32 v12, 16, v12
  v_lshlrev_b32 v13, 16, v13
  v_lshlrev_b32 v14, 16, v14
  v_lshlrev_b32 v15, 16, v15
  v_lshlrev_b32 v16, 16, v16
  v_lshlrev_b32 v17, 16, v17
  v_lshlrev_b32 v18, 16, v18
  v_lshlrev_b32 v19, 16, v19
  v_mul_f32 v40, s32, v10
  v_mul_f32 v41, s32, v11
  v_mul_f32 v42, s32, v12
  v_mul_f32 v43, s32, v13
  v_mul_f32 v44, s32, v14
  v_mul_f32 v45, s32, v15
  v_mul_f32 v46, s32, v16
  v_mul_f32 v47, s32, v17
  v_mul_f32 v48, s32, v18
  v_mul_f32 v49, s32, v19
  v_exp_f32 v40, v40
  v_exp_f32 v41, v41
  v_exp_f32 v42, v42
  v_exp_f32 v43, v43
  v_exp_f32 v44, v44
  v_exp_f32 v45, v45
  v_exp_f32 v46, v46
  v_exp_f32 v47, v47
  v_exp_f32 v48, v48
  v_exp_f32 v49, v49
  s_nop 0
  v_add_f32 v40, 1.0, v40
  v_add_f32 v41, 1.0, v41
  v_add_f32 v42, 1.0, v42
  v_add_f32 v43, 1.0, v43
  v_add_f32 v44, 1.0, v44
  v_add_f32 v45, 1.0, v45
  v_add_f32 v46, 1.0, v46
  v_add_f32 v47, 1.0, v47
  v_add_f32 v48, 1.0, v48
  v_add_f32 v49, 1.0, v49
  v_rcp_f32 v40, v40
  v_rcp_f32 v41, v41
  v_rcp_f32 v42, v42
  v_rcp_f32 v43, v43
  v_rcp_f32 v44, v44
  v_rcp_f32 v45, v45
  v_rcp_f32 v46, v46
  v_rcp_f32 v47, v47
  v_rcp_f32 v48, v48
  v_rcp_f32 v49, v49
  s_nop 0
  v_mul_f32 v10, v10, v40
  v_mul_f32 v11, v11, v41
  v_mul_f32 v12, v12, v42
  v_mul_f32 v13, v13, v43
  v_mul_f32 v14, v14, v44
  v_mul_f32 v15, v15, v45
  v_mul_f32 v16, v16, v46
  v_mul_f32 v17, v17, v47
  v_mul_f32 v18, v18, v48
  v_mul_f32 v19, v19, v49
  v_cvt_pk_bf16_f32 v10, v10, v10
  v_lshlrev_b32 v10, 16, v10
  v_cvt_pk_bf16_f32 v11, v11, v11
  v_lshlrev_b32 v11, 16, v11
  v_cvt_pk_bf16_f32 v12, v12, v12
  v_lshlrev_b32 v12, 16, v12
  v_cvt_pk_bf16_f32 v13, v13, v13
  v_lshlrev_b32 v13, 16, v13
  v_cvt_pk_bf16_f32 v14, v14, v14
  v_lshlrev_b32 v14, 16, v14
  v_cvt_pk_bf16_f32 v15, v15, v15
  v_lshlrev_b32 v15, 16, v15
  v_cvt_pk_bf16_f32 v16, v16, v16
  v_lshlrev_b32 v16, 16, v16
  v_cvt_pk_bf16_f32 v17, v17, v17
  v_lshlrev_b32 v17, 16, v17
  v_cvt_pk_bf16_f32 v18, v18, v18
  v_lshlrev_b32 v18, 16, v18
  v_cvt_pk_bf16_f32 v19, v19, v19
  v_lshlrev_b32 v19, 16, v19
  v_mov_b32 v50, 0
  v_mov_b32 v51, 0
  v_mov_b32 v52, 0
  v_mov_b32 v53, 0
  s_waitcnt vmcnt(10)
  v_lshlrev_b32 v56, 16, v20
  v_and_b32 v57, 0xffff0000, v20
  v_lshlrev_b32 v58, 16, v21
  v_and_b32 v59, 0xffff0000, v21
  v_fmac_f32 v50, v10, v56
  v_fmac_f32 v51, v10, v57
  v_fmac_f32 v52, v10, v58
  v_fmac_f32 v53, v10, v59
  s_waitcnt vmcnt(9)
  v_lshlrev_b32 v56, 16, v22
  v_and_b32 v57, 0xffff0000, v22
  v_lshlrev_b32 v58, 16, v23
  v_and_b32 v59, 0xffff0000, v23
  v_fmac_f32 v50, v11, v56
  v_fmac_f32 v51, v11, v57
  v_fmac_f32 v52, v11, v58
  v_fmac_f32 v53, v11, v59
  s_waitcnt vmcnt(8)
  v_lshlrev_b32 v56, 16, v24
  v_and_b32 v57, 0xffff0000, v24
  v_lshlrev_b32 v58, 16, v25
  v_and_b32 v59, 0xffff0000, v25
  v_fmac_f32 v50, v12, v56
  v_fmac_f32 v51, v12, v57
  v_fmac_f32 v52, v12, v58
  v_fmac_f32 v53, v12, v59
  s_waitcnt vmcnt(7)
  v_lshlrev_b32 v56, 16, v26
  v_and_b32 v57, 0xffff0000, v26
  v_lshlrev_b32 v58, 16, v27
  v_and_b32 v59, 0xffff0000, v27
  v_fmac_f32 v50, v13, v56
  v_fmac_f32 v51, v13, v57
  v_fmac_f32 v52, v13, v58
  v_fmac_f32 v53, v13, v59
  s_waitcnt vmcnt(6)
  v_lshlrev_b32 v56, 16, v28
  v_and_b32 v57, 0xffff0000, v28
  v_lshlrev_b32 v58, 16, v29
  v_and_b32 v59, 0xffff0000, v29
  v_fmac_f32 v50, v14, v56
  v_fmac_f32 v51, v14, v57
  v_fmac_f32 v52, v14, v58
  v_fmac_f32 v53, v14, v59
  s_waitcnt vmcnt(5)
  v_lshlrev_b32 v56, 16, v30
  v_and_b32 v57, 0xffff0000, v30
  v_lshlrev_b32 v58, 16, v31
  v_and_b32 v59, 0xffff0000, v31
  v_fmac_f32 v50, v15, v56
  v_fmac_f32 v51, v15, v57
  v_fmac_f32 v52, v15, v58
  v_fmac_f32 v53, v15, v59
  s_waitcnt vmcnt(4)
  v_lshlrev_b32 v56, 16, v32
  v_and_b32 v57, 0xffff0000, v32
  v_lshlrev_b32 v58, 16, v33
  v_and_b32 v59, 0xffff0000, v33
  v_fmac_f32 v50, v16, v56
  v_fmac_f32 v51, v16, v57
  v_fmac_f32 v52, v16, v58
  v_fmac_f32 v53, v16, v59
  s_waitcnt vmcnt(3)
  v_lshlrev_b32 v56, 16, v34
  v_and_b32 v57, 0xffff0000, v34
  v_lshlrev_b32 v58, 16, v35
  v_and_b32 v59, 0xffff0000, v35
  v_fmac_f32 v50, v17, v56
  v_fmac_f32 v51, v17, v57
  v_fmac_f32 v52, v17, v58
  v_fmac_f32 v53, v17, v59
  s_waitcnt vmcnt(2)
  v_lshlrev_b32 v56, 16, v36
  v_and_b32 v57, 0xffff0000, v36
  v_lshlrev_b32 v58, 16, v37
  v_and_b32 v59, 0xffff0000, v37
  v_fmac_f32 v50, v18, v56
  v_fmac_f32 v51, v18, v57
  v_fmac_f32 v52, v18, v58
  v_fmac_f32 v53, v18, v59
  s_waitcnt vmcnt(1)
  v_lshlrev_b32 v56, 16, v38
  v_and_b32 v57, 0xffff0000, v38
  v_lshlrev_b32 v58, 16, v39
  v_and_b32 v59, 0xffff0000, v39
  v_fmac_f32 v50, v19, v56
  v_fmac_f32 v51, v19, v57
  v_fmac_f32 v52, v19, v58
  v_fmac_f32 v53, v19, v59
  v_mov_b32 v60, v50
  s_nop 1
  v_permlane32_swap_b32 v50, v60
  s_nop 0
  v_add_f32 v50, v50, v60
  v_mov_b32 v60, v50
  s_nop 1
  v_permlane16_swap_b32 v50, v60
  s_nop 0
  v_add_f32 v50, v50, v60
  v_mov_b32 v60, v51
  s_nop 1
  v_permlane32_swap_b32 v51, v60
  s_nop 0
  v_add_f32 v51, v51, v60
  v_mov_b32 v60, v51
  s_nop 1
  v_permlane16_swap_b32 v51, v60
  s_nop 0
  v_add_f32 v51, v51, v60
  v_mov_b32 v60, v52
  s_nop 1
  v_permlane32_swap_b32 v52, v60
  s_nop 0
  v_add_f32 v52, v52, v60
  v_mov_b32 v60, v52
  s_nop 1
  v_permlane16_swap_b32 v52, v60
  s_nop 0
  v_add_f32 v52, v52, v60
  v_mov_b32 v60, v53
  s_nop 1
  v_permlane32_swap_b32 v53, v60
  s_nop 0
  v_add_f32 v53, v53, v60
  v_mov_b32 v60, v53
  s_nop 1
  v_permlane16_swap_b32 v53, v60
  s_nop 0
  v_add_f32 v53, v53, v60
  s_lshl_b32 s33, s24, 8
  v_lshlrev_b32 v61, 4, v4
  v_add_u32 v61, s33, v61
  ds_write_b128 v61, v[50:53]
  s_waitcnt lgkmcnt(0)
  s_barrier
  s_cmp_lg_u32 s24, 0
  s_cbranch_scc1 L_end_k0_kernel
  v_lshlrev_b32 v61, 2, v2
  ds_read_b32 v50, v61 offset:0
  ds_read_b32 v51, v61 offset:256
  ds_read_b32 v52, v61 offset:512
  ds_read_b32 v53, v61 offset:768
  s_waitcnt lgkmcnt(0)
  v_add_f32 v50, v50, v51
  v_add_f32 v52, v52, v53
  v_add_f32 v50, v50, v52
  s_mul_i32 s34, s26, 15360
  s_lshl_b32 s35, s25, 8
  s_add_u32 s34, s34, s35
  buffer_store_dword v50, v61, s[20:23], s34 offen
L_end_k0_kernel:
  s_endpgm
.globl k1_kernel
.p2align 8
.type k1_kernel,@function
k1_kernel:
  s_load_dwordx2 s[4:5], s[0:1], 0
  s_load_dwordx2 s[6:7], s[0:1], 24
  s_load_dwordx2 s[8:9], s[0:1], 104
  s_cmp_ge_u32 s2, 256
  s_cbranch_scc1 L_end_k1_kernel
  s_waitcnt lgkmcnt(0)
  s_mov_b32 s12, s4
  s_mov_b32 s13, s5
  s_mov_b32 s14, 0x280000
  s_mov_b32 s15, 0x20000
  s_mov_b32 s16, s8
  s_mov_b32 s17, s9
  s_mov_b32 s18, 0xf000
  s_mov_b32 s19, 0x20000
  s_add_u32 s20, s8, 0x100000
  s_addc_u32 s21, s9, 0
  s_mov_b32 s22, 0x280000
  s_mov_b32 s23, 0x20000
  s_mov_b32 s44, s6
  s_mov_b32 s45, s7
  s_mov_b32 s46, 0x780000
  s_mov_b32 s47, 0x20000
  s_add_u32 s48, s8, 0x10000
  s_addc_u32 s49, s9, 0
  s_mov_b32 s50, 0x3c00
  s_mov_b32 s51, 0x20000
  v_lshrrev_b32 v1, 6, v0
  v_and_b32 v2, 63, v0
  v_readfirstlane_b32 s24, v1
  v_and_b32 v3, 7, v2
  v_bfe_u32 v4, v2, 3, 2
  v_lshrrev_b32 v5, 5, v2
  s_mov_b32 s30, 1280
  v_mul_lo_u32 v6, s30, v3
  v_lshlrev_b32 v7, 5, v5
  v_add_u32 v6, v6, v7
  v_lshlrev_b32 v7, 3, v4
  v_add_u32 v6, v6, v7
  s_mul_i32 s25, s2, 10240
  s_mul_i32 s26, s24, 320
  s_add_u32 s25, s25, s26
  buffer_load_dwordx2 v[100:101], v6, s[12:15], s25 offen offset:0
  buffer_load_dwordx2 v[102:103], v6, s[12:15], s25 offen offset:64
  buffer_load_dwordx2 v[104:105], v6, s[12:15], s25 offen offset:128
  buffer_load_dwordx2 v[106:107], v6, s[12:15], s25 offen offset:192
  buffer_load_dwordx2 v[108:109], v6, s[12:15], s25 offen offset:256
  v_min_u32 v7, 39, v2
  v_lshlrev_b32 v7, 4, v7
  s_mul_i32 s27, s24, 640
  s_add_u32 s28, s27, 2560
  s_mov_b32 s33, s27
  buffer_load_dwordx4 v[64:67], v7, s[16:19], s27 offen
  s_add_u32 s27, s27, 15360
  buffer_load_dwordx4 v[68:71], v7, s[16:19], s27 offen
  s_add_u32 s27, s27, 15360
  buffer_load_dwordx4 v[72:75], v7, s[16:19], s27 offen
  s_add_u32 s27, s27, 15360
  buffer_load_dwordx4 v[76:79], v7, s[16:19], s27 offen
  buffer_load_dwordx4 v[80:83], v7, s[16:19], s28 offen
  s_add_u32 s28, s28, 15360
  buffer_load_dwordx4 v[84:87], v7, s[16:19], s28 offen
  s_add_u32 s28, s28, 15360
  buffer_load_dwordx4 v[88:91], v7, s[16:19], s28 offen
  s_add_u32 s28, s28, 15360
  buffer_load_dwordx4 v[92:95], v7, s[16:19], s28 offen
  s_getpc_b64 s[56:57]
L_cp_k1:
  s_add_u32 s56, s56, k2_kernel-L_cp_k1
  s_addc_u32 s57, s57, 0
  s_lshr_b32 s58, s2, 3
  s_mul_i32 s58, s58, 3072
  v_and_b32 v121, 63, v0
  v_min_u32 v121, 23, v121
  v_lshlrev_b32 v121, 7, v121
  v_add_u32 v121, s58, v121
  s_mov_b32 s59, L_code_end-k2_kernel-4
  v_min_u32 v121, s59, v121
  global_load_dword v122, v121, s[56:57]
  s_lshl_b32 s34, s2, 2
  s_add_u32 s34, s34, s24
  s_mul_i32 s34, s34, 3840
  s_add_u32 s34, s34, 3932160
  v_lshlrev_b32 v13, 7, v2
  v_cmp_gt_u32 vcc, 30, v2
  v_mov_b32 v14, 0x7ff00000
  s_nop 0
  v_cndmask_b32 v13, v14, v13, vcc
  buffer_load_dword v124, v13, s[44:47], s34 offen
  s_mul_i32 s29, s24, 1280
  v_add_u32 v8, s29, v7
  s_waitcnt vmcnt(6)
  v_add_f32 v64, v64, v68
  v_add_f32 v72, v72, v76
  v_add_f32 v65, v65, v69
  v_add_f32 v73, v73, v77
  v_add_f32 v66, v66, v70
  v_add_f32 v74, v74, v78
  v_add_f32 v67, v67, v71
  v_add_f32 v75, v75, v79
  v_add_f32 v64, v64, v72
  v_add_f32 v65, v65, v73
  v_add_f32 v66, v66, v74
  v_add_f32 v67, v67, v75
  v_cvt_pk_bf16_f32 v64, v64, v64
  v_lshlrev_b32 v64, 16, v64
  v_cvt_pk_bf16_f32 v65, v65, v65
  v_lshlrev_b32 v65, 16, v65
  v_cvt_pk_bf16_f32 v66, v66, v66
  v_lshlrev_b32 v66, 16, v66
  v_cvt_pk_bf16_f32 v67, v67, v67
  v_lshlrev_b32 v67, 16, v67
  ds_write_b128 v8, v[64:67] offset:0
  s_waitcnt vmcnt(2)
  v_add_f32 v80, v80, v84
  v_add_f32 v88, v88, v92
  v_add_f32 v81, v81, v85
  v_add_f32 v89, v89, v93
  v_add_f32 v82, v82, v86
  v_add_f32 v90, v90, v94
  v_add_f32 v83, v83, v87
  v_add_f32 v91, v91, v95
  v_add_f32 v80, v80, v88
  v_add_f32 v81, v81, v89
  v_add_f32 v82, v82, v90
  v_add_f32 v83, v83, v91
  v_cvt_pk_bf16_f32 v80, v80, v80
  v_lshlrev_b32 v80, 16, v80
  v_cvt_pk_bf16_f32 v81, v81, v81
  v_lshlrev_b32 v81, 16, v81
  v_cvt_pk_bf16_f32 v82, v82, v82
  v_lshlrev_b32 v82, 16, v82
  v_cvt_pk_bf16_f32 v83, v83, v83
  v_lshlrev_b32 v83, 16, v83
  v_add_f32 v80, 1.0, v80
  v_add_f32 v81, 1.0, v81
  v_add_f32 v82, 1.0, v82
  v_add_f32 v83, 1.0, v83
  v_cvt_pk_bf16_f32 v80, v80, v80
  v_lshlrev_b32 v80, 16, v80
  v_cvt_pk_bf16_f32 v81, v81, v81
  v_lshlrev_b32 v81, 16, v81
  v_cvt_pk_bf16_f32 v82, v82, v82
  v_lshlrev_b32 v82, 16, v82
  v_cvt_pk_bf16_f32 v83, v83, v83
  v_lshlrev_b32 v83, 16, v83
  ds_write_b128 v8, v[80:83] offset:640
  s_waitcnt vmcnt(10)
  v_lshlrev_b32 v20, 16, v100
  v_and_b32 v21, 0xffff0000, v100
  v_lshlrev_b32 v22, 16, v101
  v_and_b32 v23, 0xffff0000, v101
  v_lshlrev_b32 v24, 16, v102
  v_and_b32 v25, 0xffff0000, v102
  v_lshlrev_b32 v26, 16, v103
  v_and_b32 v27, 0xffff0000, v103
  v_lshlrev_b32 v28, 16, v104
  v_and_b32 v29, 0xffff0000, v104
  v_lshlrev_b32 v30, 16, v105
  v_and_b32 v31, 0xffff0000, v105
  v_lshlrev_b32 v32, 16, v106
  v_and_b32 v33, 0xffff0000, v106
  v_lshlrev_b32 v34, 16, v107
  v_and_b32 v35, 0xffff0000, v107
  v_lshlrev_b32 v36, 16, v108
  v_and_b32 v37, 0xffff0000, v108
  v_lshlrev_b32 v38, 16, v109
  v_and_b32 v39, 0xffff0000, v109
  v_lshlrev_b32 v9, 2, v3
  v_lshlrev_b32 v8, 6, v5
  v_lshlrev_b32 v10, 4, v4
  v_add_u32 v8, v8, v10
  v_add_u32 v8, s29, v8
  s_waitcnt lgkmcnt(0)
  ds_read_b128 v[64:67], v8 offset:0
  ds_read_b128 v[84:87], v8 offset:640
  ds_read_b128 v[68:71], v8 offset:128
  ds_read_b128 v[88:91], v8 offset:768
  ds_read_b128 v[72:75], v8 offset:256
  ds_read_b128 v[92:95], v8 offset:896
  ds_read_b128 v[76:79], v8 offset:384
  ds_read_b128 v[96:99], v8 offset:1024
  ds_read_b128 v[80:83], v8 offset:512
  ds_read_b128 v[100:103], v8 offset:1152
  v_add_f32 v10, v20, v21
  v_add_f32 v12, v22, v23
  v_add_f32 v10, v10, v24
  v_add_f32 v12, v12, v25
  v_add_f32 v10, v10, v26
  v_add_f32 v12, v12, v27
  v_add_f32 v10, v10, v28
  v_add_f32 v12, v12, v29
  v_add_f32 v10, v10, v30
  v_add_f32 v12, v12, v31
  v_add_f32 v10, v10, v32
  v_add_f32 v12, v12, v33
  v_add_f32 v10, v10, v34
  v_add_f32 v12, v12, v35
  v_add_f32 v10, v10, v36
  v_add_f32 v12, v12, v37
  v_add_f32 v10, v10, v38
  v_add_f32 v12, v12, v39
  v_add_f32 v10, v10, v12
  s_nop 1
  v_add_f32_dpp v10, v10, v10 row_ror:8 row_mask:0xf bank_mask:0xf
  v_mov_b32 v12, v10
  s_nop 1
  v_permlane16_swap_b32 v10, v12
  v_add_f32 v10, v10, v12
  v_mov_b32 v12, v10
  s_nop 1
  v_permlane32_swap_b32 v10, v12
  v_add_f32 v10, v10, v12
  s_lshl_b32 s40, s24, 5
  v_add_u32 v13, s40, v9
  ds_write_b32 v13, v10 offset:5120
  s_waitcnt lgkmcnt(0)
  s_barrier
  ds_read_b32 v14, v9 offset:5120
  ds_read_b32 v15, v9 offset:5152
  ds_read_b32 v16, v9 offset:5184
  ds_read_b32 v17, v9 offset:5216
  s_waitcnt lgkmcnt(0)
  v_add_f32 v10, v14, v15
  v_add_f32 v12, v16, v17
  v_add_f32 v10, v10, v12
  s_mov_b32 s41, 0x3acccccd
  v_mul_f32 v10, s41, v10
  v_sub_f32 v20, v20, v10
  v_sub_f32 v21, v21, v10
  v_sub_f32 v22, v22, v10
  v_sub_f32 v23, v23, v10
  v_sub_f32 v24, v24, v10
  v_sub_f32 v25, v25, v10
  v_sub_f32 v26, v26, v10
  v_sub_f32 v27, v27, v10
  v_sub_f32 v28, v28, v10
  v_sub_f32 v29, v29, v10
  v_sub_f32 v30, v30, v10
  v_sub_f32 v31, v31, v10
  v_sub_f32 v32, v32, v10
  v_sub_f32 v33, v33, v10
  v_sub_f32 v34, v34, v10
  v_sub_f32 v35, v35, v10
  v_sub_f32 v36, v36, v10
  v_sub_f32 v37, v37, v10
  v_sub_f32 v38, v38, v10
  v_sub_f32 v39, v39, v10
  v_mul_f32 v11, v20, v20
  v_mul_f32 v12, v21, v21
  v_fmac_f32 v11, v22, v22
  v_fmac_f32 v12, v23, v23
  v_fmac_f32 v11, v24, v24
  v_fmac_f32 v12, v25, v25
  v_fmac_f32 v11, v26, v26
  v_fmac_f32 v12, v27, v27
  v_fmac_f32 v11, v28, v28
  v_fmac_f32 v12, v29, v29
  v_fmac_f32 v11, v30, v30
  v_fmac_f32 v12, v31, v31
  v_fmac_f32 v11, v32, v32
  v_fmac_f32 v12, v33, v33
  v_fmac_f32 v11, v34, v34
  v_fmac_f32 v12, v35, v35
  v_fmac_f32 v11, v36, v36
  v_fmac_f32 v12, v37, v37
  v_fmac_f32 v11, v38, v38
  v_fmac_f32 v12, v39, v39
  v_add_f32 v11, v11, v12
  s_nop 1
  v_add_f32_dpp v11, v11, v11 row_ror:8 row_mask:0xf bank_mask:0xf
  v_mov_b32 v12, v11
  s_nop 1
  v_permlane16_swap_b32 v11, v12
  v_add_f32 v11, v11, v12
  v_mov_b32 v12, v11
  s_nop 1
  v_permlane32_swap_b32 v11, v12
  v_add_f32 v11, v11, v12
  ds_write_b32 v13, v11 offset:5248
  s_waitcnt lgkmcnt(0)
  s_barrier
  ds_read_b32 v14, v9 offset:5248
  ds_read_b32 v15, v9 offset:5280
  ds_read_b32 v16, v9 offset:5312
  ds_read_b32 v17, v9 offset:5344
  s_waitcnt lgkmcnt(0)
  v_add_f32 v11, v14, v15
  v_add_f32 v12, v16, v17
  v_add_f32 v11, v11, v12
  s_mov_b32 s42, 0x3727c5ac
  v_mov_b32 v12, s42
  v_fmac_f32 v12, s41, v11
  v_rsq_f32 v11, v12
  s_nop 0
  s_mov_b32 s43, 0x3dd53b95
  v_mul_f32 v11, s43, v11
  s_lshr_b32 s32, s2, 3
  s_mul_i32 s32, s32, 81920
  s_bfe_u32 s33, s2, 0x20001
  s_lshl_b32 s33, s33, 10
  s_add_u32 s32, s32, s33
  s_mul_i32 s33, s24, 20480
  s_add_u32 s32, s32, s33
  s_and_b32 s33, s2, 1
  s_lshl_b32 s33, s33, 7
  s_add_u32 s32, s32, s33
  v_lshlrev_b32 v12, 8, v4
  v_lshlrev_b32 v13, 4, v3
  v_add_u32 v12, v12, v13
  v_lshlrev_b32 v13, 3, v5
  v_add_u32 v12, v12, v13
  v_mul_f32 v20, v20, v84
  v_mul_f32 v64, s43, v64
  v_fma_f32 v20, v20, v11, v64
  v_mul_f32 v21, v21, v85
  v_mul_f32 v65, s43, v65
  v_fma_f32 v21, v21, v11, v65
  v_mul_f32 v22, v22, v86
  v_mul_f32 v66, s43, v66
  v_fma_f32 v22, v22, v11, v66
  v_mul_f32 v23, v23, v87
  v_mul_f32 v67, s43, v67
  v_fma_f32 v23, v23, v11, v67
  v_cvt_pk_bf16_f32 v110, v20, v21
  v_cvt_pk_bf16_f32 v111, v22, v23
  buffer_store_dwordx2 v[110:111], v12, s[20:23], s32 offen
  s_add_u32 s32, s32, 4096
  v_mul_f32 v24, v24, v88
  v_mul_f32 v68, s43, v68
  v_fma_f32 v24, v24, v11, v68
  v_mul_f32 v25, v25, v89
  v_mul_f32 v69, s43, v69
  v_fma_f32 v25, v25, v11, v69
  v_mul_f32 v26, v26, v90
  v_mul_f32 v70, s43, v70
  v_fma_f32 v26, v26, v11, v70
  v_mul_f32 v27, v27, v91
  v_mul_f32 v71, s43, v71
  v_fma_f32 v27, v27, v11, v71
  v_cvt_pk_bf16_f32 v112, v24, v25
  v_cvt_pk_bf16_f32 v113, v26, v27
  buffer_store_dwordx2 v[112:113], v12, s[20:23], s32 offen
  s_add_u32 s32, s32, 4096
  v_mul_f32 v28, v28, v92
  v_mul_f32 v72, s43, v72
  v_fma_f32 v28, v28, v11, v72
  v_mul_f32 v29, v29, v93
  v_mul_f32 v73, s43, v73
  v_fma_f32 v29, v29, v11, v73
  v_mul_f32 v30, v30, v94
  v_mul_f32 v74, s43, v74
  v_fma_f32 v30, v30, v11, v74
  v_mul_f32 v31, v31, v95
  v_mul_f32 v75, s43, v75
  v_fma_f32 v31, v31, v11, v75
  v_cvt_pk_bf16_f32 v114, v28, v29
  v_cvt_pk_bf16_f32 v115, v30, v31
  buffer_store_dwordx2 v[114:115], v12, s[20:23], s32 offen
  s_add_u32 s32, s32, 4096
  v_mul_f32 v32, v32, v96
  v_mul_f32 v76, s43, v76
  v_fma_f32 v32, v32, v11, v76
  v_mul_f32 v33, v33, v97
  v_mul_f32 v77, s43, v77
  v_fma_f32 v33, v33, v11, v77
  v_mul_f32 v34, v34, v98
  v_mul_f32 v78, s43, v78
  v_fma_f32 v34, v34, v11, v78
  v_mul_f32 v35, v35, v99
  v_mul_f32 v79, s43, v79
  v_fma_f32 v35, v35, v11, v79
  v_cvt_pk_bf16_f32 v116, v32, v33
  v_cvt_pk_bf16_f32 v117, v34, v35
  buffer_store_dwordx2 v[116:117], v12, s[20:23], s32 offen
  s_add_u32 s32, s32, 4096
  v_mul_f32 v36, v36, v100
  v_mul_f32 v80, s43, v80
  v_fma_f32 v36, v36, v11, v80
  v_mul_f32 v37, v37, v101
  v_mul_f32 v81, s43, v81
  v_fma_f32 v37, v37, v11, v81
  v_mul_f32 v38, v38, v102
  v_mul_f32 v82, s43, v82
  v_fma_f32 v38, v38, v11, v82
  v_mul_f32 v39, v39, v103
  v_mul_f32 v83, s43, v83
  v_fma_f32 v39, v39, v11, v83
  v_cvt_pk_bf16_f32 v118, v36, v37
  v_cvt_pk_bf16_f32 v119, v38, v39
  buffer_store_dwordx2 v[118:119], v12, s[20:23], s32 offen
L_end_k1_kernel:
  s_endpgm
.globl k2_kernel
.p2align 8
.type k2_kernel,@function
k2_kernel:
  s_load_dwordx2 s[4:5], s[0:1], 24
  s_load_dwordx2 s[6:7], s[0:1], 8
  s_load_dwordx2 s[40:41], s[0:1], 16
  s_load_dwordx2 s[42:43], s[0:1], 104
  s_cmp_ge_u32 s2, 256
  s_cbranch_scc1 L_end_k2_kernel
  s_waitcnt lgkmcnt(0)
  s_sub_u32 s8, s4, 2048
  s_subb_u32 s9, s5, 0
  s_mov_b32 s10, 0x780800
  s_mov_b32 s11, 0x20000
  s_add_u32 s20, s42, 0x100000
  s_addc_u32 s21, s43, 0
  s_mov_b32 s22, 0x280000
  s_mov_b32 s23, 0x20000
  v_lshrrev_b32 v1, 6, v0
  v_and_b32 v2, 63, v0
  v_readfirstlane_b32 s28, v1
  s_and_b32 s44, s2, 7
  s_lshr_b32 s45, s2, 3
  s_and_b32 s46, s44, 3
  s_lshl_b32 s46, s46, 3
  s_and_b32 s47, s45, 7
  s_add_u32 s29, s46, s47
  s_lshr_b32 s46, s44, 2
  s_lshl_b32 s46, s46, 2
  s_lshr_b32 s47, s45, 3
  s_add_u32 s30, s46, s47
  s_mul_i32 s31, s28, 3072
  v_lshlrev_b32 v208, 4, v2
  s_mov_b32 s48, 43691
  v_add_u32 v230, 0, v2
  v_mul_lo_u32 v231, s48, v230
  v_lshrrev_b32 v231, 20, v231
  v_mul_u32_u24 v232, 24, v231
  v_sub_u32 v232, v230, v232
  v_and_b32 v233, 6, v231
  v_xor_b32 v233, v232, v233
  v_lshlrev_b32 v233, 4, v233
  s_lshl_b32 s49, s28, 3
  v_add_u32 v231, s49, v231
  s_mov_b32 s50, 12288
  v_mul_lo_u32 v234, s50, v231
  v_add_u32 v234, v234, v233
  v_add_u32 v202, 2048, v234
  s_mov_b32 s50, 384
  v_mul_lo_u32 v234, s50, v231
  v_add_u32 v234, v234, v233
  v_add_u32 v205, 2048, v234
  v_add_u32 v230, 64, v2
  v_mul_lo_u32 v231, s48, v230
  v_lshrrev_b32 v231, 20, v231
  v_mul_u32_u24 v232, 24, v231
  v_sub_u32 v232, v230, v232
  v_and_b32 v233, 6, v231
  v_xor_b32 v233, v232, v233
  v_lshlrev_b32 v233, 4, v233
  s_lshl_b32 s49, s28, 3
  v_add_u32 v231, s49, v231
  s_mov_b32 s50, 12288
  v_mul_lo_u32 v234, s50, v231
  v_add_u32 v234, v234, v233
  v_add_u32 v203, 1024, v234
  s_mov_b32 s50, 384
  v_mul_lo_u32 v234, s50, v231
  v_add_u32 v234, v234, v233
  v_add_u32 v206, 1024, v234
  v_add_u32 v230, 128, v2
  v_mul_lo_u32 v231, s48, v230
  v_lshrrev_b32 v231, 20, v231
  v_mul_u32_u24 v232, 24, v231
  v_sub_u32 v232, v230, v232
  v_and_b32 v233, 6, v231
  v_xor_b32 v233, v232, v233
  v_lshlrev_b32 v233, 4, v233
  s_lshl_b32 s49, s28, 3
  v_add_u32 v231, s49, v231
  s_mov_b32 s50, 12288
  v_mul_lo_u32 v234, s50, v231
  v_add_u32 v234, v234, v233
  v_add_u32 v204, 0, v234
  s_mov_b32 s50, 384
  v_mul_lo_u32 v234, s50, v231
  v_add_u32 v234, v234, v233
  v_add_u32 v207, 0, v234
  s_mul_i32 s32, s29, 384
  s_lshl_b32 s44, s30, 2
  s_add_u32 s44, s44, s28
  s_mul_i32 s35, s44, 81920
  s_add_u32 m0, s31, 0
  s_nop 0
  buffer_load_dwordx4 v202, s[8:11], s32 offen offset:0 lds
  buffer_load_dwordx4 v203, s[8:11], s32 offen offset:1024 lds
  buffer_load_dwordx4 v204, s[8:11], s32 offen offset:2048 lds
  s_add_u32 s32, s32, 393216
  buffer_load_dwordx4 a[0:3], v208, s[20:23], s35 offen offset:0
  buffer_load_dwordx4 a[4:7], v208, s[20:23], s35 offen offset:1024
  buffer_load_dwordx4 a[8:11], v208, s[20:23], s35 offen offset:2048
  buffer_load_dwordx4 a[12:15], v208, s[20:23], s35 offen offset:3072
  s_add_u32 s35, s35, 4096
  s_add_u32 m0, s31, 12288
  s_nop 0
  buffer_load_dwordx4 v202, s[8:11], s32 offen offset:0 lds
  buffer_load_dwordx4 v203, s[8:11], s32 offen offset:1024 lds
  buffer_load_dwordx4 v204, s[8:11], s32 offen offset:2048 lds
  s_add_u32 s32, s32, 393216
  buffer_load_dwordx4 a[16:19], v208, s[20:23], s35 offen offset:0
  buffer_load_dwordx4 a[20:23], v208, s[20:23], s35 offen offset:1024
  buffer_load_dwordx4 a[24:27], v208, s[20:23], s35 offen offset:2048
  buffer_load_dwordx4 a[28:31], v208, s[20:23], s35 offen offset:3072
  s_add_u32 s35, s35, 4096
  s_and_b32 s100, s2, 7
  s_lshr_b32 s101, s2, 3
  s_add_u32 s96, s42, 0x20000
  s_addc_u32 s97, s43, 0
  s_mov_b32 s98, 0x3000
  s_mov_b32 s99, 0x20000
  s_getreg_b32 s94, hwreg(HW_REG_XCC_ID)
  s_and_b32 s94, s94, 15
  s_add_u32 s94, s94, 1
  s_lshl_b32 s93, s100, 7
  s_lshl_b32 s92, s101, 2
  s_add_u32 s93, s93, s92
  s_add_u32 s93, s93, 6144
  v_mov_b32 v1, s94
  v_mov_b32 v2, s93
  v_cmp_eq_u32 vcc, 0, v0
  s_and_saveexec_b64 s[92:93], vcc
  s_cbranch_execz L_xs_c
  buffer_store_dword v1, v2, s[96:99], 0 offen sc1
L_xs_c:
  s_mov_b64 exec, s[92:93]
  s_sub_u32 s12, s6, 2048
  s_subb_u32 s13, s7, 0
  s_mov_b32 s14, 0x1800800
  s_mov_b32 s15, 0x20000
  s_sub_u32 s16, s40, 2048
  s_subb_u32 s17, s41, 0
  s_mov_b32 s18, 0x1800800
  s_mov_b32 s19, 0x20000
  s_add_u32 s24, s42, 0x400000
  s_addc_u32 s25, s43, 0
  s_mov_b32 s26, 0x1800000
  s_mov_b32 s27, 0x20000
  v_lshrrev_b32 v2, 4, v208
  v_lshrrev_b32 v230, 4, v2
  v_bfe_u32 v231, v2, 2, 2
  v_and_b32 v232, 3, v2
  v_lshlrev_b32 v233, 2, v230
  v_add_u32 v233, v233, v231
  s_mov_b32 s50, 384
  v_mul_lo_u32 v234, s50, v233
  v_and_b32 v235, 6, v233
  v_lshrrev_b32 v236, 1, v232
  v_lshlrev_b32 v236, 4, v236
  v_add_u32 v234, v234, v236
  v_and_b32 v236, 1, v232
  v_lshlrev_b32 v236, 3, v236
  v_add_u32 v234, v234, v236
  v_xor_b32 v236, 0, v235
  v_lshlrev_b32 v236, 4, v236
  v_add_u32 v192, v234, v236
  v_add_u32 v196, 49152, v192
  v_xor_b32 v236, 2, v235
  v_lshlrev_b32 v236, 4, v236
  v_add_u32 v193, v234, v236
  v_add_u32 v197, 49152, v193
  v_xor_b32 v236, 4, v235
  v_lshlrev_b32 v236, 4, v236
  v_add_u32 v194, v234, v236
  v_add_u32 v198, 49152, v194
  v_xor_b32 v236, 6, v235
  v_lshlrev_b32 v236, 4, v236
  v_add_u32 v195, v234, v236
  v_add_u32 v199, 49152, v195
  v_and_b32 v231, 15, v2
  v_mul_lo_u32 v234, s50, v231
  v_and_b32 v235, 6, v231
  v_add_u32 v236, 0, v230
  v_xor_b32 v236, v236, v235
  v_lshlrev_b32 v236, 4, v236
  v_add_u32 v236, v236, v234
  v_add_u32 v200, 98304, v236
  v_add_u32 v236, 4, v230
  v_xor_b32 v236, v236, v235
  v_lshlrev_b32 v236, 4, v236
  v_add_u32 v236, v236, v234
  v_add_u32 v201, 98304, v236
  s_mov_b32 s37, 0
  s_mul_i32 s33, s29, 786432
  s_add_u32 s33, s33, 589824
  s_mov_b32 s34, s33
  s_load_dwordx2 s[44:45], s[0:1], 32
  s_load_dwordx2 s[46:47], s[0:1], 64
  s_load_dwordx2 s[48:49], s[0:1], 48
  s_load_dwordx2 s[50:51], s[0:1], 56
  s_waitcnt lgkmcnt(0)
  s_mov_b32 s64, s44
  s_mov_b32 s65, s45
  s_lshl_b32 s94, s2, 2
  s_add_u32 s94, s94, s28
  s_mov_b32 s52, s46
  s_mov_b32 s53, s47
  s_mov_b32 s54, 0x1e0000
  s_mov_b32 s55, 0x20000
  s_add_u32 s56, s42, 0x5400000
  s_addc_u32 s57, s43, 0
  s_mov_b32 s58, 0x1e0000
  s_mov_b32 s59, 0x20000
  s_lshl_b32 s89, s94, 11
  s_lshl_b32 s95, s94, 1
  s_add_u32 s95, s95, 0
  s_mul_i32 s96, s95, 13108
  s_lshr_b32 s96, s96, 16
  s_mul_i32 s97, s96, 5
  s_sub_u32 s97, s95, s97
  s_lshl_b32 s97, s97, 6
  s_mul_i32 s98, s96, 1366
  s_lshr_b32 s98, s98, 16
  s_mul_i32 s99, s98, 48
  s_sub_u32 s99, s96, s99
  s_mul_i32 s99, s99, 40960
  s_mul_i32 s98, s98, 160
  s_add_u32 s99, s99, s98
  s_mov_b32 s95, 52429
  s_mov_b32 s96, 1280
  v_lshrrev_b32 v212, 4, v208
  v_add_u32 v212, s97, v212
  v_mul_lo_u32 v213, s95, v212
  v_lshrrev_b32 v213, 19, v213
  v_mul_u32_u24 v214, 10, v213
  v_sub_u32 v214, v212, v214
  v_lshlrev_b32 v214, 4, v214
  v_mul_lo_u32 v213, s96, v213
  v_add_u32 v213, v213, v214
  v_add_u32 v209, s99, v213
  s_lshl_b32 s95, s94, 1
  s_add_u32 s95, s95, 1
  s_mul_i32 s96, s95, 13108
  s_lshr_b32 s96, s96, 16
  s_mul_i32 s97, s96, 5
  s_sub_u32 s97, s95, s97
  s_lshl_b32 s97, s97, 6
  s_mul_i32 s98, s96, 1366
  s_lshr_b32 s98, s98, 16
  s_mul_i32 s99, s98, 48
  s_sub_u32 s99, s96, s99
  s_mul_i32 s99, s99, 40960
  s_mul_i32 s98, s98, 160
  s_add_u32 s99, s99, s98
  s_mov_b32 s95, 52429
  s_mov_b32 s96, 1280
  v_lshrrev_b32 v212, 4, v208
  v_add_u32 v212, s97, v212
  v_mul_lo_u32 v213, s95, v212
  v_lshrrev_b32 v213, 19, v213
  v_mul_u32_u24 v214, 10, v213
  v_sub_u32 v214, v212, v214
  v_lshlrev_b32 v214, 4, v214
  v_mul_lo_u32 v213, s96, v213
  v_add_u32 v213, v213, v214
  v_add_u32 v210, s99, v213
  s_mov_b32 s88, 0
  s_cmp_lt_u32 s94, 640
  s_cselect_b32 s60, s44, s48
  s_cselect_b32 s61, s45, s49
  s_mov_b32 s95, 0x1e0000
  s_cselect_b32 s62, 0x780000, s95
  s_cselect_b32 s96, 0, 640
  s_cmp_lt_u32 s94, 800
  s_cselect_b32 s60, s60, s50
  s_cselect_b32 s61, s61, s51
  s_cselect_b32 s96, s96, 800
  s_mov_b32 s63, 0x20000
  s_sub_u32 s96, s94, s96
  s_mul_i32 s90, s96, 12288
  s_add_u32 s91, s31, 147456
  v_lshlrev_b32 v220, 3, v208
  s_getpc_b64 s[84:85]
L_cp_k2:
  s_add_u32 s84, s84, L_k2_epi-L_cp_k2
  s_addc_u32 s85, s85, 0
  s_lshr_b32 s86, s2, 3
  s_mul_i32 s86, s86, 2048
  v_lshrrev_b32 v221, 4, v208
  v_min_u32 v221, 15, v221
  v_lshlrev_b32 v221, 7, v221
  v_add_u32 v221, s86, v221
  s_mov_b32 s86, L_code_end-L_k2_epi-4
  v_min_u32 v221, s86, v221
  s_cmp_ge_u32 s2, 6
  s_cbranch_scc1 L_k2_nomodf
  s_add_u32 s96, s42, 0x0
  s_addc_u32 s97, s43, 0
  s_mov_b32 s98, 0xf000
  s_mov_b32 s99, 0x20000
  v_lshrrev_b32 v224, 4, v208
  v_min_u32 v224, 39, v224
  v_lshlrev_b32 v224, 4, v224
  s_mul_i32 s95, s2, 2560
  s_mul_i32 s94, s28, 640
  s_add_u32 s95, s95, s94
  s_mov_b32 s94, s95
  buffer_load_dwordx4 v[228:231], v224, s[96:99], s95 offen
  s_add_u32 s95, s95, 15360
  buffer_load_dwordx4 v[232:235], v224, s[96:99], s95 offen
  s_add_u32 s95, s95, 15360
  buffer_load_dwordx4 v[236:239], v224, s[96:99], s95 offen
  s_add_u32 s95, s95, 15360
  buffer_load_dwordx4 v[240:243], v224, s[96:99], s95 offen
  s_waitcnt vmcnt(0)
  v_add_f32 v228, v228, v232
  v_add_f32 v236, v236, v240
  v_add_f32 v229, v229, v233
  v_add_f32 v237, v237, v241
  v_add_f32 v230, v230, v234
  v_add_f32 v238, v238, v242
  v_add_f32 v231, v231, v235
  v_add_f32 v239, v239, v243
  v_add_f32 v228, v228, v236
  v_add_f32 v229, v229, v237
  v_add_f32 v230, v230, v238
  v_add_f32 v231, v231, v239
  v_cvt_pk_bf16_f32 v228, v228, v228
  v_lshlrev_b32 v228, 16, v228
  v_cvt_pk_bf16_f32 v229, v229, v229
  v_lshlrev_b32 v229, 16, v229
  v_cvt_pk_bf16_f32 v230, v230, v230
  v_lshlrev_b32 v230, 16, v230
  v_cvt_pk_bf16_f32 v231, v231, v231
  v_lshlrev_b32 v231, 16, v231
  v_add_f32 v232, 1.0, v228
  v_add_f32 v233, 1.0, v229
  v_add_f32 v234, 1.0, v230
  v_add_f32 v235, 1.0, v231
  v_cvt_pk_bf16_f32 v232, v232, v232
  v_lshlrev_b32 v232, 16, v232
  v_cvt_pk_bf16_f32 v233, v233, v233
  v_lshlrev_b32 v233, 16, v233
  v_cvt_pk_bf16_f32 v234, v234, v234
  v_lshlrev_b32 v234, 16, v234
  v_cvt_pk_bf16_f32 v235, v235, v235
  v_lshlrev_b32 v235, 16, v235
  s_cmp_eq_u32 s2, 1
  s_cselect_b32 s95, 1, 0
  s_cmp_eq_u32 s2, 4
  s_cselect_b32 s95, 1, s95
  s_cmp_eq_u32 s95, 1
  s_cselect_b64 vcc, -1, 0
  s_nop 1
  v_cndmask_b32 v228, v228, v232, vcc
  v_cndmask_b32 v229, v229, v233, vcc
  v_cndmask_b32 v230, v230, v234, vcc
  v_cndmask_b32 v231, v231, v235, vcc
  s_add_u32 s96, s42, 0x10000
  s_addc_u32 s97, s43, 0
  s_mov_b32 s98, 0x3c00
  s_mov_b32 s99, 0x20000
  v_lshrrev_b32 v236, 4, v208
  v_cmp_gt_u32 vcc, 40, v236
  s_mov_b32 s93, s94
  v_lshrrev_b32 v236, 4, v208
  v_cmp_gt_u32 vcc, 40, v236
  s_and_saveexec_b64 s[94:95], vcc
  buffer_store_dwordx4 v[228:231], v224, s[96:99], s93 offen sc1
  s_mov_b64 exec, s[94:95]
  s_waitcnt vmcnt(0)
L_k2_nomodf:
  s_waitcnt vmcnt(7)
  s_barrier
  ds_read_b64_tr_b16 a[192:193], v192 offset:0
  ds_read_b64_tr_b16 a[194:195], v192 offset:6144
  ds_read_b64_tr_b16 a[196:197], v193 offset:0
  ds_read_b64_tr_b16 a[198:199], v193 offset:6144
  ds_read_b64_tr_b16 a[200:201], v194 offset:0
  ds_read_b64_tr_b16 a[202:203], v194 offset:6144
  ds_read_b64_tr_b16 a[204:205], v195 offset:0
  ds_read_b64_tr_b16 a[206:207], v195 offset:6144
  ds_read_b64_tr_b16 a[208:209], v192 offset:128
  ds_read_b64_tr_b16 a[210:211], v192 offset:6272
  s_waitcnt vmcnt(4)
  s_barrier
  s_waitcnt lgkmcnt(8)
  v_mfma_f32_16x16x32_bf16 v[0:3], a[192:195], a[0:3], 0
  ds_read_b64_tr_b16 a[212:213], v193 offset:128
  ds_read_b64_tr_b16 a[214:215], v193 offset:6272
  v_mfma_f32_16x16x32_bf16 v[4:7], a[192:195], a[4:7], 0
  s_add_u32 m0, s31, 24576
  v_mfma_f32_16x16x32_bf16 v[8:11], a[192:195], a[8:11], 0
  buffer_load_dwordx4 v202, s[8:11], s32 offen offset:0 lds
  v_mfma_f32_16x16x32_bf16 v[12:15], a[192:195], a[12:15], 0
  s_waitcnt lgkmcnt(8)
  v_mfma_f32_16x16x32_bf16 v[16:19], a[196:199], a[0:3], 0
  ds_read_b64_tr_b16 a[216:217], v194 offset:128
  ds_read_b64_tr_b16 a[218:219], v194 offset:6272
  v_mfma_f32_16x16x32_bf16 v[20:23], a[196:199], a[4:7], 0
  v_mfma_f32_16x16x32_bf16 v[24:27], a[196:199], a[8:11], 0
  buffer_load_dwordx4 v203, s[8:11], s32 offen offset:1024 lds
  v_mfma_f32_16x16x32_bf16 v[28:31], a[196:199], a[12:15], 0
  s_waitcnt lgkmcnt(8)
  v_mfma_f32_16x16x32_bf16 v[32:35], a[200:203], a[0:3], 0
  ds_read_b64_tr_b16 a[220:221], v195 offset:128
  ds_read_b64_tr_b16 a[222:223], v195 offset:6272
  v_mfma_f32_16x16x32_bf16 v[36:39], a[200:203], a[4:7], 0
  v_mfma_f32_16x16x32_bf16 v[40:43], a[200:203], a[8:11], 0
  buffer_load_dwordx4 v204, s[8:11], s32 offen offset:2048 lds
  v_mfma_f32_16x16x32_bf16 v[44:47], a[200:203], a[12:15], 0
  s_waitcnt lgkmcnt(8)
  v_mfma_f32_16x16x32_bf16 v[48:51], a[204:207], a[0:3], 0
  s_add_u32 s32, s32, 393216
  ds_read_b64_tr_b16 a[192:193], v192 offset:256
  ds_read_b64_tr_b16 a[194:195], v192 offset:6400
  v_mfma_f32_16x16x32_bf16 v[52:55], a[204:207], a[4:7], 0
  v_mfma_f32_16x16x32_bf16 v[56:59], a[204:207], a[8:11], 0
  buffer_load_dwordx4 a[32:35], v208, s[20:23], s35 offen offset:0
  v_mfma_f32_16x16x32_bf16 v[60:63], a[204:207], a[12:15], 0
  s_waitcnt lgkmcnt(8)
  v_mfma_f32_16x16x32_bf16 v[64:67], a[208:211], a[0:3], 0
  ds_read_b64_tr_b16 a[196:197], v193 offset:256
  ds_read_b64_tr_b16 a[198:199], v193 offset:6400
  v_mfma_f32_16x16x32_bf16 v[68:71], a[208:211], a[4:7], 0
  v_mfma_f32_16x16x32_bf16 v[72:75], a[208:211], a[8:11], 0
  buffer_load_dwordx4 a[36:39], v208, s[20:23], s35 offen offset:1024
  v_mfma_f32_16x16x32_bf16 v[76:79], a[208:211], a[12:15], 0
  s_waitcnt lgkmcnt(8)
  v_mfma_f32_16x16x32_bf16 v[80:83], a[212:215], a[0:3], 0
  ds_read_b64_tr_b16 a[200:201], v194 offset:256
  ds_read_b64_tr_b16 a[202:203], v194 offset:6400
  v_mfma_f32_16x16x32_bf16 v[84:87], a[212:215], a[4:7], 0
  v_mfma_f32_16x16x32_bf16 v[88:91], a[212:215], a[8:11], 0
  buffer_load_dwordx4 a[40:43], v208, s[20:23], s35 offen offset:2048
  v_mfma_f32_16x16x32_bf16 v[92:95], a[212:215], a[12:15], 0
  s_waitcnt lgkmcnt(8)
  v_mfma_f32_16x16x32_bf16 v[96:99], a[216:219], a[0:3], 0
  ds_read_b64_tr_b16 a[204:205], v195 offset:256
  ds_read_b64_tr_b16 a[206:207], v195 offset:6400
  v_mfma_f32_16x16x32_bf16 v[100:103], a[216:219], a[4:7], 0
  v_mfma_f32_16x16x32_bf16 v[104:107], a[216:219], a[8:11], 0
  buffer_load_dwordx4 a[44:47], v208, s[20:23], s35 offen offset:3072
  v_mfma_f32_16x16x32_bf16 v[108:111], a[216:219], a[12:15], 0
  s_waitcnt lgkmcnt(8)
  v_mfma_f32_16x16x32_bf16 v[112:115], a[220:223], a[0:3], 0
  s_add_u32 s35, s35, 4096
  ds_read_b64_tr_b16 a[208:209], v192 offset:12288
  ds_read_b64_tr_b16 a[210:211], v192 offset:18432
  v_mfma_f32_16x16x32_bf16 v[116:119], a[220:223], a[4:7], 0
  s_add_u32 m0, s31, 36864
  v_mfma_f32_16x16x32_bf16 v[120:123], a[220:223], a[8:11], 0
  buffer_load_dwordx4 v202, s[8:11], s32 offen offset:0 lds
  v_mfma_f32_16x16x32_bf16 v[124:127], a[220:223], a[12:15], 0
  s_waitcnt lgkmcnt(8)
  v_mfma_f32_16x16x32_bf16 v[128:131], a[192:195], a[0:3], 0
  ds_read_b64_tr_b16 a[212:213], v193 offset:12288
  ds_read_b64_tr_b16 a[214:215], v193 offset:18432
  v_mfma_f32_16x16x32_bf16 v[132:135], a[192:195], a[4:7], 0
  v_mfma_f32_16x16x32_bf16 v[136:139], a[192:195], a[8:11], 0
  buffer_load_dwordx4 v203, s[8:11], s32 offen offset:1024 lds
  v_mfma_f32_16x16x32_bf16 v[140:143], a[192:195], a[12:15], 0
  s_waitcnt lgkmcnt(8)
  v_mfma_f32_16x16x32_bf16 v[144:147], a[196:199], a[0:3], 0
  ds_read_b64_tr_b16 a[216:217], v194 offset:12288
  ds_read_b64_tr_b16 a[218:219], v194 offset:18432
  v_mfma_f32_16x16x32_bf16 v[148:151], a[196:199], a[4:7], 0
  v_mfma_f32_16x16x32_bf16 v[152:155], a[196:199], a[8:11], 0
  buffer_load_dwordx4 v204, s[8:11], s32 offen offset:2048 lds
  v_mfma_f32_16x16x32_bf16 v[156:159], a[196:199], a[12:15], 0
  s_waitcnt lgkmcnt(8)
  v_mfma_f32_16x16x32_bf16 v[160:163], a[200:203], a[0:3], 0
  s_add_u32 s32, s32, 393216
  ds_read_b64_tr_b16 a[220:221], v195 offset:12288
  ds_read_b64_tr_b16 a[222:223], v195 offset:18432
  v_mfma_f32_16x16x32_bf16 v[164:167], a[200:203], a[4:7], 0
  v_mfma_f32_16x16x32_bf16 v[168:171], a[200:203], a[8:11], 0
  v_mfma_f32_16x16x32_bf16 v[172:175], a[200:203], a[12:15], 0
  s_waitcnt lgkmcnt(8)
  v_mfma_f32_16x16x32_bf16 v[176:179], a[204:207], a[0:3], 0
  ds_read_b64_tr_b16 a[192:193], v192 offset:12416
  ds_read_b64_tr_b16 a[194:195], v192 offset:18560
  v_mfma_f32_16x16x32_bf16 v[180:183], a[204:207], a[4:7], 0
  v_mfma_f32_16x16x32_bf16 v[184:187], a[204:207], a[8:11], 0
  v_mfma_f32_16x16x32_bf16 v[188:191], a[204:207], a[12:15], 0
  s_waitcnt vmcnt(7)
  s_barrier
  s_waitcnt lgkmcnt(8)
  v_mfma_f32_16x16x32_bf16 v[0:3], a[208:211], a[16:19], v[0:3]
  ds_read_b64_tr_b16 a[196:197], v193 offset:12416
  ds_read_b64_tr_b16 a[198:199], v193 offset:18560
  v_mfma_f32_16x16x32_bf16 v[4:7], a[208:211], a[20:23], v[4:7]
  buffer_load_dwordx4 a[48:51], v208, s[20:23], s35 offen offset:0
  v_mfma_f32_16x16x32_bf16 v[8:11], a[208:211], a[24:27], v[8:11]
  v_mfma_f32_16x16x32_bf16 v[12:15], a[208:211], a[28:31], v[12:15]
  s_waitcnt lgkmcnt(8)
  v_mfma_f32_16x16x32_bf16 v[16:19], a[212:215], a[16:19], v[16:19]
  ds_read_b64_tr_b16 a[200:201], v194 offset:12416
  ds_read_b64_tr_b16 a[202:203], v194 offset:18560
  v_mfma_f32_16x16x32_bf16 v[20:23], a[212:215], a[20:23], v[20:23]
  buffer_load_dwordx4 a[52:55], v208, s[20:23], s35 offen offset:1024
  v_mfma_f32_16x16x32_bf16 v[24:27], a[212:215], a[24:27], v[24:27]
  v_mfma_f32_16x16x32_bf16 v[28:31], a[212:215], a[28:31], v[28:31]
  s_waitcnt lgkmcnt(8)
  v_mfma_f32_16x16x32_bf16 v[32:35], a[216:219], a[16:19], v[32:35]
  ds_read_b64_tr_b16 a[204:205], v195 offset:12416
  ds_read_b64_tr_b16 a[206:207], v195 offset:18560
  v_mfma_f32_16x16x32_bf16 v[36:39], a[216:219], a[20:23], v[36:39]
  buffer_load_dwordx4 a[56:59], v208, s[20:23], s35 offen offset:2048
  v_mfma_f32_16x16x32_bf16 v[40:43], a[216:219], a[24:27], v[40:43]
  v_mfma_f32_16x16x32_bf16 v[44:47], a[216:219], a[28:31], v[44:47]
  s_waitcnt lgkmcnt(8)
  v_mfma_f32_16x16x32_bf16 v[48:51], a[220:223], a[16:19], v[48:51]
  ds_read_b64_tr_b16 a[208:209], v192 offset:12544
  ds_read_b64_tr_b16 a[210:211], v192 offset:18688
  v_mfma_f32_16x16x32_bf16 v[52:55], a[220:223], a[20:23], v[52:55]
  buffer_load_dwordx4 a[60:63], v208, s[20:23], s35 offen offset:3072
  v_mfma_f32_16x16x32_bf16 v[56:59], a[220:223], a[24:27], v[56:59]
  s_add_u32 s35, s35, 4096
  v_mfma_f32_16x16x32_bf16 v[60:63], a[220:223], a[28:31], v[60:63]
  s_waitcnt lgkmcnt(8)
  v_mfma_f32_16x16x32_bf16 v[64:67], a[192:195], a[16:19], v[64:67]
  s_add_u32 m0, s31, 49152
  ds_read_b64_tr_b16 a[212:213], v193 offset:12544
  ds_read_b64_tr_b16 a[214:215], v193 offset:18688
  v_mfma_f32_16x16x32_bf16 v[68:71], a[192:195], a[20:23], v[68:71]
  buffer_load_dwordx4 v202, s[8:11], s32 offen offset:0 lds
  v_mfma_f32_16x16x32_bf16 v[72:75], a[192:195], a[24:27], v[72:75]
  v_mfma_f32_16x16x32_bf16 v[76:79], a[192:195], a[28:31], v[76:79]
  s_waitcnt lgkmcnt(8)
  v_mfma_f32_16x16x32_bf16 v[80:83], a[196:199], a[16:19], v[80:83]
  ds_read_b64_tr_b16 a[216:217], v194 offset:12544
  ds_read_b64_tr_b16 a[218:219], v194 offset:18688
  v_mfma_f32_16x16x32_bf16 v[84:87], a[196:199], a[20:23], v[84:87]
  buffer_load_dwordx4 v203, s[8:11], s32 offen offset:1024 lds
  v_mfma_f32_16x16x32_bf16 v[88:91], a[196:199], a[24:27], v[88:91]
  v_mfma_f32_16x16x32_bf16 v[92:95], a[196:199], a[28:31], v[92:95]
  s_waitcnt lgkmcnt(8)
  v_mfma_f32_16x16x32_bf16 v[96:99], a[200:203], a[16:19], v[96:99]
  ds_read_b64_tr_b16 a[220:221], v195 offset:12544
  ds_read_b64_tr_b16 a[222:223], v195 offset:18688
  v_mfma_f32_16x16x32_bf16 v[100:103], a[200:203], a[20:23], v[100:103]
  buffer_load_dwordx4 v204, s[8:11], s32 offen offset:2048 lds
  v_mfma_f32_16x16x32_bf16 v[104:107], a[200:203], a[24:27], v[104:107]
  s_add_u32 s32, s32, 393216
  v_mfma_f32_16x16x32_bf16 v[108:111], a[200:203], a[28:31], v[108:111]
  s_waitcnt lgkmcnt(8)
  v_mfma_f32_16x16x32_bf16 v[112:115], a[204:207], a[16:19], v[112:115]
  ds_read_b64_tr_b16 a[192:193], v192 offset:24576
  ds_read_b64_tr_b16 a[194:195], v192 offset:30720
  v_mfma_f32_16x16x32_bf16 v[116:119], a[204:207], a[20:23], v[116:119]
  buffer_load_dwordx4 a[64:67], v208, s[20:23], s35 offen offset:0
  v_mfma_f32_16x16x32_bf16 v[120:123], a[204:207], a[24:27], v[120:123]
  v_mfma_f32_16x16x32_bf16 v[124:127], a[204:207], a[28:31], v[124:127]
  s_waitcnt lgkmcnt(8)
  v_mfma_f32_16x16x32_bf16 v[128:131], a[208:211], a[16:19], v[128:131]
  ds_read_b64_tr_b16 a[196:197], v193 offset:24576
  ds_read_b64_tr_b16 a[198:199], v193 offset:30720
  v_mfma_f32_16x16x32_bf16 v[132:135], a[208:211], a[20:23], v[132:135]
  buffer_load_dwordx4 a[68:71], v208, s[20:23], s35 offen offset:1024
  v_mfma_f32_16x16x32_bf16 v[136:139], a[208:211], a[24:27], v[136:139]
  v_mfma_f32_16x16x32_bf16 v[140:143], a[208:211], a[28:31], v[140:143]
  s_waitcnt lgkmcnt(8)
  v_mfma_f32_16x16x32_bf16 v[144:147], a[212:215], a[16:19], v[144:147]
  ds_read_b64_tr_b16 a[200:201], v194 offset:24576
  ds_read_b64_tr_b16 a[202:203], v194 offset:30720
  v_mfma_f32_16x16x32_bf16 v[148:151], a[212:215], a[20:23], v[148:151]
  buffer_load_dwordx4 a[72:75], v208, s[20:23], s35 offen offset:2048
  v_mfma_f32_16x16x32_bf16 v[152:155], a[212:215], a[24:27], v[152:155]
  v_mfma_f32_16x16x32_bf16 v[156:159], a[212:215], a[28:31], v[156:159]
  s_waitcnt lgkmcnt(8)
  v_mfma_f32_16x16x32_bf16 v[160:163], a[216:219], a[16:19], v[160:163]
  ds_read_b64_tr_b16 a[204:205], v195 offset:24576
  ds_read_b64_tr_b16 a[206:207], v195 offset:30720
  v_mfma_f32_16x16x32_bf16 v[164:167], a[216:219], a[20:23], v[164:167]
  buffer_load_dwordx4 a[76:79], v208, s[20:23], s35 offen offset:3072
  v_mfma_f32_16x16x32_bf16 v[168:171], a[216:219], a[24:27], v[168:171]
  s_add_u32 s35, s35, 4096
  v_mfma_f32_16x16x32_bf16 v[172:175], a[216:219], a[28:31], v[172:175]
  s_waitcnt lgkmcnt(8)
  v_mfma_f32_16x16x32_bf16 v[176:179], a[220:223], a[16:19], v[176:179]
  ds_read_b64_tr_b16 a[208:209], v192 offset:24704
  ds_read_b64_tr_b16 a[210:211], v192 offset:30848
  v_mfma_f32_16x16x32_bf16 v[180:183], a[220:223], a[20:23], v[180:183]
  v_mfma_f32_16x16x32_bf16 v[184:187], a[220:223], a[24:27], v[184:187]
  v_mfma_f32_16x16x32_bf16 v[188:191], a[220:223], a[28:31], v[188:191]
  s_waitcnt vmcnt(4)
  s_barrier
  s_waitcnt lgkmcnt(8)
  v_mfma_f32_16x16x32_bf16 v[0:3], a[192:195], a[32:35], v[0:3]
  ds_read_b64_tr_b16 a[212:213], v193 offset:24704
  ds_read_b64_tr_b16 a[214:215], v193 offset:30848
  v_mfma_f32_16x16x32_bf16 v[4:7], a[192:195], a[36:39], v[4:7]
  s_add_u32 m0, s31, 61440
  v_accvgpr_write_b32 a96, 0
  v_mfma_f32_16x16x32_bf16 v[8:11], a[192:195], a[40:43], v[8:11]
  buffer_load_dwordx4 v202, s[8:11], s32 offen offset:0 lds
  v_mfma_f32_16x16x32_bf16 v[12:15], a[192:195], a[44:47], v[12:15]
  s_waitcnt lgkmcnt(8)
  v_accvgpr_write_b32 a97, 0
  v_mfma_f32_16x16x32_bf16 v[16:19], a[196:199], a[32:35], v[16:19]
  ds_read_b64_tr_b16 a[216:217], v194 offset:24704
  ds_read_b64_tr_b16 a[218:219], v194 offset:30848
  v_mfma_f32_16x16x32_bf16 v[20:23], a[196:199], a[36:39], v[20:23]
  v_accvgpr_write_b32 a98, 0
  v_mfma_f32_16x16x32_bf16 v[24:27], a[196:199], a[40:43], v[24:27]
  buffer_load_dwordx4 v203, s[8:11], s32 offen offset:1024 lds
  v_mfma_f32_16x16x32_bf16 v[28:31], a[196:199], a[44:47], v[28:31]
  s_waitcnt lgkmcnt(8)
  v_accvgpr_write_b32 a99, 0
  v_mfma_f32_16x16x32_bf16 v[32:35], a[200:203], a[32:35], v[32:35]
  ds_read_b64_tr_b16 a[220:221], v195 offset:24704
  ds_read_b64_tr_b16 a[222:223], v195 offset:30848
  v_mfma_f32_16x16x32_bf16 v[36:39], a[200:203], a[36:39], v[36:39]
  v_accvgpr_write_b32 a100, 0
  v_mfma_f32_16x16x32_bf16 v[40:43], a[200:203], a[40:43], v[40:43]
  buffer_load_dwordx4 v204, s[8:11], s32 offen offset:2048 lds
  v_mfma_f32_16x16x32_bf16 v[44:47], a[200:203], a[44:47], v[44:47]
  s_waitcnt lgkmcnt(8)
  v_accvgpr_write_b32 a101, 0
  v_mfma_f32_16x16x32_bf16 v[48:51], a[204:207], a[32:35], v[48:51]
  s_add_u32 s32, s32, 393216
  ds_read_b64_tr_b16 a[192:193], v192 offset:24832
  ds_read_b64_tr_b16 a[194:195], v192 offset:30976
  v_mfma_f32_16x16x32_bf16 v[52:55], a[204:207], a[36:39], v[52:55]
  v_accvgpr_write_b32 a102, 0
  v_mfma_f32_16x16x32_bf16 v[56:59], a[204:207], a[40:43], v[56:59]
  buffer_load_dwordx4 a[80:83], v208, s[20:23], s35 offen offset:0
  v_mfma_f32_16x16x32_bf16 v[60:63], a[204:207], a[44:47], v[60:63]
  s_waitcnt lgkmcnt(8)
  v_accvgpr_write_b32 a103, 0
  v_mfma_f32_16x16x32_bf16 v[64:67], a[208:211], a[32:35], v[64:67]
  ds_read_b64_tr_b16 a[196:197], v193 offset:24832
  ds_read_b64_tr_b16 a[198:199], v193 offset:30976
  v_mfma_f32_16x16x32_bf16 v[68:71], a[208:211], a[36:39], v[68:71]
  v_accvgpr_write_b32 a104, 0
  v_mfma_f32_16x16x32_bf16 v[72:75], a[208:211], a[40:43], v[72:75]
  buffer_load_dwordx4 a[84:87], v208, s[20:23], s35 offen offset:1024
  v_mfma_f32_16x16x32_bf16 v[76:79], a[208:211], a[44:47], v[76:79]
  s_waitcnt lgkmcnt(8)
  v_accvgpr_write_b32 a105, 0
  v_mfma_f32_16x16x32_bf16 v[80:83], a[212:215], a[32:35], v[80:83]
  ds_read_b64_tr_b16 a[200:201], v194 offset:24832
  ds_read_b64_tr_b16 a[202:203], v194 offset:30976
  v_mfma_f32_16x16x32_bf16 v[84:87], a[212:215], a[36:39], v[84:87]
  v_accvgpr_write_b32 a106, 0
  v_mfma_f32_16x16x32_bf16 v[88:91], a[212:215], a[40:43], v[88:91]
  buffer_load_dwordx4 a[88:91], v208, s[20:23], s35 offen offset:2048
  v_mfma_f32_16x16x32_bf16 v[92:95], a[212:215], a[44:47], v[92:95]
  s_waitcnt lgkmcnt(8)
  v_accvgpr_write_b32 a107, 0
  v_mfma_f32_16x16x32_bf16 v[96:99], a[216:219], a[32:35], v[96:99]
  ds_read_b64_tr_b16 a[204:205], v195 offset:24832
  ds_read_b64_tr_b16 a[206:207], v195 offset:30976
  v_mfma_f32_16x16x32_bf16 v[100:103], a[216:219], a[36:39], v[100:103]
  v_accvgpr_write_b32 a108, 0
  v_mfma_f32_16x16x32_bf16 v[104:107], a[216:219], a[40:43], v[104:107]
  buffer_load_dwordx4 a[92:95], v208, s[20:23], s35 offen offset:3072
  v_mfma_f32_16x16x32_bf16 v[108:111], a[216:219], a[44:47], v[108:111]
  s_waitcnt lgkmcnt(8)
  v_accvgpr_write_b32 a109, 0
  v_mfma_f32_16x16x32_bf16 v[112:115], a[220:223], a[32:35], v[112:115]
  s_add_u32 s35, s35, 4096
  ds_read_b64_tr_b16 a[208:209], v192 offset:36864
  ds_read_b64_tr_b16 a[210:211], v192 offset:43008
  v_mfma_f32_16x16x32_bf16 v[116:119], a[220:223], a[36:39], v[116:119]
  s_add_u32 m0, s31, 73728
  v_accvgpr_write_b32 a110, 0
  v_mfma_f32_16x16x32_bf16 v[120:123], a[220:223], a[40:43], v[120:123]
  buffer_load_dwordx4 v202, s[8:11], s32 offen offset:0 lds
  v_mfma_f32_16x16x32_bf16 v[124:127], a[220:223], a[44:47], v[124:127]
  s_waitcnt lgkmcnt(8)
  v_accvgpr_write_b32 a111, 0
  v_mfma_f32_16x16x32_bf16 v[128:131], a[192:195], a[32:35], v[128:131]
  ds_read_b64_tr_b16 a[212:213], v193 offset:36864
  ds_read_b64_tr_b16 a[214:215], v193 offset:43008
  v_mfma_f32_16x16x32_bf16 v[132:135], a[192:195], a[36:39], v[132:135]
  v_accvgpr_write_b32 a112, 0
  v_mfma_f32_16x16x32_bf16 v[136:139], a[192:195], a[40:43], v[136:139]
  buffer_load_dwordx4 v203, s[8:11], s32 offen offset:1024 lds
  v_mfma_f32_16x16x32_bf16 v[140:143], a[192:195], a[44:47], v[140:143]
  s_waitcnt lgkmcnt(8)
  v_accvgpr_write_b32 a113, 0
  v_mfma_f32_16x16x32_bf16 v[144:147], a[196:199], a[32:35], v[144:147]
  ds_read_b64_tr_b16 a[216:217], v194 offset:36864
  ds_read_b64_tr_b16 a[218:219], v194 offset:43008
  v_mfma_f32_16x16x32_bf16 v[148:151], a[196:199], a[36:39], v[148:151]
  v_accvgpr_write_b32 a114, 0
  v_mfma_f32_16x16x32_bf16 v[152:155], a[196:199], a[40:43], v[152:155]
  buffer_load_dwordx4 v204, s[8:11], s32 offen offset:2048 lds
  v_mfma_f32_16x16x32_bf16 v[156:159], a[196:199], a[44:47], v[156:159]
  s_waitcnt lgkmcnt(8)
  v_accvgpr_write_b32 a115, 0
  v_mfma_f32_16x16x32_bf16 v[160:163], a[200:203], a[32:35], v[160:163]
  s_add_u32 s32, s32, 393216
  ds_read_b64_tr_b16 a[220:221], v195 offset:36864
  ds_read_b64_tr_b16 a[222:223], v195 offset:43008
  v_mfma_f32_16x16x32_bf16 v[164:167], a[200:203], a[36:39], v[164:167]
  v_accvgpr_write_b32 a116, 0
  v_mfma_f32_16x16x32_bf16 v[168:171], a[200:203], a[40:43], v[168:171]
  v_mfma_f32_16x16x32_bf16 v[172:175], a[200:203], a[44:47], v[172:175]
  s_waitcnt lgkmcnt(8)
  v_accvgpr_write_b32 a117, 0
  v_mfma_f32_16x16x32_bf16 v[176:179], a[204:207], a[32:35], v[176:179]
  ds_read_b64_tr_b16 a[192:193], v192 offset:36992
  ds_read_b64_tr_b16 a[194:195], v192 offset:43136
  v_mfma_f32_16x16x32_bf16 v[180:183], a[204:207], a[36:39], v[180:183]
  v_accvgpr_write_b32 a118, 0
  v_mfma_f32_16x16x32_bf16 v[184:187], a[204:207], a[40:43], v[184:187]
  s_waitcnt vmcnt(17)
  v_mfma_f32_16x16x32_bf16 v[188:191], a[204:207], a[44:47], v[188:191]
  s_waitcnt lgkmcnt(8)
  v_accvgpr_write_b32 a119, 0
  v_mfma_f32_16x16x32_bf16 v[0:3], a[208:211], a[48:51], v[0:3]
  ds_read_b64_tr_b16 a[196:197], v193 offset:36992
  ds_read_b64_tr_b16 a[198:199], v193 offset:43136
  v_mfma_f32_16x16x32_bf16 v[4:7], a[208:211], a[52:55], v[4:7]
  buffer_load_dwordx4 a[0:3], v208, s[20:23], s35 offen offset:0
  v_accvgpr_write_b32 a120, 0
  v_mfma_f32_16x16x32_bf16 v[8:11], a[208:211], a[56:59], v[8:11]
  v_mfma_f32_16x16x32_bf16 v[12:15], a[208:211], a[60:63], v[12:15]
  s_waitcnt lgkmcnt(8)
  v_accvgpr_write_b32 a121, 0
  v_mfma_f32_16x16x32_bf16 v[16:19], a[212:215], a[48:51], v[16:19]
  ds_read_b64_tr_b16 a[200:201], v194 offset:36992
  ds_read_b64_tr_b16 a[202:203], v194 offset:43136
  v_mfma_f32_16x16x32_bf16 v[20:23], a[212:215], a[52:55], v[20:23]
  buffer_load_dwordx4 a[4:7], v208, s[20:23], s35 offen offset:1024
  v_accvgpr_write_b32 a122, 0
  v_mfma_f32_16x16x32_bf16 v[24:27], a[212:215], a[56:59], v[24:27]
  v_mfma_f32_16x16x32_bf16 v[28:31], a[212:215], a[60:63], v[28:31]
  s_waitcnt lgkmcnt(8)
  v_accvgpr_write_b32 a123, 0
  v_mfma_f32_16x16x32_bf16 v[32:35], a[216:219], a[48:51], v[32:35]
  ds_read_b64_tr_b16 a[204:205], v195 offset:36992
  ds_read_b64_tr_b16 a[206:207], v195 offset:43136
  v_mfma_f32_16x16x32_bf16 v[36:39], a[216:219], a[52:55], v[36:39]
  buffer_load_dwordx4 a[8:11], v208, s[20:23], s35 offen offset:2048
  v_accvgpr_write_b32 a124, 0
  v_mfma_f32_16x16x32_bf16 v[40:43], a[216:219], a[56:59], v[40:43]
  v_mfma_f32_16x16x32_bf16 v[44:47], a[216:219], a[60:63], v[44:47]
  s_waitcnt lgkmcnt(8)
  v_accvgpr_write_b32 a125, 0
  v_mfma_f32_16x16x32_bf16 v[48:51], a[220:223], a[48:51], v[48:51]
  ds_read_b64_tr_b16 a[208:209], v192 offset:37120
  ds_read_b64_tr_b16 a[210:211], v192 offset:43264
  v_mfma_f32_16x16x32_bf16 v[52:55], a[220:223], a[52:55], v[52:55]
  buffer_load_dwordx4 a[12:15], v208, s[20:23], s35 offen offset:3072
  v_accvgpr_write_b32 a126, 0
  v_mfma_f32_16x16x32_bf16 v[56:59], a[220:223], a[56:59], v[56:59]
  s_add_u32 s35, s35, 4096
  v_mfma_f32_16x16x32_bf16 v[60:63], a[220:223], a[60:63], v[60:63]
  s_waitcnt lgkmcnt(8)
  v_accvgpr_write_b32 a127, 0
  v_mfma_f32_16x16x32_bf16 v[64:67], a[192:195], a[48:51], v[64:67]
  s_add_u32 m0, s31, 86016
  ds_read_b64_tr_b16 a[212:213], v193 offset:37120
  ds_read_b64_tr_b16 a[214:215], v193 offset:43264
  v_mfma_f32_16x16x32_bf16 v[68:71], a[192:195], a[52:55], v[68:71]
  buffer_load_dwordx4 v202, s[8:11], s32 offen offset:0 lds
  v_accvgpr_write_b32 a128, 0
  v_mfma_f32_16x16x32_bf16 v[72:75], a[192:195], a[56:59], v[72:75]
  v_mfma_f32_16x16x32_bf16 v[76:79], a[192:195], a[60:63], v[76:79]
  s_waitcnt lgkmcnt(8)
  v_accvgpr_write_b32 a129, 0
  v_mfma_f32_16x16x32_bf16 v[80:83], a[196:199], a[48:51], v[80:83]
  ds_read_b64_tr_b16 a[216:217], v194 offset:37120
  ds_read_b64_tr_b16 a[218:219], v194 offset:43264
  v_mfma_f32_16x16x32_bf16 v[84:87], a[196:199], a[52:55], v[84:87]
  buffer_load_dwordx4 v203, s[8:11], s32 offen offset:1024 lds
  v_accvgpr_write_b32 a130, 0
  v_mfma_f32_16x16x32_bf16 v[88:91], a[196:199], a[56:59], v[88:91]
  v_mfma_f32_16x16x32_bf16 v[92:95], a[196:199], a[60:63], v[92:95]
  s_waitcnt lgkmcnt(8)
  v_accvgpr_write_b32 a131, 0
  v_mfma_f32_16x16x32_bf16 v[96:99], a[200:203], a[48:51], v[96:99]
  ds_read_b64_tr_b16 a[220:221], v195 offset:37120
  ds_read_b64_tr_b16 a[222:223], v195 offset:43264
  v_mfma_f32_16x16x32_bf16 v[100:103], a[200:203], a[52:55], v[100:103]
  buffer_load_dwordx4 v204, s[8:11], s32 offen offset:2048 lds
  v_accvgpr_write_b32 a132, 0
  v_mfma_f32_16x16x32_bf16 v[104:107], a[200:203], a[56:59], v[104:107]
  s_add_u32 s32, s32, 393216
  v_mfma_f32_16x16x32_bf16 v[108:111], a[200:203], a[60:63], v[108:111]
  s_waitcnt lgkmcnt(8)
  v_accvgpr_write_b32 a133, 0
  v_mfma_f32_16x16x32_bf16 v[112:115], a[204:207], a[48:51], v[112:115]
  ds_read_b64_tr_b16 a[192:193], v196 offset:0
  ds_read_b64_tr_b16 a[194:195], v196 offset:6144
  v_mfma_f32_16x16x32_bf16 v[116:119], a[204:207], a[52:55], v[116:119]
  buffer_load_dwordx4 a[16:19], v208, s[20:23], s35 offen offset:0
  v_accvgpr_write_b32 a134, 0
  v_mfma_f32_16x16x32_bf16 v[120:123], a[204:207], a[56:59], v[120:123]
  v_mfma_f32_16x16x32_bf16 v[124:127], a[204:207], a[60:63], v[124:127]
  s_waitcnt lgkmcnt(8)
  v_accvgpr_write_b32 a135, 0
  v_mfma_f32_16x16x32_bf16 v[128:131], a[208:211], a[48:51], v[128:131]
  ds_read_b64_tr_b16 a[196:197], v197 offset:0
  ds_read_b64_tr_b16 a[198:199], v197 offset:6144
  v_mfma_f32_16x16x32_bf16 v[132:135], a[208:211], a[52:55], v[132:135]
  buffer_load_dwordx4 a[20:23], v208, s[20:23], s35 offen offset:1024
  v_accvgpr_write_b32 a136, 0
  v_mfma_f32_16x16x32_bf16 v[136:139], a[208:211], a[56:59], v[136:139]
  v_mfma_f32_16x16x32_bf16 v[140:143], a[208:211], a[60:63], v[140:143]
  s_waitcnt lgkmcnt(8)
  v_accvgpr_write_b32 a137, 0
  v_mfma_f32_16x16x32_bf16 v[144:147], a[212:215], a[48:51], v[144:147]
  ds_read_b64_tr_b16 a[200:201], v198 offset:0
  ds_read_b64_tr_b16 a[202:203], v198 offset:6144
  v_mfma_f32_16x16x32_bf16 v[148:151], a[212:215], a[52:55], v[148:151]
  buffer_load_dwordx4 a[24:27], v208, s[20:23], s35 offen offset:2048
  v_accvgpr_write_b32 a138, 0
  v_mfma_f32_16x16x32_bf16 v[152:155], a[212:215], a[56:59], v[152:155]
  v_mfma_f32_16x16x32_bf16 v[156:159], a[212:215], a[60:63], v[156:159]
  s_waitcnt lgkmcnt(8)
  v_accvgpr_write_b32 a139, 0
  v_mfma_f32_16x16x32_bf16 v[160:163], a[216:219], a[48:51], v[160:163]
  ds_read_b64_tr_b16 a[204:205], v199 offset:0
  ds_read_b64_tr_b16 a[206:207], v199 offset:6144
  v_mfma_f32_16x16x32_bf16 v[164:167], a[216:219], a[52:55], v[164:167]
  buffer_load_dwordx4 a[28:31], v208, s[20:23], s35 offen offset:3072
  v_accvgpr_write_b32 a140, 0
  v_mfma_f32_16x16x32_bf16 v[168:171], a[216:219], a[56:59], v[168:171]
  s_add_u32 s35, s35, 4096
  v_mfma_f32_16x16x32_bf16 v[172:175], a[216:219], a[60:63], v[172:175]
  s_waitcnt lgkmcnt(8)
  v_accvgpr_write_b32 a141, 0
  v_mfma_f32_16x16x32_bf16 v[176:179], a[220:223], a[48:51], v[176:179]
  ds_read_b64_tr_b16 a[208:209], v196 offset:128
  ds_read_b64_tr_b16 a[210:211], v196 offset:6272
  v_mfma_f32_16x16x32_bf16 v[180:183], a[220:223], a[52:55], v[180:183]
  s_waitcnt vmcnt(11)
  v_accvgpr_write_b32 a142, 0
  v_mfma_f32_16x16x32_bf16 v[184:187], a[220:223], a[56:59], v[184:187]
  s_barrier
  v_mfma_f32_16x16x32_bf16 v[188:191], a[220:223], a[60:63], v[188:191]
  s_waitcnt lgkmcnt(8)
  v_accvgpr_write_b32 a143, 0
  v_mfma_f32_16x16x32_bf16 v[0:3], a[192:195], a[64:67], v[0:3]
  ds_read_b64_tr_b16 a[212:213], v197 offset:128
  ds_read_b64_tr_b16 a[214:215], v197 offset:6272
  v_mfma_f32_16x16x32_bf16 v[4:7], a[192:195], a[68:71], v[4:7]
  s_add_u32 m0, s31, 0
  v_accvgpr_write_b32 a144, 0
  v_mfma_f32_16x16x32_bf16 v[8:11], a[192:195], a[72:75], v[8:11]
  buffer_load_dwordx4 v202, s[8:11], s32 offen offset:0 lds
  v_mfma_f32_16x16x32_bf16 v[12:15], a[192:195], a[76:79], v[12:15]
  s_waitcnt lgkmcnt(8)
  v_accvgpr_write_b32 a145, 0
  v_mfma_f32_16x16x32_bf16 v[16:19], a[196:199], a[64:67], v[16:19]
  ds_read_b64_tr_b16 a[216:217], v198 offset:128
  ds_read_b64_tr_b16 a[218:219], v198 offset:6272
  v_mfma_f32_16x16x32_bf16 v[20:23], a[196:199], a[68:71], v[20:23]
  v_accvgpr_write_b32 a146, 0
  v_mfma_f32_16x16x32_bf16 v[24:27], a[196:199], a[72:75], v[24:27]
  buffer_load_dwordx4 v203, s[8:11], s32 offen offset:1024 lds
  v_mfma_f32_16x16x32_bf16 v[28:31], a[196:199], a[76:79], v[28:31]
  s_waitcnt lgkmcnt(8)
  v_accvgpr_write_b32 a147, 0
  v_mfma_f32_16x16x32_bf16 v[32:35], a[200:203], a[64:67], v[32:35]
  ds_read_b64_tr_b16 a[220:221], v199 offset:128
  ds_read_b64_tr_b16 a[222:223], v199 offset:6272
  v_mfma_f32_16x16x32_bf16 v[36:39], a[200:203], a[68:71], v[36:39]
  v_accvgpr_write_b32 a148, 0
  v_mfma_f32_16x16x32_bf16 v[40:43], a[200:203], a[72:75], v[40:43]
  buffer_load_dwordx4 v204, s[8:11], s32 offen offset:2048 lds
  v_mfma_f32_16x16x32_bf16 v[44:47], a[200:203], a[76:79], v[44:47]
  s_waitcnt lgkmcnt(8)
  v_accvgpr_write_b32 a149, 0
  v_mfma_f32_16x16x32_bf16 v[48:51], a[204:207], a[64:67], v[48:51]
  s_add_u32 s32, s32, 393216
  ds_read_b64_tr_b16 a[192:193], v196 offset:256
  ds_read_b64_tr_b16 a[194:195], v196 offset:6400
  v_mfma_f32_16x16x32_bf16 v[52:55], a[204:207], a[68:71], v[52:55]
  v_accvgpr_write_b32 a150, 0
  v_mfma_f32_16x16x32_bf16 v[56:59], a[204:207], a[72:75], v[56:59]
  buffer_load_dwordx4 a[32:35], v208, s[20:23], s35 offen offset:0
  v_mfma_f32_16x16x32_bf16 v[60:63], a[204:207], a[76:79], v[60:63]
  s_waitcnt lgkmcnt(8)
  v_accvgpr_write_b32 a151, 0
  v_mfma_f32_16x16x32_bf16 v[64:67], a[208:211], a[64:67], v[64:67]
  ds_read_b64_tr_b16 a[196:197], v197 offset:256
  ds_read_b64_tr_b16 a[198:199], v197 offset:6400
  v_mfma_f32_16x16x32_bf16 v[68:71], a[208:211], a[68:71], v[68:71]
  v_accvgpr_write_b32 a152, 0
  v_mfma_f32_16x16x32_bf16 v[72:75], a[208:211], a[72:75], v[72:75]
  buffer_load_dwordx4 a[36:39], v208, s[20:23], s35 offen offset:1024
  v_mfma_f32_16x16x32_bf16 v[76:79], a[208:211], a[76:79], v[76:79]
  s_waitcnt lgkmcnt(8)
  v_accvgpr_write_b32 a153, 0
  v_mfma_f32_16x16x32_bf16 v[80:83], a[212:215], a[64:67], v[80:83]
  ds_read_b64_tr_b16 a[200:201], v198 offset:256
  ds_read_b64_tr_b16 a[202:203], v198 offset:6400
  v_mfma_f32_16x16x32_bf16 v[84:87], a[212:215], a[68:71], v[84:87]
  v_accvgpr_write_b32 a154, 0
  v_mfma_f32_16x16x32_bf16 v[88:91], a[212:215], a[72:75], v[88:91]
  buffer_load_dwordx4 a[40:43], v208, s[20:23], s35 offen offset:2048
  v_mfma_f32_16x16x32_bf16 v[92:95], a[212:215], a[76:79], v[92:95]
  s_waitcnt lgkmcnt(8)
  v_accvgpr_write_b32 a155, 0
  v_mfma_f32_16x16x32_bf16 v[96:99], a[216:219], a[64:67], v[96:99]
  ds_read_b64_tr_b16 a[204:205], v199 offset:256
  ds_read_b64_tr_b16 a[206:207], v199 offset:6400
  v_mfma_f32_16x16x32_bf16 v[100:103], a[216:219], a[68:71], v[100:103]
  v_accvgpr_write_b32 a156, 0
  v_mfma_f32_16x16x32_bf16 v[104:107], a[216:219], a[72:75], v[104:107]
  buffer_load_dwordx4 a[44:47], v208, s[20:23], s35 offen offset:3072
  v_mfma_f32_16x16x32_bf16 v[108:111], a[216:219], a[76:79], v[108:111]
  s_waitcnt lgkmcnt(8)
  v_accvgpr_write_b32 a157, 0
  v_mfma_f32_16x16x32_bf16 v[112:115], a[220:223], a[64:67], v[112:115]
  s_add_u32 s35, s35, 4096
  ds_read_b64_tr_b16 a[208:209], v196 offset:12288
  ds_read_b64_tr_b16 a[210:211], v196 offset:18432
  v_mfma_f32_16x16x32_bf16 v[116:119], a[220:223], a[68:71], v[116:119]
  s_add_u32 m0, s31, 12288
  v_accvgpr_write_b32 a158, 0
  v_mfma_f32_16x16x32_bf16 v[120:123], a[220:223], a[72:75], v[120:123]
  buffer_load_dwordx4 v202, s[8:11], s32 offen offset:0 lds
  v_mfma_f32_16x16x32_bf16 v[124:127], a[220:223], a[76:79], v[124:127]
  s_waitcnt lgkmcnt(8)
  v_accvgpr_write_b32 a159, 0
  v_mfma_f32_16x16x32_bf16 v[128:131], a[192:195], a[64:67], v[128:131]
  ds_read_b64_tr_b16 a[212:213], v197 offset:12288
  ds_read_b64_tr_b16 a[214:215], v197 offset:18432
  v_mfma_f32_16x16x32_bf16 v[132:135], a[192:195], a[68:71], v[132:135]
  v_accvgpr_write_b32 a160, 0
  v_mfma_f32_16x16x32_bf16 v[136:139], a[192:195], a[72:75], v[136:139]
  buffer_load_dwordx4 v203, s[8:11], s32 offen offset:1024 lds
  v_mfma_f32_16x16x32_bf16 v[140:143], a[192:195], a[76:79], v[140:143]
  s_waitcnt lgkmcnt(8)
  v_accvgpr_write_b32 a161, 0
  v_mfma_f32_16x16x32_bf16 v[144:147], a[196:199], a[64:67], v[144:147]
  ds_read_b64_tr_b16 a[216:217], v198 offset:12288
  ds_read_b64_tr_b16 a[218:219], v198 offset:18432
  v_mfma_f32_16x16x32_bf16 v[148:151], a[196:199], a[68:71], v[148:151]
  v_accvgpr_write_b32 a162, 0
  v_mfma_f32_16x16x32_bf16 v[152:155], a[196:199], a[72:75], v[152:155]
  buffer_load_dwordx4 v204, s[8:11], s32 offen offset:2048 lds
  v_mfma_f32_16x16x32_bf16 v[156:159], a[196:199], a[76:79], v[156:159]
  s_waitcnt lgkmcnt(8)
  v_accvgpr_write_b32 a163, 0
  v_mfma_f32_16x16x32_bf16 v[160:163], a[200:203], a[64:67], v[160:163]
  s_add_u32 s32, s32, 393216
  ds_read_b64_tr_b16 a[220:221], v199 offset:12288
  ds_read_b64_tr_b16 a[222:223], v199 offset:18432
  v_mfma_f32_16x16x32_bf16 v[164:167], a[200:203], a[68:71], v[164:167]
  v_accvgpr_write_b32 a164, 0
  v_mfma_f32_16x16x32_bf16 v[168:171], a[200:203], a[72:75], v[168:171]
  v_mfma_f32_16x16x32_bf16 v[172:175], a[200:203], a[76:79], v[172:175]
  s_waitcnt lgkmcnt(8)
  v_accvgpr_write_b32 a165, 0
  v_mfma_f32_16x16x32_bf16 v[176:179], a[204:207], a[64:67], v[176:179]
  ds_read_b64_tr_b16 a[192:193], v196 offset:12416
  ds_read_b64_tr_b16 a[194:195], v196 offset:18560
  v_mfma_f32_16x16x32_bf16 v[180:183], a[204:207], a[68:71], v[180:183]
  v_accvgpr_write_b32 a166, 0
  v_mfma_f32_16x16x32_bf16 v[184:187], a[204:207], a[72:75], v[184:187]
  s_waitcnt vmcnt(24)
  v_mfma_f32_16x16x32_bf16 v[188:191], a[204:207], a[76:79], v[188:191]
  s_waitcnt lgkmcnt(8)
  v_accvgpr_write_b32 a167, 0
  v_mfma_f32_16x16x32_bf16 v[0:3], a[208:211], a[80:83], v[0:3]
  ds_read_b64_tr_b16 a[196:197], v197 offset:12416
  ds_read_b64_tr_b16 a[198:199], v197 offset:18560
  v_mfma_f32_16x16x32_bf16 v[4:7], a[208:211], a[84:87], v[4:7]
  buffer_load_dwordx4 a[48:51], v208, s[20:23], s35 offen offset:0
  v_accvgpr_write_b32 a168, 0
  v_mfma_f32_16x16x32_bf16 v[8:11], a[208:211], a[88:91], v[8:11]
  v_mfma_f32_16x16x32_bf16 v[12:15], a[208:211], a[92:95], v[12:15]
  s_waitcnt lgkmcnt(8)
  v_accvgpr_write_b32 a169, 0
  v_mfma_f32_16x16x32_bf16 v[16:19], a[212:215], a[80:83], v[16:19]
  ds_read_b64_tr_b16 a[200:201], v198 offset:12416
  ds_read_b64_tr_b16 a[202:203], v198 offset:18560
  v_mfma_f32_16x16x32_bf16 v[20:23], a[212:215], a[84:87], v[20:23]
  buffer_load_dwordx4 a[52:55], v208, s[20:23], s35 offen offset:1024
  v_accvgpr_write_b32 a170, 0
  v_mfma_f32_16x16x32_bf16 v[24:27], a[212:215], a[88:91], v[24:27]
  v_mfma_f32_16x16x32_bf16 v[28:31], a[212:215], a[92:95], v[28:31]
  s_waitcnt lgkmcnt(8)
  v_accvgpr_write_b32 a171, 0
  v_mfma_f32_16x16x32_bf16 v[32:35], a[216:219], a[80:83], v[32:35]
  ds_read_b64_tr_b16 a[204:205], v199 offset:12416
  ds_read_b64_tr_b16 a[206:207], v199 offset:18560
  v_mfma_f32_16x16x32_bf16 v[36:39], a[216:219], a[84:87], v[36:39]
  buffer_load_dwordx4 a[56:59], v208, s[20:23], s35 offen offset:2048
  v_accvgpr_write_b32 a172, 0
  v_mfma_f32_16x16x32_bf16 v[40:43], a[216:219], a[88:91], v[40:43]
  v_mfma_f32_16x16x32_bf16 v[44:47], a[216:219], a[92:95], v[44:47]
  s_waitcnt lgkmcnt(8)
  v_accvgpr_write_b32 a173, 0
  v_mfma_f32_16x16x32_bf16 v[48:51], a[220:223], a[80:83], v[48:51]
  ds_read_b64_tr_b16 a[208:209], v196 offset:12544
  ds_read_b64_tr_b16 a[210:211], v196 offset:18688
  v_mfma_f32_16x16x32_bf16 v[52:55], a[220:223], a[84:87], v[52:55]
  buffer_load_dwordx4 a[60:63], v208, s[20:23], s35 offen offset:3072
  v_accvgpr_write_b32 a174, 0
  v_mfma_f32_16x16x32_bf16 v[56:59], a[220:223], a[88:91], v[56:59]
  s_add_u32 s35, s35, 4096
  v_mfma_f32_16x16x32_bf16 v[60:63], a[220:223], a[92:95], v[60:63]
  s_waitcnt lgkmcnt(8)
  v_accvgpr_write_b32 a175, 0
  v_mfma_f32_16x16x32_bf16 v[64:67], a[192:195], a[80:83], v[64:67]
  s_add_u32 m0, s31, 24576
  ds_read_b64_tr_b16 a[212:213], v197 offset:12544
  ds_read_b64_tr_b16 a[214:215], v197 offset:18688
  v_mfma_f32_16x16x32_bf16 v[68:71], a[192:195], a[84:87], v[68:71]
  buffer_load_dwordx4 v202, s[8:11], s32 offen offset:0 lds
  v_accvgpr_write_b32 a176, 0
  v_mfma_f32_16x16x32_bf16 v[72:75], a[192:195], a[88:91], v[72:75]
  v_mfma_f32_16x16x32_bf16 v[76:79], a[192:195], a[92:95], v[76:79]
  s_waitcnt lgkmcnt(8)
  v_accvgpr_write_b32 a177, 0
  v_mfma_f32_16x16x32_bf16 v[80:83], a[196:199], a[80:83], v[80:83]
  ds_read_b64_tr_b16 a[216:217], v198 offset:12544
  ds_read_b64_tr_b16 a[218:219], v198 offset:18688
  v_mfma_f32_16x16x32_bf16 v[84:87], a[196:199], a[84:87], v[84:87]
  buffer_load_dwordx4 v203, s[8:11], s32 offen offset:1024 lds
  v_accvgpr_write_b32 a178, 0
  v_mfma_f32_16x16x32_bf16 v[88:91], a[196:199], a[88:91], v[88:91]
  v_mfma_f32_16x16x32_bf16 v[92:95], a[196:199], a[92:95], v[92:95]
  s_waitcnt lgkmcnt(8)
  v_accvgpr_write_b32 a179, 0
  v_mfma_f32_16x16x32_bf16 v[96:99], a[200:203], a[80:83], v[96:99]
  ds_read_b64_tr_b16 a[220:221], v199 offset:12544
  ds_read_b64_tr_b16 a[222:223], v199 offset:18688
  v_mfma_f32_16x16x32_bf16 v[100:103], a[200:203], a[84:87], v[100:103]
  buffer_load_dwordx4 v204, s[8:11], s32 offen offset:2048 lds
  v_accvgpr_write_b32 a180, 0
  v_mfma_f32_16x16x32_bf16 v[104:107], a[200:203], a[88:91], v[104:107]
  s_add_u32 s32, s32, 393216
  v_mfma_f32_16x16x32_bf16 v[108:111], a[200:203], a[92:95], v[108:111]
  s_waitcnt lgkmcnt(8)
  v_accvgpr_write_b32 a181, 0
  v_mfma_f32_16x16x32_bf16 v[112:115], a[204:207], a[80:83], v[112:115]
  ds_read_b64_tr_b16 a[192:193], v196 offset:24576
  ds_read_b64_tr_b16 a[194:195], v196 offset:30720
  v_mfma_f32_16x16x32_bf16 v[116:119], a[204:207], a[84:87], v[116:119]
  buffer_load_dwordx4 a[64:67], v208, s[20:23], s35 offen offset:0
  v_accvgpr_write_b32 a182, 0
  v_mfma_f32_16x16x32_bf16 v[120:123], a[204:207], a[88:91], v[120:123]
  v_mfma_f32_16x16x32_bf16 v[124:127], a[204:207], a[92:95], v[124:127]
  s_waitcnt lgkmcnt(8)
  v_accvgpr_write_b32 a183, 0
  v_mfma_f32_16x16x32_bf16 v[128:131], a[208:211], a[80:83], v[128:131]
  ds_read_b64_tr_b16 a[196:197], v197 offset:24576
  ds_read_b64_tr_b16 a[198:199], v197 offset:30720
  v_mfma_f32_16x16x32_bf16 v[132:135], a[208:211], a[84:87], v[132:135]
  buffer_load_dwordx4 a[68:71], v208, s[20:23], s35 offen offset:1024
  v_accvgpr_write_b32 a184, 0
  v_mfma_f32_16x16x32_bf16 v[136:139], a[208:211], a[88:91], v[136:139]
  v_mfma_f32_16x16x32_bf16 v[140:143], a[208:211], a[92:95], v[140:143]
  s_waitcnt lgkmcnt(8)
  v_accvgpr_write_b32 a185, 0
  v_mfma_f32_16x16x32_bf16 v[144:147], a[212:215], a[80:83], v[144:147]
  ds_read_b64_tr_b16 a[200:201], v198 offset:24576
  ds_read_b64_tr_b16 a[202:203], v198 offset:30720
  v_mfma_f32_16x16x32_bf16 v[148:151], a[212:215], a[84:87], v[148:151]
  buffer_load_dwordx4 a[72:75], v208, s[20:23], s35 offen offset:2048
  v_accvgpr_write_b32 a186, 0
  v_mfma_f32_16x16x32_bf16 v[152:155], a[212:215], a[88:91], v[152:155]
  v_mfma_f32_16x16x32_bf16 v[156:159], a[212:215], a[92:95], v[156:159]
  s_waitcnt lgkmcnt(8)
  v_accvgpr_write_b32 a187, 0
  v_mfma_f32_16x16x32_bf16 v[160:163], a[216:219], a[80:83], v[160:163]
  ds_read_b64_tr_b16 a[204:205], v199 offset:24576
  ds_read_b64_tr_b16 a[206:207], v199 offset:30720
  v_mfma_f32_16x16x32_bf16 v[164:167], a[216:219], a[84:87], v[164:167]
  buffer_load_dwordx4 a[76:79], v208, s[20:23], s35 offen offset:3072
  v_accvgpr_write_b32 a188, 0
  v_mfma_f32_16x16x32_bf16 v[168:171], a[216:219], a[88:91], v[168:171]
  s_add_u32 s35, s35, 4096
  v_mfma_f32_16x16x32_bf16 v[172:175], a[216:219], a[92:95], v[172:175]
  s_waitcnt lgkmcnt(8)
  v_accvgpr_write_b32 a189, 0
  v_mfma_f32_16x16x32_bf16 v[176:179], a[220:223], a[80:83], v[176:179]
  ds_read_b64_tr_b16 a[208:209], v196 offset:24704
  ds_read_b64_tr_b16 a[210:211], v196 offset:30848
  v_mfma_f32_16x16x32_bf16 v[180:183], a[220:223], a[84:87], v[180:183]
  s_waitcnt vmcnt(18)
  v_accvgpr_write_b32 a190, 0
  v_mfma_f32_16x16x32_bf16 v[184:187], a[220:223], a[88:91], v[184:187]
  s_barrier
  v_mfma_f32_16x16x32_bf16 v[188:191], a[220:223], a[92:95], v[188:191]
  s_waitcnt lgkmcnt(8)
  v_accvgpr_write_b32 a191, 0
  v_mfma_f32_16x16x32_bf16 v[0:3], a[192:195], a[0:3], v[0:3]
  ds_read_b64_tr_b16 a[212:213], v197 offset:24704
  ds_read_b64_tr_b16 a[214:215], v197 offset:30848
  v_mfma_f32_16x16x32_bf16 v[4:7], a[192:195], a[4:7], v[4:7]
  s_add_u32 m0, s31, 36864
  v_mfma_f32_16x16x32_bf16 v[8:11], a[192:195], a[8:11], v[8:11]
  buffer_load_dwordx4 v202, s[8:11], s32 offen offset:0 lds
  v_mfma_f32_16x16x32_bf16 v[12:15], a[192:195], a[12:15], v[12:15]
  s_waitcnt lgkmcnt(8)
  v_mfma_f32_16x16x32_bf16 v[16:19], a[196:199], a[0:3], v[16:19]
  ds_read_b64_tr_b16 a[216:217], v198 offset:24704
  ds_read_b64_tr_b16 a[218:219], v198 offset:30848
  v_mfma_f32_16x16x32_bf16 v[20:23], a[196:199], a[4:7], v[20:23]
  v_mfma_f32_16x16x32_bf16 v[24:27], a[196:199], a[8:11], v[24:27]
  buffer_load_dwordx4 v203, s[8:11], s32 offen offset:1024 lds
  v_mfma_f32_16x16x32_bf16 v[28:31], a[196:199], a[12:15], v[28:31]
  s_waitcnt lgkmcnt(8)
  v_mfma_f32_16x16x32_bf16 v[32:35], a[200:203], a[0:3], v[32:35]
  ds_read_b64_tr_b16 a[220:221], v199 offset:24704
  ds_read_b64_tr_b16 a[222:223], v199 offset:30848
  v_mfma_f32_16x16x32_bf16 v[36:39], a[200:203], a[4:7], v[36:39]
  v_mfma_f32_16x16x32_bf16 v[40:43], a[200:203], a[8:11], v[40:43]
  buffer_load_dwordx4 v204, s[8:11], s32 offen offset:2048 lds
  v_mfma_f32_16x16x32_bf16 v[44:47], a[200:203], a[12:15], v[44:47]
  s_waitcnt lgkmcnt(8)
  v_mfma_f32_16x16x32_bf16 v[48:51], a[204:207], a[0:3], v[48:51]
  s_add_u32 s32, s32, 393216
  ds_read_b64_tr_b16 a[192:193], v196 offset:24832
  ds_read_b64_tr_b16 a[194:195], v196 offset:30976
  v_mfma_f32_16x16x32_bf16 v[52:55], a[204:207], a[4:7], v[52:55]
  v_mfma_f32_16x16x32_bf16 v[56:59], a[204:207], a[8:11], v[56:59]
  buffer_load_dwordx4 a[80:83], v208, s[20:23], s35 offen offset:0
  v_mfma_f32_16x16x32_bf16 v[60:63], a[204:207], a[12:15], v[60:63]
  s_waitcnt lgkmcnt(8)
  v_mfma_f32_16x16x32_bf16 v[64:67], a[208:211], a[0:3], v[64:67]
  ds_read_b64_tr_b16 a[196:197], v197 offset:24832
  ds_read_b64_tr_b16 a[198:199], v197 offset:30976
  v_mfma_f32_16x16x32_bf16 v[68:71], a[208:211], a[4:7], v[68:71]
  v_mfma_f32_16x16x32_bf16 v[72:75], a[208:211], a[8:11], v[72:75]
  buffer_load_dwordx4 a[84:87], v208, s[20:23], s35 offen offset:1024
  v_mfma_f32_16x16x32_bf16 v[76:79], a[208:211], a[12:15], v[76:79]
  s_waitcnt lgkmcnt(8)
  v_mfma_f32_16x16x32_bf16 v[80:83], a[212:215], a[0:3], v[80:83]
  ds_read_b64_tr_b16 a[200:201], v198 offset:24832
  ds_read_b64_tr_b16 a[202:203], v198 offset:30976
  v_mfma_f32_16x16x32_bf16 v[84:87], a[212:215], a[4:7], v[84:87]
  v_mfma_f32_16x16x32_bf16 v[88:91], a[212:215], a[8:11], v[88:91]
  buffer_load_dwordx4 a[88:91], v208, s[20:23], s35 offen offset:2048
  v_mfma_f32_16x16x32_bf16 v[92:95], a[212:215], a[12:15], v[92:95]
  s_waitcnt lgkmcnt(8)
  v_mfma_f32_16x16x32_bf16 v[96:99], a[216:219], a[0:3], v[96:99]
  ds_read_b64_tr_b16 a[204:205], v199 offset:24832
  ds_read_b64_tr_b16 a[206:207], v199 offset:30976
  v_mfma_f32_16x16x32_bf16 v[100:103], a[216:219], a[4:7], v[100:103]
  v_mfma_f32_16x16x32_bf16 v[104:107], a[216:219], a[8:11], v[104:107]
  buffer_load_dwordx4 a[92:95], v208, s[20:23], s35 offen offset:3072
  v_mfma_f32_16x16x32_bf16 v[108:111], a[216:219], a[12:15], v[108:111]
  s_waitcnt lgkmcnt(8)
  v_mfma_f32_16x16x32_bf16 v[112:115], a[220:223], a[0:3], v[112:115]
  s_add_u32 s35, s35, 4096
  ds_read_b64_tr_b16 a[208:209], v196 offset:36864
  ds_read_b64_tr_b16 a[210:211], v196 offset:43008
  v_mfma_f32_16x16x32_bf16 v[116:119], a[220:223], a[4:7], v[116:119]
  s_add_u32 m0, s31, 49152
  v_mfma_f32_16x16x32_bf16 v[120:123], a[220:223], a[8:11], v[120:123]
  buffer_load_dwordx4 v202, s[8:11], s32 offen offset:0 lds
  v_mfma_f32_16x16x32_bf16 v[124:127], a[220:223], a[12:15], v[124:127]
  s_waitcnt lgkmcnt(8)
  v_mfma_f32_16x16x32_bf16 v[128:131], a[192:195], a[0:3], v[128:131]
  ds_read_b64_tr_b16 a[212:213], v197 offset:36864
  ds_read_b64_tr_b16 a[214:215], v197 offset:43008
  v_mfma_f32_16x16x32_bf16 v[132:135], a[192:195], a[4:7], v[132:135]
  v_mfma_f32_16x16x32_bf16 v[136:139], a[192:195], a[8:11], v[136:139]
  buffer_load_dwordx4 v203, s[8:11], s32 offen offset:1024 lds
  v_mfma_f32_16x16x32_bf16 v[140:143], a[192:195], a[12:15], v[140:143]
  s_waitcnt lgkmcnt(8)
  v_mfma_f32_16x16x32_bf16 v[144:147], a[196:199], a[0:3], v[144:147]
  ds_read_b64_tr_b16 a[216:217], v198 offset:36864
  ds_read_b64_tr_b16 a[218:219], v198 offset:43008
  v_mfma_f32_16x16x32_bf16 v[148:151], a[196:199], a[4:7], v[148:151]
  v_mfma_f32_16x16x32_bf16 v[152:155], a[196:199], a[8:11], v[152:155]
  buffer_load_dwordx4 v204, s[8:11], s32 offen offset:2048 lds
  v_mfma_f32_16x16x32_bf16 v[156:159], a[196:199], a[12:15], v[156:159]
  s_waitcnt lgkmcnt(8)
  v_mfma_f32_16x16x32_bf16 v[160:163], a[200:203], a[0:3], v[160:163]
  s_add_u32 s32, s32, 393216
  ds_read_b64_tr_b16 a[220:221], v199 offset:36864
  ds_read_b64_tr_b16 a[222:223], v199 offset:43008
  v_mfma_f32_16x16x32_bf16 v[164:167], a[200:203], a[4:7], v[164:167]
  v_mfma_f32_16x16x32_bf16 v[168:171], a[200:203], a[8:11], v[168:171]
  v_mfma_f32_16x16x32_bf16 v[172:175], a[200:203], a[12:15], v[172:175]
  s_waitcnt lgkmcnt(8)
  v_mfma_f32_16x16x32_bf16 v[176:179], a[204:207], a[0:3], v[176:179]
  ds_read_b64_tr_b16 a[192:193], v196 offset:36992
  ds_read_b64_tr_b16 a[194:195], v196 offset:43136
  v_mfma_f32_16x16x32_bf16 v[180:183], a[204:207], a[4:7], v[180:183]
  v_mfma_f32_16x16x32_bf16 v[184:187], a[204:207], a[8:11], v[184:187]
  s_waitcnt vmcnt(31)
  v_mfma_f32_16x16x32_bf16 v[188:191], a[204:207], a[12:15], v[188:191]
  s_waitcnt lgkmcnt(8)
  v_mfma_f32_16x16x32_bf16 v[0:3], a[208:211], a[16:19], v[0:3]
  ds_read_b64_tr_b16 a[196:197], v197 offset:36992
  ds_read_b64_tr_b16 a[198:199], v197 offset:43136
  v_mfma_f32_16x16x32_bf16 v[4:7], a[208:211], a[20:23], v[4:7]
  buffer_load_dwordx4 a[0:3], v208, s[20:23], s35 offen offset:0
  v_mfma_f32_16x16x32_bf16 v[8:11], a[208:211], a[24:27], v[8:11]
  v_mfma_f32_16x16x32_bf16 v[12:15], a[208:211], a[28:31], v[12:15]
  s_waitcnt lgkmcnt(8)
  v_mfma_f32_16x16x32_bf16 v[16:19], a[212:215], a[16:19], v[16:19]
  ds_read_b64_tr_b16 a[200:201], v198 offset:36992
  ds_read_b64_tr_b16 a[202:203], v198 offset:43136
  v_mfma_f32_16x16x32_bf16 v[20:23], a[212:215], a[20:23], v[20:23]
  v_mfma_f32_16x16x32_bf16 v[24:27], a[212:215], a[24:27], v[24:27]
  v_mfma_f32_16x16x32_bf16 v[28:31], a[212:215], a[28:31], v[28:31]
  s_waitcnt lgkmcnt(8)
  buffer_load_dwordx4 a[4:7], v208, s[20:23], s35 offen offset:1024
  v_mfma_f32_16x16x32_bf16 v[32:35], a[216:219], a[16:19], v[32:35]
  ds_read_b64_tr_b16 a[204:205], v199 offset:36992
  ds_read_b64_tr_b16 a[206:207], v199 offset:43136
  v_mfma_f32_16x16x32_bf16 v[36:39], a[216:219], a[20:23], v[36:39]
  v_mfma_f32_16x16x32_bf16 v[40:43], a[216:219], a[24:27], v[40:43]
  v_mfma_f32_16x16x32_bf16 v[44:47], a[216:219], a[28:31], v[44:47]
  s_waitcnt lgkmcnt(8)
  v_mfma_f32_16x16x32_bf16 v[48:51], a[220:223], a[16:19], v[48:51]
  ds_read_b64_tr_b16 a[208:209], v196 offset:37120
  ds_read_b64_tr_b16 a[210:211], v196 offset:43264
  v_mfma_f32_16x16x32_bf16 v[52:55], a[220:223], a[20:23], v[52:55]
  buffer_load_dwordx4 a[8:11], v208, s[20:23], s35 offen offset:2048
  v_mfma_f32_16x16x32_bf16 v[56:59], a[220:223], a[24:27], v[56:59]
  v_mfma_f32_16x16x32_bf16 v[60:63], a[220:223], a[28:31], v[60:63]
  s_waitcnt lgkmcnt(8)
  v_mfma_f32_16x16x32_bf16 v[64:67], a[192:195], a[16:19], v[64:67]
  ds_read_b64_tr_b16 a[212:213], v197 offset:37120
  ds_read_b64_tr_b16 a[214:215], v197 offset:43264
  v_mfma_f32_16x16x32_bf16 v[68:71], a[192:195], a[20:23], v[68:71]
  v_mfma_f32_16x16x32_bf16 v[72:75], a[192:195], a[24:27], v[72:75]
  v_mfma_f32_16x16x32_bf16 v[76:79], a[192:195], a[28:31], v[76:79]
  s_waitcnt lgkmcnt(8)
  buffer_load_dwordx4 a[12:15], v208, s[20:23], s35 offen offset:3072
  v_mfma_f32_16x16x32_bf16 v[80:83], a[196:199], a[16:19], v[80:83]
  s_add_u32 s35, s35, 4096
  ds_read_b64_tr_b16 a[216:217], v198 offset:37120
  ds_read_b64_tr_b16 a[218:219], v198 offset:43264
  v_mfma_f32_16x16x32_bf16 v[84:87], a[196:199], a[20:23], v[84:87]
  s_add_u32 m0, s31, 61440
  v_mfma_f32_16x16x32_bf16 v[88:91], a[196:199], a[24:27], v[88:91]
  v_mfma_f32_16x16x32_bf16 v[92:95], a[196:199], a[28:31], v[92:95]
  s_waitcnt lgkmcnt(8)
  v_mfma_f32_16x16x32_bf16 v[96:99], a[200:203], a[16:19], v[96:99]
  ds_read_b64_tr_b16 a[220:221], v199 offset:37120
  ds_read_b64_tr_b16 a[222:223], v199 offset:43264
  v_mfma_f32_16x16x32_bf16 v[100:103], a[200:203], a[20:23], v[100:103]
  buffer_load_dwordx4 v202, s[8:11], s32 offen offset:0 lds
  v_mfma_f32_16x16x32_bf16 v[104:107], a[200:203], a[24:27], v[104:107]
  v_mfma_f32_16x16x32_bf16 v[108:111], a[200:203], a[28:31], v[108:111]
  s_waitcnt lgkmcnt(8)
  v_mfma_f32_16x16x32_bf16 v[112:115], a[204:207], a[16:19], v[112:115]
  ds_read_b64_tr_b16 a[192:193], v192 offset:0
  ds_read_b64_tr_b16 a[194:195], v192 offset:6144
  v_mfma_f32_16x16x32_bf16 v[116:119], a[204:207], a[20:23], v[116:119]
  v_mfma_f32_16x16x32_bf16 v[120:123], a[204:207], a[24:27], v[120:123]
  v_mfma_f32_16x16x32_bf16 v[124:127], a[204:207], a[28:31], v[124:127]
  s_waitcnt lgkmcnt(8)
  buffer_load_dwordx4 v203, s[8:11], s32 offen offset:1024 lds
  v_mfma_f32_16x16x32_bf16 v[128:131], a[208:211], a[16:19], v[128:131]
  ds_read_b64_tr_b16 a[196:197], v193 offset:0
  ds_read_b64_tr_b16 a[198:199], v193 offset:6144
  v_mfma_f32_16x16x32_bf16 v[132:135], a[208:211], a[20:23], v[132:135]
  v_mfma_f32_16x16x32_bf16 v[136:139], a[208:211], a[24:27], v[136:139]
  v_mfma_f32_16x16x32_bf16 v[140:143], a[208:211], a[28:31], v[140:143]
  s_waitcnt lgkmcnt(8)
  v_mfma_f32_16x16x32_bf16 v[144:147], a[212:215], a[16:19], v[144:147]
  ds_read_b64_tr_b16 a[200:201], v194 offset:0
  ds_read_b64_tr_b16 a[202:203], v194 offset:6144
  v_mfma_f32_16x16x32_bf16 v[148:151], a[212:215], a[20:23], v[148:151]
  buffer_load_dwordx4 v204, s[8:11], s32 offen offset:2048 lds
  v_mfma_f32_16x16x32_bf16 v[152:155], a[212:215], a[24:27], v[152:155]
  s_add_u32 s32, s32, 393216
  v_mfma_f32_16x16x32_bf16 v[156:159], a[212:215], a[28:31], v[156:159]
  s_waitcnt lgkmcnt(8)
  v_mfma_f32_16x16x32_bf16 v[160:163], a[216:219], a[16:19], v[160:163]
  ds_read_b64_tr_b16 a[204:205], v195 offset:0
  ds_read_b64_tr_b16 a[206:207], v195 offset:6144
  v_mfma_f32_16x16x32_bf16 v[164:167], a[216:219], a[20:23], v[164:167]
  v_mfma_f32_16x16x32_bf16 v[168:171], a[216:219], a[24:27], v[168:171]
  v_mfma_f32_16x16x32_bf16 v[172:175], a[216:219], a[28:31], v[172:175]
  s_waitcnt lgkmcnt(8)
  v_mfma_f32_16x16x32_bf16 v[176:179], a[220:223], a[16:19], v[176:179]
  ds_read_b64_tr_b16 a[208:209], v192 offset:128
  ds_read_b64_tr_b16 a[210:211], v192 offset:6272
  v_mfma_f32_16x16x32_bf16 v[180:183], a[220:223], a[20:23], v[180:183]
  s_waitcnt vmcnt(21)
  v_mfma_f32_16x16x32_bf16 v[184:187], a[220:223], a[24:27], v[184:187]
  s_barrier
  v_mfma_f32_16x16x32_bf16 v[188:191], a[220:223], a[28:31], v[188:191]
  s_waitcnt lgkmcnt(8)
  v_mfma_f32_16x16x32_bf16 v[0:3], a[192:195], a[32:35], v[0:3]
  ds_read_b64_tr_b16 a[212:213], v193 offset:128
  ds_read_b64_tr_b16 a[214:215], v193 offset:6272
  v_mfma_f32_16x16x32_bf16 v[4:7], a[192:195], a[36:39], v[4:7]
  buffer_load_dwordx4 a[16:19], v208, s[20:23], s35 offen offset:0
  v_mfma_f32_16x16x32_bf16 v[8:11], a[192:195], a[40:43], v[8:11]
  v_mfma_f32_16x16x32_bf16 v[12:15], a[192:195], a[44:47], v[12:15]
  s_waitcnt lgkmcnt(8)
  v_mfma_f32_16x16x32_bf16 v[16:19], a[196:199], a[32:35], v[16:19]
  ds_read_b64_tr_b16 a[216:217], v194 offset:128
  ds_read_b64_tr_b16 a[218:219], v194 offset:6272
  v_mfma_f32_16x16x32_bf16 v[20:23], a[196:199], a[36:39], v[20:23]
  buffer_load_dwordx4 a[20:23], v208, s[20:23], s35 offen offset:1024
  v_mfma_f32_16x16x32_bf16 v[24:27], a[196:199], a[40:43], v[24:27]
  v_mfma_f32_16x16x32_bf16 v[28:31], a[196:199], a[44:47], v[28:31]
  s_waitcnt lgkmcnt(8)
  v_mfma_f32_16x16x32_bf16 v[32:35], a[200:203], a[32:35], v[32:35]
  ds_read_b64_tr_b16 a[220:221], v195 offset:128
  ds_read_b64_tr_b16 a[222:223], v195 offset:6272
  v_mfma_f32_16x16x32_bf16 v[36:39], a[200:203], a[36:39], v[36:39]
  buffer_load_dwordx4 a[24:27], v208, s[20:23], s35 offen offset:2048
  v_mfma_f32_16x16x32_bf16 v[40:43], a[200:203], a[40:43], v[40:43]
  v_mfma_f32_16x16x32_bf16 v[44:47], a[200:203], a[44:47], v[44:47]
  s_waitcnt lgkmcnt(8)
  v_mfma_f32_16x16x32_bf16 v[48:51], a[204:207], a[32:35], v[48:51]
  ds_read_b64_tr_b16 a[192:193], v192 offset:256
  ds_read_b64_tr_b16 a[194:195], v192 offset:6400
  v_mfma_f32_16x16x32_bf16 v[52:55], a[204:207], a[36:39], v[52:55]
  buffer_load_dwordx4 a[28:31], v208, s[20:23], s35 offen offset:3072
  v_mfma_f32_16x16x32_bf16 v[56:59], a[204:207], a[40:43], v[56:59]
  s_add_u32 s35, s35, 4096
  v_mfma_f32_16x16x32_bf16 v[60:63], a[204:207], a[44:47], v[60:63]
  s_waitcnt lgkmcnt(8)
  v_mfma_f32_16x16x32_bf16 v[64:67], a[208:211], a[32:35], v[64:67]
  s_add_u32 m0, s31, 73728
  ds_read_b64_tr_b16 a[196:197], v193 offset:256
  ds_read_b64_tr_b16 a[198:199], v193 offset:6400
  v_mfma_f32_16x16x32_bf16 v[68:71], a[208:211], a[36:39], v[68:71]
  buffer_load_dwordx4 v202, s[8:11], s32 offen offset:0 lds
  v_mfma_f32_16x16x32_bf16 v[72:75], a[208:211], a[40:43], v[72:75]
  v_mfma_f32_16x16x32_bf16 v[76:79], a[208:211], a[44:47], v[76:79]
  s_waitcnt lgkmcnt(8)
  v_mfma_f32_16x16x32_bf16 v[80:83], a[212:215], a[32:35], v[80:83]
  ds_read_b64_tr_b16 a[200:201], v194 offset:256
  ds_read_b64_tr_b16 a[202:203], v194 offset:6400
  v_mfma_f32_16x16x32_bf16 v[84:87], a[212:215], a[36:39], v[84:87]
  buffer_load_dwordx4 v203, s[8:11], s32 offen offset:1024 lds
  v_mfma_f32_16x16x32_bf16 v[88:91], a[212:215], a[40:43], v[88:91]
  v_mfma_f32_16x16x32_bf16 v[92:95], a[212:215], a[44:47], v[92:95]
  s_waitcnt lgkmcnt(8)
  v_mfma_f32_16x16x32_bf16 v[96:99], a[216:219], a[32:35], v[96:99]
  ds_read_b64_tr_b16 a[204:205], v195 offset:256
  ds_read_b64_tr_b16 a[206:207], v195 offset:6400
  v_mfma_f32_16x16x32_bf16 v[100:103], a[216:219], a[36:39], v[100:103]
  buffer_load_dwordx4 v204, s[8:11], s32 offen offset:2048 lds
  v_mfma_f32_16x16x32_bf16 v[104:107], a[216:219], a[40:43], v[104:107]
  s_add_u32 s32, s32, 393216
  v_mfma_f32_16x16x32_bf16 v[108:111], a[216:219], a[44:47], v[108:111]
  s_waitcnt lgkmcnt(8)
  v_mfma_f32_16x16x32_bf16 v[112:115], a[220:223], a[32:35], v[112:115]
  s_add_u32 m0, s31, 98304
  ds_read_b64_tr_b16 a[208:209], v192 offset:12288
  ds_read_b64_tr_b16 a[210:211], v192 offset:18432
  v_mfma_f32_16x16x32_bf16 v[116:119], a[220:223], a[36:39], v[116:119]
  buffer_load_dwordx4 v205, s[12:15], s33 offen offset:0 lds
  v_mfma_f32_16x16x32_bf16 v[120:123], a[220:223], a[40:43], v[120:123]
  v_mfma_f32_16x16x32_bf16 v[124:127], a[220:223], a[44:47], v[124:127]
  s_waitcnt lgkmcnt(8)
  v_mfma_f32_16x16x32_bf16 v[128:131], a[192:195], a[32:35], v[128:131]
  ds_read_b64_tr_b16 a[212:213], v193 offset:12288
  ds_read_b64_tr_b16 a[214:215], v193 offset:18432
  v_mfma_f32_16x16x32_bf16 v[132:135], a[192:195], a[36:39], v[132:135]
  buffer_load_dwordx4 v206, s[12:15], s33 offen offset:1024 lds
  v_mfma_f32_16x16x32_bf16 v[136:139], a[192:195], a[40:43], v[136:139]
  v_mfma_f32_16x16x32_bf16 v[140:143], a[192:195], a[44:47], v[140:143]
  s_waitcnt lgkmcnt(8)
  v_mfma_f32_16x16x32_bf16 v[144:147], a[196:199], a[32:35], v[144:147]
  ds_read_b64_tr_b16 a[216:217], v194 offset:12288
  ds_read_b64_tr_b16 a[218:219], v194 offset:18432
  v_mfma_f32_16x16x32_bf16 v[148:151], a[196:199], a[36:39], v[148:151]
  buffer_load_dwordx4 v207, s[12:15], s33 offen offset:2048 lds
  v_mfma_f32_16x16x32_bf16 v[152:155], a[196:199], a[40:43], v[152:155]
  s_add_u32 s33, s33, 12288
  v_mfma_f32_16x16x32_bf16 v[156:159], a[196:199], a[44:47], v[156:159]
  s_waitcnt lgkmcnt(8)
  v_mfma_f32_16x16x32_bf16 v[160:163], a[200:203], a[32:35], v[160:163]
  ds_read_b64_tr_b16 a[220:221], v195 offset:12288
  ds_read_b64_tr_b16 a[222:223], v195 offset:18432
  v_mfma_f32_16x16x32_bf16 v[164:167], a[200:203], a[36:39], v[164:167]
  v_mfma_f32_16x16x32_bf16 v[168:171], a[200:203], a[40:43], v[168:171]
  v_mfma_f32_16x16x32_bf16 v[172:175], a[200:203], a[44:47], v[172:175]
  s_waitcnt lgkmcnt(8)
  v_mfma_f32_16x16x32_bf16 v[176:179], a[204:207], a[32:35], v[176:179]
  ds_read_b64_tr_b16 a[192:193], v192 offset:12416
  ds_read_b64_tr_b16 a[194:195], v192 offset:18560
  v_mfma_f32_16x16x32_bf16 v[180:183], a[204:207], a[36:39], v[180:183]
  v_mfma_f32_16x16x32_bf16 v[184:187], a[204:207], a[40:43], v[184:187]
  s_waitcnt vmcnt(34)
  v_mfma_f32_16x16x32_bf16 v[188:191], a[204:207], a[44:47], v[188:191]
  s_waitcnt lgkmcnt(8)
  v_mfma_f32_16x16x32_bf16 v[0:3], a[208:211], a[48:51], v[0:3]
  ds_read_b64_tr_b16 a[196:197], v193 offset:12416
  ds_read_b64_tr_b16 a[198:199], v193 offset:18560
  v_mfma_f32_16x16x32_bf16 v[4:7], a[208:211], a[52:55], v[4:7]
  buffer_load_dwordx4 a[32:35], v208, s[20:23], s35 offen offset:0
  v_mfma_f32_16x16x32_bf16 v[8:11], a[208:211], a[56:59], v[8:11]
  v_mfma_f32_16x16x32_bf16 v[12:15], a[208:211], a[60:63], v[12:15]
  s_waitcnt lgkmcnt(8)
  v_mfma_f32_16x16x32_bf16 v[16:19], a[212:215], a[48:51], v[16:19]
  ds_read_b64_tr_b16 a[200:201], v194 offset:12416
  ds_read_b64_tr_b16 a[202:203], v194 offset:18560
  v_mfma_f32_16x16x32_bf16 v[20:23], a[212:215], a[52:55], v[20:23]
  v_mfma_f32_16x16x32_bf16 v[24:27], a[212:215], a[56:59], v[24:27]
  v_mfma_f32_16x16x32_bf16 v[28:31], a[212:215], a[60:63], v[28:31]
  s_waitcnt lgkmcnt(8)
  buffer_load_dwordx4 a[36:39], v208, s[20:23], s35 offen offset:1024
  v_mfma_f32_16x16x32_bf16 v[32:35], a[216:219], a[48:51], v[32:35]
  ds_read_b64_tr_b16 a[204:205], v195 offset:12416
  ds_read_b64_tr_b16 a[206:207], v195 offset:18560
  v_mfma_f32_16x16x32_bf16 v[36:39], a[216:219], a[52:55], v[36:39]
  v_mfma_f32_16x16x32_bf16 v[40:43], a[216:219], a[56:59], v[40:43]
  v_mfma_f32_16x16x32_bf16 v[44:47], a[216:219], a[60:63], v[44:47]
  s_waitcnt lgkmcnt(8)
  v_mfma_f32_16x16x32_bf16 v[48:51], a[220:223], a[48:51], v[48:51]
  ds_read_b64_tr_b16 a[208:209], v192 offset:12544
  ds_read_b64_tr_b16 a[210:211], v192 offset:18688
  v_mfma_f32_16x16x32_bf16 v[52:55], a[220:223], a[52:55], v[52:55]
  buffer_load_dwordx4 a[40:43], v208, s[20:23], s35 offen offset:2048
  v_mfma_f32_16x16x32_bf16 v[56:59], a[220:223], a[56:59], v[56:59]
  v_mfma_f32_16x16x32_bf16 v[60:63], a[220:223], a[60:63], v[60:63]
  s_waitcnt lgkmcnt(8)
  v_mfma_f32_16x16x32_bf16 v[64:67], a[192:195], a[48:51], v[64:67]
  ds_read_b64_tr_b16 a[212:213], v193 offset:12544
  ds_read_b64_tr_b16 a[214:215], v193 offset:18688
  v_mfma_f32_16x16x32_bf16 v[68:71], a[192:195], a[52:55], v[68:71]
  v_mfma_f32_16x16x32_bf16 v[72:75], a[192:195], a[56:59], v[72:75]
  v_mfma_f32_16x16x32_bf16 v[76:79], a[192:195], a[60:63], v[76:79]
  s_waitcnt lgkmcnt(8)
  buffer_load_dwordx4 a[44:47], v208, s[20:23], s35 offen offset:3072
  v_mfma_f32_16x16x32_bf16 v[80:83], a[196:199], a[48:51], v[80:83]
  s_add_u32 s35, s35, 4096
  ds_read_b64_tr_b16 a[216:217], v194 offset:12544
  ds_read_b64_tr_b16 a[218:219], v194 offset:18688
  v_mfma_f32_16x16x32_bf16 v[84:87], a[196:199], a[52:55], v[84:87]
  s_add_u32 m0, s31, 86016
  v_mfma_f32_16x16x32_bf16 v[88:91], a[196:199], a[56:59], v[88:91]
  v_mfma_f32_16x16x32_bf16 v[92:95], a[196:199], a[60:63], v[92:95]
  s_waitcnt lgkmcnt(8)
  v_mfma_f32_16x16x32_bf16 v[96:99], a[200:203], a[48:51], v[96:99]
  ds_read_b64_tr_b16 a[220:221], v195 offset:12544
  ds_read_b64_tr_b16 a[222:223], v195 offset:18688
  v_mfma_f32_16x16x32_bf16 v[100:103], a[200:203], a[52:55], v[100:103]
  buffer_load_dwordx4 v202, s[8:11], s32 offen offset:0 lds
  v_mfma_f32_16x16x32_bf16 v[104:107], a[200:203], a[56:59], v[104:107]
  v_mfma_f32_16x16x32_bf16 v[108:111], a[200:203], a[60:63], v[108:111]
  s_waitcnt lgkmcnt(8)
  v_mfma_f32_16x16x32_bf16 v[112:115], a[204:207], a[48:51], v[112:115]
  ds_read_b64_tr_b16 a[192:193], v192 offset:24576
  ds_read_b64_tr_b16 a[194:195], v192 offset:30720
  v_mfma_f32_16x16x32_bf16 v[116:119], a[204:207], a[52:55], v[116:119]
  v_mfma_f32_16x16x32_bf16 v[120:123], a[204:207], a[56:59], v[120:123]
  v_mfma_f32_16x16x32_bf16 v[124:127], a[204:207], a[60:63], v[124:127]
  s_waitcnt lgkmcnt(8)
  buffer_load_dwordx4 v203, s[8:11], s32 offen offset:1024 lds
  v_mfma_f32_16x16x32_bf16 v[128:131], a[208:211], a[48:51], v[128:131]
  ds_read_b64_tr_b16 a[196:197], v193 offset:24576
  ds_read_b64_tr_b16 a[198:199], v193 offset:30720
  v_mfma_f32_16x16x32_bf16 v[132:135], a[208:211], a[52:55], v[132:135]
  v_mfma_f32_16x16x32_bf16 v[136:139], a[208:211], a[56:59], v[136:139]
  v_mfma_f32_16x16x32_bf16 v[140:143], a[208:211], a[60:63], v[140:143]
  s_waitcnt lgkmcnt(8)
  v_mfma_f32_16x16x32_bf16 v[144:147], a[212:215], a[48:51], v[144:147]
  ds_read_b64_tr_b16 a[200:201], v194 offset:24576
  ds_read_b64_tr_b16 a[202:203], v194 offset:30720
  v_mfma_f32_16x16x32_bf16 v[148:151], a[212:215], a[52:55], v[148:151]
  buffer_load_dwordx4 v204, s[8:11], s32 offen offset:2048 lds
  v_mfma_f32_16x16x32_bf16 v[152:155], a[212:215], a[56:59], v[152:155]
  s_add_u32 s32, s32, 393216
  v_mfma_f32_16x16x32_bf16 v[156:159], a[212:215], a[60:63], v[156:159]
  s_waitcnt lgkmcnt(8)
  v_mfma_f32_16x16x32_bf16 v[160:163], a[216:219], a[48:51], v[160:163]
  ds_read_b64_tr_b16 a[204:205], v195 offset:24576
  ds_read_b64_tr_b16 a[206:207], v195 offset:30720
  v_mfma_f32_16x16x32_bf16 v[164:167], a[216:219], a[52:55], v[164:167]
  v_mfma_f32_16x16x32_bf16 v[168:171], a[216:219], a[56:59], v[168:171]
  v_mfma_f32_16x16x32_bf16 v[172:175], a[216:219], a[60:63], v[172:175]
  s_waitcnt lgkmcnt(8)
  v_mfma_f32_16x16x32_bf16 v[176:179], a[220:223], a[48:51], v[176:179]
  ds_read_b64_tr_b16 a[208:209], v192 offset:24704
  ds_read_b64_tr_b16 a[210:211], v192 offset:30848
  v_mfma_f32_16x16x32_bf16 v[180:183], a[220:223], a[52:55], v[180:183]
  s_waitcnt vmcnt(24)
  v_mfma_f32_16x16x32_bf16 v[184:187], a[220:223], a[56:59], v[184:187]
  s_barrier
  v_mfma_f32_16x16x32_bf16 v[188:191], a[220:223], a[60:63], v[188:191]
  s_waitcnt lgkmcnt(8)
  v_mfma_f32_16x16x32_bf16 v[0:3], a[192:195], a[64:67], v[0:3]
  ds_read_b64_tr_b16 a[212:213], v193 offset:24704
  ds_read_b64_tr_b16 a[214:215], v193 offset:30848
  v_mfma_f32_16x16x32_bf16 v[4:7], a[192:195], a[68:71], v[4:7]
  buffer_load_dwordx4 a[48:51], v208, s[20:23], s35 offen offset:0
  v_mfma_f32_16x16x32_bf16 v[8:11], a[192:195], a[72:75], v[8:11]
  v_mfma_f32_16x16x32_bf16 v[12:15], a[192:195], a[76:79], v[12:15]
  s_waitcnt lgkmcnt(8)
  v_mfma_f32_16x16x32_bf16 v[16:19], a[196:199], a[64:67], v[16:19]
  ds_read_b64_tr_b16 a[216:217], v194 offset:24704
  ds_read_b64_tr_b16 a[218:219], v194 offset:30848
  v_mfma_f32_16x16x32_bf16 v[20:23], a[196:199], a[68:71], v[20:23]
  v_mfma_f32_16x16x32_bf16 v[24:27], a[196:199], a[72:75], v[24:27]
  v_mfma_f32_16x16x32_bf16 v[28:31], a[196:199], a[76:79], v[28:31]
  s_waitcnt lgkmcnt(8)
  buffer_load_dwordx4 a[52:55], v208, s[20:23], s35 offen offset:1024
  v_mfma_f32_16x16x32_bf16 v[32:35], a[200:203], a[64:67], v[32:35]
  ds_read_b64_tr_b16 a[220:221], v195 offset:24704
  ds_read_b64_tr_b16 a[222:223], v195 offset:30848
  v_mfma_f32_16x16x32_bf16 v[36:39], a[200:203], a[68:71], v[36:39]
  v_mfma_f32_16x16x32_bf16 v[40:43], a[200:203], a[72:75], v[40:43]
  v_mfma_f32_16x16x32_bf16 v[44:47], a[200:203], a[76:79], v[44:47]
  s_waitcnt lgkmcnt(8)
  v_mfma_f32_16x16x32_bf16 v[48:51], a[204:207], a[64:67], v[48:51]
  ds_read_b64_tr_b16 a[192:193], v192 offset:24832
  ds_read_b64_tr_b16 a[194:195], v192 offset:30976
  v_mfma_f32_16x16x32_bf16 v[52:55], a[204:207], a[68:71], v[52:55]
  buffer_load_dwordx4 a[56:59], v208, s[20:23], s35 offen offset:2048
  v_mfma_f32_16x16x32_bf16 v[56:59], a[204:207], a[72:75], v[56:59]
  v_mfma_f32_16x16x32_bf16 v[60:63], a[204:207], a[76:79], v[60:63]
  s_waitcnt lgkmcnt(8)
  v_mfma_f32_16x16x32_bf16 v[64:67], a[208:211], a[64:67], v[64:67]
  ds_read_b64_tr_b16 a[196:197], v193 offset:24832
  ds_read_b64_tr_b16 a[198:199], v193 offset:30976
  v_mfma_f32_16x16x32_bf16 v[68:71], a[208:211], a[68:71], v[68:71]
  v_mfma_f32_16x16x32_bf16 v[72:75], a[208:211], a[72:75], v[72:75]
  v_mfma_f32_16x16x32_bf16 v[76:79], a[208:211], a[76:79], v[76:79]
  s_waitcnt lgkmcnt(8)
  buffer_load_dwordx4 a[60:63], v208, s[20:23], s35 offen offset:3072
  v_mfma_f32_16x16x32_bf16 v[80:83], a[212:215], a[64:67], v[80:83]
  s_add_u32 s35, s35, 4096
  ds_read_b64_tr_b16 a[200:201], v194 offset:24832
  ds_read_b64_tr_b16 a[202:203], v194 offset:30976
  v_mfma_f32_16x16x32_bf16 v[84:87], a[212:215], a[68:71], v[84:87]
  s_add_u32 m0, s31, 0
  v_mfma_f32_16x16x32_bf16 v[88:91], a[212:215], a[72:75], v[88:91]
  v_mfma_f32_16x16x32_bf16 v[92:95], a[212:215], a[76:79], v[92:95]
  s_waitcnt lgkmcnt(8)
  v_mfma_f32_16x16x32_bf16 v[96:99], a[216:219], a[64:67], v[96:99]
  ds_read_b64_tr_b16 a[204:205], v195 offset:24832
  ds_read_b64_tr_b16 a[206:207], v195 offset:30976
  v_mfma_f32_16x16x32_bf16 v[100:103], a[216:219], a[68:71], v[100:103]
  buffer_load_dwordx4 v202, s[8:11], s32 offen offset:0 lds
  v_mfma_f32_16x16x32_bf16 v[104:107], a[216:219], a[72:75], v[104:107]
  v_mfma_f32_16x16x32_bf16 v[108:111], a[216:219], a[76:79], v[108:111]
  s_waitcnt lgkmcnt(8)
  v_mfma_f32_16x16x32_bf16 v[112:115], a[220:223], a[64:67], v[112:115]
  ds_read_b64_tr_b16 a[208:209], v192 offset:36864
  ds_read_b64_tr_b16 a[210:211], v192 offset:43008
  v_mfma_f32_16x16x32_bf16 v[116:119], a[220:223], a[68:71], v[116:119]
  v_mfma_f32_16x16x32_bf16 v[120:123], a[220:223], a[72:75], v[120:123]
  v_mfma_f32_16x16x32_bf16 v[124:127], a[220:223], a[76:79], v[124:127]
  s_waitcnt lgkmcnt(8)
  buffer_load_dwordx4 v203, s[8:11], s32 offen offset:1024 lds
  v_mfma_f32_16x16x32_bf16 v[128:131], a[192:195], a[64:67], v[128:131]
  ds_read_b64_tr_b16 a[212:213], v193 offset:36864
  ds_read_b64_tr_b16 a[214:215], v193 offset:43008
  v_mfma_f32_16x16x32_bf16 v[132:135], a[192:195], a[68:71], v[132:135]
  v_mfma_f32_16x16x32_bf16 v[136:139], a[192:195], a[72:75], v[136:139]
  v_mfma_f32_16x16x32_bf16 v[140:143], a[192:195], a[76:79], v[140:143]
  s_waitcnt lgkmcnt(8)
  v_mfma_f32_16x16x32_bf16 v[144:147], a[196:199], a[64:67], v[144:147]
  ds_read_b64_tr_b16 a[216:217], v194 offset:36864
  ds_read_b64_tr_b16 a[218:219], v194 offset:43008
  v_mfma_f32_16x16x32_bf16 v[148:151], a[196:199], a[68:71], v[148:151]
  buffer_load_dwordx4 v204, s[8:11], s32 offen offset:2048 lds
  v_mfma_f32_16x16x32_bf16 v[152:155], a[196:199], a[72:75], v[152:155]
  s_add_u32 s32, s32, 393216
  v_mfma_f32_16x16x32_bf16 v[156:159], a[196:199], a[76:79], v[156:159]
  s_waitcnt lgkmcnt(8)
  v_mfma_f32_16x16x32_bf16 v[160:163], a[200:203], a[64:67], v[160:163]
  ds_read_b64_tr_b16 a[220:221], v195 offset:36864
  ds_read_b64_tr_b16 a[222:223], v195 offset:43008
  v_mfma_f32_16x16x32_bf16 v[164:167], a[200:203], a[68:71], v[164:167]
  v_mfma_f32_16x16x32_bf16 v[168:171], a[200:203], a[72:75], v[168:171]
  v_mfma_f32_16x16x32_bf16 v[172:175], a[200:203], a[76:79], v[172:175]
  s_waitcnt lgkmcnt(8)
  v_mfma_f32_16x16x32_bf16 v[176:179], a[204:207], a[64:67], v[176:179]
  ds_read_b64_tr_b16 a[192:193], v192 offset:36992
  ds_read_b64_tr_b16 a[194:195], v192 offset:43136
  v_mfma_f32_16x16x32_bf16 v[180:183], a[204:207], a[68:71], v[180:183]
  v_mfma_f32_16x16x32_bf16 v[184:187], a[204:207], a[72:75], v[184:187]
  s_waitcnt vmcnt(34)
  v_mfma_f32_16x16x32_bf16 v[188:191], a[204:207], a[76:79], v[188:191]
  s_waitcnt lgkmcnt(8)
  v_mfma_f32_16x16x32_bf16 v[0:3], a[208:211], a[80:83], v[0:3]
  ds_read_b64_tr_b16 a[196:197], v193 offset:36992
  ds_read_b64_tr_b16 a[198:199], v193 offset:43136
  v_mfma_f32_16x16x32_bf16 v[4:7], a[208:211], a[84:87], v[4:7]
  buffer_load_dwordx4 a[64:67], v208, s[20:23], s35 offen offset:0
  v_mfma_f32_16x16x32_bf16 v[8:11], a[208:211], a[88:91], v[8:11]
  v_mfma_f32_16x16x32_bf16 v[12:15], a[208:211], a[92:95], v[12:15]
  s_waitcnt lgkmcnt(8)
  v_mfma_f32_16x16x32_bf16 v[16:19], a[212:215], a[80:83], v[16:19]
  ds_read_b64_tr_b16 a[200:201], v194 offset:36992
  ds_read_b64_tr_b16 a[202:203], v194 offset:43136
  v_mfma_f32_16x16x32_bf16 v[20:23], a[212:215], a[84:87], v[20:23]
  v_mfma_f32_16x16x32_bf16 v[24:27], a[212:215], a[88:91], v[24:27]
  v_mfma_f32_16x16x32_bf16 v[28:31], a[212:215], a[92:95], v[28:31]
  s_waitcnt lgkmcnt(8)
  buffer_load_dwordx4 a[68:71], v208, s[20:23], s35 offen offset:1024
  v_mfma_f32_16x16x32_bf16 v[32:35], a[216:219], a[80:83], v[32:35]
  ds_read_b64_tr_b16 a[204:205], v195 offset:36992
  ds_read_b64_tr_b16 a[206:207], v195 offset:43136
  v_mfma_f32_16x16x32_bf16 v[36:39], a[216:219], a[84:87], v[36:39]
  v_mfma_f32_16x16x32_bf16 v[40:43], a[216:219], a[88:91], v[40:43]
  v_mfma_f32_16x16x32_bf16 v[44:47], a[216:219], a[92:95], v[44:47]
  s_waitcnt lgkmcnt(8)
  v_mfma_f32_16x16x32_bf16 v[48:51], a[220:223], a[80:83], v[48:51]
  ds_read_b64_tr_b16 a[208:209], v192 offset:37120
  ds_read_b64_tr_b16 a[210:211], v192 offset:43264
  v_mfma_f32_16x16x32_bf16 v[52:55], a[220:223], a[84:87], v[52:55]
  buffer_load_dwordx4 a[72:75], v208, s[20:23], s35 offen offset:2048
  v_mfma_f32_16x16x32_bf16 v[56:59], a[220:223], a[88:91], v[56:59]
  v_mfma_f32_16x16x32_bf16 v[60:63], a[220:223], a[92:95], v[60:63]
  s_waitcnt lgkmcnt(8)
  v_mfma_f32_16x16x32_bf16 v[64:67], a[192:195], a[80:83], v[64:67]
  ds_read_b64_tr_b16 a[212:213], v193 offset:37120
  ds_read_b64_tr_b16 a[214:215], v193 offset:43264
  v_mfma_f32_16x16x32_bf16 v[68:71], a[192:195], a[84:87], v[68:71]
  v_mfma_f32_16x16x32_bf16 v[72:75], a[192:195], a[88:91], v[72:75]
  v_mfma_f32_16x16x32_bf16 v[76:79], a[192:195], a[92:95], v[76:79]
  s_waitcnt lgkmcnt(8)
  buffer_load_dwordx4 a[76:79], v208, s[20:23], s35 offen offset:3072
  v_mfma_f32_16x16x32_bf16 v[80:83], a[196:199], a[80:83], v[80:83]
  s_add_u32 s35, s35, 4096
  ds_read_b64_tr_b16 a[216:217], v194 offset:37120
  ds_read_b64_tr_b16 a[218:219], v194 offset:43264
  v_mfma_f32_16x16x32_bf16 v[84:87], a[196:199], a[84:87], v[84:87]
  s_add_u32 m0, s31, 12288
  v_mfma_f32_16x16x32_bf16 v[88:91], a[196:199], a[88:91], v[88:91]
  v_mfma_f32_16x16x32_bf16 v[92:95], a[196:199], a[92:95], v[92:95]
  s_waitcnt lgkmcnt(8)
  v_mfma_f32_16x16x32_bf16 v[96:99], a[200:203], a[80:83], v[96:99]
  ds_read_b64_tr_b16 a[220:221], v195 offset:37120
  ds_read_b64_tr_b16 a[222:223], v195 offset:43264
  v_mfma_f32_16x16x32_bf16 v[100:103], a[200:203], a[84:87], v[100:103]
  buffer_load_dwordx4 v202, s[8:11], s32 offen offset:0 lds
  v_mfma_f32_16x16x32_bf16 v[104:107], a[200:203], a[88:91], v[104:107]
  v_mfma_f32_16x16x32_bf16 v[108:111], a[200:203], a[92:95], v[108:111]
  s_waitcnt lgkmcnt(8)
  v_mfma_f32_16x16x32_bf16 v[112:115], a[204:207], a[80:83], v[112:115]
  ds_read_b64_tr_b16 a[192:193], v196 offset:0
  ds_read_b64_tr_b16 a[194:195], v196 offset:6144
  v_mfma_f32_16x16x32_bf16 v[116:119], a[204:207], a[84:87], v[116:119]
  v_mfma_f32_16x16x32_bf16 v[120:123], a[204:207], a[88:91], v[120:123]
  v_mfma_f32_16x16x32_bf16 v[124:127], a[204:207], a[92:95], v[124:127]
  s_waitcnt lgkmcnt(8)
  buffer_load_dwordx4 v203, s[8:11], s32 offen offset:1024 lds
  v_mfma_f32_16x16x32_bf16 v[128:131], a[208:211], a[80:83], v[128:131]
  ds_read_b64_tr_b16 a[196:197], v197 offset:0
  ds_read_b64_tr_b16 a[198:199], v197 offset:6144
  v_mfma_f32_16x16x32_bf16 v[132:135], a[208:211], a[84:87], v[132:135]
  v_mfma_f32_16x16x32_bf16 v[136:139], a[208:211], a[88:91], v[136:139]
  v_mfma_f32_16x16x32_bf16 v[140:143], a[208:211], a[92:95], v[140:143]
  s_waitcnt lgkmcnt(8)
  v_mfma_f32_16x16x32_bf16 v[144:147], a[212:215], a[80:83], v[144:147]
  ds_read_b64_tr_b16 a[200:201], v198 offset:0
  ds_read_b64_tr_b16 a[202:203], v198 offset:6144
  v_mfma_f32_16x16x32_bf16 v[148:151], a[212:215], a[84:87], v[148:151]
  buffer_load_dwordx4 v204, s[8:11], s32 offen offset:2048 lds
  v_mfma_f32_16x16x32_bf16 v[152:155], a[212:215], a[88:91], v[152:155]
  s_add_u32 s32, s32, 393216
  v_mfma_f32_16x16x32_bf16 v[156:159], a[212:215], a[92:95], v[156:159]
  s_waitcnt lgkmcnt(8)
  v_mfma_f32_16x16x32_bf16 v[160:163], a[216:219], a[80:83], v[160:163]
  ds_read_b64_tr_b16 a[204:205], v199 offset:0
  ds_read_b64_tr_b16 a[206:207], v199 offset:6144
  v_mfma_f32_16x16x32_bf16 v[164:167], a[216:219], a[84:87], v[164:167]
  v_mfma_f32_16x16x32_bf16 v[168:171], a[216:219], a[88:91], v[168:171]
  v_mfma_f32_16x16x32_bf16 v[172:175], a[216:219], a[92:95], v[172:175]
  s_waitcnt lgkmcnt(8)
  v_mfma_f32_16x16x32_bf16 v[176:179], a[220:223], a[80:83], v[176:179]
  ds_read_b64_tr_b16 a[208:209], v196 offset:128
  ds_read_b64_tr_b16 a[210:211], v196 offset:6272
  v_mfma_f32_16x16x32_bf16 v[180:183], a[220:223], a[84:87], v[180:183]
  s_waitcnt vmcnt(24)
  v_mfma_f32_16x16x32_bf16 v[184:187], a[220:223], a[88:91], v[184:187]
  s_barrier
  v_mfma_f32_16x16x32_bf16 v[188:191], a[220:223], a[92:95], v[188:191]
  s_waitcnt lgkmcnt(8)
  v_mfma_f32_16x16x32_bf16 v[0:3], a[192:195], a[0:3], v[0:3]
  ds_read_b64_tr_b16 a[212:213], v197 offset:128
  ds_read_b64_tr_b16 a[214:215], v197 offset:6272
  v_mfma_f32_16x16x32_bf16 v[4:7], a[192:195], a[4:7], v[4:7]
  buffer_load_dwordx4 a[80:83], v208, s[20:23], s35 offen offset:0
  v_mfma_f32_16x16x32_bf16 v[8:11], a[192:195], a[8:11], v[8:11]
  v_mfma_f32_16x16x32_bf16 v[12:15], a[192:195], a[12:15], v[12:15]
  s_waitcnt lgkmcnt(8)
  v_mfma_f32_16x16x32_bf16 v[16:19], a[196:199], a[0:3], v[16:19]
  ds_read_b64_tr_b16 a[216:217], v198 offset:128
  ds_read_b64_tr_b16 a[218:219], v198 offset:6272
  v_mfma_f32_16x16x32_bf16 v[20:23], a[196:199], a[4:7], v[20:23]
  v_mfma_f32_16x16x32_bf16 v[24:27], a[196:199], a[8:11], v[24:27]
  v_mfma_f32_16x16x32_bf16 v[28:31], a[196:199], a[12:15], v[28:31]
  s_waitcnt lgkmcnt(8)
  buffer_load_dwordx4 a[84:87], v208, s[20:23], s35 offen offset:1024
  v_mfma_f32_16x16x32_bf16 v[32:35], a[200:203], a[0:3], v[32:35]
  ds_read_b64_tr_b16 a[220:221], v199 offset:128
  ds_read_b64_tr_b16 a[222:223], v199 offset:6272
  v_mfma_f32_16x16x32_bf16 v[36:39], a[200:203], a[4:7], v[36:39]
  v_mfma_f32_16x16x32_bf16 v[40:43], a[200:203], a[8:11], v[40:43]
  v_mfma_f32_16x16x32_bf16 v[44:47], a[200:203], a[12:15], v[44:47]
  s_waitcnt lgkmcnt(8)
  v_mfma_f32_16x16x32_bf16 v[48:51], a[204:207], a[0:3], v[48:51]
  ds_read_b64_tr_b16 a[192:193], v196 offset:256
  ds_read_b64_tr_b16 a[194:195], v196 offset:6400
  v_mfma_f32_16x16x32_bf16 v[52:55], a[204:207], a[4:7], v[52:55]
  buffer_load_dwordx4 a[88:91], v208, s[20:23], s35 offen offset:2048
  v_mfma_f32_16x16x32_bf16 v[56:59], a[204:207], a[8:11], v[56:59]
  v_mfma_f32_16x16x32_bf16 v[60:63], a[204:207], a[12:15], v[60:63]
  s_waitcnt lgkmcnt(8)
  v_mfma_f32_16x16x32_bf16 v[64:67], a[208:211], a[0:3], v[64:67]
  ds_read_b64_tr_b16 a[196:197], v197 offset:256
  ds_read_b64_tr_b16 a[198:199], v197 offset:6400
  v_mfma_f32_16x16x32_bf16 v[68:71], a[208:211], a[4:7], v[68:71]
  v_mfma_f32_16x16x32_bf16 v[72:75], a[208:211], a[8:11], v[72:75]
  v_mfma_f32_16x16x32_bf16 v[76:79], a[208:211], a[12:15], v[76:79]
  s_waitcnt lgkmcnt(8)
  buffer_load_dwordx4 a[92:95], v208, s[20:23], s35 offen offset:3072
  v_mfma_f32_16x16x32_bf16 v[80:83], a[212:215], a[0:3], v[80:83]
  s_add_u32 s35, s35, 4096
  ds_read_b64_tr_b16 a[200:201], v198 offset:256
  ds_read_b64_tr_b16 a[202:203], v198 offset:6400
  v_mfma_f32_16x16x32_bf16 v[84:87], a[212:215], a[4:7], v[84:87]
  s_add_u32 m0, s31, 24576
  v_mfma_f32_16x16x32_bf16 v[88:91], a[212:215], a[8:11], v[88:91]
  v_mfma_f32_16x16x32_bf16 v[92:95], a[212:215], a[12:15], v[92:95]
  s_waitcnt lgkmcnt(8)
  v_mfma_f32_16x16x32_bf16 v[96:99], a[216:219], a[0:3], v[96:99]
  ds_read_b64_tr_b16 a[204:205], v199 offset:256
  ds_read_b64_tr_b16 a[206:207], v199 offset:6400
  v_mfma_f32_16x16x32_bf16 v[100:103], a[216:219], a[4:7], v[100:103]
  buffer_load_dwordx4 v202, s[8:11], s32 offen offset:0 lds
  v_mfma_f32_16x16x32_bf16 v[104:107], a[216:219], a[8:11], v[104:107]
  v_mfma_f32_16x16x32_bf16 v[108:111], a[216:219], a[12:15], v[108:111]
  s_waitcnt lgkmcnt(8)
  v_mfma_f32_16x16x32_bf16 v[112:115], a[220:223], a[0:3], v[112:115]
  ds_read_b64_tr_b16 a[208:209], v196 offset:12288
  ds_read_b64_tr_b16 a[210:211], v196 offset:18432
  v_mfma_f32_16x16x32_bf16 v[116:119], a[220:223], a[4:7], v[116:119]
  v_mfma_f32_16x16x32_bf16 v[120:123], a[220:223], a[8:11], v[120:123]
  v_mfma_f32_16x16x32_bf16 v[124:127], a[220:223], a[12:15], v[124:127]
  s_waitcnt lgkmcnt(8)
  buffer_load_dwordx4 v203, s[8:11], s32 offen offset:1024 lds
  v_mfma_f32_16x16x32_bf16 v[128:131], a[192:195], a[0:3], v[128:131]
  ds_read_b64_tr_b16 a[212:213], v197 offset:12288
  ds_read_b64_tr_b16 a[214:215], v197 offset:18432
  v_mfma_f32_16x16x32_bf16 v[132:135], a[192:195], a[4:7], v[132:135]
  v_mfma_f32_16x16x32_bf16 v[136:139], a[192:195], a[8:11], v[136:139]
  v_mfma_f32_16x16x32_bf16 v[140:143], a[192:195], a[12:15], v[140:143]
  s_waitcnt lgkmcnt(8)
  v_mfma_f32_16x16x32_bf16 v[144:147], a[196:199], a[0:3], v[144:147]
  ds_read_b64_tr_b16 a[216:217], v198 offset:12288
  ds_read_b64_tr_b16 a[218:219], v198 offset:18432
  v_mfma_f32_16x16x32_bf16 v[148:151], a[196:199], a[4:7], v[148:151]
  buffer_load_dwordx4 v204, s[8:11], s32 offen offset:2048 lds
  v_mfma_f32_16x16x32_bf16 v[152:155], a[196:199], a[8:11], v[152:155]
  s_add_u32 s32, s32, 393216
  v_mfma_f32_16x16x32_bf16 v[156:159], a[196:199], a[12:15], v[156:159]
  s_waitcnt lgkmcnt(8)
  v_mfma_f32_16x16x32_bf16 v[160:163], a[200:203], a[0:3], v[160:163]
  ds_read_b64_tr_b16 a[220:221], v199 offset:12288
  ds_read_b64_tr_b16 a[222:223], v199 offset:18432
  v_mfma_f32_16x16x32_bf16 v[164:167], a[200:203], a[4:7], v[164:167]
  v_mfma_f32_16x16x32_bf16 v[168:171], a[200:203], a[8:11], v[168:171]
  v_mfma_f32_16x16x32_bf16 v[172:175], a[200:203], a[12:15], v[172:175]
  s_waitcnt lgkmcnt(8)
  v_mfma_f32_16x16x32_bf16 v[176:179], a[204:207], a[0:3], v[176:179]
  ds_read_b64_tr_b16 a[192:193], v196 offset:12416
  ds_read_b64_tr_b16 a[194:195], v196 offset:18560
  v_mfma_f32_16x16x32_bf16 v[180:183], a[204:207], a[4:7], v[180:183]
  v_mfma_f32_16x16x32_bf16 v[184:187], a[204:207], a[8:11], v[184:187]
  s_waitcnt vmcnt(34)
  v_mfma_f32_16x16x32_bf16 v[188:191], a[204:207], a[12:15], v[188:191]
  s_waitcnt lgkmcnt(8)
  v_mfma_f32_16x16x32_bf16 v[0:3], a[208:211], a[16:19], v[0:3]
  ds_read_b64_tr_b16 a[196:197], v197 offset:12416
  ds_read_b64_tr_b16 a[198:199], v197 offset:18560
  v_mfma_f32_16x16x32_bf16 v[4:7], a[208:211], a[20:23], v[4:7]
  buffer_load_dwordx4 a[0:3], v208, s[20:23], s35 offen offset:0
  v_mfma_f32_16x16x32_bf16 v[8:11], a[208:211], a[24:27], v[8:11]
  v_mfma_f32_16x16x32_bf16 v[12:15], a[208:211], a[28:31], v[12:15]
  s_waitcnt lgkmcnt(8)
  v_mfma_f32_16x16x32_bf16 v[16:19], a[212:215], a[16:19], v[16:19]
  ds_read_b64_tr_b16 a[200:201], v198 offset:12416
  ds_read_b64_tr_b16 a[202:203], v198 offset:18560
  v_mfma_f32_16x16x32_bf16 v[20:23], a[212:215], a[20:23], v[20:23]
  v_mfma_f32_16x16x32_bf16 v[24:27], a[212:215], a[24:27], v[24:27]
  v_mfma_f32_16x16x32_bf16 v[28:31], a[212:215], a[28:31], v[28:31]
  s_waitcnt lgkmcnt(8)
  buffer_load_dwordx4 a[4:7], v208, s[20:23], s35 offen offset:1024
  v_mfma_f32_16x16x32_bf16 v[32:35], a[216:219], a[16:19], v[32:35]
  ds_read_b64_tr_b16 a[204:205], v199 offset:12416
  ds_read_b64_tr_b16 a[206:207], v199 offset:18560
  v_mfma_f32_16x16x32_bf16 v[36:39], a[216:219], a[20:23], v[36:39]
  v_mfma_f32_16x16x32_bf16 v[40:43], a[216:219], a[24:27], v[40:43]
  v_mfma_f32_16x16x32_bf16 v[44:47], a[216:219], a[28:31], v[44:47]
  s_waitcnt lgkmcnt(8)
  v_mfma_f32_16x16x32_bf16 v[48:51], a[220:223], a[16:19], v[48:51]
  ds_read_b64_tr_b16 a[208:209], v196 offset:12544
  ds_read_b64_tr_b16 a[210:211], v196 offset:18688
  v_mfma_f32_16x16x32_bf16 v[52:55], a[220:223], a[20:23], v[52:55]
  buffer_load_dwordx4 a[8:11], v208, s[20:23], s35 offen offset:2048
  v_mfma_f32_16x16x32_bf16 v[56:59], a[220:223], a[24:27], v[56:59]
  v_mfma_f32_16x16x32_bf16 v[60:63], a[220:223], a[28:31], v[60:63]
  s_waitcnt lgkmcnt(8)
  v_mfma_f32_16x16x32_bf16 v[64:67], a[192:195], a[16:19], v[64:67]
  ds_read_b64_tr_b16 a[212:213], v197 offset:12544
  ds_read_b64_tr_b16 a[214:215], v197 offset:18688
  v_mfma_f32_16x16x32_bf16 v[68:71], a[192:195], a[20:23], v[68:71]
  v_mfma_f32_16x16x32_bf16 v[72:75], a[192:195], a[24:27], v[72:75]
  v_mfma_f32_16x16x32_bf16 v[76:79], a[192:195], a[28:31], v[76:79]
  s_waitcnt lgkmcnt(8)
  buffer_load_dwordx4 a[12:15], v208, s[20:23], s35 offen offset:3072
  v_mfma_f32_16x16x32_bf16 v[80:83], a[196:199], a[16:19], v[80:83]
  s_add_u32 s35, s35, 4096
  ds_read_b64_tr_b16 a[216:217], v198 offset:12544
  ds_read_b64_tr_b16 a[218:219], v198 offset:18688
  v_mfma_f32_16x16x32_bf16 v[84:87], a[196:199], a[20:23], v[84:87]
  s_add_u32 m0, s31, 36864
  v_mfma_f32_16x16x32_bf16 v[88:91], a[196:199], a[24:27], v[88:91]
  v_mfma_f32_16x16x32_bf16 v[92:95], a[196:199], a[28:31], v[92:95]
  s_waitcnt lgkmcnt(8)
  v_mfma_f32_16x16x32_bf16 v[96:99], a[200:203], a[16:19], v[96:99]
  ds_read_b64_tr_b16 a[220:221], v199 offset:12544
  ds_read_b64_tr_b16 a[222:223], v199 offset:18688
  v_mfma_f32_16x16x32_bf16 v[100:103], a[200:203], a[20:23], v[100:103]
  buffer_load_dwordx4 v202, s[8:11], s32 offen offset:0 lds
  v_mfma_f32_16x16x32_bf16 v[104:107], a[200:203], a[24:27], v[104:107]
  v_mfma_f32_16x16x32_bf16 v[108:111], a[200:203], a[28:31], v[108:111]
  s_waitcnt lgkmcnt(8)
  v_mfma_f32_16x16x32_bf16 v[112:115], a[204:207], a[16:19], v[112:115]
  ds_read_b64_tr_b16 a[192:193], v196 offset:24576
  ds_read_b64_tr_b16 a[194:195], v196 offset:30720
  v_mfma_f32_16x16x32_bf16 v[116:119], a[204:207], a[20:23], v[116:119]
  v_mfma_f32_16x16x32_bf16 v[120:123], a[204:207], a[24:27], v[120:123]
  v_mfma_f32_16x16x32_bf16 v[124:127], a[204:207], a[28:31], v[124:127]
  s_waitcnt lgkmcnt(8)
  buffer_load_dwordx4 v203, s[8:11], s32 offen offset:1024 lds
  v_mfma_f32_16x16x32_bf16 v[128:131], a[208:211], a[16:19], v[128:131]
  ds_read_b64_tr_b16 a[196:197], v197 offset:24576
  ds_read_b64_tr_b16 a[198:199], v197 offset:30720
  v_mfma_f32_16x16x32_bf16 v[132:135], a[208:211], a[20:23], v[132:135]
  v_mfma_f32_16x16x32_bf16 v[136:139], a[208:211], a[24:27], v[136:139]
  v_mfma_f32_16x16x32_bf16 v[140:143], a[208:211], a[28:31], v[140:143]
  s_waitcnt lgkmcnt(8)
  v_mfma_f32_16x16x32_bf16 v[144:147], a[212:215], a[16:19], v[144:147]
  ds_read_b64_tr_b16 a[200:201], v198 offset:24576
  ds_read_b64_tr_b16 a[202:203], v198 offset:30720
  v_mfma_f32_16x16x32_bf16 v[148:151], a[212:215], a[20:23], v[148:151]
  buffer_load_dwordx4 v204, s[8:11], s32 offen offset:2048 lds
  v_mfma_f32_16x16x32_bf16 v[152:155], a[212:215], a[24:27], v[152:155]
  s_add_u32 s32, s32, 393216
  v_mfma_f32_16x16x32_bf16 v[156:159], a[212:215], a[28:31], v[156:159]
  s_waitcnt lgkmcnt(8)
  v_mfma_f32_16x16x32_bf16 v[160:163], a[216:219], a[16:19], v[160:163]
  ds_read_b64_tr_b16 a[204:205], v199 offset:24576
  ds_read_b64_tr_b16 a[206:207], v199 offset:30720
  v_mfma_f32_16x16x32_bf16 v[164:167], a[216:219], a[20:23], v[164:167]
  v_mfma_f32_16x16x32_bf16 v[168:171], a[216:219], a[24:27], v[168:171]
  v_mfma_f32_16x16x32_bf16 v[172:175], a[216:219], a[28:31], v[172:175]
  s_waitcnt lgkmcnt(8)
  v_mfma_f32_16x16x32_bf16 v[176:179], a[220:223], a[16:19], v[176:179]
  ds_read_b64_tr_b16 a[208:209], v196 offset:24704
  ds_read_b64_tr_b16 a[210:211], v196 offset:30848
  v_mfma_f32_16x16x32_bf16 v[180:183], a[220:223], a[20:23], v[180:183]
  s_waitcnt vmcnt(21)
  v_mfma_f32_16x16x32_bf16 v[184:187], a[220:223], a[24:27], v[184:187]
  s_barrier
  v_mfma_f32_16x16x32_bf16 v[188:191], a[220:223], a[28:31], v[188:191]
  s_waitcnt lgkmcnt(8)
  v_mfma_f32_16x16x32_bf16 v[0:3], a[192:195], a[32:35], v[0:3]
  ds_read_b64_tr_b16 a[212:213], v197 offset:24704
  ds_read_b64_tr_b16 a[214:215], v197 offset:30848
  v_mfma_f32_16x16x32_bf16 v[4:7], a[192:195], a[36:39], v[4:7]
  buffer_load_dwordx4 a[16:19], v208, s[20:23], s35 offen offset:0
  v_mfma_f32_16x16x32_bf16 v[8:11], a[192:195], a[40:43], v[8:11]
  v_mfma_f32_16x16x32_bf16 v[12:15], a[192:195], a[44:47], v[12:15]
  s_waitcnt lgkmcnt(8)
  v_mfma_f32_16x16x32_bf16 v[16:19], a[196:199], a[32:35], v[16:19]
  ds_read_b64_tr_b16 a[216:217], v198 offset:24704
  ds_read_b64_tr_b16 a[218:219], v198 offset:30848
  v_mfma_f32_16x16x32_bf16 v[20:23], a[196:199], a[36:39], v[20:23]
  buffer_load_dwordx4 a[20:23], v208, s[20:23], s35 offen offset:1024
  v_mfma_f32_16x16x32_bf16 v[24:27], a[196:199], a[40:43], v[24:27]
  v_mfma_f32_16x16x32_bf16 v[28:31], a[196:199], a[44:47], v[28:31]
  s_waitcnt lgkmcnt(8)
  v_mfma_f32_16x16x32_bf16 v[32:35], a[200:203], a[32:35], v[32:35]
  ds_read_b64_tr_b16 a[220:221], v199 offset:24704
  ds_read_b64_tr_b16 a[222:223], v199 offset:30848
  v_mfma_f32_16x16x32_bf16 v[36:39], a[200:203], a[36:39], v[36:39]
  buffer_load_dwordx4 a[24:27], v208, s[20:23], s35 offen offset:2048
  v_mfma_f32_16x16x32_bf16 v[40:43], a[200:203], a[40:43], v[40:43]
  v_mfma_f32_16x16x32_bf16 v[44:47], a[200:203], a[44:47], v[44:47]
  s_waitcnt lgkmcnt(8)
  v_mfma_f32_16x16x32_bf16 v[48:51], a[204:207], a[32:35], v[48:51]
  ds_read_b64_tr_b16 a[192:193], v196 offset:24832
  ds_read_b64_tr_b16 a[194:195], v196 offset:30976
  v_mfma_f32_16x16x32_bf16 v[52:55], a[204:207], a[36:39], v[52:55]
  buffer_load_dwordx4 a[28:31], v208, s[20:23], s35 offen offset:3072
  v_mfma_f32_16x16x32_bf16 v[56:59], a[204:207], a[40:43], v[56:59]
  s_add_u32 s35, s35, 4096
  v_mfma_f32_16x16x32_bf16 v[60:63], a[204:207], a[44:47], v[60:63]
  s_waitcnt lgkmcnt(8)
  v_mfma_f32_16x16x32_bf16 v[64:67], a[208:211], a[32:35], v[64:67]
  s_add_u32 m0, s31, 110592
  ds_read_b64_tr_b16 a[196:197], v197 offset:24832
  ds_read_b64_tr_b16 a[198:199], v197 offset:30976
  v_mfma_f32_16x16x32_bf16 v[68:71], a[208:211], a[36:39], v[68:71]
  buffer_load_dwordx4 v205, s[12:15], s33 offen offset:0 lds
  v_mfma_f32_16x16x32_bf16 v[72:75], a[208:211], a[40:43], v[72:75]
  v_mfma_f32_16x16x32_bf16 v[76:79], a[208:211], a[44:47], v[76:79]
  s_waitcnt lgkmcnt(8)
  v_mfma_f32_16x16x32_bf16 v[80:83], a[212:215], a[32:35], v[80:83]
  ds_read_b64_tr_b16 a[200:201], v198 offset:24832
  ds_read_b64_tr_b16 a[202:203], v198 offset:30976
  v_mfma_f32_16x16x32_bf16 v[84:87], a[212:215], a[36:39], v[84:87]
  buffer_load_dwordx4 v206, s[12:15], s33 offen offset:1024 lds
  v_mfma_f32_16x16x32_bf16 v[88:91], a[212:215], a[40:43], v[88:91]
  v_mfma_f32_16x16x32_bf16 v[92:95], a[212:215], a[44:47], v[92:95]
  s_waitcnt lgkmcnt(8)
  v_mfma_f32_16x16x32_bf16 v[96:99], a[216:219], a[32:35], v[96:99]
  ds_read_b64_tr_b16 a[204:205], v199 offset:24832
  ds_read_b64_tr_b16 a[206:207], v199 offset:30976
  v_mfma_f32_16x16x32_bf16 v[100:103], a[216:219], a[36:39], v[100:103]
  buffer_load_dwordx4 v207, s[12:15], s33 offen offset:2048 lds
  v_mfma_f32_16x16x32_bf16 v[104:107], a[216:219], a[40:43], v[104:107]
  s_add_u32 s33, s33, 12288
  v_mfma_f32_16x16x32_bf16 v[108:111], a[216:219], a[44:47], v[108:111]
  s_waitcnt lgkmcnt(8)
  v_mfma_f32_16x16x32_bf16 v[112:115], a[220:223], a[32:35], v[112:115]
  s_add_u32 m0, s31, 49152
  ds_read_b64_tr_b16 a[208:209], v196 offset:36864
  ds_read_b64_tr_b16 a[210:211], v196 offset:43008
  v_mfma_f32_16x16x32_bf16 v[116:119], a[220:223], a[36:39], v[116:119]
  buffer_load_dwordx4 v205, s[16:19], s34 offen offset:0 lds
  v_mfma_f32_16x16x32_bf16 v[120:123], a[220:223], a[40:43], v[120:123]
  v_mfma_f32_16x16x32_bf16 v[124:127], a[220:223], a[44:47], v[124:127]
  s_waitcnt lgkmcnt(8)
  v_mfma_f32_16x16x32_bf16 v[128:131], a[192:195], a[32:35], v[128:131]
  ds_read_b64_tr_b16 a[212:213], v197 offset:36864
  ds_read_b64_tr_b16 a[214:215], v197 offset:43008
  v_mfma_f32_16x16x32_bf16 v[132:135], a[192:195], a[36:39], v[132:135]
  buffer_load_dwordx4 v206, s[16:19], s34 offen offset:1024 lds
  v_mfma_f32_16x16x32_bf16 v[136:139], a[192:195], a[40:43], v[136:139]
  v_mfma_f32_16x16x32_bf16 v[140:143], a[192:195], a[44:47], v[140:143]
  s_waitcnt lgkmcnt(8)
  v_mfma_f32_16x16x32_bf16 v[144:147], a[196:199], a[32:35], v[144:147]
  ds_read_b64_tr_b16 a[216:217], v198 offset:36864
  ds_read_b64_tr_b16 a[218:219], v198 offset:43008
  v_mfma_f32_16x16x32_bf16 v[148:151], a[196:199], a[36:39], v[148:151]
  buffer_load_dwordx4 v207, s[16:19], s34 offen offset:2048 lds
  v_mfma_f32_16x16x32_bf16 v[152:155], a[196:199], a[40:43], v[152:155]
  s_add_u32 s34, s34, 12288
  v_mfma_f32_16x16x32_bf16 v[156:159], a[196:199], a[44:47], v[156:159]
  s_waitcnt lgkmcnt(8)
  v_mfma_f32_16x16x32_bf16 v[160:163], a[200:203], a[32:35], v[160:163]
  ds_read_b64_tr_b16 a[220:221], v199 offset:36864
  ds_read_b64_tr_b16 a[222:223], v199 offset:43008
  v_mfma_f32_16x16x32_bf16 v[164:167], a[200:203], a[36:39], v[164:167]
  v_mfma_f32_16x16x32_bf16 v[168:171], a[200:203], a[40:43], v[168:171]
  v_mfma_f32_16x16x32_bf16 v[172:175], a[200:203], a[44:47], v[172:175]
  s_waitcnt lgkmcnt(8)
  v_mfma_f32_16x16x32_bf16 v[176:179], a[204:207], a[32:35], v[176:179]
  ds_read_b64_tr_b16 a[192:193], v196 offset:36992
  ds_read_b64_tr_b16 a[194:195], v196 offset:43136
  v_mfma_f32_16x16x32_bf16 v[180:183], a[204:207], a[36:39], v[180:183]
  v_mfma_f32_16x16x32_bf16 v[184:187], a[204:207], a[40:43], v[184:187]
  s_waitcnt vmcnt(34)
  v_mfma_f32_16x16x32_bf16 v[188:191], a[204:207], a[44:47], v[188:191]
  s_waitcnt lgkmcnt(8)
  v_mfma_f32_16x16x32_bf16 v[0:3], a[208:211], a[48:51], v[0:3]
  ds_read_b64_tr_b16 a[196:197], v197 offset:36992
  ds_read_b64_tr_b16 a[198:199], v197 offset:43136
  v_mfma_f32_16x16x32_bf16 v[4:7], a[208:211], a[52:55], v[4:7]
  v_accvgpr_write_b32 a32, 0
  v_mfma_f32_16x16x32_bf16 v[8:11], a[208:211], a[56:59], v[8:11]
  v_mfma_f32_16x16x32_bf16 v[12:15], a[208:211], a[60:63], v[12:15]
  s_waitcnt lgkmcnt(8)
  v_accvgpr_write_b32 a33, 0
  v_mfma_f32_16x16x32_bf16 v[16:19], a[212:215], a[48:51], v[16:19]
  ds_read_b64_tr_b16 a[200:201], v198 offset:36992
  ds_read_b64_tr_b16 a[202:203], v198 offset:43136
  v_mfma_f32_16x16x32_bf16 v[20:23], a[212:215], a[52:55], v[20:23]
  v_accvgpr_write_b32 a34, 0
  v_mfma_f32_16x16x32_bf16 v[24:27], a[212:215], a[56:59], v[24:27]
  v_mfma_f32_16x16x32_bf16 v[28:31], a[212:215], a[60:63], v[28:31]
  s_waitcnt lgkmcnt(8)
  v_accvgpr_write_b32 a35, 0
  v_mfma_f32_16x16x32_bf16 v[32:35], a[216:219], a[48:51], v[32:35]
  ds_read_b64_tr_b16 a[204:205], v199 offset:36992
  ds_read_b64_tr_b16 a[206:207], v199 offset:43136
  v_mfma_f32_16x16x32_bf16 v[36:39], a[216:219], a[52:55], v[36:39]
  v_accvgpr_write_b32 a36, 0
  v_mfma_f32_16x16x32_bf16 v[40:43], a[216:219], a[56:59], v[40:43]
  v_mfma_f32_16x16x32_bf16 v[44:47], a[216:219], a[60:63], v[44:47]
  s_waitcnt lgkmcnt(8)
  v_accvgpr_write_b32 a37, 0
  v_mfma_f32_16x16x32_bf16 v[48:51], a[220:223], a[48:51], v[48:51]
  ds_read_b64_tr_b16 a[208:209], v196 offset:37120
  ds_read_b64_tr_b16 a[210:211], v196 offset:43264
  v_mfma_f32_16x16x32_bf16 v[52:55], a[220:223], a[52:55], v[52:55]
  v_accvgpr_write_b32 a38, 0
  v_mfma_f32_16x16x32_bf16 v[56:59], a[220:223], a[56:59], v[56:59]
  v_mfma_f32_16x16x32_bf16 v[60:63], a[220:223], a[60:63], v[60:63]
  s_waitcnt lgkmcnt(8)
  v_accvgpr_write_b32 a39, 0
  v_mfma_f32_16x16x32_bf16 v[64:67], a[192:195], a[48:51], v[64:67]
  ds_read_b64_tr_b16 a[212:213], v197 offset:37120
  ds_read_b64_tr_b16 a[214:215], v197 offset:43264
  v_mfma_f32_16x16x32_bf16 v[68:71], a[192:195], a[52:55], v[68:71]
  v_accvgpr_write_b32 a40, 0
  v_mfma_f32_16x16x32_bf16 v[72:75], a[192:195], a[56:59], v[72:75]
  v_mfma_f32_16x16x32_bf16 v[76:79], a[192:195], a[60:63], v[76:79]
  s_waitcnt lgkmcnt(8)
  v_accvgpr_write_b32 a41, 0
  v_mfma_f32_16x16x32_bf16 v[80:83], a[196:199], a[48:51], v[80:83]
  ds_read_b64_tr_b16 a[216:217], v198 offset:37120
  ds_read_b64_tr_b16 a[218:219], v198 offset:43264
  v_mfma_f32_16x16x32_bf16 v[84:87], a[196:199], a[52:55], v[84:87]
  v_accvgpr_write_b32 a42, 0
  v_mfma_f32_16x16x32_bf16 v[88:91], a[196:199], a[56:59], v[88:91]
  v_mfma_f32_16x16x32_bf16 v[92:95], a[196:199], a[60:63], v[92:95]
  s_waitcnt lgkmcnt(8)
  v_accvgpr_write_b32 a43, 0
  v_mfma_f32_16x16x32_bf16 v[96:99], a[200:203], a[48:51], v[96:99]
  ds_read_b64_tr_b16 a[220:221], v199 offset:37120
  ds_read_b64_tr_b16 a[222:223], v199 offset:43264
  v_mfma_f32_16x16x32_bf16 v[100:103], a[200:203], a[52:55], v[100:103]
  v_accvgpr_write_b32 a44, 0
  v_mfma_f32_16x16x32_bf16 v[104:107], a[200:203], a[56:59], v[104:107]
  v_mfma_f32_16x16x32_bf16 v[108:111], a[200:203], a[60:63], v[108:111]
  s_waitcnt lgkmcnt(8)
  v_accvgpr_write_b32 a45, 0
  v_mfma_f32_16x16x32_bf16 v[112:115], a[204:207], a[48:51], v[112:115]
  ds_read_b64_tr_b16 a[192:193], v192 offset:0
  ds_read_b64_tr_b16 a[194:195], v192 offset:6144
  v_mfma_f32_16x16x32_bf16 v[116:119], a[204:207], a[52:55], v[116:119]
  v_accvgpr_write_b32 a46, 0
  v_mfma_f32_16x16x32_bf16 v[120:123], a[204:207], a[56:59], v[120:123]
  v_mfma_f32_16x16x32_bf16 v[124:127], a[204:207], a[60:63], v[124:127]
  s_waitcnt lgkmcnt(8)
  v_accvgpr_write_b32 a47, 0
  v_mfma_f32_16x16x32_bf16 v[128:131], a[208:211], a[48:51], v[128:131]
  ds_read_b64_tr_b16 a[196:197], v193 offset:0
  ds_read_b64_tr_b16 a[198:199], v193 offset:6144
  v_mfma_f32_16x16x32_bf16 v[132:135], a[208:211], a[52:55], v[132:135]
  v_mfma_f32_16x16x32_bf16 v[136:139], a[208:211], a[56:59], v[136:139]
  v_mfma_f32_16x16x32_bf16 v[140:143], a[208:211], a[60:63], v[140:143]
  s_waitcnt lgkmcnt(8)
  v_mfma_f32_16x16x32_bf16 v[144:147], a[212:215], a[48:51], v[144:147]
  ds_read_b64_tr_b16 a[200:201], v194 offset:0
  ds_read_b64_tr_b16 a[202:203], v194 offset:6144
  v_mfma_f32_16x16x32_bf16 v[148:151], a[212:215], a[52:55], v[148:151]
  v_mfma_f32_16x16x32_bf16 v[152:155], a[212:215], a[56:59], v[152:155]
  v_mfma_f32_16x16x32_bf16 v[156:159], a[212:215], a[60:63], v[156:159]
  s_waitcnt lgkmcnt(8)
  v_mfma_f32_16x16x32_bf16 v[160:163], a[216:219], a[48:51], v[160:163]
  ds_read_b64_tr_b16 a[204:205], v195 offset:0
  ds_read_b64_tr_b16 a[206:207], v195 offset:6144
  v_mfma_f32_16x16x32_bf16 v[164:167], a[216:219], a[52:55], v[164:167]
  v_mfma_f32_16x16x32_bf16 v[168:171], a[216:219], a[56:59], v[168:171]
  v_mfma_f32_16x16x32_bf16 v[172:175], a[216:219], a[60:63], v[172:175]
  s_waitcnt lgkmcnt(8)
  v_mfma_f32_16x16x32_bf16 v[176:179], a[220:223], a[48:51], v[176:179]
  ds_read_b64_tr_b16 a[208:209], v192 offset:128
  ds_read_b64_tr_b16 a[210:211], v192 offset:6272
  v_mfma_f32_16x16x32_bf16 v[180:183], a[220:223], a[52:55], v[180:183]
  s_waitcnt vmcnt(17)
  v_mfma_f32_16x16x32_bf16 v[184:187], a[220:223], a[56:59], v[184:187]
  s_barrier
  v_mfma_f32_16x16x32_bf16 v[188:191], a[220:223], a[60:63], v[188:191]
  s_waitcnt lgkmcnt(8)
  v_mfma_f32_16x16x32_bf16 v[0:3], a[192:195], a[64:67], v[0:3]
  ds_read_b64_tr_b16 a[212:213], v193 offset:128
  ds_read_b64_tr_b16 a[214:215], v193 offset:6272
  v_mfma_f32_16x16x32_bf16 v[4:7], a[192:195], a[68:71], v[4:7]
  s_add_u32 m0, s31, 122880
  v_accvgpr_write_b32 a48, 0
  v_mfma_f32_16x16x32_bf16 v[8:11], a[192:195], a[72:75], v[8:11]
  buffer_load_dwordx4 v205, s[12:15], s33 offen offset:0 lds
  v_mfma_f32_16x16x32_bf16 v[12:15], a[192:195], a[76:79], v[12:15]
  s_waitcnt lgkmcnt(8)
  v_accvgpr_write_b32 a49, 0
  v_mfma_f32_16x16x32_bf16 v[16:19], a[196:199], a[64:67], v[16:19]
  ds_read_b64_tr_b16 a[216:217], v194 offset:128
  ds_read_b64_tr_b16 a[218:219], v194 offset:6272
  v_mfma_f32_16x16x32_bf16 v[20:23], a[196:199], a[68:71], v[20:23]
  v_accvgpr_write_b32 a50, 0
  v_mfma_f32_16x16x32_bf16 v[24:27], a[196:199], a[72:75], v[24:27]
  v_mfma_f32_16x16x32_bf16 v[28:31], a[196:199], a[76:79], v[28:31]
  s_waitcnt lgkmcnt(8)
  v_accvgpr_write_b32 a51, 0
  v_mfma_f32_16x16x32_bf16 v[32:35], a[200:203], a[64:67], v[32:35]
  ds_read_b64_tr_b16 a[220:221], v195 offset:128
  ds_read_b64_tr_b16 a[222:223], v195 offset:6272
  v_mfma_f32_16x16x32_bf16 v[36:39], a[200:203], a[68:71], v[36:39]
  buffer_load_dwordx4 v206, s[12:15], s33 offen offset:1024 lds
  v_accvgpr_write_b32 a52, 0
  v_mfma_f32_16x16x32_bf16 v[40:43], a[200:203], a[72:75], v[40:43]
  v_mfma_f32_16x16x32_bf16 v[44:47], a[200:203], a[76:79], v[44:47]
  s_waitcnt lgkmcnt(8)
  v_accvgpr_write_b32 a53, 0
  v_mfma_f32_16x16x32_bf16 v[48:51], a[204:207], a[64:67], v[48:51]
  ds_read_b64_tr_b16 a[192:193], v192 offset:256
  ds_read_b64_tr_b16 a[194:195], v192 offset:6400
  v_mfma_f32_16x16x32_bf16 v[52:55], a[204:207], a[68:71], v[52:55]
  v_accvgpr_write_b32 a54, 0
  v_mfma_f32_16x16x32_bf16 v[56:59], a[204:207], a[72:75], v[56:59]
  v_mfma_f32_16x16x32_bf16 v[60:63], a[204:207], a[76:79], v[60:63]
  s_waitcnt lgkmcnt(8)
  v_accvgpr_write_b32 a55, 0
  v_mfma_f32_16x16x32_bf16 v[64:67], a[208:211], a[64:67], v[64:67]
  ds_read_b64_tr_b16 a[196:197], v193 offset:256
  ds_read_b64_tr_b16 a[198:199], v193 offset:6400
  v_mfma_f32_16x16x32_bf16 v[68:71], a[208:211], a[68:71], v[68:71]
  buffer_load_dwordx4 v207, s[12:15], s33 offen offset:2048 lds
  v_accvgpr_write_b32 a56, 0
  v_mfma_f32_16x16x32_bf16 v[72:75], a[208:211], a[72:75], v[72:75]
  s_add_u32 s33, s33, 12288
  v_mfma_f32_16x16x32_bf16 v[76:79], a[208:211], a[76:79], v[76:79]
  s_waitcnt lgkmcnt(8)
  v_accvgpr_write_b32 a57, 0
  v_mfma_f32_16x16x32_bf16 v[80:83], a[212:215], a[64:67], v[80:83]
  s_add_u32 m0, s31, 61440
  ds_read_b64_tr_b16 a[200:201], v194 offset:256
  ds_read_b64_tr_b16 a[202:203], v194 offset:6400
  v_mfma_f32_16x16x32_bf16 v[84:87], a[212:215], a[68:71], v[84:87]
  v_accvgpr_write_b32 a58, 0
  v_mfma_f32_16x16x32_bf16 v[88:91], a[212:215], a[72:75], v[88:91]
  v_mfma_f32_16x16x32_bf16 v[92:95], a[212:215], a[76:79], v[92:95]
  s_waitcnt lgkmcnt(8)
  v_accvgpr_write_b32 a59, 0
  v_mfma_f32_16x16x32_bf16 v[96:99], a[216:219], a[64:67], v[96:99]
  ds_read_b64_tr_b16 a[204:205], v195 offset:256
  ds_read_b64_tr_b16 a[206:207], v195 offset:6400
  v_mfma_f32_16x16x32_bf16 v[100:103], a[216:219], a[68:71], v[100:103]
  buffer_load_dwordx4 v205, s[16:19], s34 offen offset:0 lds
  v_accvgpr_write_b32 a60, 0
  v_mfma_f32_16x16x32_bf16 v[104:107], a[216:219], a[72:75], v[104:107]
  v_mfma_f32_16x16x32_bf16 v[108:111], a[216:219], a[76:79], v[108:111]
  s_waitcnt lgkmcnt(8)
  v_accvgpr_write_b32 a61, 0
  v_mfma_f32_16x16x32_bf16 v[112:115], a[220:223], a[64:67], v[112:115]
  ds_read_b64_tr_b16 a[208:209], v192 offset:12288
  ds_read_b64_tr_b16 a[210:211], v192 offset:18432
  v_mfma_f32_16x16x32_bf16 v[116:119], a[220:223], a[68:71], v[116:119]
  v_accvgpr_write_b32 a62, 0
  v_mfma_f32_16x16x32_bf16 v[120:123], a[220:223], a[72:75], v[120:123]
  v_mfma_f32_16x16x32_bf16 v[124:127], a[220:223], a[76:79], v[124:127]
  s_waitcnt lgkmcnt(8)
  v_accvgpr_write_b32 a63, 0
  v_mfma_f32_16x16x32_bf16 v[128:131], a[192:195], a[64:67], v[128:131]
  ds_read_b64_tr_b16 a[212:213], v193 offset:12288
  ds_read_b64_tr_b16 a[214:215], v193 offset:18432
  v_mfma_f32_16x16x32_bf16 v[132:135], a[192:195], a[68:71], v[132:135]
  buffer_load_dwordx4 v206, s[16:19], s34 offen offset:1024 lds
  v_mfma_f32_16x16x32_bf16 v[136:139], a[192:195], a[72:75], v[136:139]
  v_mfma_f32_16x16x32_bf16 v[140:143], a[192:195], a[76:79], v[140:143]
  s_waitcnt lgkmcnt(8)
  v_mfma_f32_16x16x32_bf16 v[144:147], a[196:199], a[64:67], v[144:147]
  ds_read_b64_tr_b16 a[216:217], v194 offset:12288
  ds_read_b64_tr_b16 a[218:219], v194 offset:18432
  v_mfma_f32_16x16x32_bf16 v[148:151], a[196:199], a[68:71], v[148:151]
  v_mfma_f32_16x16x32_bf16 v[152:155], a[196:199], a[72:75], v[152:155]
  v_mfma_f32_16x16x32_bf16 v[156:159], a[196:199], a[76:79], v[156:159]
  s_waitcnt lgkmcnt(8)
  v_mfma_f32_16x16x32_bf16 v[160:163], a[200:203], a[64:67], v[160:163]
  ds_read_b64_tr_b16 a[220:221], v195 offset:12288
  ds_read_b64_tr_b16 a[222:223], v195 offset:18432
  v_mfma_f32_16x16x32_bf16 v[164:167], a[200:203], a[68:71], v[164:167]
  buffer_load_dwordx4 v207, s[16:19], s34 offen offset:2048 lds
  v_mfma_f32_16x16x32_bf16 v[168:171], a[200:203], a[72:75], v[168:171]
  s_add_u32 s34, s34, 12288
  v_mfma_f32_16x16x32_bf16 v[172:175], a[200:203], a[76:79], v[172:175]
  s_waitcnt lgkmcnt(8)
  v_mfma_f32_16x16x32_bf16 v[176:179], a[204:207], a[64:67], v[176:179]
  ds_read_b64_tr_b16 a[192:193], v192 offset:12416
  ds_read_b64_tr_b16 a[194:195], v192 offset:18560
  v_mfma_f32_16x16x32_bf16 v[180:183], a[204:207], a[68:71], v[180:183]
  v_mfma_f32_16x16x32_bf16 v[184:187], a[204:207], a[72:75], v[184:187]
  s_waitcnt vmcnt(26)
  v_mfma_f32_16x16x32_bf16 v[188:191], a[204:207], a[76:79], v[188:191]
  s_waitcnt lgkmcnt(8)
  v_mfma_f32_16x16x32_bf16 v[0:3], a[208:211], a[80:83], v[0:3]
  ds_read_b64_tr_b16 a[196:197], v193 offset:12416
  ds_read_b64_tr_b16 a[198:199], v193 offset:18560
  v_mfma_f32_16x16x32_bf16 v[4:7], a[208:211], a[84:87], v[4:7]
  s_add_u32 m0, s31, 135168
  v_accvgpr_write_b32 a64, 0
  v_mfma_f32_16x16x32_bf16 v[8:11], a[208:211], a[88:91], v[8:11]
  buffer_load_dwordx4 v205, s[12:15], s33 offen offset:0 lds
  v_mfma_f32_16x16x32_bf16 v[12:15], a[208:211], a[92:95], v[12:15]
  s_waitcnt lgkmcnt(8)
  v_accvgpr_write_b32 a65, 0
  v_mfma_f32_16x16x32_bf16 v[16:19], a[212:215], a[80:83], v[16:19]
  ds_read_b64_tr_b16 a[200:201], v194 offset:12416
  ds_read_b64_tr_b16 a[202:203], v194 offset:18560
  v_mfma_f32_16x16x32_bf16 v[20:23], a[212:215], a[84:87], v[20:23]
  v_accvgpr_write_b32 a66, 0
  v_mfma_f32_16x16x32_bf16 v[24:27], a[212:215], a[88:91], v[24:27]
  v_mfma_f32_16x16x32_bf16 v[28:31], a[212:215], a[92:95], v[28:31]
  s_waitcnt lgkmcnt(8)
  v_accvgpr_write_b32 a67, 0
  v_mfma_f32_16x16x32_bf16 v[32:35], a[216:219], a[80:83], v[32:35]
  ds_read_b64_tr_b16 a[204:205], v195 offset:12416
  ds_read_b64_tr_b16 a[206:207], v195 offset:18560
  v_mfma_f32_16x16x32_bf16 v[36:39], a[216:219], a[84:87], v[36:39]
  v_accvgpr_write_b32 a68, 0
  v_mfma_f32_16x16x32_bf16 v[40:43], a[216:219], a[88:91], v[40:43]
  v_mfma_f32_16x16x32_bf16 v[44:47], a[216:219], a[92:95], v[44:47]
  s_waitcnt lgkmcnt(8)
  v_accvgpr_write_b32 a69, 0
  v_mfma_f32_16x16x32_bf16 v[48:51], a[220:223], a[80:83], v[48:51]
  ds_read_b64_tr_b16 a[208:209], v192 offset:12544
  ds_read_b64_tr_b16 a[210:211], v192 offset:18688
  v_mfma_f32_16x16x32_bf16 v[52:55], a[220:223], a[84:87], v[52:55]
  v_accvgpr_write_b32 a70, 0
  v_mfma_f32_16x16x32_bf16 v[56:59], a[220:223], a[88:91], v[56:59]
  v_mfma_f32_16x16x32_bf16 v[60:63], a[220:223], a[92:95], v[60:63]
  s_waitcnt lgkmcnt(8)
  v_accvgpr_write_b32 a71, 0
  v_mfma_f32_16x16x32_bf16 v[64:67], a[192:195], a[80:83], v[64:67]
  ds_read_b64_tr_b16 a[212:213], v193 offset:12544
  ds_read_b64_tr_b16 a[214:215], v193 offset:18688
  v_mfma_f32_16x16x32_bf16 v[68:71], a[192:195], a[84:87], v[68:71]
  buffer_load_dwordx4 v206, s[12:15], s33 offen offset:1024 lds
  v_accvgpr_write_b32 a72, 0
  v_mfma_f32_16x16x32_bf16 v[72:75], a[192:195], a[88:91], v[72:75]
  v_mfma_f32_16x16x32_bf16 v[76:79], a[192:195], a[92:95], v[76:79]
  s_waitcnt lgkmcnt(8)
  v_accvgpr_write_b32 a73, 0
  v_mfma_f32_16x16x32_bf16 v[80:83], a[196:199], a[80:83], v[80:83]
  ds_read_b64_tr_b16 a[216:217], v194 offset:12544
  ds_read_b64_tr_b16 a[218:219], v194 offset:18688
  v_mfma_f32_16x16x32_bf16 v[84:87], a[196:199], a[84:87], v[84:87]
  v_accvgpr_write_b32 a74, 0
  v_mfma_f32_16x16x32_bf16 v[88:91], a[196:199], a[88:91], v[88:91]
  v_mfma_f32_16x16x32_bf16 v[92:95], a[196:199], a[92:95], v[92:95]
  s_waitcnt lgkmcnt(8)
  v_accvgpr_write_b32 a75, 0
  v_mfma_f32_16x16x32_bf16 v[96:99], a[200:203], a[80:83], v[96:99]
  ds_read_b64_tr_b16 a[220:221], v195 offset:12544
  ds_read_b64_tr_b16 a[222:223], v195 offset:18688
  v_mfma_f32_16x16x32_bf16 v[100:103], a[200:203], a[84:87], v[100:103]
  v_accvgpr_write_b32 a76, 0
  v_mfma_f32_16x16x32_bf16 v[104:107], a[200:203], a[88:91], v[104:107]
  v_mfma_f32_16x16x32_bf16 v[108:111], a[200:203], a[92:95], v[108:111]
  s_waitcnt lgkmcnt(8)
  v_accvgpr_write_b32 a77, 0
  v_mfma_f32_16x16x32_bf16 v[112:115], a[204:207], a[80:83], v[112:115]
  ds_read_b64_tr_b16 a[192:193], v192 offset:24576
  ds_read_b64_tr_b16 a[194:195], v192 offset:30720
  v_mfma_f32_16x16x32_bf16 v[116:119], a[204:207], a[84:87], v[116:119]
  v_accvgpr_write_b32 a78, 0
  v_mfma_f32_16x16x32_bf16 v[120:123], a[204:207], a[88:91], v[120:123]
  v_mfma_f32_16x16x32_bf16 v[124:127], a[204:207], a[92:95], v[124:127]
  s_waitcnt lgkmcnt(8)
  buffer_load_dwordx4 v207, s[12:15], s33 offen offset:2048 lds
  v_accvgpr_write_b32 a79, 0
  v_mfma_f32_16x16x32_bf16 v[128:131], a[208:211], a[80:83], v[128:131]
  s_add_u32 s33, s33, 12288
  ds_read_b64_tr_b16 a[196:197], v193 offset:24576
  ds_read_b64_tr_b16 a[198:199], v193 offset:30720
  v_mfma_f32_16x16x32_bf16 v[132:135], a[208:211], a[84:87], v[132:135]
  v_mfma_f32_16x16x32_bf16 v[136:139], a[208:211], a[88:91], v[136:139]
  v_mfma_f32_16x16x32_bf16 v[140:143], a[208:211], a[92:95], v[140:143]
  s_waitcnt lgkmcnt(8)
  v_mfma_f32_16x16x32_bf16 v[144:147], a[212:215], a[80:83], v[144:147]
  ds_read_b64_tr_b16 a[200:201], v194 offset:24576
  ds_read_b64_tr_b16 a[202:203], v194 offset:30720
  v_mfma_f32_16x16x32_bf16 v[148:151], a[212:215], a[84:87], v[148:151]
  v_mfma_f32_16x16x32_bf16 v[152:155], a[212:215], a[88:91], v[152:155]
  v_mfma_f32_16x16x32_bf16 v[156:159], a[212:215], a[92:95], v[156:159]
  s_waitcnt lgkmcnt(8)
  v_mfma_f32_16x16x32_bf16 v[160:163], a[216:219], a[80:83], v[160:163]
  ds_read_b64_tr_b16 a[204:205], v195 offset:24576
  ds_read_b64_tr_b16 a[206:207], v195 offset:30720
  v_mfma_f32_16x16x32_bf16 v[164:167], a[216:219], a[84:87], v[164:167]
  v_mfma_f32_16x16x32_bf16 v[168:171], a[216:219], a[88:91], v[168:171]
  v_mfma_f32_16x16x32_bf16 v[172:175], a[216:219], a[92:95], v[172:175]
  s_waitcnt lgkmcnt(8)
  v_mfma_f32_16x16x32_bf16 v[176:179], a[220:223], a[80:83], v[176:179]
  ds_read_b64_tr_b16 a[208:209], v192 offset:24704
  ds_read_b64_tr_b16 a[210:211], v192 offset:30848
  v_mfma_f32_16x16x32_bf16 v[180:183], a[220:223], a[84:87], v[180:183]
  s_waitcnt vmcnt(19)
  v_mfma_f32_16x16x32_bf16 v[184:187], a[220:223], a[88:91], v[184:187]
  s_barrier
  v_mfma_f32_16x16x32_bf16 v[188:191], a[220:223], a[92:95], v[188:191]
  s_waitcnt lgkmcnt(8)
  v_mfma_f32_16x16x32_bf16 v[0:3], a[192:195], a[0:3], v[0:3]
  ds_read_b64_tr_b16 a[212:213], v193 offset:24704
  ds_read_b64_tr_b16 a[214:215], v193 offset:30848
  v_mfma_f32_16x16x32_bf16 v[4:7], a[192:195], a[4:7], v[4:7]
  s_add_u32 m0, s31, 73728
  v_accvgpr_write_b32 a80, 0
  v_mfma_f32_16x16x32_bf16 v[8:11], a[192:195], a[8:11], v[8:11]
  buffer_load_dwordx4 v205, s[16:19], s34 offen offset:0 lds
  v_mfma_f32_16x16x32_bf16 v[12:15], a[192:195], a[12:15], v[12:15]
  s_waitcnt lgkmcnt(8)
  v_accvgpr_write_b32 a81, 0
  v_mfma_f32_16x16x32_bf16 v[16:19], a[196:199], a[0:3], v[16:19]
  ds_read_b64_tr_b16 a[216:217], v194 offset:24704
  ds_read_b64_tr_b16 a[218:219], v194 offset:30848
  v_mfma_f32_16x16x32_bf16 v[20:23], a[196:199], a[4:7], v[20:23]
  v_accvgpr_write_b32 a82, 0
  v_mfma_f32_16x16x32_bf16 v[24:27], a[196:199], a[8:11], v[24:27]
  v_mfma_f32_16x16x32_bf16 v[28:31], a[196:199], a[12:15], v[28:31]
  s_waitcnt lgkmcnt(8)
  v_accvgpr_write_b32 a83, 0
  v_mfma_f32_16x16x32_bf16 v[32:35], a[200:203], a[0:3], v[32:35]
  ds_read_b64_tr_b16 a[220:221], v195 offset:24704
  ds_read_b64_tr_b16 a[222:223], v195 offset:30848
  v_mfma_f32_16x16x32_bf16 v[36:39], a[200:203], a[4:7], v[36:39]
  v_accvgpr_write_b32 a84, 0
  v_mfma_f32_16x16x32_bf16 v[40:43], a[200:203], a[8:11], v[40:43]
  v_mfma_f32_16x16x32_bf16 v[44:47], a[200:203], a[12:15], v[44:47]
  s_waitcnt lgkmcnt(8)
  v_accvgpr_write_b32 a85, 0
  v_mfma_f32_16x16x32_bf16 v[48:51], a[204:207], a[0:3], v[48:51]
  ds_read_b64_tr_b16 a[192:193], v192 offset:24832
  ds_read_b64_tr_b16 a[194:195], v192 offset:30976
  v_mfma_f32_16x16x32_bf16 v[52:55], a[204:207], a[4:7], v[52:55]
  v_accvgpr_write_b32 a86, 0
  v_mfma_f32_16x16x32_bf16 v[56:59], a[204:207], a[8:11], v[56:59]
  v_mfma_f32_16x16x32_bf16 v[60:63], a[204:207], a[12:15], v[60:63]
  s_waitcnt lgkmcnt(8)
  v_accvgpr_write_b32 a87, 0
  v_mfma_f32_16x16x32_bf16 v[64:67], a[208:211], a[0:3], v[64:67]
  ds_read_b64_tr_b16 a[196:197], v193 offset:24832
  ds_read_b64_tr_b16 a[198:199], v193 offset:30976
  v_mfma_f32_16x16x32_bf16 v[68:71], a[208:211], a[4:7], v[68:71]
  buffer_load_dwordx4 v206, s[16:19], s34 offen offset:1024 lds
  v_accvgpr_write_b32 a88, 0
  v_mfma_f32_16x16x32_bf16 v[72:75], a[208:211], a[8:11], v[72:75]
  v_mfma_f32_16x16x32_bf16 v[76:79], a[208:211], a[12:15], v[76:79]
  s_waitcnt lgkmcnt(8)
  v_accvgpr_write_b32 a89, 0
  v_mfma_f32_16x16x32_bf16 v[80:83], a[212:215], a[0:3], v[80:83]
  ds_read_b64_tr_b16 a[200:201], v194 offset:24832
  ds_read_b64_tr_b16 a[202:203], v194 offset:30976
  v_mfma_f32_16x16x32_bf16 v[84:87], a[212:215], a[4:7], v[84:87]
  v_accvgpr_write_b32 a90, 0
  v_mfma_f32_16x16x32_bf16 v[88:91], a[212:215], a[8:11], v[88:91]
  v_mfma_f32_16x16x32_bf16 v[92:95], a[212:215], a[12:15], v[92:95]
  s_waitcnt lgkmcnt(8)
  v_accvgpr_write_b32 a91, 0
  v_mfma_f32_16x16x32_bf16 v[96:99], a[216:219], a[0:3], v[96:99]
  ds_read_b64_tr_b16 a[204:205], v195 offset:24832
  ds_read_b64_tr_b16 a[206:207], v195 offset:30976
  v_mfma_f32_16x16x32_bf16 v[100:103], a[216:219], a[4:7], v[100:103]
  v_accvgpr_write_b32 a92, 0
  v_mfma_f32_16x16x32_bf16 v[104:107], a[216:219], a[8:11], v[104:107]
  v_mfma_f32_16x16x32_bf16 v[108:111], a[216:219], a[12:15], v[108:111]
  s_waitcnt lgkmcnt(8)
  v_accvgpr_write_b32 a93, 0
  v_mfma_f32_16x16x32_bf16 v[112:115], a[220:223], a[0:3], v[112:115]
  ds_read_b64_tr_b16 a[208:209], v192 offset:36864
  ds_read_b64_tr_b16 a[210:211], v192 offset:43008
  v_mfma_f32_16x16x32_bf16 v[116:119], a[220:223], a[4:7], v[116:119]
  v_accvgpr_write_b32 a94, 0
  v_mfma_f32_16x16x32_bf16 v[120:123], a[220:223], a[8:11], v[120:123]
  v_mfma_f32_16x16x32_bf16 v[124:127], a[220:223], a[12:15], v[124:127]
  s_waitcnt lgkmcnt(8)
  buffer_load_dwordx4 v207, s[16:19], s34 offen offset:2048 lds
  v_accvgpr_write_b32 a95, 0
  v_mfma_f32_16x16x32_bf16 v[128:131], a[192:195], a[0:3], v[128:131]
  s_add_u32 s34, s34, 12288
  ds_read_b64_tr_b16 a[212:213], v193 offset:36864
  ds_read_b64_tr_b16 a[214:215], v193 offset:43008
  v_mfma_f32_16x16x32_bf16 v[132:135], a[192:195], a[4:7], v[132:135]
  v_mfma_f32_16x16x32_bf16 v[136:139], a[192:195], a[8:11], v[136:139]
  v_mfma_f32_16x16x32_bf16 v[140:143], a[192:195], a[12:15], v[140:143]
  s_waitcnt lgkmcnt(8)
  v_mfma_f32_16x16x32_bf16 v[144:147], a[196:199], a[0:3], v[144:147]
  ds_read_b64_tr_b16 a[216:217], v194 offset:36864
  ds_read_b64_tr_b16 a[218:219], v194 offset:43008
  v_mfma_f32_16x16x32_bf16 v[148:151], a[196:199], a[4:7], v[148:151]
  v_mfma_f32_16x16x32_bf16 v[152:155], a[196:199], a[8:11], v[152:155]
  v_mfma_f32_16x16x32_bf16 v[156:159], a[196:199], a[12:15], v[156:159]
  s_waitcnt lgkmcnt(8)
  v_mfma_f32_16x16x32_bf16 v[160:163], a[200:203], a[0:3], v[160:163]
  ds_read_b64_tr_b16 a[220:221], v195 offset:36864
  ds_read_b64_tr_b16 a[222:223], v195 offset:43008
  v_mfma_f32_16x16x32_bf16 v[164:167], a[200:203], a[4:7], v[164:167]
  v_mfma_f32_16x16x32_bf16 v[168:171], a[200:203], a[8:11], v[168:171]
  v_mfma_f32_16x16x32_bf16 v[172:175], a[200:203], a[12:15], v[172:175]
  s_waitcnt lgkmcnt(8)
  v_mfma_f32_16x16x32_bf16 v[176:179], a[204:207], a[0:3], v[176:179]
  ds_read_b64_tr_b16 a[192:193], v192 offset:36992
  ds_read_b64_tr_b16 a[194:195], v192 offset:43136
  v_mfma_f32_16x16x32_bf16 v[180:183], a[204:207], a[4:7], v[180:183]
  v_mfma_f32_16x16x32_bf16 v[184:187], a[204:207], a[8:11], v[184:187]
  s_waitcnt vmcnt(18)
  v_mfma_f32_16x16x32_bf16 v[188:191], a[204:207], a[12:15], v[188:191]
  s_waitcnt lgkmcnt(8)
  v_mfma_f32_16x16x32_bf16 v[0:3], a[208:211], a[16:19], v[0:3]
  ds_read_b64_tr_b16 a[196:197], v193 offset:36992
  ds_read_b64_tr_b16 a[198:199], v193 offset:43136
  v_mfma_f32_16x16x32_bf16 v[4:7], a[208:211], a[20:23], v[4:7]
  v_accvgpr_write_b32 a0, 0
  v_mfma_f32_16x16x32_bf16 v[8:11], a[208:211], a[24:27], v[8:11]
  v_mfma_f32_16x16x32_bf16 v[12:15], a[208:211], a[28:31], v[12:15]
  s_waitcnt lgkmcnt(8)
  v_accvgpr_write_b32 a1, 0
  v_mfma_f32_16x16x32_bf16 v[16:19], a[212:215], a[16:19], v[16:19]
  ds_read_b64_tr_b16 a[200:201], v194 offset:36992
  ds_read_b64_tr_b16 a[202:203], v194 offset:43136
  v_mfma_f32_16x16x32_bf16 v[20:23], a[212:215], a[20:23], v[20:23]
  v_accvgpr_write_b32 a2, 0
  v_mfma_f32_16x16x32_bf16 v[24:27], a[212:215], a[24:27], v[24:27]
  v_mfma_f32_16x16x32_bf16 v[28:31], a[212:215], a[28:31], v[28:31]
  s_waitcnt lgkmcnt(8)
  v_accvgpr_write_b32 a3, 0
  v_mfma_f32_16x16x32_bf16 v[32:35], a[216:219], a[16:19], v[32:35]
  ds_read_b64_tr_b16 a[204:205], v195 offset:36992
  ds_read_b64_tr_b16 a[206:207], v195 offset:43136
  v_mfma_f32_16x16x32_bf16 v[36:39], a[216:219], a[20:23], v[36:39]
  v_accvgpr_write_b32 a4, 0
  v_mfma_f32_16x16x32_bf16 v[40:43], a[216:219], a[24:27], v[40:43]
  v_mfma_f32_16x16x32_bf16 v[44:47], a[216:219], a[28:31], v[44:47]
  s_waitcnt lgkmcnt(8)
  v_accvgpr_write_b32 a5, 0
  v_cvt_pk_bf16_f32 v0, v0, v1
  v_mfma_f32_16x16x32_bf16 v[48:51], a[220:223], a[16:19], v[48:51]
  ds_read_b64_tr_b16 a[208:209], v192 offset:37120
  ds_read_b64_tr_b16 a[210:211], v192 offset:43264
  v_mfma_f32_16x16x32_bf16 v[52:55], a[220:223], a[20:23], v[52:55]
  v_accvgpr_write_b32 a6, 0
  v_cvt_pk_bf16_f32 v1, v2, v3
  v_mfma_f32_16x16x32_bf16 v[56:59], a[220:223], a[24:27], v[56:59]
  v_cvt_pk_bf16_f32 v2, v16, v17
  v_cvt_pk_bf16_f32 v3, v18, v19
  v_mfma_f32_16x16x32_bf16 v[60:63], a[220:223], a[28:31], v[60:63]
  s_waitcnt lgkmcnt(8)
  v_accvgpr_write_b32 a7, 0
  v_cvt_pk_bf16_f32 v4, v4, v5
  v_mfma_f32_16x16x32_bf16 v[64:67], a[192:195], a[16:19], v[64:67]
  ds_read_b64_tr_b16 a[212:213], v193 offset:37120
  ds_read_b64_tr_b16 a[214:215], v193 offset:43264
  v_mfma_f32_16x16x32_bf16 v[68:71], a[192:195], a[20:23], v[68:71]
  v_accvgpr_write_b32 a8, 0
  v_cvt_pk_bf16_f32 v5, v6, v7
  v_mfma_f32_16x16x32_bf16 v[72:75], a[192:195], a[24:27], v[72:75]
  v_cvt_pk_bf16_f32 v6, v20, v21
  v_cvt_pk_bf16_f32 v7, v22, v23
  v_mfma_f32_16x16x32_bf16 v[76:79], a[192:195], a[28:31], v[76:79]
  s_waitcnt lgkmcnt(8)
  v_accvgpr_write_b32 a9, 0
  v_cvt_pk_bf16_f32 v8, v8, v9
  v_mfma_f32_16x16x32_bf16 v[80:83], a[196:199], a[16:19], v[80:83]
  ds_read_b64_tr_b16 a[216:217], v194 offset:37120
  ds_read_b64_tr_b16 a[218:219], v194 offset:43264
  v_mfma_f32_16x16x32_bf16 v[84:87], a[196:199], a[20:23], v[84:87]
  v_accvgpr_write_b32 a10, 0
  v_cvt_pk_bf16_f32 v9, v10, v11
  v_mfma_f32_16x16x32_bf16 v[88:91], a[196:199], a[24:27], v[88:91]
  v_cvt_pk_bf16_f32 v10, v24, v25
  v_cvt_pk_bf16_f32 v11, v26, v27
  v_mfma_f32_16x16x32_bf16 v[92:95], a[196:199], a[28:31], v[92:95]
  s_waitcnt lgkmcnt(8)
  v_accvgpr_write_b32 a11, 0
  v_cvt_pk_bf16_f32 v12, v12, v13
  v_mfma_f32_16x16x32_bf16 v[96:99], a[200:203], a[16:19], v[96:99]
  ds_read_b64_tr_b16 a[220:221], v195 offset:37120
  ds_read_b64_tr_b16 a[222:223], v195 offset:43264
  v_mfma_f32_16x16x32_bf16 v[100:103], a[200:203], a[20:23], v[100:103]
  v_accvgpr_write_b32 a12, 0
  v_cvt_pk_bf16_f32 v13, v14, v15
  v_mfma_f32_16x16x32_bf16 v[104:107], a[200:203], a[24:27], v[104:107]
  v_cvt_pk_bf16_f32 v14, v28, v29
  v_cvt_pk_bf16_f32 v15, v30, v31
  v_mfma_f32_16x16x32_bf16 v[108:111], a[200:203], a[28:31], v[108:111]
  s_waitcnt lgkmcnt(8)
  v_accvgpr_write_b32 a13, 0
  v_permlane32_swap_b32 v0, v2
  v_mfma_f32_16x16x32_bf16 v[112:115], a[204:207], a[16:19], v[112:115]
  v_permlane32_swap_b32 v1, v3
  v_permlane32_swap_b32 v4, v6
  v_mfma_f32_16x16x32_bf16 v[116:119], a[204:207], a[20:23], v[116:119]
  v_accvgpr_write_b32 a14, 0
  v_permlane32_swap_b32 v5, v7
  v_mfma_f32_16x16x32_bf16 v[120:123], a[204:207], a[24:27], v[120:123]
  v_permlane32_swap_b32 v8, v10
  v_permlane32_swap_b32 v9, v11
  v_mfma_f32_16x16x32_bf16 v[124:127], a[204:207], a[28:31], v[124:127]
  s_waitcnt lgkmcnt(6)
  v_accvgpr_write_b32 a15, 0
  v_permlane32_swap_b32 v12, v14
  v_mfma_f32_16x16x32_bf16 v[128:131], a[208:211], a[16:19], v[128:131]
  v_permlane32_swap_b32 v13, v15
  v_permlane16_swap_b32 v0, v2
  v_mfma_f32_16x16x32_bf16 v[132:135], a[208:211], a[20:23], v[132:135]
  v_permlane16_swap_b32 v1, v3
  v_permlane16_swap_b32 v4, v6
  v_mfma_f32_16x16x32_bf16 v[136:139], a[208:211], a[24:27], v[136:139]
  v_permlane16_swap_b32 v5, v7
  v_permlane16_swap_b32 v8, v10
  v_mfma_f32_16x16x32_bf16 v[140:143], a[208:211], a[28:31], v[140:143]
  s_waitcnt lgkmcnt(4)
  v_permlane16_swap_b32 v9, v11
  v_permlane16_swap_b32 v12, v14
  v_mfma_f32_16x16x32_bf16 v[144:147], a[212:215], a[16:19], v[144:147]
  v_permlane16_swap_b32 v13, v15
  v_cvt_pk_bf16_f32 v16, v32, v33
  v_mfma_f32_16x16x32_bf16 v[148:151], a[212:215], a[20:23], v[148:151]
  v_cvt_pk_bf16_f32 v17, v34, v35
  v_cvt_pk_bf16_f32 v18, v48, v49
  v_mfma_f32_16x16x32_bf16 v[152:155], a[212:215], a[24:27], v[152:155]
  v_cvt_pk_bf16_f32 v19, v50, v51
  v_cvt_pk_bf16_f32 v20, v36, v37
  v_mfma_f32_16x16x32_bf16 v[156:159], a[212:215], a[28:31], v[156:159]
  s_waitcnt lgkmcnt(2)
  v_cvt_pk_bf16_f32 v21, v38, v39
  v_cvt_pk_bf16_f32 v22, v52, v53
  v_mfma_f32_16x16x32_bf16 v[160:163], a[216:219], a[16:19], v[160:163]
  v_cvt_pk_bf16_f32 v23, v54, v55
  v_cvt_pk_bf16_f32 v24, v40, v41
  v_mfma_f32_16x16x32_bf16 v[164:167], a[216:219], a[20:23], v[164:167]
  v_cvt_pk_bf16_f32 v25, v42, v43
  v_cvt_pk_bf16_f32 v26, v56, v57
  v_mfma_f32_16x16x32_bf16 v[168:171], a[216:219], a[24:27], v[168:171]
  v_cvt_pk_bf16_f32 v27, v58, v59
  v_cvt_pk_bf16_f32 v28, v44, v45
  v_mfma_f32_16x16x32_bf16 v[172:175], a[216:219], a[28:31], v[172:175]
  s_waitcnt lgkmcnt(0)
  v_cvt_pk_bf16_f32 v29, v46, v47
  v_cvt_pk_bf16_f32 v30, v60, v61
  v_mfma_f32_16x16x32_bf16 v[176:179], a[220:223], a[16:19], v[176:179]
  v_cvt_pk_bf16_f32 v31, v62, v63
  v_permlane32_swap_b32 v16, v18
  v_mfma_f32_16x16x32_bf16 v[180:183], a[220:223], a[20:23], v[180:183]
  s_waitcnt vmcnt(15)
  v_permlane32_swap_b32 v17, v19
  v_permlane32_swap_b32 v20, v22
  v_mfma_f32_16x16x32_bf16 v[184:187], a[220:223], a[24:27], v[184:187]
  s_barrier
  v_permlane32_swap_b32 v21, v23
  v_permlane32_swap_b32 v24, v26
  v_mfma_f32_16x16x32_bf16 v[188:191], a[220:223], a[28:31], v[188:191]
  v_permlane32_swap_b32 v25, v27
  v_permlane32_swap_b32 v28, v30
  ds_read_b128 a[192:195], v200 offset:0
  ds_read_b128 a[196:199], v201 offset:0
  ds_read_b128 a[200:203], v200 offset:128
  ds_read_b128 a[204:207], v201 offset:128
  ds_read_b128 a[208:211], v200 offset:256
  s_waitcnt lgkmcnt(4)
  s_nop 1
  v_mfma_f32_16x16x32_bf16 v[224:227], a[192:195], v[0:3], 0
  ds_read_b128 a[212:215], v201 offset:256
  v_permlane32_swap_b32 v29, v31
  v_mfma_f32_16x16x32_bf16 v[228:231], a[192:195], v[4:7], 0
  v_permlane16_swap_b32 v16, v18
  v_permlane16_swap_b32 v17, v19
  v_mfma_f32_16x16x32_bf16 v[232:235], a[192:195], v[8:11], 0
  v_permlane16_swap_b32 v20, v22
  v_permlane16_swap_b32 v21, v23
  v_mfma_f32_16x16x32_bf16 v[236:239], a[192:195], v[12:15], 0
  s_waitcnt lgkmcnt(4)
  v_permlane16_swap_b32 v24, v26
  v_permlane16_swap_b32 v25, v27
  v_permlane16_swap_b32 v28, v30
  v_permlane16_swap_b32 v29, v31
  s_nop 1
  v_mfma_f32_16x16x32_bf16 v[224:227], a[196:199], v[16:19], v[224:227]
  ds_read_b128 a[216:219], v200 offset:6144
  v_cvt_pk_bf16_f32 v32, v64, v65
  v_mfma_f32_16x16x32_bf16 v[228:231], a[196:199], v[20:23], v[228:231]
  v_cvt_pk_bf16_f32 v33, v66, v67
  v_cvt_pk_bf16_f32 v34, v80, v81
  v_mfma_f32_16x16x32_bf16 v[232:235], a[196:199], v[24:27], v[232:235]
  v_cvt_pk_bf16_f32 v35, v82, v83
  v_cvt_pk_bf16_f32 v36, v68, v69
  v_mfma_f32_16x16x32_bf16 v[236:239], a[196:199], v[28:31], v[236:239]
  s_waitcnt lgkmcnt(4)
  v_cvt_pk_bf16_f32 v37, v70, v71
  v_cvt_pk_bf16_f32 v38, v84, v85
  v_cvt_pk_bf16_f32 v39, v86, v87
  v_cvt_pk_bf16_f32 v40, v72, v73
  v_cvt_pk_bf16_f32 v41, v74, v75
  v_cvt_pk_bf16_f32 v42, v88, v89
  v_cvt_pk_bf16_f32 v43, v90, v91
  v_cvt_pk_bf16_f32 v44, v76, v77
  v_cvt_pk_bf16_f32 v45, v78, v79
  v_cvt_pk_bf16_f32 v46, v92, v93
  v_cvt_pk_bf16_f32 v47, v94, v95
  v_permlane32_swap_b32 v32, v34
  v_permlane32_swap_b32 v33, v35
  v_permlane32_swap_b32 v36, v38
  v_permlane32_swap_b32 v37, v39
  v_permlane32_swap_b32 v40, v42
  v_permlane32_swap_b32 v41, v43
  v_permlane32_swap_b32 v44, v46
  v_permlane32_swap_b32 v45, v47
  v_permlane16_swap_b32 v32, v34
  v_permlane16_swap_b32 v33, v35
  v_permlane16_swap_b32 v36, v38
  v_permlane16_swap_b32 v37, v39
  v_permlane16_swap_b32 v40, v42
  v_permlane16_swap_b32 v41, v43
  v_permlane16_swap_b32 v44, v46
  v_permlane16_swap_b32 v45, v47
  s_nop 1
  v_mfma_f32_16x16x32_bf16 v[224:227], a[200:203], v[32:35], v[224:227]
  ds_read_b128 a[220:223], v201 offset:6144
  v_cvt_pk_bf16_f32 v48, v96, v97
  v_mfma_f32_16x16x32_bf16 v[228:231], a[200:203], v[36:39], v[228:231]
  v_cvt_pk_bf16_f32 v49, v98, v99
  v_cvt_pk_bf16_f32 v50, v112, v113
  v_mfma_f32_16x16x32_bf16 v[232:235], a[200:203], v[40:43], v[232:235]
  v_cvt_pk_bf16_f32 v51, v114, v115
  v_cvt_pk_bf16_f32 v52, v100, v101
  v_mfma_f32_16x16x32_bf16 v[236:239], a[200:203], v[44:47], v[236:239]
  s_waitcnt lgkmcnt(4)
  v_cvt_pk_bf16_f32 v53, v102, v103
  v_cvt_pk_bf16_f32 v54, v116, v117
  v_cvt_pk_bf16_f32 v55, v118, v119
  v_cvt_pk_bf16_f32 v56, v104, v105
  v_cvt_pk_bf16_f32 v57, v106, v107
  v_cvt_pk_bf16_f32 v58, v120, v121
  v_cvt_pk_bf16_f32 v59, v122, v123
  v_cvt_pk_bf16_f32 v60, v108, v109
  v_cvt_pk_bf16_f32 v61, v110, v111
  v_cvt_pk_bf16_f32 v62, v124, v125
  v_cvt_pk_bf16_f32 v63, v126, v127
  v_permlane32_swap_b32 v48, v50
  v_permlane32_swap_b32 v49, v51
  v_permlane32_swap_b32 v52, v54
  v_permlane32_swap_b32 v53, v55
  v_permlane32_swap_b32 v56, v58
  v_permlane32_swap_b32 v57, v59
  v_permlane32_swap_b32 v60, v62
  v_permlane32_swap_b32 v61, v63
  v_permlane16_swap_b32 v48, v50
  v_permlane16_swap_b32 v49, v51
  v_permlane16_swap_b32 v52, v54
  v_permlane16_swap_b32 v53, v55
  v_permlane16_swap_b32 v56, v58
  v_permlane16_swap_b32 v57, v59
  v_permlane16_swap_b32 v60, v62
  v_permlane16_swap_b32 v61, v63
  s_nop 1
  v_mfma_f32_16x16x32_bf16 v[224:227], a[204:207], v[48:51], v[224:227]
  ds_read_b128 a[192:195], v200 offset:6272
  v_cvt_pk_bf16_f32 v64, v128, v129
  v_mfma_f32_16x16x32_bf16 v[228:231], a[204:207], v[52:55], v[228:231]
  v_cvt_pk_bf16_f32 v65, v130, v131
  v_cvt_pk_bf16_f32 v66, v144, v145
  v_mfma_f32_16x16x32_bf16 v[232:235], a[204:207], v[56:59], v[232:235]
  v_cvt_pk_bf16_f32 v67, v146, v147
  v_cvt_pk_bf16_f32 v68, v132, v133
  v_mfma_f32_16x16x32_bf16 v[236:239], a[204:207], v[60:63], v[236:239]
  s_waitcnt lgkmcnt(4)
  v_cvt_pk_bf16_f32 v69, v134, v135
  v_cvt_pk_bf16_f32 v70, v148, v149
  v_cvt_pk_bf16_f32 v71, v150, v151
  v_cvt_pk_bf16_f32 v72, v136, v137
  v_cvt_pk_bf16_f32 v73, v138, v139
  v_cvt_pk_bf16_f32 v74, v152, v153
  v_cvt_pk_bf16_f32 v75, v154, v155
  v_cvt_pk_bf16_f32 v76, v140, v141
  v_cvt_pk_bf16_f32 v77, v142, v143
  v_cvt_pk_bf16_f32 v78, v156, v157
  v_cvt_pk_bf16_f32 v79, v158, v159
  v_permlane32_swap_b32 v64, v66
  v_permlane32_swap_b32 v65, v67
  v_permlane32_swap_b32 v68, v70
  v_permlane32_swap_b32 v69, v71
  v_permlane32_swap_b32 v72, v74
  v_permlane32_swap_b32 v73, v75
  v_permlane32_swap_b32 v76, v78
  v_permlane32_swap_b32 v77, v79
  v_permlane16_swap_b32 v64, v66
  v_permlane16_swap_b32 v65, v67
  v_permlane16_swap_b32 v68, v70
  v_permlane16_swap_b32 v69, v71
  v_permlane16_swap_b32 v72, v74
  v_permlane16_swap_b32 v73, v75
  v_permlane16_swap_b32 v76, v78
  v_permlane16_swap_b32 v77, v79
  s_nop 1
  v_mfma_f32_16x16x32_bf16 v[224:227], a[208:211], v[64:67], v[224:227]
  ds_read_b128 a[196:199], v201 offset:6272
  v_cvt_pk_bf16_f32 v80, v160, v161
  v_mfma_f32_16x16x32_bf16 v[228:231], a[208:211], v[68:71], v[228:231]
  v_cvt_pk_bf16_f32 v81, v162, v163
  v_cvt_pk_bf16_f32 v82, v176, v177
  v_mfma_f32_16x16x32_bf16 v[232:235], a[208:211], v[72:75], v[232:235]
  v_cvt_pk_bf16_f32 v83, v178, v179
  v_cvt_pk_bf16_f32 v84, v164, v165
  v_mfma_f32_16x16x32_bf16 v[236:239], a[208:211], v[76:79], v[236:239]
  s_waitcnt lgkmcnt(4)
  v_cvt_pk_bf16_f32 v85, v166, v167
  v_cvt_pk_bf16_f32 v86, v180, v181
  v_cvt_pk_bf16_f32 v87, v182, v183
  v_cvt_pk_bf16_f32 v88, v168, v169
  v_cvt_pk_bf16_f32 v89, v170, v171
  v_cvt_pk_bf16_f32 v90, v184, v185
  v_cvt_pk_bf16_f32 v91, v186, v187
  v_cvt_pk_bf16_f32 v92, v172, v173
  v_cvt_pk_bf16_f32 v93, v174, v175
  v_cvt_pk_bf16_f32 v94, v188, v189
  v_cvt_pk_bf16_f32 v95, v190, v191
  v_permlane32_swap_b32 v80, v82
  v_permlane32_swap_b32 v81, v83
  v_permlane32_swap_b32 v84, v86
  v_permlane32_swap_b32 v85, v87
  v_permlane32_swap_b32 v88, v90
  v_permlane32_swap_b32 v89, v91
  v_permlane32_swap_b32 v92, v94
  v_permlane32_swap_b32 v93, v95
  v_permlane16_swap_b32 v80, v82
  v_permlane16_swap_b32 v81, v83
  v_permlane16_swap_b32 v84, v86
  v_permlane16_swap_b32 v85, v87
  v_permlane16_swap_b32 v88, v90
  v_permlane16_swap_b32 v89, v91
  v_permlane16_swap_b32 v92, v94
  v_permlane16_swap_b32 v93, v95
  s_nop 1
  v_mfma_f32_16x16x32_bf16 v[224:227], a[212:215], v[80:83], v[224:227]
  ds_read_b128 a[200:203], v200 offset:6400
  v_accvgpr_write_b32 a16, 0
  v_mfma_f32_16x16x32_bf16 v[228:231], a[212:215], v[84:87], v[228:231]
  v_accvgpr_write_b32 a17, 0
  v_accvgpr_write_b32 a18, 0
  v_mfma_f32_16x16x32_bf16 v[232:235], a[212:215], v[88:91], v[232:235]
  v_accvgpr_write_b32 a19, 0
  v_accvgpr_write_b32 a20, 0
  v_mfma_f32_16x16x32_bf16 v[236:239], a[212:215], v[92:95], v[236:239]
  s_waitcnt lgkmcnt(4)
  v_accvgpr_write_b32 a21, 0
  v_accvgpr_write_b32 a22, 0
  v_accvgpr_write_b32 a23, 0
  v_accvgpr_write_b32 a24, 0
  v_accvgpr_write_b32 a25, 0
  v_accvgpr_write_b32 a26, 0
  v_accvgpr_write_b32 a27, 0
  v_accvgpr_write_b32 a28, 0
  v_accvgpr_write_b32 a29, 0
  v_accvgpr_write_b32 a30, 0
  v_accvgpr_write_b32 a31, 0
  s_nop 7
  v_max3_f32 v182, v224, v225, v226
  v_max3_f32 v183, v228, v229, v230
  v_max3_f32 v184, v232, v233, v234
  v_max3_f32 v185, v236, v237, v238
  v_max_f32 v182, v182, v227
  v_mov_b32 v186, 0
  v_max_f32 v183, v183, v231
  v_mov_b32 v187, 0
  v_max_f32 v184, v184, v235
  v_mov_b32 v188, 0
  v_max_f32 v185, v185, v239
  v_mov_b32 v189, 0
  v_mov_b32 v186, v182
  v_mov_b32 v187, v183
  v_mov_b32 v188, v184
  v_mov_b32 v189, v185
  s_nop 0
  v_permlane32_swap_b32 v182, v186
  v_permlane32_swap_b32 v183, v187
  v_permlane32_swap_b32 v184, v188
  v_permlane32_swap_b32 v185, v189
  v_max_f32 v182, v182, v186
  v_max_f32 v183, v183, v187
  v_max_f32 v184, v184, v188
  v_max_f32 v185, v185, v189
  v_mov_b32 v186, v182
  v_mov_b32 v187, v183
  v_mov_b32 v188, v184
  v_mov_b32 v189, v185
  s_nop 0
  v_permlane16_swap_b32 v182, v186
  v_permlane16_swap_b32 v183, v187
  v_permlane16_swap_b32 v184, v188
  v_permlane16_swap_b32 v185, v189
  v_max_f32 v182, v182, v186
  v_max_f32 v183, v183, v187
  v_max_f32 v184, v184, v188
  v_max_f32 v185, v185, v189
  v_sub_f32 v160, 0, v182
  v_sub_f32 v161, 0, v182
  v_sub_f32 v162, 0, v182
  v_sub_f32 v163, 0, v182
  v_mov_b32 v176, 0
  v_sub_f32 v164, 0, v183
  v_sub_f32 v165, 0, v183
  v_sub_f32 v166, 0, v183
  v_sub_f32 v167, 0, v183
  v_mov_b32 v177, 0
  v_sub_f32 v168, 0, v184
  v_sub_f32 v169, 0, v184
  v_sub_f32 v170, 0, v184
  v_sub_f32 v171, 0, v184
  v_mov_b32 v178, 0
  v_sub_f32 v172, 0, v185
  v_sub_f32 v173, 0, v185
  v_sub_f32 v174, 0, v185
  v_sub_f32 v175, 0, v185
  v_mov_b32 v179, 0
  s_nop 1
  v_mfma_f32_16x16x32_bf16 v[240:243], a[216:219], v[0:3], v[160:163]
  ds_read_b128 a[204:207], v201 offset:6400
  v_add_f32 v224, v224, v160
  v_mfma_f32_16x16x32_bf16 v[244:247], a[216:219], v[4:7], v[164:167]
  v_add_f32 v225, v225, v160
  v_add_f32 v226, v226, v160
  v_mfma_f32_16x16x32_bf16 v[248:251], a[216:219], v[8:11], v[168:171]
  v_add_f32 v227, v227, v160
  v_add_f32 v228, v228, v164
  v_mfma_f32_16x16x32_bf16 v[252:255], a[216:219], v[12:15], v[172:175]
  s_waitcnt lgkmcnt(4)
  v_add_f32 v229, v229, v164
  v_add_f32 v230, v230, v164
  v_mfma_f32_16x16x32_bf16 v[240:243], a[220:223], v[16:19], v[240:243]
  v_add_f32 v231, v231, v164
  v_add_f32 v232, v232, v168
  v_mfma_f32_16x16x32_bf16 v[244:247], a[220:223], v[20:23], v[244:247]
  v_add_f32 v233, v233, v168
  v_add_f32 v234, v234, v168
  v_mfma_f32_16x16x32_bf16 v[248:251], a[220:223], v[24:27], v[248:251]
  v_add_f32 v235, v235, v168
  v_add_f32 v236, v236, v172
  v_mfma_f32_16x16x32_bf16 v[252:255], a[220:223], v[28:31], v[252:255]
  s_waitcnt lgkmcnt(3)
  v_add_f32 v237, v237, v172
  v_add_f32 v238, v238, v172
  v_mfma_f32_16x16x32_bf16 v[240:243], a[192:195], v[32:35], v[240:243]
  v_add_f32 v239, v239, v172
  v_mfma_f32_16x16x32_bf16 v[244:247], a[192:195], v[36:39], v[244:247]
  v_exp_f32 v224, v224
  v_mfma_f32_16x16x32_bf16 v[248:251], a[192:195], v[40:43], v[248:251]
  v_exp_f32 v225, v225
  v_mfma_f32_16x16x32_bf16 v[252:255], a[192:195], v[44:47], v[252:255]
  s_waitcnt lgkmcnt(2)
  v_exp_f32 v226, v226
  v_mfma_f32_16x16x32_bf16 v[240:243], a[196:199], v[48:51], v[240:243]
  ds_read_b128 a[192:195], v200 offset:12288
  v_mfma_f32_16x16x32_bf16 v[244:247], a[196:199], v[52:55], v[244:247]
  v_exp_f32 v227, v227
  v_mfma_f32_16x16x32_bf16 v[248:251], a[196:199], v[56:59], v[248:251]
  s_nop 0
  v_add_f32 v176, v176, v224
  v_mfma_f32_16x16x32_bf16 v[252:255], a[196:199], v[60:63], v[252:255]
  s_waitcnt lgkmcnt(2)
  v_add_f32 v176, v176, v225
  v_cvt_pk_bf16_f32 v128, v224, v225
  v_mfma_f32_16x16x32_bf16 v[240:243], a[200:203], v[64:67], v[240:243]
  ds_read_b128 a[196:199], v201 offset:12288
  v_add_f32 v176, v176, v226
  v_mfma_f32_16x16x32_bf16 v[244:247], a[200:203], v[68:71], v[244:247]
  v_add_f32 v176, v176, v227
  v_cvt_pk_bf16_f32 v129, v226, v227
  v_mfma_f32_16x16x32_bf16 v[248:251], a[200:203], v[72:75], v[248:251]
  v_exp_f32 v228, v228
  v_mfma_f32_16x16x32_bf16 v[252:255], a[200:203], v[76:79], v[252:255]
  s_waitcnt lgkmcnt(2)
  v_exp_f32 v229, v229
  v_mfma_f32_16x16x32_bf16 v[240:243], a[204:207], v[80:83], v[240:243]
  ds_read_b128 a[200:203], v200 offset:12416
  v_mfma_f32_16x16x32_bf16 v[244:247], a[204:207], v[84:87], v[244:247]
  v_exp_f32 v230, v230
  v_mfma_f32_16x16x32_bf16 v[248:251], a[204:207], v[88:91], v[248:251]
  v_exp_f32 v231, v231
  v_mfma_f32_16x16x32_bf16 v[252:255], a[204:207], v[92:95], v[252:255]
  s_nop 0
  v_add_f32 v177, v177, v228
  ds_read_b128 a[204:207], v201 offset:12416
  ds_read_b128 a[208:211], v200 offset:12544
  v_add_f32 v177, v177, v229
  v_cvt_pk_bf16_f32 v132, v228, v229
  v_add_f32 v177, v177, v230
  v_add_f32 v177, v177, v231
  v_cvt_pk_bf16_f32 v133, v230, v231
  v_exp_f32 v232, v232
  v_exp_f32 v233, v233
  v_exp_f32 v234, v234
  v_exp_f32 v235, v235
  s_nop 0
  v_add_f32 v178, v178, v232
  v_add_f32 v178, v178, v233
  v_cvt_pk_bf16_f32 v136, v232, v233
  v_add_f32 v178, v178, v234
  v_add_f32 v178, v178, v235
  v_cvt_pk_bf16_f32 v137, v234, v235
  v_exp_f32 v236, v236
  v_exp_f32 v237, v237
  v_exp_f32 v238, v238
  v_exp_f32 v239, v239
  s_nop 0
  v_add_f32 v179, v179, v236
  v_add_f32 v179, v179, v237
  v_cvt_pk_bf16_f32 v140, v236, v237
  v_add_f32 v179, v179, v238
  v_add_f32 v179, v179, v239
  v_cvt_pk_bf16_f32 v141, v238, v239
  s_nop 7
  v_exp_f32 v240, v240
  v_exp_f32 v241, v241
  v_exp_f32 v242, v242
  v_exp_f32 v243, v243
  s_nop 0
  v_add_f32 v176, v176, v240
  v_add_f32 v176, v176, v241
  v_cvt_pk_bf16_f32 v130, v240, v241
  v_add_f32 v176, v176, v242
  v_add_f32 v176, v176, v243
  v_cvt_pk_bf16_f32 v131, v242, v243
  v_exp_f32 v244, v244
  v_exp_f32 v245, v245
  v_exp_f32 v246, v246
  v_exp_f32 v247, v247
  s_nop 0
  v_add_f32 v177, v177, v244
  v_add_f32 v177, v177, v245
  v_cvt_pk_bf16_f32 v134, v244, v245
  v_add_f32 v177, v177, v246
  v_add_f32 v177, v177, v247
  v_cvt_pk_bf16_f32 v135, v246, v247
  s_waitcnt lgkmcnt(4)
  s_mov_b32 s36, 3
.p2align 6
L_k2_loop:
  v_mfma_f32_16x16x32_bf16 v[224:227], a[192:195], v[0:3], v[160:163]
  s_waitcnt vmcnt(9)
  ds_read_b128 a[212:215], v201 offset:12544
  v_mfma_f32_16x16x32_bf16 v[228:231], a[192:195], v[4:7], v[164:167]
  s_barrier
  v_mfma_f32_16x16x32_bf16 v[232:235], a[192:195], v[8:11], v[168:171]
  v_exp_f32 v248, v248
  v_mfma_f32_16x16x32_bf16 v[236:239], a[192:195], v[12:15], v[172:175]
  s_waitcnt lgkmcnt(4)
  v_exp_f32 v249, v249
  v_mfma_f32_16x16x32_bf16 v[224:227], a[196:199], v[16:19], v[224:227]
  ds_read_b128 a[216:219], v200 offset:18432
  v_add_f32 v178, v178, v248
  v_mfma_f32_16x16x32_bf16 v[228:231], a[196:199], v[20:23], v[228:231]
  s_add_u32 m0, s31, 98304
  v_exp_f32 v250, v250
  v_mfma_f32_16x16x32_bf16 v[232:235], a[196:199], v[24:27], v[232:235]
  buffer_load_dwordx4 v205, s[12:15], s33 offen offset:0 lds
  v_add_f32 v178, v178, v249
  v_mfma_f32_16x16x32_bf16 v[236:239], a[196:199], v[28:31], v[236:239]
  s_waitcnt lgkmcnt(4)
  v_exp_f32 v251, v251
  v_mfma_f32_16x16x32_bf16 v[224:227], a[200:203], v[32:35], v[224:227]
  ds_read_b128 a[220:223], v201 offset:18432
  v_cvt_pk_bf16_f32 v138, v248, v249
  v_mfma_f32_16x16x32_bf16 v[228:231], a[200:203], v[36:39], v[228:231]
  v_add_f32 v178, v178, v250
  v_add_f32 v178, v178, v251
  v_mfma_f32_16x16x32_bf16 v[232:235], a[200:203], v[40:43], v[232:235]
  v_cvt_pk_bf16_f32 v139, v250, v251
  v_mfma_f32_16x16x32_bf16 v[236:239], a[200:203], v[44:47], v[236:239]
  s_waitcnt lgkmcnt(4)
  v_mfma_f32_16x16x32_bf16 v[224:227], a[204:207], v[48:51], v[224:227]
  ds_read_b128 a[192:195], v200 offset:18560
  v_mfma_f32_16x16x32_bf16 v[228:231], a[204:207], v[52:55], v[228:231]
  v_mfma_f32_16x16x32_bf16 v[232:235], a[204:207], v[56:59], v[232:235]
  buffer_load_dwordx4 v206, s[12:15], s33 offen offset:1024 lds
  v_mfma_f32_16x16x32_bf16 v[236:239], a[204:207], v[60:63], v[236:239]
  s_waitcnt lgkmcnt(4)
  v_exp_f32 v252, v252
  v_mfma_f32_16x16x32_bf16 v[224:227], a[208:211], v[64:67], v[224:227]
  ds_read_b128 a[196:199], v201 offset:18560
  v_add_f32 v179, v179, v252
  v_mfma_f32_16x16x32_bf16 v[228:231], a[208:211], v[68:71], v[228:231]
  v_exp_f32 v253, v253
  v_mfma_f32_16x16x32_bf16 v[232:235], a[208:211], v[72:75], v[232:235]
  v_exp_f32 v254, v254
  v_mfma_f32_16x16x32_bf16 v[236:239], a[208:211], v[76:79], v[236:239]
  s_waitcnt lgkmcnt(4)
  v_exp_f32 v255, v255
  v_mfma_f32_16x16x32_bf16 v[224:227], a[212:215], v[80:83], v[224:227]
  ds_read_b128 a[200:203], v200 offset:18688
  v_add_f32 v179, v179, v253
  v_mfma_f32_16x16x32_bf16 v[228:231], a[212:215], v[84:87], v[228:231]
  v_cvt_pk_bf16_f32 v142, v252, v253
  v_add_f32 v179, v179, v254
  v_mfma_f32_16x16x32_bf16 v[232:235], a[212:215], v[88:91], v[232:235]
  buffer_load_dwordx4 v207, s[12:15], s33 offen offset:2048 lds
  v_add_f32 v179, v179, v255
  v_mfma_f32_16x16x32_bf16 v[236:239], a[212:215], v[92:95], v[236:239]
  s_waitcnt lgkmcnt(4)
  v_cvt_pk_bf16_f32 v143, v254, v255
  v_mfma_f32_16x16x32_bf16 v[240:243], a[216:219], v[0:3], v[160:163]
  ds_read_b128 a[204:207], v201 offset:18688
  v_mfma_f32_16x16x32_bf16 v[244:247], a[216:219], v[4:7], v[164:167]
  s_add_u32 s33, s33, 12288
  v_mfma_f32_16x16x32_bf16 v[248:251], a[216:219], v[8:11], v[168:171]
  v_exp_f32 v224, v224
  v_mfma_f32_16x16x32_bf16 v[252:255], a[216:219], v[12:15], v[172:175]
  s_waitcnt lgkmcnt(4)
  v_exp_f32 v225, v225
  v_mfma_f32_16x16x32_bf16 v[240:243], a[220:223], v[16:19], v[240:243]
  s_mov_b32 m0, s91
  ds_read_b64_tr_b16 a[208:209], v196 offset:0
  ds_read_b64_tr_b16 a[210:211], v196 offset:6144
  v_mfma_f32_16x16x32_bf16 v[244:247], a[220:223], v[20:23], v[244:247]
  v_exp_f32 v226, v226
  v_mfma_f32_16x16x32_bf16 v[248:251], a[220:223], v[24:27], v[248:251]
  v_exp_f32 v227, v227
  v_mfma_f32_16x16x32_bf16 v[252:255], a[220:223], v[28:31], v[252:255]
  s_waitcnt lgkmcnt(5)
  v_add_f32 v176, v176, v224
  v_add_f32 v176, v176, v225
  v_mfma_f32_16x16x32_bf16 v[240:243], a[192:195], v[32:35], v[240:243]
  ds_read_b64_tr_b16 a[212:213], v197 offset:0
  ds_read_b64_tr_b16 a[214:215], v197 offset:6144
  v_mfma_f32_16x16x32_bf16 v[244:247], a[192:195], v[36:39], v[244:247]
  v_cvt_pk_bf16_f32 v144, v224, v225
  v_add_f32 v176, v176, v226
  v_mfma_f32_16x16x32_bf16 v[248:251], a[192:195], v[40:43], v[248:251]
  v_add_f32 v176, v176, v227
  v_cvt_pk_bf16_f32 v145, v226, v227
  v_mfma_f32_16x16x32_bf16 v[252:255], a[192:195], v[44:47], v[252:255]
  s_waitcnt lgkmcnt(6)
  buffer_load_dwordx4 v208, s[60:63], s90 offen lds
  v_mfma_f32_16x16x32_bf16 v[240:243], a[196:199], v[48:51], v[240:243]
  ds_read_b64_tr_b16 a[216:217], v198 offset:0
  ds_read_b64_tr_b16 a[218:219], v198 offset:6144
  v_mfma_f32_16x16x32_bf16 v[244:247], a[196:199], v[52:55], v[244:247]
  v_mfma_f32_16x16x32_bf16 v[248:251], a[196:199], v[56:59], v[248:251]
  v_exp_f32 v228, v228
  v_mfma_f32_16x16x32_bf16 v[252:255], a[196:199], v[60:63], v[252:255]
  s_waitcnt lgkmcnt(7)
  v_exp_f32 v229, v229
  v_mfma_f32_16x16x32_bf16 v[240:243], a[200:203], v[64:67], v[240:243]
  ds_read_b64_tr_b16 a[220:221], v199 offset:0
  ds_read_b64_tr_b16 a[222:223], v199 offset:6144
  v_mfma_f32_16x16x32_bf16 v[244:247], a[200:203], v[68:71], v[244:247]
  s_add_u32 s90, s90, 1024
  v_exp_f32 v230, v230
  v_mfma_f32_16x16x32_bf16 v[248:251], a[200:203], v[72:75], v[248:251]
  v_exp_f32 v231, v231
  v_mfma_f32_16x16x32_bf16 v[252:255], a[200:203], v[76:79], v[252:255]
  s_waitcnt lgkmcnt(8)
  v_add_f32 v177, v177, v228
  v_add_f32 v177, v177, v229
  v_mfma_f32_16x16x32_bf16 v[240:243], a[204:207], v[80:83], v[240:243]
  ds_read_b64_tr_b16 a[192:193], v196 offset:128
  ds_read_b64_tr_b16 a[194:195], v196 offset:6272
  v_mfma_f32_16x16x32_bf16 v[244:247], a[204:207], v[84:87], v[244:247]
  v_cvt_pk_bf16_f32 v148, v228, v229
  v_add_f32 v177, v177, v230
  v_mfma_f32_16x16x32_bf16 v[248:251], a[204:207], v[88:91], v[248:251]
  v_add_f32 v177, v177, v231
  v_cvt_pk_bf16_f32 v149, v230, v231
  v_mfma_f32_16x16x32_bf16 v[252:255], a[204:207], v[92:95], v[252:255]
  s_waitcnt lgkmcnt(8)
  v_mfma_f32_16x16x32_bf16 a[0:3], a[208:211], v[128:131], a[0:3]
  ds_read_b64_tr_b16 a[196:197], v197 offset:128
  ds_read_b64_tr_b16 a[198:199], v197 offset:6272
  v_mfma_f32_16x16x32_bf16 a[4:7], a[208:211], v[132:135], a[4:7]
  v_mfma_f32_16x16x32_bf16 a[8:11], a[208:211], v[136:139], a[8:11]
  v_exp_f32 v232, v232
  v_mfma_f32_16x16x32_bf16 a[12:15], a[208:211], v[140:143], a[12:15]
  s_waitcnt lgkmcnt(8)
  v_exp_f32 v233, v233
  v_mfma_f32_16x16x32_bf16 a[16:19], a[212:215], v[128:131], a[16:19]
  ds_read_b64_tr_b16 a[200:201], v198 offset:128
  ds_read_b64_tr_b16 a[202:203], v198 offset:6272
  v_mfma_f32_16x16x32_bf16 a[20:23], a[212:215], v[132:135], a[20:23]
  s_add_u32 m0, s31, 86016
  v_exp_f32 v234, v234
  v_mfma_f32_16x16x32_bf16 a[24:27], a[212:215], v[136:139], a[24:27]
  buffer_load_dwordx4 v205, s[16:19], s34 offen offset:0 lds
  v_add_f32 v178, v178, v232
  v_mfma_f32_16x16x32_bf16 a[28:31], a[212:215], v[140:143], a[28:31]
  s_waitcnt lgkmcnt(8)
  v_exp_f32 v235, v235
  v_mfma_f32_16x16x32_bf16 a[32:35], a[216:219], v[128:131], a[32:35]
  ds_read_b64_tr_b16 a[204:205], v199 offset:128
  ds_read_b64_tr_b16 a[206:207], v199 offset:6272
  v_mfma_f32_16x16x32_bf16 a[36:39], a[216:219], v[132:135], a[36:39]
  v_add_f32 v178, v178, v233
  v_cvt_pk_bf16_f32 v152, v232, v233
  v_mfma_f32_16x16x32_bf16 a[40:43], a[216:219], v[136:139], a[40:43]
  v_add_f32 v178, v178, v234
  v_add_f32 v178, v178, v235
  v_mfma_f32_16x16x32_bf16 a[44:47], a[216:219], v[140:143], a[44:47]
  s_waitcnt lgkmcnt(8)
  v_cvt_pk_bf16_f32 v153, v234, v235
  v_mfma_f32_16x16x32_bf16 a[48:51], a[220:223], v[128:131], a[48:51]
  ds_read_b64_tr_b16 a[208:209], v196 offset:256
  ds_read_b64_tr_b16 a[210:211], v196 offset:6400
  v_mfma_f32_16x16x32_bf16 a[52:55], a[220:223], v[132:135], a[52:55]
  v_mfma_f32_16x16x32_bf16 a[56:59], a[220:223], v[136:139], a[56:59]
  buffer_load_dwordx4 v206, s[16:19], s34 offen offset:1024 lds
  v_mfma_f32_16x16x32_bf16 a[60:63], a[220:223], v[140:143], a[60:63]
  s_waitcnt lgkmcnt(8)
  v_exp_f32 v236, v236
  v_mfma_f32_16x16x32_bf16 a[64:67], a[192:195], v[128:131], a[64:67]
  ds_read_b64_tr_b16 a[212:213], v197 offset:256
  ds_read_b64_tr_b16 a[214:215], v197 offset:6400
  v_mfma_f32_16x16x32_bf16 a[68:71], a[192:195], v[132:135], a[68:71]
  v_exp_f32 v237, v237
  v_mfma_f32_16x16x32_bf16 a[72:75], a[192:195], v[136:139], a[72:75]
  v_exp_f32 v238, v238
  v_mfma_f32_16x16x32_bf16 a[76:79], a[192:195], v[140:143], a[76:79]
  s_waitcnt lgkmcnt(8)
  v_exp_f32 v239, v239
  v_mfma_f32_16x16x32_bf16 a[80:83], a[196:199], v[128:131], a[80:83]
  ds_read_b64_tr_b16 a[216:217], v198 offset:256
  ds_read_b64_tr_b16 a[218:219], v198 offset:6400
  v_mfma_f32_16x16x32_bf16 a[84:87], a[196:199], v[132:135], a[84:87]
  v_add_f32 v179, v179, v236
  v_add_f32 v179, v179, v237
  v_mfma_f32_16x16x32_bf16 a[88:91], a[196:199], v[136:139], a[88:91]
  buffer_load_dwordx4 v207, s[16:19], s34 offen offset:2048 lds
  v_cvt_pk_bf16_f32 v156, v236, v237
  v_mfma_f32_16x16x32_bf16 a[92:95], a[196:199], v[140:143], a[92:95]
  s_waitcnt lgkmcnt(8)
  v_add_f32 v179, v179, v238
  v_add_f32 v179, v179, v239
  v_mfma_f32_16x16x32_bf16 a[96:99], a[200:203], v[128:131], a[96:99]
  ds_read_b64_tr_b16 a[220:221], v199 offset:256
  ds_read_b64_tr_b16 a[222:223], v199 offset:6400
  v_mfma_f32_16x16x32_bf16 a[100:103], a[200:203], v[132:135], a[100:103]
  s_add_u32 s34, s34, 12288
  v_cvt_pk_bf16_f32 v157, v238, v239
  v_mfma_f32_16x16x32_bf16 a[104:107], a[200:203], v[136:139], a[104:107]
  v_exp_f32 v240, v240
  v_mfma_f32_16x16x32_bf16 a[108:111], a[200:203], v[140:143], a[108:111]
  s_waitcnt lgkmcnt(8)
  v_exp_f32 v241, v241
  v_mfma_f32_16x16x32_bf16 a[112:115], a[204:207], v[128:131], a[112:115]
  ds_read_b128 a[192:195], v200 offset:24576
  v_add_f32 v176, v176, v240
  v_mfma_f32_16x16x32_bf16 a[116:119], a[204:207], v[132:135], a[116:119]
  v_exp_f32 v242, v242
  v_mfma_f32_16x16x32_bf16 a[120:123], a[204:207], v[136:139], a[120:123]
  v_exp_f32 v243, v243
  v_mfma_f32_16x16x32_bf16 a[124:127], a[204:207], v[140:143], a[124:127]
  s_waitcnt lgkmcnt(7)
  v_add_f32 v176, v176, v241
  v_cvt_pk_bf16_f32 v146, v240, v241
  v_mfma_f32_16x16x32_bf16 a[128:131], a[208:211], v[128:131], a[128:131]
  ds_read_b128 a[196:199], v201 offset:24576
  v_add_f32 v176, v176, v242
  v_mfma_f32_16x16x32_bf16 a[132:135], a[208:211], v[132:135], a[132:135]
  v_add_f32 v176, v176, v243
  v_cvt_pk_bf16_f32 v147, v242, v243
  v_mfma_f32_16x16x32_bf16 a[136:139], a[208:211], v[136:139], a[136:139]
  v_mfma_f32_16x16x32_bf16 a[140:143], a[208:211], v[140:143], a[140:143]
  s_waitcnt lgkmcnt(6)
  v_mfma_f32_16x16x32_bf16 a[144:147], a[212:215], v[128:131], a[144:147]
  ds_read_b128 a[200:203], v200 offset:24704
  v_mfma_f32_16x16x32_bf16 a[148:151], a[212:215], v[132:135], a[148:151]
  v_mfma_f32_16x16x32_bf16 a[152:155], a[212:215], v[136:139], a[152:155]
  v_exp_f32 v244, v244
  v_mfma_f32_16x16x32_bf16 a[156:159], a[212:215], v[140:143], a[156:159]
  s_waitcnt lgkmcnt(5)
  v_exp_f32 v245, v245
  v_mfma_f32_16x16x32_bf16 a[160:163], a[216:219], v[128:131], a[160:163]
  ds_read_b128 a[204:207], v201 offset:24704
  v_add_f32 v177, v177, v244
  v_mfma_f32_16x16x32_bf16 a[164:167], a[216:219], v[132:135], a[164:167]
  v_exp_f32 v246, v246
  v_mfma_f32_16x16x32_bf16 a[168:171], a[216:219], v[136:139], a[168:171]
  v_exp_f32 v247, v247
  v_mfma_f32_16x16x32_bf16 a[172:175], a[216:219], v[140:143], a[172:175]
  s_waitcnt lgkmcnt(4)
  v_add_f32 v177, v177, v245
  v_cvt_pk_bf16_f32 v150, v244, v245
  v_mfma_f32_16x16x32_bf16 a[176:179], a[220:223], v[128:131], a[176:179]
  ds_read_b128 a[208:211], v200 offset:24832
  v_add_f32 v177, v177, v246
  v_mfma_f32_16x16x32_bf16 a[180:183], a[220:223], v[132:135], a[180:183]
  v_add_f32 v177, v177, v247
  v_cvt_pk_bf16_f32 v151, v246, v247
  v_mfma_f32_16x16x32_bf16 a[184:187], a[220:223], v[136:139], a[184:187]
  v_mfma_f32_16x16x32_bf16 a[188:191], a[220:223], v[140:143], a[188:191]
  s_waitcnt lgkmcnt(4)
  v_mfma_f32_16x16x32_bf16 v[224:227], a[192:195], v[0:3], v[160:163]
  s_waitcnt vmcnt(10)
  ds_read_b128 a[212:215], v201 offset:24832
  v_mfma_f32_16x16x32_bf16 v[228:231], a[192:195], v[4:7], v[164:167]
  s_barrier
  v_mfma_f32_16x16x32_bf16 v[232:235], a[192:195], v[8:11], v[168:171]
  v_exp_f32 v248, v248
  v_mfma_f32_16x16x32_bf16 v[236:239], a[192:195], v[12:15], v[172:175]
  s_waitcnt lgkmcnt(4)
  v_exp_f32 v249, v249
  v_mfma_f32_16x16x32_bf16 v[224:227], a[196:199], v[16:19], v[224:227]
  ds_read_b128 a[216:219], v200 offset:30720
  v_add_f32 v178, v178, v248
  v_mfma_f32_16x16x32_bf16 v[228:231], a[196:199], v[20:23], v[228:231]
  s_add_u32 m0, s31, 110592
  v_exp_f32 v250, v250
  v_mfma_f32_16x16x32_bf16 v[232:235], a[196:199], v[24:27], v[232:235]
  buffer_load_dwordx4 v205, s[12:15], s33 offen offset:0 lds
  v_add_f32 v178, v178, v249
  v_mfma_f32_16x16x32_bf16 v[236:239], a[196:199], v[28:31], v[236:239]
  s_waitcnt lgkmcnt(4)
  v_exp_f32 v251, v251
  v_mfma_f32_16x16x32_bf16 v[224:227], a[200:203], v[32:35], v[224:227]
  ds_read_b128 a[220:223], v201 offset:30720
  v_cvt_pk_bf16_f32 v154, v248, v249
  v_mfma_f32_16x16x32_bf16 v[228:231], a[200:203], v[36:39], v[228:231]
  v_add_f32 v178, v178, v250
  v_add_f32 v178, v178, v251
  v_mfma_f32_16x16x32_bf16 v[232:235], a[200:203], v[40:43], v[232:235]
  v_cvt_pk_bf16_f32 v155, v250, v251
  v_mfma_f32_16x16x32_bf16 v[236:239], a[200:203], v[44:47], v[236:239]
  s_waitcnt lgkmcnt(4)
  v_mfma_f32_16x16x32_bf16 v[224:227], a[204:207], v[48:51], v[224:227]
  ds_read_b128 a[192:195], v200 offset:30848
  v_mfma_f32_16x16x32_bf16 v[228:231], a[204:207], v[52:55], v[228:231]
  v_mfma_f32_16x16x32_bf16 v[232:235], a[204:207], v[56:59], v[232:235]
  buffer_load_dwordx4 v206, s[12:15], s33 offen offset:1024 lds
  v_mfma_f32_16x16x32_bf16 v[236:239], a[204:207], v[60:63], v[236:239]
  s_waitcnt lgkmcnt(4)
  v_exp_f32 v252, v252
  v_mfma_f32_16x16x32_bf16 v[224:227], a[208:211], v[64:67], v[224:227]
  ds_read_b128 a[196:199], v201 offset:30848
  v_add_f32 v179, v179, v252
  v_mfma_f32_16x16x32_bf16 v[228:231], a[208:211], v[68:71], v[228:231]
  v_exp_f32 v253, v253
  v_mfma_f32_16x16x32_bf16 v[232:235], a[208:211], v[72:75], v[232:235]
  v_exp_f32 v254, v254
  v_mfma_f32_16x16x32_bf16 v[236:239], a[208:211], v[76:79], v[236:239]
  s_waitcnt lgkmcnt(4)
  v_exp_f32 v255, v255
  v_mfma_f32_16x16x32_bf16 v[224:227], a[212:215], v[80:83], v[224:227]
  ds_read_b128 a[200:203], v200 offset:30976
  v_add_f32 v179, v179, v253
  v_mfma_f32_16x16x32_bf16 v[228:231], a[212:215], v[84:87], v[228:231]
  v_cvt_pk_bf16_f32 v158, v252, v253
  v_add_f32 v179, v179, v254
  v_mfma_f32_16x16x32_bf16 v[232:235], a[212:215], v[88:91], v[232:235]
  buffer_load_dwordx4 v207, s[12:15], s33 offen offset:2048 lds
  v_add_f32 v179, v179, v255
  v_mfma_f32_16x16x32_bf16 v[236:239], a[212:215], v[92:95], v[236:239]
  s_waitcnt lgkmcnt(4)
  v_cvt_pk_bf16_f32 v159, v254, v255
  v_mfma_f32_16x16x32_bf16 v[240:243], a[216:219], v[0:3], v[160:163]
  ds_read_b128 a[204:207], v201 offset:30976
  v_mfma_f32_16x16x32_bf16 v[244:247], a[216:219], v[4:7], v[164:167]
  s_add_u32 s33, s33, 12288
  v_mfma_f32_16x16x32_bf16 v[248:251], a[216:219], v[8:11], v[168:171]
  v_exp_f32 v224, v224
  v_mfma_f32_16x16x32_bf16 v[252:255], a[216:219], v[12:15], v[172:175]
  s_waitcnt lgkmcnt(4)
  v_exp_f32 v225, v225
  v_mfma_f32_16x16x32_bf16 v[240:243], a[220:223], v[16:19], v[240:243]
  s_mov_b32 m0, s91
  ds_read_b64_tr_b16 a[208:209], v196 offset:12288
  ds_read_b64_tr_b16 a[210:211], v196 offset:18432
  v_mfma_f32_16x16x32_bf16 v[244:247], a[220:223], v[20:23], v[244:247]
  v_exp_f32 v226, v226
  v_mfma_f32_16x16x32_bf16 v[248:251], a[220:223], v[24:27], v[248:251]
  v_exp_f32 v227, v227
  v_mfma_f32_16x16x32_bf16 v[252:255], a[220:223], v[28:31], v[252:255]
  s_waitcnt lgkmcnt(5)
  v_add_f32 v176, v176, v224
  v_add_f32 v176, v176, v225
  v_mfma_f32_16x16x32_bf16 v[240:243], a[192:195], v[32:35], v[240:243]
  ds_read_b64_tr_b16 a[212:213], v197 offset:12288
  ds_read_b64_tr_b16 a[214:215], v197 offset:18432
  v_mfma_f32_16x16x32_bf16 v[244:247], a[192:195], v[36:39], v[244:247]
  v_cvt_pk_bf16_f32 v128, v224, v225
  v_add_f32 v176, v176, v226
  v_mfma_f32_16x16x32_bf16 v[248:251], a[192:195], v[40:43], v[248:251]
  v_add_f32 v176, v176, v227
  v_cvt_pk_bf16_f32 v129, v226, v227
  v_mfma_f32_16x16x32_bf16 v[252:255], a[192:195], v[44:47], v[252:255]
  s_waitcnt lgkmcnt(6)
  buffer_load_dwordx4 v208, s[60:63], s90 offen lds
  v_mfma_f32_16x16x32_bf16 v[240:243], a[196:199], v[48:51], v[240:243]
  ds_read_b64_tr_b16 a[216:217], v198 offset:12288
  ds_read_b64_tr_b16 a[218:219], v198 offset:18432
  v_mfma_f32_16x16x32_bf16 v[244:247], a[196:199], v[52:55], v[244:247]
  v_mfma_f32_16x16x32_bf16 v[248:251], a[196:199], v[56:59], v[248:251]
  v_exp_f32 v228, v228
  v_mfma_f32_16x16x32_bf16 v[252:255], a[196:199], v[60:63], v[252:255]
  s_waitcnt lgkmcnt(7)
  v_exp_f32 v229, v229
  v_mfma_f32_16x16x32_bf16 v[240:243], a[200:203], v[64:67], v[240:243]
  ds_read_b64_tr_b16 a[220:221], v199 offset:12288
  ds_read_b64_tr_b16 a[222:223], v199 offset:18432
  v_mfma_f32_16x16x32_bf16 v[244:247], a[200:203], v[68:71], v[244:247]
  s_add_u32 s90, s90, 1024
  v_exp_f32 v230, v230
  v_mfma_f32_16x16x32_bf16 v[248:251], a[200:203], v[72:75], v[248:251]
  v_exp_f32 v231, v231
  v_mfma_f32_16x16x32_bf16 v[252:255], a[200:203], v[76:79], v[252:255]
  s_waitcnt lgkmcnt(8)
  v_add_f32 v177, v177, v228
  v_add_f32 v177, v177, v229
  v_mfma_f32_16x16x32_bf16 v[240:243], a[204:207], v[80:83], v[240:243]
  ds_read_b64_tr_b16 a[192:193], v196 offset:12416
  ds_read_b64_tr_b16 a[194:195], v196 offset:18560
  v_mfma_f32_16x16x32_bf16 v[244:247], a[204:207], v[84:87], v[244:247]
  v_cvt_pk_bf16_f32 v132, v228, v229
  v_add_f32 v177, v177, v230
  v_mfma_f32_16x16x32_bf16 v[248:251], a[204:207], v[88:91], v[248:251]
  v_add_f32 v177, v177, v231
  v_cvt_pk_bf16_f32 v133, v230, v231
  v_mfma_f32_16x16x32_bf16 v[252:255], a[204:207], v[92:95], v[252:255]
  s_waitcnt lgkmcnt(8)
  v_mfma_f32_16x16x32_bf16 a[0:3], a[208:211], v[144:147], a[0:3]
  ds_read_b64_tr_b16 a[196:197], v197 offset:12416
  ds_read_b64_tr_b16 a[198:199], v197 offset:18560
  v_mfma_f32_16x16x32_bf16 a[4:7], a[208:211], v[148:151], a[4:7]
  v_mfma_f32_16x16x32_bf16 a[8:11], a[208:211], v[152:155], a[8:11]
  v_exp_f32 v232, v232
  v_mfma_f32_16x16x32_bf16 a[12:15], a[208:211], v[156:159], a[12:15]
  s_waitcnt lgkmcnt(8)
  v_exp_f32 v233, v233
  v_mfma_f32_16x16x32_bf16 a[16:19], a[212:215], v[144:147], a[16:19]
  ds_read_b64_tr_b16 a[200:201], v198 offset:12416
  ds_read_b64_tr_b16 a[202:203], v198 offset:18560
  v_mfma_f32_16x16x32_bf16 a[20:23], a[212:215], v[148:151], a[20:23]
  s_add_u32 m0, s31, 49152
  v_exp_f32 v234, v234
  v_mfma_f32_16x16x32_bf16 a[24:27], a[212:215], v[152:155], a[24:27]
  buffer_load_dwordx4 v205, s[16:19], s34 offen offset:0 lds
  v_add_f32 v178, v178, v232
  v_mfma_f32_16x16x32_bf16 a[28:31], a[212:215], v[156:159], a[28:31]
  s_waitcnt lgkmcnt(8)
  v_exp_f32 v235, v235
  v_mfma_f32_16x16x32_bf16 a[32:35], a[216:219], v[144:147], a[32:35]
  ds_read_b64_tr_b16 a[204:205], v199 offset:12416
  ds_read_b64_tr_b16 a[206:207], v199 offset:18560
  v_mfma_f32_16x16x32_bf16 a[36:39], a[216:219], v[148:151], a[36:39]
  v_add_f32 v178, v178, v233
  v_cvt_pk_bf16_f32 v136, v232, v233
  v_mfma_f32_16x16x32_bf16 a[40:43], a[216:219], v[152:155], a[40:43]
  v_add_f32 v178, v178, v234
  v_add_f32 v178, v178, v235
  v_mfma_f32_16x16x32_bf16 a[44:47], a[216:219], v[156:159], a[44:47]
  s_waitcnt lgkmcnt(8)
  v_cvt_pk_bf16_f32 v137, v234, v235
  v_mfma_f32_16x16x32_bf16 a[48:51], a[220:223], v[144:147], a[48:51]
  ds_read_b64_tr_b16 a[208:209], v196 offset:12544
  ds_read_b64_tr_b16 a[210:211], v196 offset:18688
  v_mfma_f32_16x16x32_bf16 a[52:55], a[220:223], v[148:151], a[52:55]
  v_mfma_f32_16x16x32_bf16 a[56:59], a[220:223], v[152:155], a[56:59]
  buffer_load_dwordx4 v206, s[16:19], s34 offen offset:1024 lds
  v_mfma_f32_16x16x32_bf16 a[60:63], a[220:223], v[156:159], a[60:63]
  s_waitcnt lgkmcnt(8)
  v_exp_f32 v236, v236
  v_mfma_f32_16x16x32_bf16 a[64:67], a[192:195], v[144:147], a[64:67]
  ds_read_b64_tr_b16 a[212:213], v197 offset:12544
  ds_read_b64_tr_b16 a[214:215], v197 offset:18688
  v_mfma_f32_16x16x32_bf16 a[68:71], a[192:195], v[148:151], a[68:71]
  v_exp_f32 v237, v237
  v_mfma_f32_16x16x32_bf16 a[72:75], a[192:195], v[152:155], a[72:75]
  v_exp_f32 v238, v238
  v_mfma_f32_16x16x32_bf16 a[76:79], a[192:195], v[156:159], a[76:79]
  s_waitcnt lgkmcnt(8)
  v_exp_f32 v239, v239
  v_mfma_f32_16x16x32_bf16 a[80:83], a[196:199], v[144:147], a[80:83]
  ds_read_b64_tr_b16 a[216:217], v198 offset:12544
  ds_read_b64_tr_b16 a[218:219], v198 offset:18688
  v_mfma_f32_16x16x32_bf16 a[84:87], a[196:199], v[148:151], a[84:87]
  v_add_f32 v179, v179, v236
  v_add_f32 v179, v179, v237
  v_mfma_f32_16x16x32_bf16 a[88:91], a[196:199], v[152:155], a[88:91]
  buffer_load_dwordx4 v207, s[16:19], s34 offen offset:2048 lds
  v_cvt_pk_bf16_f32 v140, v236, v237
  v_mfma_f32_16x16x32_bf16 a[92:95], a[196:199], v[156:159], a[92:95]
  s_waitcnt lgkmcnt(8)
  v_add_f32 v179, v179, v238
  v_add_f32 v179, v179, v239
  v_mfma_f32_16x16x32_bf16 a[96:99], a[200:203], v[144:147], a[96:99]
  ds_read_b64_tr_b16 a[220:221], v199 offset:12544
  ds_read_b64_tr_b16 a[222:223], v199 offset:18688
  v_mfma_f32_16x16x32_bf16 a[100:103], a[200:203], v[148:151], a[100:103]
  s_add_u32 s34, s34, 12288
  v_cvt_pk_bf16_f32 v141, v238, v239
  v_mfma_f32_16x16x32_bf16 a[104:107], a[200:203], v[152:155], a[104:107]
  v_exp_f32 v240, v240
  v_mfma_f32_16x16x32_bf16 a[108:111], a[200:203], v[156:159], a[108:111]
  s_waitcnt lgkmcnt(8)
  v_exp_f32 v241, v241
  v_mfma_f32_16x16x32_bf16 a[112:115], a[204:207], v[144:147], a[112:115]
  ds_read_b128 a[192:195], v200 offset:36864
  v_add_f32 v176, v176, v240
  v_mfma_f32_16x16x32_bf16 a[116:119], a[204:207], v[148:151], a[116:119]
  v_exp_f32 v242, v242
  v_mfma_f32_16x16x32_bf16 a[120:123], a[204:207], v[152:155], a[120:123]
  v_exp_f32 v243, v243
  v_mfma_f32_16x16x32_bf16 a[124:127], a[204:207], v[156:159], a[124:127]
  s_waitcnt lgkmcnt(7)
  v_add_f32 v176, v176, v241
  v_cvt_pk_bf16_f32 v130, v240, v241
  v_mfma_f32_16x16x32_bf16 a[128:131], a[208:211], v[144:147], a[128:131]
  ds_read_b128 a[196:199], v201 offset:36864
  v_add_f32 v176, v176, v242
  v_mfma_f32_16x16x32_bf16 a[132:135], a[208:211], v[148:151], a[132:135]
  v_add_f32 v176, v176, v243
  v_cvt_pk_bf16_f32 v131, v242, v243
  v_mfma_f32_16x16x32_bf16 a[136:139], a[208:211], v[152:155], a[136:139]
  v_mfma_f32_16x16x32_bf16 a[140:143], a[208:211], v[156:159], a[140:143]
  s_waitcnt lgkmcnt(6)
  v_mfma_f32_16x16x32_bf16 a[144:147], a[212:215], v[144:147], a[144:147]
  ds_read_b128 a[200:203], v200 offset:36992
  v_mfma_f32_16x16x32_bf16 a[148:151], a[212:215], v[148:151], a[148:151]
  v_mfma_f32_16x16x32_bf16 a[152:155], a[212:215], v[152:155], a[152:155]
  v_exp_f32 v244, v244
  v_mfma_f32_16x16x32_bf16 a[156:159], a[212:215], v[156:159], a[156:159]
  s_waitcnt lgkmcnt(5)
  v_exp_f32 v245, v245
  v_mfma_f32_16x16x32_bf16 a[160:163], a[216:219], v[144:147], a[160:163]
  ds_read_b128 a[204:207], v201 offset:36992
  v_add_f32 v177, v177, v244
  v_mfma_f32_16x16x32_bf16 a[164:167], a[216:219], v[148:151], a[164:167]
  v_exp_f32 v246, v246
  v_mfma_f32_16x16x32_bf16 a[168:171], a[216:219], v[152:155], a[168:171]
  v_exp_f32 v247, v247
  v_mfma_f32_16x16x32_bf16 a[172:175], a[216:219], v[156:159], a[172:175]
  s_waitcnt lgkmcnt(4)
  v_add_f32 v177, v177, v245
  v_cvt_pk_bf16_f32 v134, v244, v245
  v_mfma_f32_16x16x32_bf16 a[176:179], a[220:223], v[144:147], a[176:179]
  ds_read_b128 a[208:211], v200 offset:37120
  v_add_f32 v177, v177, v246
  v_mfma_f32_16x16x32_bf16 a[180:183], a[220:223], v[148:151], a[180:183]
  v_add_f32 v177, v177, v247
  v_cvt_pk_bf16_f32 v135, v246, v247
  v_mfma_f32_16x16x32_bf16 a[184:187], a[220:223], v[152:155], a[184:187]
  v_mfma_f32_16x16x32_bf16 a[188:191], a[220:223], v[156:159], a[188:191]
  s_waitcnt lgkmcnt(4)
  v_mfma_f32_16x16x32_bf16 v[224:227], a[192:195], v[0:3], v[160:163]
  s_waitcnt vmcnt(11)
  ds_read_b128 a[212:215], v201 offset:37120
  v_mfma_f32_16x16x32_bf16 v[228:231], a[192:195], v[4:7], v[164:167]
  s_barrier
  v_mfma_f32_16x16x32_bf16 v[232:235], a[192:195], v[8:11], v[168:171]
  v_exp_f32 v248, v248
  v_mfma_f32_16x16x32_bf16 v[236:239], a[192:195], v[12:15], v[172:175]
  s_waitcnt lgkmcnt(4)
  v_exp_f32 v249, v249
  v_mfma_f32_16x16x32_bf16 v[224:227], a[196:199], v[16:19], v[224:227]
  ds_read_b128 a[216:219], v200 offset:43008
  v_add_f32 v178, v178, v248
  v_mfma_f32_16x16x32_bf16 v[228:231], a[196:199], v[20:23], v[228:231]
  s_add_u32 m0, s31, 122880
  v_exp_f32 v250, v250
  v_mfma_f32_16x16x32_bf16 v[232:235], a[196:199], v[24:27], v[232:235]
  buffer_load_dwordx4 v205, s[12:15], s33 offen offset:0 lds
  v_add_f32 v178, v178, v249
  v_mfma_f32_16x16x32_bf16 v[236:239], a[196:199], v[28:31], v[236:239]
  s_waitcnt lgkmcnt(4)
  v_exp_f32 v251, v251
  v_mfma_f32_16x16x32_bf16 v[224:227], a[200:203], v[32:35], v[224:227]
  ds_read_b128 a[220:223], v201 offset:43008
  v_cvt_pk_bf16_f32 v138, v248, v249
  v_mfma_f32_16x16x32_bf16 v[228:231], a[200:203], v[36:39], v[228:231]
  v_add_f32 v178, v178, v250
  v_add_f32 v178, v178, v251
  v_mfma_f32_16x16x32_bf16 v[232:235], a[200:203], v[40:43], v[232:235]
  v_cvt_pk_bf16_f32 v139, v250, v251
  v_mfma_f32_16x16x32_bf16 v[236:239], a[200:203], v[44:47], v[236:239]
  s_waitcnt lgkmcnt(4)
  v_mfma_f32_16x16x32_bf16 v[224:227], a[204:207], v[48:51], v[224:227]
  ds_read_b128 a[192:195], v200 offset:43136
  v_mfma_f32_16x16x32_bf16 v[228:231], a[204:207], v[52:55], v[228:231]
  v_mfma_f32_16x16x32_bf16 v[232:235], a[204:207], v[56:59], v[232:235]
  buffer_load_dwordx4 v206, s[12:15], s33 offen offset:1024 lds
  v_mfma_f32_16x16x32_bf16 v[236:239], a[204:207], v[60:63], v[236:239]
  s_waitcnt lgkmcnt(4)
  v_exp_f32 v252, v252
  v_mfma_f32_16x16x32_bf16 v[224:227], a[208:211], v[64:67], v[224:227]
  ds_read_b128 a[196:199], v201 offset:43136
  v_add_f32 v179, v179, v252
  v_mfma_f32_16x16x32_bf16 v[228:231], a[208:211], v[68:71], v[228:231]
  v_exp_f32 v253, v253
  v_mfma_f32_16x16x32_bf16 v[232:235], a[208:211], v[72:75], v[232:235]
  v_exp_f32 v254, v254
  v_mfma_f32_16x16x32_bf16 v[236:239], a[208:211], v[76:79], v[236:239]
  s_waitcnt lgkmcnt(4)
  v_exp_f32 v255, v255
  v_mfma_f32_16x16x32_bf16 v[224:227], a[212:215], v[80:83], v[224:227]
  ds_read_b128 a[200:203], v200 offset:43264
  v_add_f32 v179, v179, v253
  v_mfma_f32_16x16x32_bf16 v[228:231], a[212:215], v[84:87], v[228:231]
  v_cvt_pk_bf16_f32 v142, v252, v253
  v_add_f32 v179, v179, v254
  v_mfma_f32_16x16x32_bf16 v[232:235], a[212:215], v[88:91], v[232:235]
  buffer_load_dwordx4 v207, s[12:15], s33 offen offset:2048 lds
  v_add_f32 v179, v179, v255
  v_mfma_f32_16x16x32_bf16 v[236:239], a[212:215], v[92:95], v[236:239]
  s_waitcnt lgkmcnt(4)
  v_cvt_pk_bf16_f32 v143, v254, v255
  v_mfma_f32_16x16x32_bf16 v[240:243], a[216:219], v[0:3], v[160:163]
  ds_read_b128 a[204:207], v201 offset:43264
  v_mfma_f32_16x16x32_bf16 v[244:247], a[216:219], v[4:7], v[164:167]
  s_add_u32 s33, s33, 12288
  v_mfma_f32_16x16x32_bf16 v[248:251], a[216:219], v[8:11], v[168:171]
  v_exp_f32 v224, v224
  v_mfma_f32_16x16x32_bf16 v[252:255], a[216:219], v[12:15], v[172:175]
  s_waitcnt lgkmcnt(4)
  v_exp_f32 v225, v225
  v_mfma_f32_16x16x32_bf16 v[240:243], a[220:223], v[16:19], v[240:243]
  s_mov_b32 m0, s91
  ds_read_b64_tr_b16 a[208:209], v196 offset:24576
  ds_read_b64_tr_b16 a[210:211], v196 offset:30720
  v_mfma_f32_16x16x32_bf16 v[244:247], a[220:223], v[20:23], v[244:247]
  v_exp_f32 v226, v226
  v_mfma_f32_16x16x32_bf16 v[248:251], a[220:223], v[24:27], v[248:251]
  v_exp_f32 v227, v227
  v_mfma_f32_16x16x32_bf16 v[252:255], a[220:223], v[28:31], v[252:255]
  s_waitcnt lgkmcnt(5)
  v_add_f32 v176, v176, v224
  v_add_f32 v176, v176, v225
  v_mfma_f32_16x16x32_bf16 v[240:243], a[192:195], v[32:35], v[240:243]
  ds_read_b64_tr_b16 a[212:213], v197 offset:24576
  ds_read_b64_tr_b16 a[214:215], v197 offset:30720
  v_mfma_f32_16x16x32_bf16 v[244:247], a[192:195], v[36:39], v[244:247]
  v_cvt_pk_bf16_f32 v144, v224, v225
  v_add_f32 v176, v176, v226
  v_mfma_f32_16x16x32_bf16 v[248:251], a[192:195], v[40:43], v[248:251]
  v_add_f32 v176, v176, v227
  v_cvt_pk_bf16_f32 v145, v226, v227
  v_mfma_f32_16x16x32_bf16 v[252:255], a[192:195], v[44:47], v[252:255]
  s_waitcnt lgkmcnt(6)
  buffer_load_dwordx4 v208, s[60:63], s90 offen lds
  v_mfma_f32_16x16x32_bf16 v[240:243], a[196:199], v[48:51], v[240:243]
  ds_read_b64_tr_b16 a[216:217], v198 offset:24576
  ds_read_b64_tr_b16 a[218:219], v198 offset:30720
  v_mfma_f32_16x16x32_bf16 v[244:247], a[196:199], v[52:55], v[244:247]
  v_mfma_f32_16x16x32_bf16 v[248:251], a[196:199], v[56:59], v[248:251]
  v_exp_f32 v228, v228
  v_mfma_f32_16x16x32_bf16 v[252:255], a[196:199], v[60:63], v[252:255]
  s_waitcnt lgkmcnt(7)
  v_exp_f32 v229, v229
  v_mfma_f32_16x16x32_bf16 v[240:243], a[200:203], v[64:67], v[240:243]
  ds_read_b64_tr_b16 a[220:221], v199 offset:24576
  ds_read_b64_tr_b16 a[222:223], v199 offset:30720
  v_mfma_f32_16x16x32_bf16 v[244:247], a[200:203], v[68:71], v[244:247]
  s_add_u32 s90, s90, 1024
  v_exp_f32 v230, v230
  v_mfma_f32_16x16x32_bf16 v[248:251], a[200:203], v[72:75], v[248:251]
  v_exp_f32 v231, v231
  v_mfma_f32_16x16x32_bf16 v[252:255], a[200:203], v[76:79], v[252:255]
  s_waitcnt lgkmcnt(8)
  v_add_f32 v177, v177, v228
  v_add_f32 v177, v177, v229
  v_mfma_f32_16x16x32_bf16 v[240:243], a[204:207], v[80:83], v[240:243]
  ds_read_b64_tr_b16 a[192:193], v196 offset:24704
  ds_read_b64_tr_b16 a[194:195], v196 offset:30848
  v_mfma_f32_16x16x32_bf16 v[244:247], a[204:207], v[84:87], v[244:247]
  v_cvt_pk_bf16_f32 v148, v228, v229
  v_add_f32 v177, v177, v230
  v_mfma_f32_16x16x32_bf16 v[248:251], a[204:207], v[88:91], v[248:251]
  v_add_f32 v177, v177, v231
  v_cvt_pk_bf16_f32 v149, v230, v231
  v_mfma_f32_16x16x32_bf16 v[252:255], a[204:207], v[92:95], v[252:255]
  s_waitcnt lgkmcnt(8)
  v_mfma_f32_16x16x32_bf16 a[0:3], a[208:211], v[128:131], a[0:3]
  ds_read_b64_tr_b16 a[196:197], v197 offset:24704
  ds_read_b64_tr_b16 a[198:199], v197 offset:30848
  v_mfma_f32_16x16x32_bf16 a[4:7], a[208:211], v[132:135], a[4:7]
  v_mfma_f32_16x16x32_bf16 a[8:11], a[208:211], v[136:139], a[8:11]
  v_exp_f32 v232, v232
  v_mfma_f32_16x16x32_bf16 a[12:15], a[208:211], v[140:143], a[12:15]
  s_waitcnt lgkmcnt(8)
  v_exp_f32 v233, v233
  v_mfma_f32_16x16x32_bf16 a[16:19], a[212:215], v[128:131], a[16:19]
  ds_read_b64_tr_b16 a[200:201], v198 offset:24704
  ds_read_b64_tr_b16 a[202:203], v198 offset:30848
  v_mfma_f32_16x16x32_bf16 a[20:23], a[212:215], v[132:135], a[20:23]
  s_add_u32 m0, s31, 61440
  v_exp_f32 v234, v234
  v_mfma_f32_16x16x32_bf16 a[24:27], a[212:215], v[136:139], a[24:27]
  buffer_load_dwordx4 v205, s[16:19], s34 offen offset:0 lds
  v_add_f32 v178, v178, v232
  v_mfma_f32_16x16x32_bf16 a[28:31], a[212:215], v[140:143], a[28:31]
  s_waitcnt lgkmcnt(8)
  v_exp_f32 v235, v235
  v_mfma_f32_16x16x32_bf16 a[32:35], a[216:219], v[128:131], a[32:35]
  ds_read_b64_tr_b16 a[204:205], v199 offset:24704
  ds_read_b64_tr_b16 a[206:207], v199 offset:30848
  v_mfma_f32_16x16x32_bf16 a[36:39], a[216:219], v[132:135], a[36:39]
  v_add_f32 v178, v178, v233
  v_cvt_pk_bf16_f32 v152, v232, v233
  v_mfma_f32_16x16x32_bf16 a[40:43], a[216:219], v[136:139], a[40:43]
  v_add_f32 v178, v178, v234
  v_add_f32 v178, v178, v235
  v_mfma_f32_16x16x32_bf16 a[44:47], a[216:219], v[140:143], a[44:47]
  s_waitcnt lgkmcnt(8)
  v_cvt_pk_bf16_f32 v153, v234, v235
  v_mfma_f32_16x16x32_bf16 a[48:51], a[220:223], v[128:131], a[48:51]
  ds_read_b64_tr_b16 a[208:209], v196 offset:24832
  ds_read_b64_tr_b16 a[210:211], v196 offset:30976
  v_mfma_f32_16x16x32_bf16 a[52:55], a[220:223], v[132:135], a[52:55]
  v_mfma_f32_16x16x32_bf16 a[56:59], a[220:223], v[136:139], a[56:59]
  buffer_load_dwordx4 v206, s[16:19], s34 offen offset:1024 lds
  v_mfma_f32_16x16x32_bf16 a[60:63], a[220:223], v[140:143], a[60:63]
  s_waitcnt lgkmcnt(8)
  v_exp_f32 v236, v236
  v_mfma_f32_16x16x32_bf16 a[64:67], a[192:195], v[128:131], a[64:67]
  ds_read_b64_tr_b16 a[212:213], v197 offset:24832
  ds_read_b64_tr_b16 a[214:215], v197 offset:30976
  v_mfma_f32_16x16x32_bf16 a[68:71], a[192:195], v[132:135], a[68:71]
  v_exp_f32 v237, v237
  v_mfma_f32_16x16x32_bf16 a[72:75], a[192:195], v[136:139], a[72:75]
  v_exp_f32 v238, v238
  v_mfma_f32_16x16x32_bf16 a[76:79], a[192:195], v[140:143], a[76:79]
  s_waitcnt lgkmcnt(8)
  v_exp_f32 v239, v239
  v_mfma_f32_16x16x32_bf16 a[80:83], a[196:199], v[128:131], a[80:83]
  ds_read_b64_tr_b16 a[216:217], v198 offset:24832
  ds_read_b64_tr_b16 a[218:219], v198 offset:30976
  v_mfma_f32_16x16x32_bf16 a[84:87], a[196:199], v[132:135], a[84:87]
  v_add_f32 v179, v179, v236
  v_add_f32 v179, v179, v237
  v_mfma_f32_16x16x32_bf16 a[88:91], a[196:199], v[136:139], a[88:91]
  buffer_load_dwordx4 v207, s[16:19], s34 offen offset:2048 lds
  v_cvt_pk_bf16_f32 v156, v236, v237
  v_mfma_f32_16x16x32_bf16 a[92:95], a[196:199], v[140:143], a[92:95]
  s_waitcnt lgkmcnt(8)
  v_add_f32 v179, v179, v238
  v_add_f32 v179, v179, v239
  v_mfma_f32_16x16x32_bf16 a[96:99], a[200:203], v[128:131], a[96:99]
  ds_read_b64_tr_b16 a[220:221], v199 offset:24832
  ds_read_b64_tr_b16 a[222:223], v199 offset:30976
  v_mfma_f32_16x16x32_bf16 a[100:103], a[200:203], v[132:135], a[100:103]
  s_add_u32 s34, s34, 12288
  v_cvt_pk_bf16_f32 v157, v238, v239
  v_mfma_f32_16x16x32_bf16 a[104:107], a[200:203], v[136:139], a[104:107]
  v_exp_f32 v240, v240
  v_mfma_f32_16x16x32_bf16 a[108:111], a[200:203], v[140:143], a[108:111]
  s_waitcnt lgkmcnt(8)
  v_exp_f32 v241, v241
  v_mfma_f32_16x16x32_bf16 a[112:115], a[204:207], v[128:131], a[112:115]
  ds_read_b128 a[192:195], v200 offset:0
  v_add_f32 v176, v176, v240
  v_mfma_f32_16x16x32_bf16 a[116:119], a[204:207], v[132:135], a[116:119]
  v_exp_f32 v242, v242
  v_mfma_f32_16x16x32_bf16 a[120:123], a[204:207], v[136:139], a[120:123]
  v_exp_f32 v243, v243
  v_mfma_f32_16x16x32_bf16 a[124:127], a[204:207], v[140:143], a[124:127]
  s_waitcnt lgkmcnt(7)
  v_add_f32 v176, v176, v241
  v_cvt_pk_bf16_f32 v146, v240, v241
  v_mfma_f32_16x16x32_bf16 a[128:131], a[208:211], v[128:131], a[128:131]
  ds_read_b128 a[196:199], v201 offset:0
  v_add_f32 v176, v176, v242
  v_mfma_f32_16x16x32_bf16 a[132:135], a[208:211], v[132:135], a[132:135]
  v_add_f32 v176, v176, v243
  v_cvt_pk_bf16_f32 v147, v242, v243
  v_mfma_f32_16x16x32_bf16 a[136:139], a[208:211], v[136:139], a[136:139]
  v_mfma_f32_16x16x32_bf16 a[140:143], a[208:211], v[140:143], a[140:143]
  s_waitcnt lgkmcnt(6)
  v_mfma_f32_16x16x32_bf16 a[144:147], a[212:215], v[128:131], a[144:147]
  ds_read_b128 a[200:203], v200 offset:128
  v_mfma_f32_16x16x32_bf16 a[148:151], a[212:215], v[132:135], a[148:151]
  v_mfma_f32_16x16x32_bf16 a[152:155], a[212:215], v[136:139], a[152:155]
  v_exp_f32 v244, v244
  v_mfma_f32_16x16x32_bf16 a[156:159], a[212:215], v[140:143], a[156:159]
  s_waitcnt lgkmcnt(5)
  v_exp_f32 v245, v245
  v_mfma_f32_16x16x32_bf16 a[160:163], a[216:219], v[128:131], a[160:163]
  ds_read_b128 a[204:207], v201 offset:128
  v_add_f32 v177, v177, v244
  v_mfma_f32_16x16x32_bf16 a[164:167], a[216:219], v[132:135], a[164:167]
  v_exp_f32 v246, v246
  v_mfma_f32_16x16x32_bf16 a[168:171], a[216:219], v[136:139], a[168:171]
  v_exp_f32 v247, v247
  v_mfma_f32_16x16x32_bf16 a[172:175], a[216:219], v[140:143], a[172:175]
  s_waitcnt lgkmcnt(4)
  v_add_f32 v177, v177, v245
  v_cvt_pk_bf16_f32 v150, v244, v245
  v_mfma_f32_16x16x32_bf16 a[176:179], a[220:223], v[128:131], a[176:179]
  ds_read_b128 a[208:211], v200 offset:256
  v_add_f32 v177, v177, v246
  v_mfma_f32_16x16x32_bf16 a[180:183], a[220:223], v[132:135], a[180:183]
  v_add_f32 v177, v177, v247
  v_cvt_pk_bf16_f32 v151, v246, v247
  v_mfma_f32_16x16x32_bf16 a[184:187], a[220:223], v[136:139], a[184:187]
  v_mfma_f32_16x16x32_bf16 a[188:191], a[220:223], v[140:143], a[188:191]
  s_waitcnt lgkmcnt(4)
  v_mfma_f32_16x16x32_bf16 v[224:227], a[192:195], v[0:3], v[160:163]
  s_waitcnt vmcnt(11)
  ds_read_b128 a[212:215], v201 offset:256
  v_mfma_f32_16x16x32_bf16 v[228:231], a[192:195], v[4:7], v[164:167]
  s_barrier
  v_mfma_f32_16x16x32_bf16 v[232:235], a[192:195], v[8:11], v[168:171]
  v_exp_f32 v248, v248
  v_mfma_f32_16x16x32_bf16 v[236:239], a[192:195], v[12:15], v[172:175]
  s_waitcnt lgkmcnt(4)
  v_exp_f32 v249, v249
  v_mfma_f32_16x16x32_bf16 v[224:227], a[196:199], v[16:19], v[224:227]
  ds_read_b128 a[216:219], v200 offset:6144
  v_add_f32 v178, v178, v248
  v_mfma_f32_16x16x32_bf16 v[228:231], a[196:199], v[20:23], v[228:231]
  s_add_u32 m0, s31, 135168
  v_exp_f32 v250, v250
  v_mfma_f32_16x16x32_bf16 v[232:235], a[196:199], v[24:27], v[232:235]
  buffer_load_dwordx4 v205, s[12:15], s33 offen offset:0 lds
  v_add_f32 v178, v178, v249
  v_mfma_f32_16x16x32_bf16 v[236:239], a[196:199], v[28:31], v[236:239]
  s_waitcnt lgkmcnt(4)
  v_exp_f32 v251, v251
  v_mfma_f32_16x16x32_bf16 v[224:227], a[200:203], v[32:35], v[224:227]
  ds_read_b128 a[220:223], v201 offset:6144
  v_cvt_pk_bf16_f32 v154, v248, v249
  v_mfma_f32_16x16x32_bf16 v[228:231], a[200:203], v[36:39], v[228:231]
  v_add_f32 v178, v178, v250
  v_add_f32 v178, v178, v251
  v_mfma_f32_16x16x32_bf16 v[232:235], a[200:203], v[40:43], v[232:235]
  v_cvt_pk_bf16_f32 v155, v250, v251
  v_mfma_f32_16x16x32_bf16 v[236:239], a[200:203], v[44:47], v[236:239]
  s_waitcnt lgkmcnt(4)
  v_mfma_f32_16x16x32_bf16 v[224:227], a[204:207], v[48:51], v[224:227]
  ds_read_b128 a[192:195], v200 offset:6272
  v_mfma_f32_16x16x32_bf16 v[228:231], a[204:207], v[52:55], v[228:231]
  v_mfma_f32_16x16x32_bf16 v[232:235], a[204:207], v[56:59], v[232:235]
  buffer_load_dwordx4 v206, s[12:15], s33 offen offset:1024 lds
  v_mfma_f32_16x16x32_bf16 v[236:239], a[204:207], v[60:63], v[236:239]
  s_waitcnt lgkmcnt(4)
  v_exp_f32 v252, v252
  v_mfma_f32_16x16x32_bf16 v[224:227], a[208:211], v[64:67], v[224:227]
  ds_read_b128 a[196:199], v201 offset:6272
  v_add_f32 v179, v179, v252
  v_mfma_f32_16x16x32_bf16 v[228:231], a[208:211], v[68:71], v[228:231]
  v_exp_f32 v253, v253
  v_mfma_f32_16x16x32_bf16 v[232:235], a[208:211], v[72:75], v[232:235]
  v_exp_f32 v254, v254
  v_mfma_f32_16x16x32_bf16 v[236:239], a[208:211], v[76:79], v[236:239]
  s_waitcnt lgkmcnt(4)
  v_exp_f32 v255, v255
  v_mfma_f32_16x16x32_bf16 v[224:227], a[212:215], v[80:83], v[224:227]
  ds_read_b128 a[200:203], v200 offset:6400
  v_add_f32 v179, v179, v253
  v_mfma_f32_16x16x32_bf16 v[228:231], a[212:215], v[84:87], v[228:231]
  v_cvt_pk_bf16_f32 v158, v252, v253
  v_add_f32 v179, v179, v254
  v_mfma_f32_16x16x32_bf16 v[232:235], a[212:215], v[88:91], v[232:235]
  buffer_load_dwordx4 v207, s[12:15], s33 offen offset:2048 lds
  v_add_f32 v179, v179, v255
  v_mfma_f32_16x16x32_bf16 v[236:239], a[212:215], v[92:95], v[236:239]
  s_waitcnt lgkmcnt(4)
  v_cvt_pk_bf16_f32 v159, v254, v255
  v_mfma_f32_16x16x32_bf16 v[240:243], a[216:219], v[0:3], v[160:163]
  ds_read_b128 a[204:207], v201 offset:6400
  v_mfma_f32_16x16x32_bf16 v[244:247], a[216:219], v[4:7], v[164:167]
  s_add_u32 s33, s33, 12288
  v_mfma_f32_16x16x32_bf16 v[248:251], a[216:219], v[8:11], v[168:171]
  v_exp_f32 v224, v224
  v_mfma_f32_16x16x32_bf16 v[252:255], a[216:219], v[12:15], v[172:175]
  s_waitcnt lgkmcnt(4)
  v_exp_f32 v225, v225
  v_mfma_f32_16x16x32_bf16 v[240:243], a[220:223], v[16:19], v[240:243]
  s_mov_b32 m0, s91
  ds_read_b64_tr_b16 a[208:209], v196 offset:36864
  ds_read_b64_tr_b16 a[210:211], v196 offset:43008
  v_mfma_f32_16x16x32_bf16 v[244:247], a[220:223], v[20:23], v[244:247]
  v_exp_f32 v226, v226
  v_mfma_f32_16x16x32_bf16 v[248:251], a[220:223], v[24:27], v[248:251]
  v_exp_f32 v227, v227
  v_mfma_f32_16x16x32_bf16 v[252:255], a[220:223], v[28:31], v[252:255]
  s_waitcnt lgkmcnt(5)
  v_add_f32 v176, v176, v224
  v_add_f32 v176, v176, v225
  v_mfma_f32_16x16x32_bf16 v[240:243], a[192:195], v[32:35], v[240:243]
  ds_read_b64_tr_b16 a[212:213], v197 offset:36864
  ds_read_b64_tr_b16 a[214:215], v197 offset:43008
  v_mfma_f32_16x16x32_bf16 v[244:247], a[192:195], v[36:39], v[244:247]
  v_cvt_pk_bf16_f32 v128, v224, v225
  v_add_f32 v176, v176, v226
  v_mfma_f32_16x16x32_bf16 v[248:251], a[192:195], v[40:43], v[248:251]
  v_add_f32 v176, v176, v227
  v_cvt_pk_bf16_f32 v129, v226, v227
  v_mfma_f32_16x16x32_bf16 v[252:255], a[192:195], v[44:47], v[252:255]
  s_waitcnt lgkmcnt(6)
  buffer_load_dwordx4 v208, s[60:63], s90 offen lds
  v_mfma_f32_16x16x32_bf16 v[240:243], a[196:199], v[48:51], v[240:243]
  ds_read_b64_tr_b16 a[216:217], v198 offset:36864
  ds_read_b64_tr_b16 a[218:219], v198 offset:43008
  v_mfma_f32_16x16x32_bf16 v[244:247], a[196:199], v[52:55], v[244:247]
  v_mfma_f32_16x16x32_bf16 v[248:251], a[196:199], v[56:59], v[248:251]
  v_exp_f32 v228, v228
  v_mfma_f32_16x16x32_bf16 v[252:255], a[196:199], v[60:63], v[252:255]
  s_waitcnt lgkmcnt(7)
  v_exp_f32 v229, v229
  v_mfma_f32_16x16x32_bf16 v[240:243], a[200:203], v[64:67], v[240:243]
  ds_read_b64_tr_b16 a[220:221], v199 offset:36864
  ds_read_b64_tr_b16 a[222:223], v199 offset:43008
  v_mfma_f32_16x16x32_bf16 v[244:247], a[200:203], v[68:71], v[244:247]
  s_add_u32 s90, s90, 1024
  v_exp_f32 v230, v230
  v_mfma_f32_16x16x32_bf16 v[248:251], a[200:203], v[72:75], v[248:251]
  v_exp_f32 v231, v231
  v_mfma_f32_16x16x32_bf16 v[252:255], a[200:203], v[76:79], v[252:255]
  s_waitcnt lgkmcnt(8)
  v_add_f32 v177, v177, v228
  v_add_f32 v177, v177, v229
  v_mfma_f32_16x16x32_bf16 v[240:243], a[204:207], v[80:83], v[240:243]
  ds_read_b64_tr_b16 a[192:193], v196 offset:36992
  ds_read_b64_tr_b16 a[194:195], v196 offset:43136
  v_mfma_f32_16x16x32_bf16 v[244:247], a[204:207], v[84:87], v[244:247]
  v_cvt_pk_bf16_f32 v132, v228, v229
  v_add_f32 v177, v177, v230
  v_mfma_f32_16x16x32_bf16 v[248:251], a[204:207], v[88:91], v[248:251]
  v_add_f32 v177, v177, v231
  v_cvt_pk_bf16_f32 v133, v230, v231
  v_mfma_f32_16x16x32_bf16 v[252:255], a[204:207], v[92:95], v[252:255]
  s_waitcnt lgkmcnt(8)
  v_mfma_f32_16x16x32_bf16 a[0:3], a[208:211], v[144:147], a[0:3]
  ds_read_b64_tr_b16 a[196:197], v197 offset:36992
  ds_read_b64_tr_b16 a[198:199], v197 offset:43136
  v_mfma_f32_16x16x32_bf16 a[4:7], a[208:211], v[148:151], a[4:7]
  v_mfma_f32_16x16x32_bf16 a[8:11], a[208:211], v[152:155], a[8:11]
  v_exp_f32 v232, v232
  v_mfma_f32_16x16x32_bf16 a[12:15], a[208:211], v[156:159], a[12:15]
  s_waitcnt lgkmcnt(8)
  v_exp_f32 v233, v233
  v_mfma_f32_16x16x32_bf16 a[16:19], a[212:215], v[144:147], a[16:19]
  ds_read_b64_tr_b16 a[200:201], v198 offset:36992
  ds_read_b64_tr_b16 a[202:203], v198 offset:43136
  v_mfma_f32_16x16x32_bf16 a[20:23], a[212:215], v[148:151], a[20:23]
  s_add_u32 m0, s31, 73728
  v_exp_f32 v234, v234
  v_mfma_f32_16x16x32_bf16 a[24:27], a[212:215], v[152:155], a[24:27]
  buffer_load_dwordx4 v205, s[16:19], s34 offen offset:0 lds
  v_add_f32 v178, v178, v232
  v_mfma_f32_16x16x32_bf16 a[28:31], a[212:215], v[156:159], a[28:31]
  s_waitcnt lgkmcnt(8)
  v_exp_f32 v235, v235
  v_mfma_f32_16x16x32_bf16 a[32:35], a[216:219], v[144:147], a[32:35]
  ds_read_b64_tr_b16 a[204:205], v199 offset:36992
  ds_read_b64_tr_b16 a[206:207], v199 offset:43136
  v_mfma_f32_16x16x32_bf16 a[36:39], a[216:219], v[148:151], a[36:39]
  v_add_f32 v178, v178, v233
  v_cvt_pk_bf16_f32 v136, v232, v233
  v_mfma_f32_16x16x32_bf16 a[40:43], a[216:219], v[152:155], a[40:43]
  v_add_f32 v178, v178, v234
  v_add_f32 v178, v178, v235
  v_mfma_f32_16x16x32_bf16 a[44:47], a[216:219], v[156:159], a[44:47]
  s_waitcnt lgkmcnt(8)
  v_cvt_pk_bf16_f32 v137, v234, v235
  v_mfma_f32_16x16x32_bf16 a[48:51], a[220:223], v[144:147], a[48:51]
  ds_read_b64_tr_b16 a[208:209], v196 offset:37120
  ds_read_b64_tr_b16 a[210:211], v196 offset:43264
  v_mfma_f32_16x16x32_bf16 a[52:55], a[220:223], v[148:151], a[52:55]
  v_mfma_f32_16x16x32_bf16 a[56:59], a[220:223], v[152:155], a[56:59]
  buffer_load_dwordx4 v206, s[16:19], s34 offen offset:1024 lds
  v_mfma_f32_16x16x32_bf16 a[60:63], a[220:223], v[156:159], a[60:63]
  s_waitcnt lgkmcnt(8)
  v_exp_f32 v236, v236
  v_mfma_f32_16x16x32_bf16 a[64:67], a[192:195], v[144:147], a[64:67]
  ds_read_b64_tr_b16 a[212:213], v197 offset:37120
  ds_read_b64_tr_b16 a[214:215], v197 offset:43264
  v_mfma_f32_16x16x32_bf16 a[68:71], a[192:195], v[148:151], a[68:71]
  v_exp_f32 v237, v237
  v_mfma_f32_16x16x32_bf16 a[72:75], a[192:195], v[152:155], a[72:75]
  v_exp_f32 v238, v238
  v_mfma_f32_16x16x32_bf16 a[76:79], a[192:195], v[156:159], a[76:79]
  s_waitcnt lgkmcnt(8)
  v_exp_f32 v239, v239
  v_mfma_f32_16x16x32_bf16 a[80:83], a[196:199], v[144:147], a[80:83]
  ds_read_b64_tr_b16 a[216:217], v198 offset:37120
  ds_read_b64_tr_b16 a[218:219], v198 offset:43264
  v_mfma_f32_16x16x32_bf16 a[84:87], a[196:199], v[148:151], a[84:87]
  v_add_f32 v179, v179, v236
  v_add_f32 v179, v179, v237
  v_mfma_f32_16x16x32_bf16 a[88:91], a[196:199], v[152:155], a[88:91]
  buffer_load_dwordx4 v207, s[16:19], s34 offen offset:2048 lds
  v_cvt_pk_bf16_f32 v140, v236, v237
  v_mfma_f32_16x16x32_bf16 a[92:95], a[196:199], v[156:159], a[92:95]
  s_waitcnt lgkmcnt(8)
  v_add_f32 v179, v179, v238
  v_add_f32 v179, v179, v239
  v_mfma_f32_16x16x32_bf16 a[96:99], a[200:203], v[144:147], a[96:99]
  ds_read_b64_tr_b16 a[220:221], v199 offset:37120
  ds_read_b64_tr_b16 a[222:223], v199 offset:43264
  v_mfma_f32_16x16x32_bf16 a[100:103], a[200:203], v[148:151], a[100:103]
  s_add_u32 s34, s34, 12288
  v_cvt_pk_bf16_f32 v141, v238, v239
  v_mfma_f32_16x16x32_bf16 a[104:107], a[200:203], v[152:155], a[104:107]
  v_exp_f32 v240, v240
  v_mfma_f32_16x16x32_bf16 a[108:111], a[200:203], v[156:159], a[108:111]
  s_waitcnt lgkmcnt(8)
  v_exp_f32 v241, v241
  v_mfma_f32_16x16x32_bf16 a[112:115], a[204:207], v[144:147], a[112:115]
  ds_read_b128 a[192:195], v200 offset:12288
  v_add_f32 v176, v176, v240
  v_mfma_f32_16x16x32_bf16 a[116:119], a[204:207], v[148:151], a[116:119]
  v_exp_f32 v242, v242
  v_mfma_f32_16x16x32_bf16 a[120:123], a[204:207], v[152:155], a[120:123]
  v_exp_f32 v243, v243
  v_mfma_f32_16x16x32_bf16 a[124:127], a[204:207], v[156:159], a[124:127]
  s_waitcnt lgkmcnt(7)
  v_add_f32 v176, v176, v241
  v_cvt_pk_bf16_f32 v130, v240, v241
  v_mfma_f32_16x16x32_bf16 a[128:131], a[208:211], v[144:147], a[128:131]
  ds_read_b128 a[196:199], v201 offset:12288
  v_add_f32 v176, v176, v242
  v_mfma_f32_16x16x32_bf16 a[132:135], a[208:211], v[148:151], a[132:135]
  v_add_f32 v176, v176, v243
  v_cvt_pk_bf16_f32 v131, v242, v243
  v_mfma_f32_16x16x32_bf16 a[136:139], a[208:211], v[152:155], a[136:139]
  v_mfma_f32_16x16x32_bf16 a[140:143], a[208:211], v[156:159], a[140:143]
  s_waitcnt lgkmcnt(6)
  v_mfma_f32_16x16x32_bf16 a[144:147], a[212:215], v[144:147], a[144:147]
  ds_read_b128 a[200:203], v200 offset:12416
  v_mfma_f32_16x16x32_bf16 a[148:151], a[212:215], v[148:151], a[148:151]
  v_mfma_f32_16x16x32_bf16 a[152:155], a[212:215], v[152:155], a[152:155]
  v_exp_f32 v244, v244
  v_mfma_f32_16x16x32_bf16 a[156:159], a[212:215], v[156:159], a[156:159]
  s_waitcnt lgkmcnt(5)
  v_exp_f32 v245, v245
  v_mfma_f32_16x16x32_bf16 a[160:163], a[216:219], v[144:147], a[160:163]
  ds_read_b128 a[204:207], v201 offset:12416
  v_add_f32 v177, v177, v244
  v_mfma_f32_16x16x32_bf16 a[164:167], a[216:219], v[148:151], a[164:167]
  v_exp_f32 v246, v246
  v_mfma_f32_16x16x32_bf16 a[168:171], a[216:219], v[152:155], a[168:171]
  v_exp_f32 v247, v247
  v_mfma_f32_16x16x32_bf16 a[172:175], a[216:219], v[156:159], a[172:175]
  s_waitcnt lgkmcnt(4)
  v_add_f32 v177, v177, v245
  v_cvt_pk_bf16_f32 v134, v244, v245
  v_mfma_f32_16x16x32_bf16 a[176:179], a[220:223], v[144:147], a[176:179]
  ds_read_b128 a[208:211], v200 offset:12544
  v_add_f32 v177, v177, v246
  v_mfma_f32_16x16x32_bf16 a[180:183], a[220:223], v[148:151], a[180:183]
  v_add_f32 v177, v177, v247
  v_cvt_pk_bf16_f32 v135, v246, v247
  v_mfma_f32_16x16x32_bf16 a[184:187], a[220:223], v[152:155], a[184:187]
  v_mfma_f32_16x16x32_bf16 a[188:191], a[220:223], v[156:159], a[188:191]
  s_waitcnt lgkmcnt(4)
  s_sub_u32 s36, s36, 1
  s_cmp_lg_u32 s36, 0
  s_cbranch_scc1 L_k2_loop
  v_mfma_f32_16x16x32_bf16 v[224:227], a[192:195], v[0:3], v[160:163]
  s_waitcnt vmcnt(11)
  ds_read_b128 a[212:215], v201 offset:12544
  v_mfma_f32_16x16x32_bf16 v[228:231], a[192:195], v[4:7], v[164:167]
  s_barrier
  v_mfma_f32_16x16x32_bf16 v[232:235], a[192:195], v[8:11], v[168:171]
  v_exp_f32 v248, v248
  v_mfma_f32_16x16x32_bf16 v[236:239], a[192:195], v[12:15], v[172:175]
  s_waitcnt lgkmcnt(4)
  v_exp_f32 v249, v249
  v_mfma_f32_16x16x32_bf16 v[224:227], a[196:199], v[16:19], v[224:227]
  ds_read_b128 a[216:219], v200 offset:18432
  v_add_f32 v178, v178, v248
  v_mfma_f32_16x16x32_bf16 v[228:231], a[196:199], v[20:23], v[228:231]
  v_exp_f32 v250, v250
  v_mfma_f32_16x16x32_bf16 v[232:235], a[196:199], v[24:27], v[232:235]
  v_add_f32 v178, v178, v249
  v_mfma_f32_16x16x32_bf16 v[236:239], a[196:199], v[28:31], v[236:239]
  s_waitcnt lgkmcnt(4)
  v_exp_f32 v251, v251
  v_mfma_f32_16x16x32_bf16 v[224:227], a[200:203], v[32:35], v[224:227]
  ds_read_b128 a[220:223], v201 offset:18432
  v_cvt_pk_bf16_f32 v138, v248, v249
  v_mfma_f32_16x16x32_bf16 v[228:231], a[200:203], v[36:39], v[228:231]
  v_add_f32 v178, v178, v250
  v_add_f32 v178, v178, v251
  v_mfma_f32_16x16x32_bf16 v[232:235], a[200:203], v[40:43], v[232:235]
  v_cvt_pk_bf16_f32 v139, v250, v251
  v_mfma_f32_16x16x32_bf16 v[236:239], a[200:203], v[44:47], v[236:239]
  s_waitcnt lgkmcnt(4)
  v_mfma_f32_16x16x32_bf16 v[224:227], a[204:207], v[48:51], v[224:227]
  ds_read_b128 a[192:195], v200 offset:18560
  v_mfma_f32_16x16x32_bf16 v[228:231], a[204:207], v[52:55], v[228:231]
  v_mfma_f32_16x16x32_bf16 v[232:235], a[204:207], v[56:59], v[232:235]
  v_mfma_f32_16x16x32_bf16 v[236:239], a[204:207], v[60:63], v[236:239]
  s_waitcnt lgkmcnt(4)
  v_exp_f32 v252, v252
  v_mfma_f32_16x16x32_bf16 v[224:227], a[208:211], v[64:67], v[224:227]
  ds_read_b128 a[196:199], v201 offset:18560
  v_add_f32 v179, v179, v252
  v_mfma_f32_16x16x32_bf16 v[228:231], a[208:211], v[68:71], v[228:231]
  v_exp_f32 v253, v253
  v_mfma_f32_16x16x32_bf16 v[232:235], a[208:211], v[72:75], v[232:235]
  v_exp_f32 v254, v254
  v_mfma_f32_16x16x32_bf16 v[236:239], a[208:211], v[76:79], v[236:239]
  s_waitcnt lgkmcnt(4)
  v_exp_f32 v255, v255
  v_mfma_f32_16x16x32_bf16 v[224:227], a[212:215], v[80:83], v[224:227]
  ds_read_b128 a[200:203], v200 offset:18688
  v_add_f32 v179, v179, v253
  v_mfma_f32_16x16x32_bf16 v[228:231], a[212:215], v[84:87], v[228:231]
  v_cvt_pk_bf16_f32 v142, v252, v253
  v_add_f32 v179, v179, v254
  v_mfma_f32_16x16x32_bf16 v[232:235], a[212:215], v[88:91], v[232:235]
  v_add_f32 v179, v179, v255
  v_mfma_f32_16x16x32_bf16 v[236:239], a[212:215], v[92:95], v[236:239]
  s_waitcnt lgkmcnt(4)
  v_cvt_pk_bf16_f32 v143, v254, v255
  v_mfma_f32_16x16x32_bf16 v[240:243], a[216:219], v[0:3], v[160:163]
  ds_read_b128 a[204:207], v201 offset:18688
  v_mfma_f32_16x16x32_bf16 v[244:247], a[216:219], v[4:7], v[164:167]
  v_mfma_f32_16x16x32_bf16 v[248:251], a[216:219], v[8:11], v[168:171]
  v_exp_f32 v224, v224
  v_mfma_f32_16x16x32_bf16 v[252:255], a[216:219], v[12:15], v[172:175]
  s_waitcnt lgkmcnt(4)
  v_exp_f32 v225, v225
  v_mfma_f32_16x16x32_bf16 v[240:243], a[220:223], v[16:19], v[240:243]
  ds_read_b64_tr_b16 a[208:209], v196 offset:0
  ds_read_b64_tr_b16 a[210:211], v196 offset:6144
  v_mfma_f32_16x16x32_bf16 v[244:247], a[220:223], v[20:23], v[244:247]
  v_exp_f32 v226, v226
  v_mfma_f32_16x16x32_bf16 v[248:251], a[220:223], v[24:27], v[248:251]
  v_exp_f32 v227, v227
  v_mfma_f32_16x16x32_bf16 v[252:255], a[220:223], v[28:31], v[252:255]
  s_waitcnt lgkmcnt(5)
  v_add_f32 v176, v176, v224
  v_add_f32 v176, v176, v225
  v_mfma_f32_16x16x32_bf16 v[240:243], a[192:195], v[32:35], v[240:243]
  ds_read_b64_tr_b16 a[212:213], v197 offset:0
  ds_read_b64_tr_b16 a[214:215], v197 offset:6144
  v_mfma_f32_16x16x32_bf16 v[244:247], a[192:195], v[36:39], v[244:247]
  v_cvt_pk_bf16_f32 v144, v224, v225
  v_add_f32 v176, v176, v226
  v_mfma_f32_16x16x32_bf16 v[248:251], a[192:195], v[40:43], v[248:251]
  v_add_f32 v176, v176, v227
  v_cvt_pk_bf16_f32 v145, v226, v227
  v_mfma_f32_16x16x32_bf16 v[252:255], a[192:195], v[44:47], v[252:255]
  s_waitcnt lgkmcnt(6)
  buffer_load_dwordx4 v[212:215], v209, s[52:55], s88 offen
  v_mfma_f32_16x16x32_bf16 v[240:243], a[196:199], v[48:51], v[240:243]
  ds_read_b64_tr_b16 a[216:217], v198 offset:0
  ds_read_b64_tr_b16 a[218:219], v198 offset:6144
  v_mfma_f32_16x16x32_bf16 v[244:247], a[196:199], v[52:55], v[244:247]
  v_mfma_f32_16x16x32_bf16 v[248:251], a[196:199], v[56:59], v[248:251]
  v_exp_f32 v228, v228
  v_mfma_f32_16x16x32_bf16 v[252:255], a[196:199], v[60:63], v[252:255]
  s_waitcnt lgkmcnt(7)
  v_exp_f32 v229, v229
  v_mfma_f32_16x16x32_bf16 v[240:243], a[200:203], v[64:67], v[240:243]
  ds_read_b64_tr_b16 a[220:221], v199 offset:0
  ds_read_b64_tr_b16 a[222:223], v199 offset:6144
  v_mfma_f32_16x16x32_bf16 v[244:247], a[200:203], v[68:71], v[244:247]
  v_exp_f32 v230, v230
  v_mfma_f32_16x16x32_bf16 v[248:251], a[200:203], v[72:75], v[248:251]
  v_exp_f32 v231, v231
  v_mfma_f32_16x16x32_bf16 v[252:255], a[200:203], v[76:79], v[252:255]
  s_waitcnt lgkmcnt(8)
  v_add_f32 v177, v177, v228
  v_add_f32 v177, v177, v229
  v_mfma_f32_16x16x32_bf16 v[240:243], a[204:207], v[80:83], v[240:243]
  ds_read_b64_tr_b16 a[192:193], v196 offset:128
  ds_read_b64_tr_b16 a[194:195], v196 offset:6272
  v_mfma_f32_16x16x32_bf16 v[244:247], a[204:207], v[84:87], v[244:247]
  v_cvt_pk_bf16_f32 v148, v228, v229
  v_add_f32 v177, v177, v230
  v_mfma_f32_16x16x32_bf16 v[248:251], a[204:207], v[88:91], v[248:251]
  v_add_f32 v177, v177, v231
  v_cvt_pk_bf16_f32 v149, v230, v231
  v_mfma_f32_16x16x32_bf16 v[252:255], a[204:207], v[92:95], v[252:255]
  s_waitcnt lgkmcnt(8)
  buffer_load_dwordx4 v[216:219], v210, s[52:55], s88 offen
  v_mfma_f32_16x16x32_bf16 a[0:3], a[208:211], v[128:131], a[0:3]
  ds_read_b64_tr_b16 a[196:197], v197 offset:128
  ds_read_b64_tr_b16 a[198:199], v197 offset:6272
  v_mfma_f32_16x16x32_bf16 a[4:7], a[208:211], v[132:135], a[4:7]
  v_mfma_f32_16x16x32_bf16 a[8:11], a[208:211], v[136:139], a[8:11]
  v_exp_f32 v232, v232
  v_mfma_f32_16x16x32_bf16 a[12:15], a[208:211], v[140:143], a[12:15]
  s_waitcnt lgkmcnt(8)
  v_exp_f32 v233, v233
  v_mfma_f32_16x16x32_bf16 a[16:19], a[212:215], v[128:131], a[16:19]
  ds_read_b64_tr_b16 a[200:201], v198 offset:128
  ds_read_b64_tr_b16 a[202:203], v198 offset:6272
  v_mfma_f32_16x16x32_bf16 a[20:23], a[212:215], v[132:135], a[20:23]
  s_add_u32 m0, s31, 86016
  v_exp_f32 v234, v234
  v_mfma_f32_16x16x32_bf16 a[24:27], a[212:215], v[136:139], a[24:27]
  buffer_load_dwordx4 v205, s[16:19], s34 offen offset:0 lds
  v_add_f32 v178, v178, v232
  v_mfma_f32_16x16x32_bf16 a[28:31], a[212:215], v[140:143], a[28:31]
  s_waitcnt lgkmcnt(8)
  v_exp_f32 v235, v235
  v_mfma_f32_16x16x32_bf16 a[32:35], a[216:219], v[128:131], a[32:35]
  ds_read_b64_tr_b16 a[204:205], v199 offset:128
  ds_read_b64_tr_b16 a[206:207], v199 offset:6272
  v_mfma_f32_16x16x32_bf16 a[36:39], a[216:219], v[132:135], a[36:39]
  v_add_f32 v178, v178, v233
  v_cvt_pk_bf16_f32 v152, v232, v233
  v_mfma_f32_16x16x32_bf16 a[40:43], a[216:219], v[136:139], a[40:43]
  v_add_f32 v178, v178, v234
  v_add_f32 v178, v178, v235
  v_mfma_f32_16x16x32_bf16 a[44:47], a[216:219], v[140:143], a[44:47]
  s_waitcnt lgkmcnt(8)
  v_cvt_pk_bf16_f32 v153, v234, v235
  v_mfma_f32_16x16x32_bf16 a[48:51], a[220:223], v[128:131], a[48:51]
  ds_read_b64_tr_b16 a[208:209], v196 offset:256
  ds_read_b64_tr_b16 a[210:211], v196 offset:6400
  v_mfma_f32_16x16x32_bf16 a[52:55], a[220:223], v[132:135], a[52:55]
  v_mfma_f32_16x16x32_bf16 a[56:59], a[220:223], v[136:139], a[56:59]
  buffer_load_dwordx4 v206, s[16:19], s34 offen offset:1024 lds
  v_mfma_f32_16x16x32_bf16 a[60:63], a[220:223], v[140:143], a[60:63]
  s_waitcnt lgkmcnt(8)
  v_exp_f32 v236, v236
  v_mfma_f32_16x16x32_bf16 a[64:67], a[192:195], v[128:131], a[64:67]
  ds_read_b64_tr_b16 a[212:213], v197 offset:256
  ds_read_b64_tr_b16 a[214:215], v197 offset:6400
  v_mfma_f32_16x16x32_bf16 a[68:71], a[192:195], v[132:135], a[68:71]
  v_exp_f32 v237, v237
  v_mfma_f32_16x16x32_bf16 a[72:75], a[192:195], v[136:139], a[72:75]
  v_exp_f32 v238, v238
  v_mfma_f32_16x16x32_bf16 a[76:79], a[192:195], v[140:143], a[76:79]
  s_waitcnt lgkmcnt(8)
  v_exp_f32 v239, v239
  v_mfma_f32_16x16x32_bf16 a[80:83], a[196:199], v[128:131], a[80:83]
  ds_read_b64_tr_b16 a[216:217], v198 offset:256
  ds_read_b64_tr_b16 a[218:219], v198 offset:6400
  v_mfma_f32_16x16x32_bf16 a[84:87], a[196:199], v[132:135], a[84:87]
  v_add_f32 v179, v179, v236
  v_add_f32 v179, v179, v237
  v_mfma_f32_16x16x32_bf16 a[88:91], a[196:199], v[136:139], a[88:91]
  buffer_load_dwordx4 v207, s[16:19], s34 offen offset:2048 lds
  v_cvt_pk_bf16_f32 v156, v236, v237
  v_mfma_f32_16x16x32_bf16 a[92:95], a[196:199], v[140:143], a[92:95]
  s_waitcnt lgkmcnt(8)
  v_add_f32 v179, v179, v238
  v_add_f32 v179, v179, v239
  v_mfma_f32_16x16x32_bf16 a[96:99], a[200:203], v[128:131], a[96:99]
  ds_read_b64_tr_b16 a[220:221], v199 offset:256
  ds_read_b64_tr_b16 a[222:223], v199 offset:6400
  v_mfma_f32_16x16x32_bf16 a[100:103], a[200:203], v[132:135], a[100:103]
  s_add_u32 s34, s34, 12288
  v_cvt_pk_bf16_f32 v157, v238, v239
  v_mfma_f32_16x16x32_bf16 a[104:107], a[200:203], v[136:139], a[104:107]
  v_exp_f32 v240, v240
  v_mfma_f32_16x16x32_bf16 a[108:111], a[200:203], v[140:143], a[108:111]
  s_waitcnt lgkmcnt(8)
  v_exp_f32 v241, v241
  v_mfma_f32_16x16x32_bf16 a[112:115], a[204:207], v[128:131], a[112:115]
  ds_read_b128 a[192:195], v200 offset:24576
  v_add_f32 v176, v176, v240
  v_mfma_f32_16x16x32_bf16 a[116:119], a[204:207], v[132:135], a[116:119]
  v_exp_f32 v242, v242
  v_mfma_f32_16x16x32_bf16 a[120:123], a[204:207], v[136:139], a[120:123]
  v_exp_f32 v243, v243
  v_mfma_f32_16x16x32_bf16 a[124:127], a[204:207], v[140:143], a[124:127]
  s_waitcnt lgkmcnt(7)
  v_add_f32 v176, v176, v241
  v_cvt_pk_bf16_f32 v146, v240, v241
  v_mfma_f32_16x16x32_bf16 a[128:131], a[208:211], v[128:131], a[128:131]
  ds_read_b128 a[196:199], v201 offset:24576
  v_add_f32 v176, v176, v242
  v_mfma_f32_16x16x32_bf16 a[132:135], a[208:211], v[132:135], a[132:135]
  v_add_f32 v176, v176, v243
  v_cvt_pk_bf16_f32 v147, v242, v243
  v_mfma_f32_16x16x32_bf16 a[136:139], a[208:211], v[136:139], a[136:139]
  v_mfma_f32_16x16x32_bf16 a[140:143], a[208:211], v[140:143], a[140:143]
  s_waitcnt lgkmcnt(6)
  v_mfma_f32_16x16x32_bf16 a[144:147], a[212:215], v[128:131], a[144:147]
  ds_read_b128 a[200:203], v200 offset:24704
  v_mfma_f32_16x16x32_bf16 a[148:151], a[212:215], v[132:135], a[148:151]
  v_mfma_f32_16x16x32_bf16 a[152:155], a[212:215], v[136:139], a[152:155]
  v_exp_f32 v244, v244
  v_mfma_f32_16x16x32_bf16 a[156:159], a[212:215], v[140:143], a[156:159]
  s_waitcnt lgkmcnt(5)
  v_exp_f32 v245, v245
  v_mfma_f32_16x16x32_bf16 a[160:163], a[216:219], v[128:131], a[160:163]
  ds_read_b128 a[204:207], v201 offset:24704
  v_add_f32 v177, v177, v244
  v_mfma_f32_16x16x32_bf16 a[164:167], a[216:219], v[132:135], a[164:167]
  v_exp_f32 v246, v246
  v_mfma_f32_16x16x32_bf16 a[168:171], a[216:219], v[136:139], a[168:171]
  v_exp_f32 v247, v247
  v_mfma_f32_16x16x32_bf16 a[172:175], a[216:219], v[140:143], a[172:175]
  s_waitcnt lgkmcnt(4)
  v_add_f32 v177, v177, v245
  v_cvt_pk_bf16_f32 v150, v244, v245
  v_mfma_f32_16x16x32_bf16 a[176:179], a[220:223], v[128:131], a[176:179]
  ds_read_b128 a[208:211], v200 offset:24832
  v_add_f32 v177, v177, v246
  v_mfma_f32_16x16x32_bf16 a[180:183], a[220:223], v[132:135], a[180:183]
  v_add_f32 v177, v177, v247
  v_cvt_pk_bf16_f32 v151, v246, v247
  v_mfma_f32_16x16x32_bf16 a[184:187], a[220:223], v[136:139], a[184:187]
  v_mfma_f32_16x16x32_bf16 a[188:191], a[220:223], v[140:143], a[188:191]
  s_waitcnt lgkmcnt(4)
  v_mfma_f32_16x16x32_bf16 v[224:227], a[192:195], v[0:3], v[160:163]
  s_waitcnt vmcnt(9)
  ds_read_b128 a[212:215], v201 offset:24832
  v_mfma_f32_16x16x32_bf16 v[228:231], a[192:195], v[4:7], v[164:167]
  s_barrier
  v_mfma_f32_16x16x32_bf16 v[232:235], a[192:195], v[8:11], v[168:171]
  v_exp_f32 v248, v248
  v_mfma_f32_16x16x32_bf16 v[236:239], a[192:195], v[12:15], v[172:175]
  s_waitcnt lgkmcnt(4)
  v_exp_f32 v249, v249
  v_mfma_f32_16x16x32_bf16 v[224:227], a[196:199], v[16:19], v[224:227]
  ds_read_b128 a[216:219], v200 offset:30720
  v_add_f32 v178, v178, v248
  v_mfma_f32_16x16x32_bf16 v[228:231], a[196:199], v[20:23], v[228:231]
  v_exp_f32 v250, v250
  v_mfma_f32_16x16x32_bf16 v[232:235], a[196:199], v[24:27], v[232:235]
  v_add_f32 v178, v178, v249
  v_mfma_f32_16x16x32_bf16 v[236:239], a[196:199], v[28:31], v[236:239]
  s_waitcnt lgkmcnt(4)
  v_exp_f32 v251, v251
  v_mfma_f32_16x16x32_bf16 v[224:227], a[200:203], v[32:35], v[224:227]
  ds_read_b128 a[220:223], v201 offset:30720
  v_cvt_pk_bf16_f32 v154, v248, v249
  v_mfma_f32_16x16x32_bf16 v[228:231], a[200:203], v[36:39], v[228:231]
  v_add_f32 v178, v178, v250
  v_add_f32 v178, v178, v251
  v_mfma_f32_16x16x32_bf16 v[232:235], a[200:203], v[40:43], v[232:235]
  v_cvt_pk_bf16_f32 v155, v250, v251
  v_mfma_f32_16x16x32_bf16 v[236:239], a[200:203], v[44:47], v[236:239]
  s_waitcnt lgkmcnt(4)
  v_mfma_f32_16x16x32_bf16 v[224:227], a[204:207], v[48:51], v[224:227]
  ds_read_b128 a[192:195], v200 offset:30848
  v_mfma_f32_16x16x32_bf16 v[228:231], a[204:207], v[52:55], v[228:231]
  v_mfma_f32_16x16x32_bf16 v[232:235], a[204:207], v[56:59], v[232:235]
  v_mfma_f32_16x16x32_bf16 v[236:239], a[204:207], v[60:63], v[236:239]
  s_waitcnt lgkmcnt(4)
  v_exp_f32 v252, v252
  v_mfma_f32_16x16x32_bf16 v[224:227], a[208:211], v[64:67], v[224:227]
  ds_read_b128 a[196:199], v201 offset:30848
  v_add_f32 v179, v179, v252
  v_mfma_f32_16x16x32_bf16 v[228:231], a[208:211], v[68:71], v[228:231]
  v_exp_f32 v253, v253
  v_mfma_f32_16x16x32_bf16 v[232:235], a[208:211], v[72:75], v[232:235]
  v_exp_f32 v254, v254
  v_mfma_f32_16x16x32_bf16 v[236:239], a[208:211], v[76:79], v[236:239]
  s_waitcnt lgkmcnt(4)
  v_exp_f32 v255, v255
  v_mfma_f32_16x16x32_bf16 v[224:227], a[212:215], v[80:83], v[224:227]
  ds_read_b128 a[200:203], v200 offset:30976
  v_add_f32 v179, v179, v253
  v_mfma_f32_16x16x32_bf16 v[228:231], a[212:215], v[84:87], v[228:231]
  v_cvt_pk_bf16_f32 v158, v252, v253
  v_add_f32 v179, v179, v254
  v_mfma_f32_16x16x32_bf16 v[232:235], a[212:215], v[88:91], v[232:235]
  v_add_f32 v179, v179, v255
  v_mfma_f32_16x16x32_bf16 v[236:239], a[212:215], v[92:95], v[236:239]
  s_waitcnt lgkmcnt(4)
  v_cvt_pk_bf16_f32 v159, v254, v255
  v_mfma_f32_16x16x32_bf16 v[240:243], a[216:219], v[0:3], v[160:163]
  ds_read_b128 a[204:207], v201 offset:30976
  v_mfma_f32_16x16x32_bf16 v[244:247], a[216:219], v[4:7], v[164:167]
  v_mfma_f32_16x16x32_bf16 v[248:251], a[216:219], v[8:11], v[168:171]
  v_exp_f32 v224, v224
  v_mfma_f32_16x16x32_bf16 v[252:255], a[216:219], v[12:15], v[172:175]
  s_waitcnt lgkmcnt(4)
  v_exp_f32 v225, v225
  v_mfma_f32_16x16x32_bf16 v[240:243], a[220:223], v[16:19], v[240:243]
  ds_read_b64_tr_b16 a[208:209], v196 offset:12288
  ds_read_b64_tr_b16 a[210:211], v196 offset:18432
  v_mfma_f32_16x16x32_bf16 v[244:247], a[220:223], v[20:23], v[244:247]
  v_exp_f32 v226, v226
  v_mfma_f32_16x16x32_bf16 v[248:251], a[220:223], v[24:27], v[248:251]
  v_exp_f32 v227, v227
  v_mfma_f32_16x16x32_bf16 v[252:255], a[220:223], v[28:31], v[252:255]
  s_waitcnt lgkmcnt(5)
  v_add_f32 v176, v176, v224
  v_add_f32 v176, v176, v225
  v_mfma_f32_16x16x32_bf16 v[240:243], a[192:195], v[32:35], v[240:243]
  ds_read_b64_tr_b16 a[212:213], v197 offset:12288
  ds_read_b64_tr_b16 a[214:215], v197 offset:18432
  v_mfma_f32_16x16x32_bf16 v[244:247], a[192:195], v[36:39], v[244:247]
  v_cvt_pk_bf16_f32 v128, v224, v225
  v_add_f32 v176, v176, v226
  v_mfma_f32_16x16x32_bf16 v[248:251], a[192:195], v[40:43], v[248:251]
  v_add_f32 v176, v176, v227
  v_cvt_pk_bf16_f32 v129, v226, v227
  v_mfma_f32_16x16x32_bf16 v[252:255], a[192:195], v[44:47], v[252:255]
  s_waitcnt lgkmcnt(6)
  v_mfma_f32_16x16x32_bf16 v[240:243], a[196:199], v[48:51], v[240:243]
  ds_read_b64_tr_b16 a[216:217], v198 offset:12288
  ds_read_b64_tr_b16 a[218:219], v198 offset:18432
  v_mfma_f32_16x16x32_bf16 v[244:247], a[196:199], v[52:55], v[244:247]
  v_mfma_f32_16x16x32_bf16 v[248:251], a[196:199], v[56:59], v[248:251]
  v_exp_f32 v228, v228
  v_mfma_f32_16x16x32_bf16 v[252:255], a[196:199], v[60:63], v[252:255]
  s_waitcnt lgkmcnt(7)
  v_exp_f32 v229, v229
  v_mfma_f32_16x16x32_bf16 v[240:243], a[200:203], v[64:67], v[240:243]
  ds_read_b64_tr_b16 a[220:221], v199 offset:12288
  ds_read_b64_tr_b16 a[222:223], v199 offset:18432
  v_mfma_f32_16x16x32_bf16 v[244:247], a[200:203], v[68:71], v[244:247]
  v_exp_f32 v230, v230
  v_mfma_f32_16x16x32_bf16 v[248:251], a[200:203], v[72:75], v[248:251]
  v_exp_f32 v231, v231
  v_mfma_f32_16x16x32_bf16 v[252:255], a[200:203], v[76:79], v[252:255]
  s_waitcnt lgkmcnt(8)
  v_add_f32 v177, v177, v228
  v_add_f32 v177, v177, v229
  v_mfma_f32_16x16x32_bf16 v[240:243], a[204:207], v[80:83], v[240:243]
  ds_read_b64_tr_b16 a[192:193], v196 offset:12416
  ds_read_b64_tr_b16 a[194:195], v196 offset:18560
  v_mfma_f32_16x16x32_bf16 v[244:247], a[204:207], v[84:87], v[244:247]
  v_cvt_pk_bf16_f32 v132, v228, v229
  v_add_f32 v177, v177, v230
  v_mfma_f32_16x16x32_bf16 v[248:251], a[204:207], v[88:91], v[248:251]
  v_add_f32 v177, v177, v231
  v_cvt_pk_bf16_f32 v133, v230, v231
  v_mfma_f32_16x16x32_bf16 v[252:255], a[204:207], v[92:95], v[252:255]
  s_waitcnt lgkmcnt(8)
  v_mfma_f32_16x16x32_bf16 a[0:3], a[208:211], v[144:147], a[0:3]
  ds_read_b64_tr_b16 a[196:197], v197 offset:12416
  ds_read_b64_tr_b16 a[198:199], v197 offset:18560
  v_mfma_f32_16x16x32_bf16 a[4:7], a[208:211], v[148:151], a[4:7]
  v_mfma_f32_16x16x32_bf16 a[8:11], a[208:211], v[152:155], a[8:11]
  v_exp_f32 v232, v232
  v_mfma_f32_16x16x32_bf16 a[12:15], a[208:211], v[156:159], a[12:15]
  s_waitcnt lgkmcnt(8)
  v_exp_f32 v233, v233
  v_mfma_f32_16x16x32_bf16 a[16:19], a[212:215], v[144:147], a[16:19]
  ds_read_b64_tr_b16 a[200:201], v198 offset:12416
  ds_read_b64_tr_b16 a[202:203], v198 offset:18560
  v_mfma_f32_16x16x32_bf16 a[20:23], a[212:215], v[148:151], a[20:23]
  v_exp_f32 v234, v234
  v_mfma_f32_16x16x32_bf16 a[24:27], a[212:215], v[152:155], a[24:27]
  v_add_f32 v178, v178, v232
  v_mfma_f32_16x16x32_bf16 a[28:31], a[212:215], v[156:159], a[28:31]
  s_waitcnt lgkmcnt(8)
  v_exp_f32 v235, v235
  v_mfma_f32_16x16x32_bf16 a[32:35], a[216:219], v[144:147], a[32:35]
  ds_read_b64_tr_b16 a[204:205], v199 offset:12416
  ds_read_b64_tr_b16 a[206:207], v199 offset:18560
  v_mfma_f32_16x16x32_bf16 a[36:39], a[216:219], v[148:151], a[36:39]
  v_add_f32 v178, v178, v233
  v_cvt_pk_bf16_f32 v136, v232, v233
  v_mfma_f32_16x16x32_bf16 a[40:43], a[216:219], v[152:155], a[40:43]
  v_add_f32 v178, v178, v234
  v_add_f32 v178, v178, v235
  v_mfma_f32_16x16x32_bf16 a[44:47], a[216:219], v[156:159], a[44:47]
  s_waitcnt lgkmcnt(8)
  v_cvt_pk_bf16_f32 v137, v234, v235
  v_mfma_f32_16x16x32_bf16 a[48:51], a[220:223], v[144:147], a[48:51]
  ds_read_b64_tr_b16 a[208:209], v196 offset:12544
  ds_read_b64_tr_b16 a[210:211], v196 offset:18688
  v_mfma_f32_16x16x32_bf16 a[52:55], a[220:223], v[148:151], a[52:55]
  v_mfma_f32_16x16x32_bf16 a[56:59], a[220:223], v[152:155], a[56:59]
  v_mfma_f32_16x16x32_bf16 a[60:63], a[220:223], v[156:159], a[60:63]
  s_waitcnt lgkmcnt(8)
  v_exp_f32 v236, v236
  v_mfma_f32_16x16x32_bf16 a[64:67], a[192:195], v[144:147], a[64:67]
  ds_read_b64_tr_b16 a[212:213], v197 offset:12544
  ds_read_b64_tr_b16 a[214:215], v197 offset:18688
  v_mfma_f32_16x16x32_bf16 a[68:71], a[192:195], v[148:151], a[68:71]
  v_exp_f32 v237, v237
  v_mfma_f32_16x16x32_bf16 a[72:75], a[192:195], v[152:155], a[72:75]
  v_exp_f32 v238, v238
  v_mfma_f32_16x16x32_bf16 a[76:79], a[192:195], v[156:159], a[76:79]
  s_waitcnt lgkmcnt(8)
  v_exp_f32 v239, v239
  v_mfma_f32_16x16x32_bf16 a[80:83], a[196:199], v[144:147], a[80:83]
  ds_read_b64_tr_b16 a[216:217], v198 offset:12544
  ds_read_b64_tr_b16 a[218:219], v198 offset:18688
  v_mfma_f32_16x16x32_bf16 a[84:87], a[196:199], v[148:151], a[84:87]
  v_add_f32 v179, v179, v236
  v_add_f32 v179, v179, v237
  v_mfma_f32_16x16x32_bf16 a[88:91], a[196:199], v[152:155], a[88:91]
  v_cvt_pk_bf16_f32 v140, v236, v237
  v_mfma_f32_16x16x32_bf16 a[92:95], a[196:199], v[156:159], a[92:95]
  s_waitcnt lgkmcnt(8)
  v_add_f32 v179, v179, v238
  v_add_f32 v179, v179, v239
  v_mfma_f32_16x16x32_bf16 a[96:99], a[200:203], v[144:147], a[96:99]
  ds_read_b64_tr_b16 a[220:221], v199 offset:12544
  ds_read_b64_tr_b16 a[222:223], v199 offset:18688
  v_mfma_f32_16x16x32_bf16 a[100:103], a[200:203], v[148:151], a[100:103]
  v_cvt_pk_bf16_f32 v141, v238, v239
  v_mfma_f32_16x16x32_bf16 a[104:107], a[200:203], v[152:155], a[104:107]
  v_exp_f32 v240, v240
  v_mfma_f32_16x16x32_bf16 a[108:111], a[200:203], v[156:159], a[108:111]
  s_waitcnt lgkmcnt(8)
  v_exp_f32 v241, v241
  v_mfma_f32_16x16x32_bf16 a[112:115], a[204:207], v[144:147], a[112:115]
  ds_read_b128 a[192:195], v200 offset:36864
  v_add_f32 v176, v176, v240
  v_mfma_f32_16x16x32_bf16 a[116:119], a[204:207], v[148:151], a[116:119]
  v_exp_f32 v242, v242
  v_mfma_f32_16x16x32_bf16 a[120:123], a[204:207], v[152:155], a[120:123]
  v_exp_f32 v243, v243
  v_mfma_f32_16x16x32_bf16 a[124:127], a[204:207], v[156:159], a[124:127]
  s_waitcnt lgkmcnt(7)
  v_add_f32 v176, v176, v241
  v_cvt_pk_bf16_f32 v130, v240, v241
  v_mfma_f32_16x16x32_bf16 a[128:131], a[208:211], v[144:147], a[128:131]
  ds_read_b128 a[196:199], v201 offset:36864
  v_add_f32 v176, v176, v242
  v_mfma_f32_16x16x32_bf16 a[132:135], a[208:211], v[148:151], a[132:135]
  v_add_f32 v176, v176, v243
  v_cvt_pk_bf16_f32 v131, v242, v243
  v_mfma_f32_16x16x32_bf16 a[136:139], a[208:211], v[152:155], a[136:139]
  v_mfma_f32_16x16x32_bf16 a[140:143], a[208:211], v[156:159], a[140:143]
  s_waitcnt lgkmcnt(6)
  v_mfma_f32_16x16x32_bf16 a[144:147], a[212:215], v[144:147], a[144:147]
  ds_read_b128 a[200:203], v200 offset:36992
  v_mfma_f32_16x16x32_bf16 a[148:151], a[212:215], v[148:151], a[148:151]
  v_mfma_f32_16x16x32_bf16 a[152:155], a[212:215], v[152:155], a[152:155]
  v_exp_f32 v244, v244
  v_mfma_f32_16x16x32_bf16 a[156:159], a[212:215], v[156:159], a[156:159]
  s_waitcnt lgkmcnt(5)
  v_exp_f32 v245, v245
  v_mfma_f32_16x16x32_bf16 a[160:163], a[216:219], v[144:147], a[160:163]
  ds_read_b128 a[204:207], v201 offset:36992
  v_add_f32 v177, v177, v244
  v_mfma_f32_16x16x32_bf16 a[164:167], a[216:219], v[148:151], a[164:167]
  v_exp_f32 v246, v246
  v_mfma_f32_16x16x32_bf16 a[168:171], a[216:219], v[152:155], a[168:171]
  v_exp_f32 v247, v247
  v_mfma_f32_16x16x32_bf16 a[172:175], a[216:219], v[156:159], a[172:175]
  s_waitcnt lgkmcnt(4)
  v_add_f32 v177, v177, v245
  v_cvt_pk_bf16_f32 v134, v244, v245
  v_mfma_f32_16x16x32_bf16 a[176:179], a[220:223], v[144:147], a[176:179]
  ds_read_b128 a[208:211], v200 offset:37120
  v_add_f32 v177, v177, v246
  v_mfma_f32_16x16x32_bf16 a[180:183], a[220:223], v[148:151], a[180:183]
  v_add_f32 v177, v177, v247
  v_cvt_pk_bf16_f32 v135, v246, v247
  v_mfma_f32_16x16x32_bf16 a[184:187], a[220:223], v[152:155], a[184:187]
  v_mfma_f32_16x16x32_bf16 a[188:191], a[220:223], v[156:159], a[188:191]
  s_waitcnt lgkmcnt(4)
  v_mfma_f32_16x16x32_bf16 v[224:227], a[192:195], v[0:3], v[160:163]
  s_waitcnt vmcnt(5)
  ds_read_b128 a[212:215], v201 offset:37120
  v_mfma_f32_16x16x32_bf16 v[228:231], a[192:195], v[4:7], v[164:167]
  s_barrier
  v_mfma_f32_16x16x32_bf16 v[232:235], a[192:195], v[8:11], v[168:171]
  v_exp_f32 v248, v248
  v_mfma_f32_16x16x32_bf16 v[236:239], a[192:195], v[12:15], v[172:175]
  s_waitcnt lgkmcnt(4)
  v_exp_f32 v249, v249
  v_mfma_f32_16x16x32_bf16 v[224:227], a[196:199], v[16:19], v[224:227]
  ds_read_b128 a[216:219], v200 offset:43008
  v_add_f32 v178, v178, v248
  v_mfma_f32_16x16x32_bf16 v[228:231], a[196:199], v[20:23], v[228:231]
  v_exp_f32 v250, v250
  v_mfma_f32_16x16x32_bf16 v[232:235], a[196:199], v[24:27], v[232:235]
  v_add_f32 v178, v178, v249
  v_mfma_f32_16x16x32_bf16 v[236:239], a[196:199], v[28:31], v[236:239]
  s_waitcnt lgkmcnt(4)
  v_exp_f32 v251, v251
  v_mfma_f32_16x16x32_bf16 v[224:227], a[200:203], v[32:35], v[224:227]
  ds_read_b128 a[220:223], v201 offset:43008
  v_cvt_pk_bf16_f32 v138, v248, v249
  v_mfma_f32_16x16x32_bf16 v[228:231], a[200:203], v[36:39], v[228:231]
  v_add_f32 v178, v178, v250
  v_add_f32 v178, v178, v251
  v_mfma_f32_16x16x32_bf16 v[232:235], a[200:203], v[40:43], v[232:235]
  v_cvt_pk_bf16_f32 v139, v250, v251
  v_mfma_f32_16x16x32_bf16 v[236:239], a[200:203], v[44:47], v[236:239]
  s_waitcnt lgkmcnt(4)
  v_mfma_f32_16x16x32_bf16 v[224:227], a[204:207], v[48:51], v[224:227]
  ds_read_b128 a[192:195], v200 offset:43136
  v_mfma_f32_16x16x32_bf16 v[228:231], a[204:207], v[52:55], v[228:231]
  v_mfma_f32_16x16x32_bf16 v[232:235], a[204:207], v[56:59], v[232:235]
  v_mfma_f32_16x16x32_bf16 v[236:239], a[204:207], v[60:63], v[236:239]
  s_waitcnt lgkmcnt(4)
  v_exp_f32 v252, v252
  v_mfma_f32_16x16x32_bf16 v[224:227], a[208:211], v[64:67], v[224:227]
  ds_read_b128 a[196:199], v201 offset:43136
  v_add_f32 v179, v179, v252
  v_mfma_f32_16x16x32_bf16 v[228:231], a[208:211], v[68:71], v[228:231]
  v_exp_f32 v253, v253
  v_mfma_f32_16x16x32_bf16 v[232:235], a[208:211], v[72:75], v[232:235]
  v_exp_f32 v254, v254
  v_mfma_f32_16x16x32_bf16 v[236:239], a[208:211], v[76:79], v[236:239]
  s_waitcnt lgkmcnt(4)
  v_exp_f32 v255, v255
  v_mfma_f32_16x16x32_bf16 v[224:227], a[212:215], v[80:83], v[224:227]
  ds_read_b128 a[200:203], v200 offset:43264
  v_add_f32 v179, v179, v253
  v_mfma_f32_16x16x32_bf16 v[228:231], a[212:215], v[84:87], v[228:231]
  v_cvt_pk_bf16_f32 v142, v252, v253
  v_add_f32 v179, v179, v254
  v_mfma_f32_16x16x32_bf16 v[232:235], a[212:215], v[88:91], v[232:235]
  v_add_f32 v179, v179, v255
  v_mfma_f32_16x16x32_bf16 v[236:239], a[212:215], v[92:95], v[236:239]
  s_waitcnt lgkmcnt(4)
  v_cvt_pk_bf16_f32 v143, v254, v255
  v_mfma_f32_16x16x32_bf16 v[240:243], a[216:219], v[0:3], v[160:163]
  ds_read_b128 a[204:207], v201 offset:43264
  v_mfma_f32_16x16x32_bf16 v[244:247], a[216:219], v[4:7], v[164:167]
  v_mfma_f32_16x16x32_bf16 v[248:251], a[216:219], v[8:11], v[168:171]
  v_exp_f32 v224, v224
  v_mfma_f32_16x16x32_bf16 v[252:255], a[216:219], v[12:15], v[172:175]
  s_waitcnt lgkmcnt(4)
  v_exp_f32 v225, v225
  v_mfma_f32_16x16x32_bf16 v[240:243], a[220:223], v[16:19], v[240:243]
  s_waitcnt vmcnt(3)
  ds_read_b64_tr_b16 a[208:209], v196 offset:24576
  ds_read_b64_tr_b16 a[210:211], v196 offset:30720
  v_mfma_f32_16x16x32_bf16 v[244:247], a[220:223], v[20:23], v[244:247]
  v_exp_f32 v226, v226
  v_mfma_f32_16x16x32_bf16 v[248:251], a[220:223], v[24:27], v[248:251]
  v_exp_f32 v227, v227
  v_mfma_f32_16x16x32_bf16 v[252:255], a[220:223], v[28:31], v[252:255]
  s_waitcnt lgkmcnt(5)
  v_add_f32 v176, v176, v224
  v_add_f32 v176, v176, v225
  v_mfma_f32_16x16x32_bf16 v[240:243], a[192:195], v[32:35], v[240:243]
  ds_read_b64_tr_b16 a[212:213], v197 offset:24576
  ds_read_b64_tr_b16 a[214:215], v197 offset:30720
  v_mfma_f32_16x16x32_bf16 v[244:247], a[192:195], v[36:39], v[244:247]
  v_cvt_pk_bf16_f32 v144, v224, v225
  v_add_f32 v176, v176, v226
  v_mfma_f32_16x16x32_bf16 v[248:251], a[192:195], v[40:43], v[248:251]
  v_add_f32 v176, v176, v227
  v_cvt_pk_bf16_f32 v145, v226, v227
  v_mfma_f32_16x16x32_bf16 v[252:255], a[192:195], v[44:47], v[252:255]
  s_waitcnt lgkmcnt(6)
  buffer_store_dwordx4 v[212:215], v208, s[56:59], s89 offen offset:0 sc1
  v_mfma_f32_16x16x32_bf16 v[240:243], a[196:199], v[48:51], v[240:243]
  ds_read_b64_tr_b16 a[216:217], v198 offset:24576
  ds_read_b64_tr_b16 a[218:219], v198 offset:30720
  v_mfma_f32_16x16x32_bf16 v[244:247], a[196:199], v[52:55], v[244:247]
  v_mfma_f32_16x16x32_bf16 v[248:251], a[196:199], v[56:59], v[248:251]
  v_exp_f32 v228, v228
  v_mfma_f32_16x16x32_bf16 v[252:255], a[196:199], v[60:63], v[252:255]
  s_waitcnt lgkmcnt(7)
  v_exp_f32 v229, v229
  v_mfma_f32_16x16x32_bf16 v[240:243], a[200:203], v[64:67], v[240:243]
  ds_read_b64_tr_b16 a[220:221], v199 offset:24576
  ds_read_b64_tr_b16 a[222:223], v199 offset:30720
  v_mfma_f32_16x16x32_bf16 v[244:247], a[200:203], v[68:71], v[244:247]
  v_exp_f32 v230, v230
  v_mfma_f32_16x16x32_bf16 v[248:251], a[200:203], v[72:75], v[248:251]
  v_exp_f32 v231, v231
  v_mfma_f32_16x16x32_bf16 v[252:255], a[200:203], v[76:79], v[252:255]
  s_waitcnt lgkmcnt(8)
  v_add_f32 v177, v177, v228
  v_add_f32 v177, v177, v229
  v_mfma_f32_16x16x32_bf16 v[240:243], a[204:207], v[80:83], v[240:243]
  ds_read_b64_tr_b16 a[192:193], v196 offset:24704
  ds_read_b64_tr_b16 a[194:195], v196 offset:30848
  v_mfma_f32_16x16x32_bf16 v[244:247], a[204:207], v[84:87], v[244:247]
  v_cvt_pk_bf16_f32 v148, v228, v229
  v_add_f32 v177, v177, v230
  v_mfma_f32_16x16x32_bf16 v[248:251], a[204:207], v[88:91], v[248:251]
  v_add_f32 v177, v177, v231
  v_cvt_pk_bf16_f32 v149, v230, v231
  v_mfma_f32_16x16x32_bf16 v[252:255], a[204:207], v[92:95], v[252:255]
  s_waitcnt lgkmcnt(8)
  buffer_store_dwordx4 v[216:219], v208, s[56:59], s89 offen offset:1024 sc1
  v_mfma_f32_16x16x32_bf16 a[0:3], a[208:211], v[128:131], a[0:3]
  ds_read_b64_tr_b16 a[196:197], v197 offset:24704
  ds_read_b64_tr_b16 a[198:199], v197 offset:30848
  v_mfma_f32_16x16x32_bf16 a[4:7], a[208:211], v[132:135], a[4:7]
  v_mfma_f32_16x16x32_bf16 a[8:11], a[208:211], v[136:139], a[8:11]
  v_exp_f32 v232, v232
  v_mfma_f32_16x16x32_bf16 a[12:15], a[208:211], v[140:143], a[12:15]
  s_waitcnt lgkmcnt(8)
  v_exp_f32 v233, v233
  v_mfma_f32_16x16x32_bf16 a[16:19], a[212:215], v[128:131], a[16:19]
  ds_read_b64_tr_b16 a[200:201], v198 offset:24704
  ds_read_b64_tr_b16 a[202:203], v198 offset:30848
  v_mfma_f32_16x16x32_bf16 a[20:23], a[212:215], v[132:135], a[20:23]
  v_exp_f32 v234, v234
  v_mfma_f32_16x16x32_bf16 a[24:27], a[212:215], v[136:139], a[24:27]
  v_add_f32 v178, v178, v232
  v_mfma_f32_16x16x32_bf16 a[28:31], a[212:215], v[140:143], a[28:31]
  s_waitcnt lgkmcnt(8)
  v_exp_f32 v235, v235
  v_mfma_f32_16x16x32_bf16 a[32:35], a[216:219], v[128:131], a[32:35]
  ds_read_b64_tr_b16 a[204:205], v199 offset:24704
  ds_read_b64_tr_b16 a[206:207], v199 offset:30848
  v_mfma_f32_16x16x32_bf16 a[36:39], a[216:219], v[132:135], a[36:39]
  v_add_f32 v178, v178, v233
  v_cvt_pk_bf16_f32 v152, v232, v233
  v_mfma_f32_16x16x32_bf16 a[40:43], a[216:219], v[136:139], a[40:43]
  v_add_f32 v178, v178, v234
  v_add_f32 v178, v178, v235
  v_mfma_f32_16x16x32_bf16 a[44:47], a[216:219], v[140:143], a[44:47]
  s_waitcnt lgkmcnt(8)
  v_cvt_pk_bf16_f32 v153, v234, v235
  v_mfma_f32_16x16x32_bf16 a[48:51], a[220:223], v[128:131], a[48:51]
  ds_read_b64_tr_b16 a[208:209], v196 offset:24832
  ds_read_b64_tr_b16 a[210:211], v196 offset:30976
  v_mfma_f32_16x16x32_bf16 a[52:55], a[220:223], v[132:135], a[52:55]
  v_mfma_f32_16x16x32_bf16 a[56:59], a[220:223], v[136:139], a[56:59]
  v_mfma_f32_16x16x32_bf16 a[60:63], a[220:223], v[140:143], a[60:63]
  s_waitcnt lgkmcnt(8)
  v_exp_f32 v236, v236
  v_mfma_f32_16x16x32_bf16 a[64:67], a[192:195], v[128:131], a[64:67]
  ds_read_b64_tr_b16 a[212:213], v197 offset:24832
  ds_read_b64_tr_b16 a[214:215], v197 offset:30976
  v_mfma_f32_16x16x32_bf16 a[68:71], a[192:195], v[132:135], a[68:71]
  v_exp_f32 v237, v237
  v_mfma_f32_16x16x32_bf16 a[72:75], a[192:195], v[136:139], a[72:75]
  v_exp_f32 v238, v238
  v_mfma_f32_16x16x32_bf16 a[76:79], a[192:195], v[140:143], a[76:79]
  s_waitcnt lgkmcnt(8)
  v_exp_f32 v239, v239
  v_mfma_f32_16x16x32_bf16 a[80:83], a[196:199], v[128:131], a[80:83]
  ds_read_b64_tr_b16 a[216:217], v198 offset:24832
  ds_read_b64_tr_b16 a[218:219], v198 offset:30976
  v_mfma_f32_16x16x32_bf16 a[84:87], a[196:199], v[132:135], a[84:87]
  v_add_f32 v179, v179, v236
  v_add_f32 v179, v179, v237
  v_mfma_f32_16x16x32_bf16 a[88:91], a[196:199], v[136:139], a[88:91]
  v_cvt_pk_bf16_f32 v156, v236, v237
  v_mfma_f32_16x16x32_bf16 a[92:95], a[196:199], v[140:143], a[92:95]
  s_waitcnt lgkmcnt(8)
  v_add_f32 v179, v179, v238
  v_add_f32 v179, v179, v239
  v_mfma_f32_16x16x32_bf16 a[96:99], a[200:203], v[128:131], a[96:99]
  ds_read_b64_tr_b16 a[220:221], v199 offset:24832
  ds_read_b64_tr_b16 a[222:223], v199 offset:30976
  v_mfma_f32_16x16x32_bf16 a[100:103], a[200:203], v[132:135], a[100:103]
  v_cvt_pk_bf16_f32 v157, v238, v239
  v_mfma_f32_16x16x32_bf16 a[104:107], a[200:203], v[136:139], a[104:107]
  v_exp_f32 v240, v240
  v_mfma_f32_16x16x32_bf16 a[108:111], a[200:203], v[140:143], a[108:111]
  s_waitcnt lgkmcnt(8)
  v_exp_f32 v241, v241
  v_mfma_f32_16x16x32_bf16 a[112:115], a[204:207], v[128:131], a[112:115]
  v_add_f32 v176, v176, v240
  v_mfma_f32_16x16x32_bf16 a[116:119], a[204:207], v[132:135], a[116:119]
  v_exp_f32 v242, v242
  v_mfma_f32_16x16x32_bf16 a[120:123], a[204:207], v[136:139], a[120:123]
  v_exp_f32 v243, v243
  v_mfma_f32_16x16x32_bf16 a[124:127], a[204:207], v[140:143], a[124:127]
  s_waitcnt lgkmcnt(6)
  v_add_f32 v176, v176, v241
  v_cvt_pk_bf16_f32 v146, v240, v241
  v_mfma_f32_16x16x32_bf16 a[128:131], a[208:211], v[128:131], a[128:131]
  v_add_f32 v176, v176, v242
  v_mfma_f32_16x16x32_bf16 a[132:135], a[208:211], v[132:135], a[132:135]
  v_add_f32 v176, v176, v243
  v_cvt_pk_bf16_f32 v147, v242, v243
  v_mfma_f32_16x16x32_bf16 a[136:139], a[208:211], v[136:139], a[136:139]
  v_mfma_f32_16x16x32_bf16 a[140:143], a[208:211], v[140:143], a[140:143]
  s_waitcnt lgkmcnt(4)
  v_mfma_f32_16x16x32_bf16 a[144:147], a[212:215], v[128:131], a[144:147]
  v_mfma_f32_16x16x32_bf16 a[148:151], a[212:215], v[132:135], a[148:151]
  v_mfma_f32_16x16x32_bf16 a[152:155], a[212:215], v[136:139], a[152:155]
  v_exp_f32 v244, v244
  v_mfma_f32_16x16x32_bf16 a[156:159], a[212:215], v[140:143], a[156:159]
  s_waitcnt lgkmcnt(2)
  v_exp_f32 v245, v245
  v_mfma_f32_16x16x32_bf16 a[160:163], a[216:219], v[128:131], a[160:163]
  v_add_f32 v177, v177, v244
  v_mfma_f32_16x16x32_bf16 a[164:167], a[216:219], v[132:135], a[164:167]
  v_exp_f32 v246, v246
  v_mfma_f32_16x16x32_bf16 a[168:171], a[216:219], v[136:139], a[168:171]
  v_exp_f32 v247, v247
  v_mfma_f32_16x16x32_bf16 a[172:175], a[216:219], v[140:143], a[172:175]
  s_waitcnt lgkmcnt(0)
  v_add_f32 v177, v177, v245
  v_cvt_pk_bf16_f32 v150, v244, v245
  v_mfma_f32_16x16x32_bf16 a[176:179], a[220:223], v[128:131], a[176:179]
  v_add_f32 v177, v177, v246
  v_mfma_f32_16x16x32_bf16 a[180:183], a[220:223], v[132:135], a[180:183]
  v_add_f32 v177, v177, v247
  v_cvt_pk_bf16_f32 v151, v246, v247
  v_mfma_f32_16x16x32_bf16 a[184:187], a[220:223], v[136:139], a[184:187]
  v_mfma_f32_16x16x32_bf16 a[188:191], a[220:223], v[140:143], a[188:191]
  s_waitcnt vmcnt(2)
  s_barrier
  v_exp_f32 v248, v248
  v_exp_f32 v249, v249
  v_add_f32 v178, v178, v248
  v_exp_f32 v250, v250
  v_add_f32 v178, v178, v249
  v_exp_f32 v251, v251
  v_cvt_pk_bf16_f32 v154, v248, v249
  v_add_f32 v178, v178, v250
  v_add_f32 v178, v178, v251
  v_cvt_pk_bf16_f32 v155, v250, v251
  v_exp_f32 v252, v252
  s_nop 0
  v_add_f32 v179, v179, v252
  v_exp_f32 v253, v253
  v_exp_f32 v254, v254
  v_exp_f32 v255, v255
  v_add_f32 v179, v179, v253
  v_cvt_pk_bf16_f32 v158, v252, v253
  v_add_f32 v179, v179, v254
  v_add_f32 v179, v179, v255
  v_cvt_pk_bf16_f32 v159, v254, v255
  ds_read_b64_tr_b16 a[208:209], v196 offset:36864
  ds_read_b64_tr_b16 a[210:211], v196 offset:43008
  ds_read_b64_tr_b16 a[212:213], v197 offset:36864
  ds_read_b64_tr_b16 a[214:215], v197 offset:43008
  ds_read_b64_tr_b16 a[216:217], v198 offset:36864
  ds_read_b64_tr_b16 a[218:219], v198 offset:43008
  ds_read_b64_tr_b16 a[220:221], v199 offset:36864
  ds_read_b64_tr_b16 a[222:223], v199 offset:43008
  ds_read_b64_tr_b16 a[192:193], v196 offset:36992
  ds_read_b64_tr_b16 a[194:195], v196 offset:43136
  s_waitcnt lgkmcnt(8)
  v_mfma_f32_16x16x32_bf16 a[0:3], a[208:211], v[144:147], a[0:3]
  ds_read_b64_tr_b16 a[196:197], v197 offset:36992
  ds_read_b64_tr_b16 a[198:199], v197 offset:43136
  v_mfma_f32_16x16x32_bf16 a[4:7], a[208:211], v[148:151], a[4:7]
  v_mfma_f32_16x16x32_bf16 a[8:11], a[208:211], v[152:155], a[8:11]
  v_mfma_f32_16x16x32_bf16 a[12:15], a[208:211], v[156:159], a[12:15]
  s_waitcnt lgkmcnt(8)
  v_mfma_f32_16x16x32_bf16 a[16:19], a[212:215], v[144:147], a[16:19]
  ds_read_b64_tr_b16 a[200:201], v198 offset:36992
  ds_read_b64_tr_b16 a[202:203], v198 offset:43136
  v_mfma_f32_16x16x32_bf16 a[20:23], a[212:215], v[148:151], a[20:23]
  v_mfma_f32_16x16x32_bf16 a[24:27], a[212:215], v[152:155], a[24:27]
  v_mfma_f32_16x16x32_bf16 a[28:31], a[212:215], v[156:159], a[28:31]
  s_waitcnt lgkmcnt(8)
  v_mfma_f32_16x16x32_bf16 a[32:35], a[216:219], v[144:147], a[32:35]
  ds_read_b64_tr_b16 a[204:205], v199 offset:36992
  ds_read_b64_tr_b16 a[206:207], v199 offset:43136
  v_mfma_f32_16x16x32_bf16 a[36:39], a[216:219], v[148:151], a[36:39]
  v_mfma_f32_16x16x32_bf16 a[40:43], a[216:219], v[152:155], a[40:43]
  v_mfma_f32_16x16x32_bf16 a[44:47], a[216:219], v[156:159], a[44:47]
  s_waitcnt lgkmcnt(8)
  v_mfma_f32_16x16x32_bf16 a[48:51], a[220:223], v[144:147], a[48:51]
  ds_read_b64_tr_b16 a[208:209], v196 offset:37120
  ds_read_b64_tr_b16 a[210:211], v196 offset:43264
  v_mfma_f32_16x16x32_bf16 a[52:55], a[220:223], v[148:151], a[52:55]
  v_mfma_f32_16x16x32_bf16 a[56:59], a[220:223], v[152:155], a[56:59]
  v_mfma_f32_16x16x32_bf16 a[60:63], a[220:223], v[156:159], a[60:63]
  s_waitcnt lgkmcnt(8)
  v_mfma_f32_16x16x32_bf16 a[64:67], a[192:195], v[144:147], a[64:67]
  ds_read_b64_tr_b16 a[212:213], v197 offset:37120
  ds_read_b64_tr_b16 a[214:215], v197 offset:43264
  v_mfma_f32_16x16x32_bf16 a[68:71], a[192:195], v[148:151], a[68:71]
  v_mfma_f32_16x16x32_bf16 a[72:75], a[192:195], v[152:155], a[72:75]
  v_mfma_f32_16x16x32_bf16 a[76:79], a[192:195], v[156:159], a[76:79]
  s_waitcnt lgkmcnt(8)
  v_mfma_f32_16x16x32_bf16 a[80:83], a[196:199], v[144:147], a[80:83]
  ds_read_b64_tr_b16 a[216:217], v198 offset:37120
  ds_read_b64_tr_b16 a[218:219], v198 offset:43264
  v_mfma_f32_16x16x32_bf16 a[84:87], a[196:199], v[148:151], a[84:87]
  v_mfma_f32_16x16x32_bf16 a[88:91], a[196:199], v[152:155], a[88:91]
  v_mfma_f32_16x16x32_bf16 a[92:95], a[196:199], v[156:159], a[92:95]
  s_waitcnt lgkmcnt(8)
  v_mfma_f32_16x16x32_bf16 a[96:99], a[200:203], v[144:147], a[96:99]
  ds_read_b64_tr_b16 a[220:221], v199 offset:37120
  ds_read_b64_tr_b16 a[222:223], v199 offset:43264
  v_mfma_f32_16x16x32_bf16 a[100:103], a[200:203], v[148:151], a[100:103]
  v_mfma_f32_16x16x32_bf16 a[104:107], a[200:203], v[152:155], a[104:107]
  v_mfma_f32_16x16x32_bf16 a[108:111], a[200:203], v[156:159], a[108:111]
  s_waitcnt lgkmcnt(8)
  v_mfma_f32_16x16x32_bf16 a[112:115], a[204:207], v[144:147], a[112:115]
  v_mfma_f32_16x16x32_bf16 a[116:119], a[204:207], v[148:151], a[116:119]
  v_mfma_f32_16x16x32_bf16 a[120:123], a[204:207], v[152:155], a[120:123]
  v_mfma_f32_16x16x32_bf16 a[124:127], a[204:207], v[156:159], a[124:127]
  s_waitcnt lgkmcnt(6)
  v_mfma_f32_16x16x32_bf16 a[128:131], a[208:211], v[144:147], a[128:131]
  v_mfma_f32_16x16x32_bf16 a[132:135], a[208:211], v[148:151], a[132:135]
  v_mfma_f32_16x16x32_bf16 a[136:139], a[208:211], v[152:155], a[136:139]
  v_mfma_f32_16x16x32_bf16 a[140:143], a[208:211], v[156:159], a[140:143]
  s_waitcnt lgkmcnt(4)
  v_mfma_f32_16x16x32_bf16 a[144:147], a[212:215], v[144:147], a[144:147]
  v_mfma_f32_16x16x32_bf16 a[148:151], a[212:215], v[148:151], a[148:151]
  v_mfma_f32_16x16x32_bf16 a[152:155], a[212:215], v[152:155], a[152:155]
  v_mfma_f32_16x16x32_bf16 a[156:159], a[212:215], v[156:159], a[156:159]
  s_waitcnt lgkmcnt(2)
  v_mfma_f32_16x16x32_bf16 a[160:163], a[216:219], v[144:147], a[160:163]
  v_mfma_f32_16x16x32_bf16 a[164:167], a[216:219], v[148:151], a[164:167]
  v_mfma_f32_16x16x32_bf16 a[168:171], a[216:219], v[152:155], a[168:171]
  v_mfma_f32_16x16x32_bf16 a[172:175], a[216:219], v[156:159], a[172:175]
  s_waitcnt lgkmcnt(0)
  v_mfma_f32_16x16x32_bf16 a[176:179], a[220:223], v[144:147], a[176:179]
  v_mfma_f32_16x16x32_bf16 a[180:183], a[220:223], v[148:151], a[180:183]
  v_mfma_f32_16x16x32_bf16 a[184:187], a[220:223], v[152:155], a[184:187]
  v_mfma_f32_16x16x32_bf16 a[188:191], a[220:223], v[156:159], a[188:191]
L_k2_epi:
  s_nop 7
  v_mov_b32 v180, v176
  s_nop 1
  v_permlane32_swap_b32 v176, v180
  v_add_f32 v176, v176, v180
  v_mov_b32 v180, v176
  s_nop 1
  v_permlane16_swap_b32 v176, v180
  v_add_f32 v176, v176, v180
  v_mov_b32 v180, v177
  s_nop 1
  v_permlane32_swap_b32 v177, v180
  v_add_f32 v177, v177, v180
  v_mov_b32 v180, v177
  s_nop 1
  v_permlane16_swap_b32 v177, v180
  v_add_f32 v177, v177, v180
  v_mov_b32 v180, v178
  s_nop 1
  v_permlane32_swap_b32 v178, v180
  v_add_f32 v178, v178, v180
  v_mov_b32 v180, v178
  s_nop 1
  v_permlane16_swap_b32 v178, v180
  v_add_f32 v178, v178, v180
  v_mov_b32 v180, v179
  s_nop 1
  v_permlane32_swap_b32 v179, v180
  v_add_f32 v179, v179, v180
  v_mov_b32 v180, v179
  s_nop 1
  v_permlane16_swap_b32 v179, v180
  v_add_f32 v179, v179, v180
  s_cmp_lg_u32 s37, 0
  s_cbranch_scc1 L_k2_safe
  s_mov_b32 s44, 0x5d800000
  v_max3_f32 v180, v176, v177, v178
  v_add_f32 v181, v176, v177
  v_add_f32 v182, v178, v179
  v_add_f32 v181, v181, v182
  v_cmp_nge_f32 vcc, s44, v181
  s_nop 4
  s_cbranch_vccnz L_k2_slow
L_k2_safe:
  v_rcp_f32 v160, v176
  v_rcp_f32 v162, v177
  v_rcp_f32 v164, v178
  v_rcp_f32 v166, v179
  s_nop 0
  v_mov_b32 v161, v160
  v_mov_b32 v163, v162
  v_mov_b32 v165, v164
  v_mov_b32 v167, v166
  s_lshl_b32 s44, s30, 3
  s_lshl_b32 s45, s28, 1
  s_add_u32 s44, s44, s45
  s_mul_i32 s44, s44, 393216
  s_mul_i32 s45, s29, 12288
  s_add_u32 s44, s44, s45
  s_add_u32 s45, s44, 393216
  v_accvgpr_read_b32 v96, a0
  v_accvgpr_read_b32 v100, a16
  v_accvgpr_read_b32 v97, a1
  v_accvgpr_read_b32 v101, a17
  v_accvgpr_read_b32 v98, a2
  v_accvgpr_read_b32 v102, a18
  v_accvgpr_read_b32 v99, a3
  v_accvgpr_read_b32 v103, a19
  v_pk_mul_f32 v[96:97], v[96:97], v[160:161]
  v_pk_mul_f32 v[98:99], v[98:99], v[160:161]
  v_pk_mul_f32 v[100:101], v[100:101], v[160:161]
  v_pk_mul_f32 v[102:103], v[102:103], v[160:161]
  v_cvt_pk_bf16_f32 v104, v96, v97
  v_cvt_pk_bf16_f32 v105, v98, v99
  v_cvt_pk_bf16_f32 v106, v100, v101
  v_cvt_pk_bf16_f32 v107, v102, v103
  buffer_store_dwordx4 v[104:107], v208, s[24:27], s44 offen offset:0 sc1
  v_accvgpr_read_b32 v108, a4
  v_accvgpr_read_b32 v112, a20
  v_accvgpr_read_b32 v109, a5
  v_accvgpr_read_b32 v113, a21
  v_accvgpr_read_b32 v110, a6
  v_accvgpr_read_b32 v114, a22
  v_accvgpr_read_b32 v111, a7
  v_accvgpr_read_b32 v115, a23
  v_pk_mul_f32 v[108:109], v[108:109], v[162:163]
  v_pk_mul_f32 v[110:111], v[110:111], v[162:163]
  v_pk_mul_f32 v[112:113], v[112:113], v[162:163]
  v_pk_mul_f32 v[114:115], v[114:115], v[162:163]
  v_cvt_pk_bf16_f32 v116, v108, v109
  v_cvt_pk_bf16_f32 v117, v110, v111
  v_cvt_pk_bf16_f32 v118, v112, v113
  v_cvt_pk_bf16_f32 v119, v114, v115
  buffer_store_dwordx4 v[116:119], v208, s[24:27], s44 offen offset:1024 sc1
  v_accvgpr_read_b32 v120, a8
  v_accvgpr_read_b32 v124, a24
  v_accvgpr_read_b32 v121, a9
  v_accvgpr_read_b32 v125, a25
  v_accvgpr_read_b32 v122, a10
  v_accvgpr_read_b32 v126, a26
  v_accvgpr_read_b32 v123, a11
  v_accvgpr_read_b32 v127, a27
  v_pk_mul_f32 v[120:121], v[120:121], v[164:165]
  v_pk_mul_f32 v[122:123], v[122:123], v[164:165]
  v_pk_mul_f32 v[124:125], v[124:125], v[164:165]
  v_pk_mul_f32 v[126:127], v[126:127], v[164:165]
  v_cvt_pk_bf16_f32 v128, v120, v121
  v_cvt_pk_bf16_f32 v129, v122, v123
  v_cvt_pk_bf16_f32 v130, v124, v125
  v_cvt_pk_bf16_f32 v131, v126, v127
  buffer_store_dwordx4 v[128:131], v208, s[24:27], s45 offen offset:0 sc1
  v_accvgpr_read_b32 v132, a12
  v_accvgpr_read_b32 v136, a28
  v_accvgpr_read_b32 v133, a13
  v_accvgpr_read_b32 v137, a29
  v_accvgpr_read_b32 v134, a14
  v_accvgpr_read_b32 v138, a30
  v_accvgpr_read_b32 v135, a15
  v_accvgpr_read_b32 v139, a31
  v_pk_mul_f32 v[132:133], v[132:133], v[166:167]
  v_pk_mul_f32 v[134:135], v[134:135], v[166:167]
  v_pk_mul_f32 v[136:137], v[136:137], v[166:167]
  v_pk_mul_f32 v[138:139], v[138:139], v[166:167]
  v_cvt_pk_bf16_f32 v140, v132, v133
  v_cvt_pk_bf16_f32 v141, v134, v135
  v_cvt_pk_bf16_f32 v142, v136, v137
  v_cvt_pk_bf16_f32 v143, v138, v139
  buffer_store_dwordx4 v[140:143], v208, s[24:27], s45 offen offset:1024 sc1
  v_accvgpr_read_b32 v96, a32
  v_accvgpr_read_b32 v100, a48
  v_accvgpr_read_b32 v97, a33
  v_accvgpr_read_b32 v101, a49
  v_accvgpr_read_b32 v98, a34
  v_accvgpr_read_b32 v102, a50
  v_accvgpr_read_b32 v99, a35
  v_accvgpr_read_b32 v103, a51
  v_pk_mul_f32 v[96:97], v[96:97], v[160:161]
  v_pk_mul_f32 v[98:99], v[98:99], v[160:161]
  v_pk_mul_f32 v[100:101], v[100:101], v[160:161]
  v_pk_mul_f32 v[102:103], v[102:103], v[160:161]
  v_cvt_pk_bf16_f32 v104, v96, v97
  v_cvt_pk_bf16_f32 v105, v98, v99
  v_cvt_pk_bf16_f32 v106, v100, v101
  v_cvt_pk_bf16_f32 v107, v102, v103
  buffer_store_dwordx4 v[104:107], v208, s[24:27], s44 offen offset:2048 sc1
  v_accvgpr_read_b32 v108, a36
  v_accvgpr_read_b32 v112, a52
  v_accvgpr_read_b32 v109, a37
  v_accvgpr_read_b32 v113, a53
  v_accvgpr_read_b32 v110, a38
  v_accvgpr_read_b32 v114, a54
  v_accvgpr_read_b32 v111, a39
  v_accvgpr_read_b32 v115, a55
  v_pk_mul_f32 v[108:109], v[108:109], v[162:163]
  v_pk_mul_f32 v[110:111], v[110:111], v[162:163]
  v_pk_mul_f32 v[112:113], v[112:113], v[162:163]
  v_pk_mul_f32 v[114:115], v[114:115], v[162:163]
  v_cvt_pk_bf16_f32 v116, v108, v109
  v_cvt_pk_bf16_f32 v117, v110, v111
  v_cvt_pk_bf16_f32 v118, v112, v113
  v_cvt_pk_bf16_f32 v119, v114, v115
  buffer_store_dwordx4 v[116:119], v208, s[24:27], s44 offen offset:3072 sc1
  v_accvgpr_read_b32 v120, a40
  v_accvgpr_read_b32 v124, a56
  v_accvgpr_read_b32 v121, a41
  v_accvgpr_read_b32 v125, a57
  v_accvgpr_read_b32 v122, a42
  v_accvgpr_read_b32 v126, a58
  v_accvgpr_read_b32 v123, a43
  v_accvgpr_read_b32 v127, a59
  v_pk_mul_f32 v[120:121], v[120:121], v[164:165]
  v_pk_mul_f32 v[122:123], v[122:123], v[164:165]
  v_pk_mul_f32 v[124:125], v[124:125], v[164:165]
  v_pk_mul_f32 v[126:127], v[126:127], v[164:165]
  v_cvt_pk_bf16_f32 v128, v120, v121
  v_cvt_pk_bf16_f32 v129, v122, v123
  v_cvt_pk_bf16_f32 v130, v124, v125
  v_cvt_pk_bf16_f32 v131, v126, v127
  buffer_store_dwordx4 v[128:131], v208, s[24:27], s45 offen offset:2048 sc1
  v_accvgpr_read_b32 v132, a44
  v_accvgpr_read_b32 v136, a60
  v_accvgpr_read_b32 v133, a45
  v_accvgpr_read_b32 v137, a61
  v_accvgpr_read_b32 v134, a46
  v_accvgpr_read_b32 v138, a62
  v_accvgpr_read_b32 v135, a47
  v_accvgpr_read_b32 v139, a63
  v_pk_mul_f32 v[132:133], v[132:133], v[166:167]
  v_pk_mul_f32 v[134:135], v[134:135], v[166:167]
  v_pk_mul_f32 v[136:137], v[136:137], v[166:167]
  v_pk_mul_f32 v[138:139], v[138:139], v[166:167]
  v_cvt_pk_bf16_f32 v140, v132, v133
  v_cvt_pk_bf16_f32 v141, v134, v135
  v_cvt_pk_bf16_f32 v142, v136, v137
  v_cvt_pk_bf16_f32 v143, v138, v139
  buffer_store_dwordx4 v[140:143], v208, s[24:27], s45 offen offset:3072 sc1
  s_add_u32 s44, s44, 4096
  s_add_u32 s45, s45, 4096
  v_accvgpr_read_b32 v96, a64
  v_accvgpr_read_b32 v100, a80
  v_accvgpr_read_b32 v97, a65
  v_accvgpr_read_b32 v101, a81
  v_accvgpr_read_b32 v98, a66
  v_accvgpr_read_b32 v102, a82
  v_accvgpr_read_b32 v99, a67
  v_accvgpr_read_b32 v103, a83
  v_pk_mul_f32 v[96:97], v[96:97], v[160:161]
  v_pk_mul_f32 v[98:99], v[98:99], v[160:161]
  v_pk_mul_f32 v[100:101], v[100:101], v[160:161]
  v_pk_mul_f32 v[102:103], v[102:103], v[160:161]
  v_cvt_pk_bf16_f32 v104, v96, v97
  v_cvt_pk_bf16_f32 v105, v98, v99
  v_cvt_pk_bf16_f32 v106, v100, v101
  v_cvt_pk_bf16_f32 v107, v102, v103
  buffer_store_dwordx4 v[104:107], v208, s[24:27], s44 offen offset:0 sc1
  v_accvgpr_read_b32 v108, a68
  v_accvgpr_read_b32 v112, a84
  v_accvgpr_read_b32 v109, a69
  v_accvgpr_read_b32 v113, a85
  v_accvgpr_read_b32 v110, a70
  v_accvgpr_read_b32 v114, a86
  v_accvgpr_read_b32 v111, a71
  v_accvgpr_read_b32 v115, a87
  v_pk_mul_f32 v[108:109], v[108:109], v[162:163]
  v_pk_mul_f32 v[110:111], v[110:111], v[162:163]
  v_pk_mul_f32 v[112:113], v[112:113], v[162:163]
  v_pk_mul_f32 v[114:115], v[114:115], v[162:163]
  v_cvt_pk_bf16_f32 v116, v108, v109
  v_cvt_pk_bf16_f32 v117, v110, v111
  v_cvt_pk_bf16_f32 v118, v112, v113
  v_cvt_pk_bf16_f32 v119, v114, v115
  buffer_store_dwordx4 v[116:119], v208, s[24:27], s44 offen offset:1024 sc1
  v_accvgpr_read_b32 v120, a72
  v_accvgpr_read_b32 v124, a88
  v_accvgpr_read_b32 v121, a73
  v_accvgpr_read_b32 v125, a89
  v_accvgpr_read_b32 v122, a74
  v_accvgpr_read_b32 v126, a90
  v_accvgpr_read_b32 v123, a75
  v_accvgpr_read_b32 v127, a91
  v_pk_mul_f32 v[120:121], v[120:121], v[164:165]
  v_pk_mul_f32 v[122:123], v[122:123], v[164:165]
  v_pk_mul_f32 v[124:125], v[124:125], v[164:165]
  v_pk_mul_f32 v[126:127], v[126:127], v[164:165]
  v_cvt_pk_bf16_f32 v128, v120, v121
  v_cvt_pk_bf16_f32 v129, v122, v123
  v_cvt_pk_bf16_f32 v130, v124, v125
  v_cvt_pk_bf16_f32 v131, v126, v127
  buffer_store_dwordx4 v[128:131], v208, s[24:27], s45 offen offset:0 sc1
  v_accvgpr_read_b32 v132, a76
  v_accvgpr_read_b32 v136, a92
  v_accvgpr_read_b32 v133, a77
  v_accvgpr_read_b32 v137, a93
  v_accvgpr_read_b32 v134, a78
  v_accvgpr_read_b32 v138, a94
  v_accvgpr_read_b32 v135, a79
  v_accvgpr_read_b32 v139, a95
  v_pk_mul_f32 v[132:133], v[132:133], v[166:167]
  v_pk_mul_f32 v[134:135], v[134:135], v[166:167]
  v_pk_mul_f32 v[136:137], v[136:137], v[166:167]
  v_pk_mul_f32 v[138:139], v[138:139], v[166:167]
  v_cvt_pk_bf16_f32 v140, v132, v133
  v_cvt_pk_bf16_f32 v141, v134, v135
  v_cvt_pk_bf16_f32 v142, v136, v137
  v_cvt_pk_bf16_f32 v143, v138, v139
  buffer_store_dwordx4 v[140:143], v208, s[24:27], s45 offen offset:1024 sc1
  v_accvgpr_read_b32 v96, a96
  v_accvgpr_read_b32 v100, a112
  v_accvgpr_read_b32 v97, a97
  v_accvgpr_read_b32 v101, a113
  v_accvgpr_read_b32 v98, a98
  v_accvgpr_read_b32 v102, a114
  v_accvgpr_read_b32 v99, a99
  v_accvgpr_read_b32 v103, a115
  v_pk_mul_f32 v[96:97], v[96:97], v[160:161]
  v_pk_mul_f32 v[98:99], v[98:99], v[160:161]
  v_pk_mul_f32 v[100:101], v[100:101], v[160:161]
  v_pk_mul_f32 v[102:103], v[102:103], v[160:161]
  v_cvt_pk_bf16_f32 v104, v96, v97
  v_cvt_pk_bf16_f32 v105, v98, v99
  v_cvt_pk_bf16_f32 v106, v100, v101
  v_cvt_pk_bf16_f32 v107, v102, v103
  buffer_store_dwordx4 v[104:107], v208, s[24:27], s44 offen offset:2048 sc1
  v_accvgpr_read_b32 v108, a100
  v_accvgpr_read_b32 v112, a116
  v_accvgpr_read_b32 v109, a101
  v_accvgpr_read_b32 v113, a117
  v_accvgpr_read_b32 v110, a102
  v_accvgpr_read_b32 v114, a118
  v_accvgpr_read_b32 v111, a103
  v_accvgpr_read_b32 v115, a119
  v_pk_mul_f32 v[108:109], v[108:109], v[162:163]
  v_pk_mul_f32 v[110:111], v[110:111], v[162:163]
  v_pk_mul_f32 v[112:113], v[112:113], v[162:163]
  v_pk_mul_f32 v[114:115], v[114:115], v[162:163]
  v_cvt_pk_bf16_f32 v116, v108, v109
  v_cvt_pk_bf16_f32 v117, v110, v111
  v_cvt_pk_bf16_f32 v118, v112, v113
  v_cvt_pk_bf16_f32 v119, v114, v115
  buffer_store_dwordx4 v[116:119], v208, s[24:27], s44 offen offset:3072 sc1
  v_accvgpr_read_b32 v120, a104
  v_accvgpr_read_b32 v124, a120
  v_accvgpr_read_b32 v121, a105
  v_accvgpr_read_b32 v125, a121
  v_accvgpr_read_b32 v122, a106
  v_accvgpr_read_b32 v126, a122
  v_accvgpr_read_b32 v123, a107
  v_accvgpr_read_b32 v127, a123
  v_pk_mul_f32 v[120:121], v[120:121], v[164:165]
  v_pk_mul_f32 v[122:123], v[122:123], v[164:165]
  v_pk_mul_f32 v[124:125], v[124:125], v[164:165]
  v_pk_mul_f32 v[126:127], v[126:127], v[164:165]
  v_cvt_pk_bf16_f32 v128, v120, v121
  v_cvt_pk_bf16_f32 v129, v122, v123
  v_cvt_pk_bf16_f32 v130, v124, v125
  v_cvt_pk_bf16_f32 v131, v126, v127
  buffer_store_dwordx4 v[128:131], v208, s[24:27], s45 offen offset:2048 sc1
  v_accvgpr_read_b32 v132, a108
  v_accvgpr_read_b32 v136, a124
  v_accvgpr_read_b32 v133, a109
  v_accvgpr_read_b32 v137, a125
  v_accvgpr_read_b32 v134, a110
  v_accvgpr_read_b32 v138, a126
  v_accvgpr_read_b32 v135, a111
  v_accvgpr_read_b32 v139, a127
  v_pk_mul_f32 v[132:133], v[132:133], v[166:167]
  v_pk_mul_f32 v[134:135], v[134:135], v[166:167]
  v_pk_mul_f32 v[136:137], v[136:137], v[166:167]
  v_pk_mul_f32 v[138:139], v[138:139], v[166:167]
  v_cvt_pk_bf16_f32 v140, v132, v133
  v_cvt_pk_bf16_f32 v141, v134, v135
  v_cvt_pk_bf16_f32 v142, v136, v137
  v_cvt_pk_bf16_f32 v143, v138, v139
  buffer_store_dwordx4 v[140:143], v208, s[24:27], s45 offen offset:3072 sc1
  s_add_u32 s44, s44, 4096
  s_add_u32 s45, s45, 4096
  v_accvgpr_read_b32 v96, a128
  v_accvgpr_read_b32 v100, a144
  v_accvgpr_read_b32 v97, a129
  v_accvgpr_read_b32 v101, a145
  v_accvgpr_read_b32 v98, a130
  v_accvgpr_read_b32 v102, a146
  v_accvgpr_read_b32 v99, a131
  v_accvgpr_read_b32 v103, a147
  v_pk_mul_f32 v[96:97], v[96:97], v[160:161]
  v_pk_mul_f32 v[98:99], v[98:99], v[160:161]
  v_pk_mul_f32 v[100:101], v[100:101], v[160:161]
  v_pk_mul_f32 v[102:103], v[102:103], v[160:161]
  v_cvt_pk_bf16_f32 v104, v96, v97
  v_cvt_pk_bf16_f32 v105, v98, v99
  v_cvt_pk_bf16_f32 v106, v100, v101
  v_cvt_pk_bf16_f32 v107, v102, v103
  buffer_store_dwordx4 v[104:107], v208, s[24:27], s44 offen offset:0 sc1
  v_accvgpr_read_b32 v108, a132
  v_accvgpr_read_b32 v112, a148
  v_accvgpr_read_b32 v109, a133
  v_accvgpr_read_b32 v113, a149
  v_accvgpr_read_b32 v110, a134
  v_accvgpr_read_b32 v114, a150
  v_accvgpr_read_b32 v111, a135
  v_accvgpr_read_b32 v115, a151
  v_pk_mul_f32 v[108:109], v[108:109], v[162:163]
  v_pk_mul_f32 v[110:111], v[110:111], v[162:163]
  v_pk_mul_f32 v[112:113], v[112:113], v[162:163]
  v_pk_mul_f32 v[114:115], v[114:115], v[162:163]
  v_cvt_pk_bf16_f32 v116, v108, v109
  v_cvt_pk_bf16_f32 v117, v110, v111
  v_cvt_pk_bf16_f32 v118, v112, v113
  v_cvt_pk_bf16_f32 v119, v114, v115
  buffer_store_dwordx4 v[116:119], v208, s[24:27], s44 offen offset:1024 sc1
  v_accvgpr_read_b32 v120, a136
  v_accvgpr_read_b32 v124, a152
  v_accvgpr_read_b32 v121, a137
  v_accvgpr_read_b32 v125, a153
  v_accvgpr_read_b32 v122, a138
  v_accvgpr_read_b32 v126, a154
  v_accvgpr_read_b32 v123, a139
  v_accvgpr_read_b32 v127, a155
  v_pk_mul_f32 v[120:121], v[120:121], v[164:165]
  v_pk_mul_f32 v[122:123], v[122:123], v[164:165]
  v_pk_mul_f32 v[124:125], v[124:125], v[164:165]
  v_pk_mul_f32 v[126:127], v[126:127], v[164:165]
  v_cvt_pk_bf16_f32 v128, v120, v121
  v_cvt_pk_bf16_f32 v129, v122, v123
  v_cvt_pk_bf16_f32 v130, v124, v125
  v_cvt_pk_bf16_f32 v131, v126, v127
  buffer_store_dwordx4 v[128:131], v208, s[24:27], s45 offen offset:0 sc1
  v_accvgpr_read_b32 v132, a140
  v_accvgpr_read_b32 v136, a156
  v_accvgpr_read_b32 v133, a141
  v_accvgpr_read_b32 v137, a157
  v_accvgpr_read_b32 v134, a142
  v_accvgpr_read_b32 v138, a158
  v_accvgpr_read_b32 v135, a143
  v_accvgpr_read_b32 v139, a159
  v_pk_mul_f32 v[132:133], v[132:133], v[166:167]
  v_pk_mul_f32 v[134:135], v[134:135], v[166:167]
  v_pk_mul_f32 v[136:137], v[136:137], v[166:167]
  v_pk_mul_f32 v[138:139], v[138:139], v[166:167]
  v_cvt_pk_bf16_f32 v140, v132, v133
  v_cvt_pk_bf16_f32 v141, v134, v135
  v_cvt_pk_bf16_f32 v142, v136, v137
  v_cvt_pk_bf16_f32 v143, v138, v139
  buffer_store_dwordx4 v[140:143], v208, s[24:27], s45 offen offset:1024 sc1
  v_accvgpr_read_b32 v96, a160
  v_accvgpr_read_b32 v100, a176
  v_accvgpr_read_b32 v97, a161
  v_accvgpr_read_b32 v101, a177
  v_accvgpr_read_b32 v98, a162
  v_accvgpr_read_b32 v102, a178
  v_accvgpr_read_b32 v99, a163
  v_accvgpr_read_b32 v103, a179
  v_pk_mul_f32 v[96:97], v[96:97], v[160:161]
  v_pk_mul_f32 v[98:99], v[98:99], v[160:161]
  v_pk_mul_f32 v[100:101], v[100:101], v[160:161]
  v_pk_mul_f32 v[102:103], v[102:103], v[160:161]
  v_cvt_pk_bf16_f32 v104, v96, v97
  v_cvt_pk_bf16_f32 v105, v98, v99
  v_cvt_pk_bf16_f32 v106, v100, v101
  v_cvt_pk_bf16_f32 v107, v102, v103
  buffer_store_dwordx4 v[104:107], v208, s[24:27], s44 offen offset:2048 sc1
  v_accvgpr_read_b32 v108, a164
  v_accvgpr_read_b32 v112, a180
  v_accvgpr_read_b32 v109, a165
  v_accvgpr_read_b32 v113, a181
  v_accvgpr_read_b32 v110, a166
  v_accvgpr_read_b32 v114, a182
  v_accvgpr_read_b32 v111, a167
  v_accvgpr_read_b32 v115, a183
  v_pk_mul_f32 v[108:109], v[108:109], v[162:163]
  v_pk_mul_f32 v[110:111], v[110:111], v[162:163]
  v_pk_mul_f32 v[112:113], v[112:113], v[162:163]
  v_pk_mul_f32 v[114:115], v[114:115], v[162:163]
  v_cvt_pk_bf16_f32 v116, v108, v109
  v_cvt_pk_bf16_f32 v117, v110, v111
  v_cvt_pk_bf16_f32 v118, v112, v113
  v_cvt_pk_bf16_f32 v119, v114, v115
  buffer_store_dwordx4 v[116:119], v208, s[24:27], s44 offen offset:3072 sc1
  v_accvgpr_read_b32 v120, a168
  v_accvgpr_read_b32 v124, a184
  v_accvgpr_read_b32 v121, a169
  v_accvgpr_read_b32 v125, a185
  v_accvgpr_read_b32 v122, a170
  v_accvgpr_read_b32 v126, a186
  v_accvgpr_read_b32 v123, a171
  v_accvgpr_read_b32 v127, a187
  v_pk_mul_f32 v[120:121], v[120:121], v[164:165]
  v_pk_mul_f32 v[122:123], v[122:123], v[164:165]
  v_pk_mul_f32 v[124:125], v[124:125], v[164:165]
  v_pk_mul_f32 v[126:127], v[126:127], v[164:165]
  v_cvt_pk_bf16_f32 v128, v120, v121
  v_cvt_pk_bf16_f32 v129, v122, v123
  v_cvt_pk_bf16_f32 v130, v124, v125
  v_cvt_pk_bf16_f32 v131, v126, v127
  buffer_store_dwordx4 v[128:131], v208, s[24:27], s45 offen offset:2048 sc1
  v_accvgpr_read_b32 v132, a172
  v_accvgpr_read_b32 v136, a188
  v_accvgpr_read_b32 v133, a173
  v_accvgpr_read_b32 v137, a189
  v_accvgpr_read_b32 v134, a174
  v_accvgpr_read_b32 v138, a190
  v_accvgpr_read_b32 v135, a175
  v_accvgpr_read_b32 v139, a191
  v_pk_mul_f32 v[132:133], v[132:133], v[166:167]
  v_pk_mul_f32 v[134:135], v[134:135], v[166:167]
  v_pk_mul_f32 v[136:137], v[136:137], v[166:167]
  v_pk_mul_f32 v[138:139], v[138:139], v[166:167]
  v_cvt_pk_bf16_f32 v140, v132, v133
  v_cvt_pk_bf16_f32 v141, v134, v135
  v_cvt_pk_bf16_f32 v142, v136, v137
  v_cvt_pk_bf16_f32 v143, v138, v139
  buffer_store_dwordx4 v[140:143], v208, s[24:27], s45 offen offset:3072 sc1
  s_lshl_b32 s44, s28, 6
  v_lshrrev_b32 v0, 4, v208
  v_add_u32 v0, s44, v0
  s_load_dwordx2 s[4:5], s[0:1], 32
  s_load_dwordx2 s[42:43], s[0:1], 104
  s_waitcnt lgkmcnt(0)
  s_sub_u32 s8, s4, 4096
  s_subb_u32 s9, s5, 0
  s_mov_b32 s10, 0x781000
  s_mov_b32 s11, 0x20000
  s_add_u32 s12, s42, 0x400000
  s_addc_u32 s13, s43, 0
  s_mov_b32 s14, 0x1800000
  s_mov_b32 s15, 0x20000
  s_add_u32 s16, s42, 0x2000000
  s_addc_u32 s17, s43, 0
  s_mov_b32 s18, 0x1400000
  s_mov_b32 s19, 0x20000
  v_lshrrev_b32 v1, 6, v0
  v_and_b32 v2, 63, v0
  v_readfirstlane_b32 s28, v1
  s_and_b32 s44, s2, 7
  s_lshr_b32 s45, s2, 3
  s_and_b32 s46, s44, 3
  s_lshr_b32 s47, s44, 2
  s_lshl_b32 s47, s47, 3
  s_lshr_b32 s48, s45, 2
  s_add_u32 s47, s47, s48
  s_and_b32 s48, s45, 3
  s_mul_i32 s31, s28, 5120
  v_lshlrev_b32 v19, 4, v2
  s_mov_b32 s49, 52429
  s_mov_b32 s50, 1280
  v_add_u32 v20, 0, v2
  v_mul_lo_u32 v21, s49, v20
  v_lshrrev_b32 v21, 20, v21
  v_mul_u32_u24 v22, 20, v21
  v_sub_u32 v22, v20, v22
  v_bfe_u32 v23, v21, 2, 1
  v_lshlrev_b32 v23, 1, v23
  v_xor_b32 v23, v22, v23
  v_lshlrev_b32 v23, 4, v23
  s_lshl_b32 s51, s28, 4
  v_add_u32 v21, s51, v21
  v_mul_lo_u32 v24, s50, v21
  v_add_u32 v24, v24, v23
  v_add_u32 v14, 4096, v24
  v_add_u32 v20, 64, v2
  v_mul_lo_u32 v21, s49, v20
  v_lshrrev_b32 v21, 20, v21
  v_mul_u32_u24 v22, 20, v21
  v_sub_u32 v22, v20, v22
  v_bfe_u32 v23, v21, 2, 1
  v_lshlrev_b32 v23, 1, v23
  v_xor_b32 v23, v22, v23
  v_lshlrev_b32 v23, 4, v23
  s_lshl_b32 s51, s28, 4
  v_add_u32 v21, s51, v21
  v_mul_lo_u32 v24, s50, v21
  v_add_u32 v24, v24, v23
  v_add_u32 v15, 3072, v24
  v_add_u32 v20, 128, v2
  v_mul_lo_u32 v21, s49, v20
  v_lshrrev_b32 v21, 20, v21
  v_mul_u32_u24 v22, 20, v21
  v_sub_u32 v22, v20, v22
  v_bfe_u32 v23, v21, 2, 1
  v_lshlrev_b32 v23, 1, v23
  v_xor_b32 v23, v22, v23
  v_lshlrev_b32 v23, 4, v23
  s_lshl_b32 s51, s28, 4
  v_add_u32 v21, s51, v21
  v_mul_lo_u32 v24, s50, v21
  v_add_u32 v24, v24, v23
  v_add_u32 v16, 2048, v24
  v_add_u32 v20, 192, v2
  v_mul_lo_u32 v21, s49, v20
  v_lshrrev_b32 v21, 20, v21
  v_mul_u32_u24 v22, 20, v21
  v_sub_u32 v22, v20, v22
  v_bfe_u32 v23, v21, 2, 1
  v_lshlrev_b32 v23, 1, v23
  v_xor_b32 v23, v22, v23
  v_lshlrev_b32 v23, 4, v23
  s_lshl_b32 s51, s28, 4
  v_add_u32 v21, s51, v21
  v_mul_lo_u32 v24, s50, v21
  v_add_u32 v24, v24, v23
  v_add_u32 v17, 1024, v24
  v_add_u32 v20, 256, v2
  v_mul_lo_u32 v21, s49, v20
  v_lshrrev_b32 v21, 20, v21
  v_mul_u32_u24 v22, 20, v21
  v_sub_u32 v22, v20, v22
  v_bfe_u32 v23, v21, 2, 1
  v_lshlrev_b32 v23, 1, v23
  v_xor_b32 v23, v22, v23
  v_lshlrev_b32 v23, 4, v23
  s_lshl_b32 s51, s28, 4
  v_add_u32 v21, s51, v21
  v_mul_lo_u32 v24, s50, v21
  v_add_u32 v24, v24, v23
  v_add_u32 v18, 4096, v24
  v_lshrrev_b32 v20, 4, v2
  v_bfe_u32 v21, v2, 2, 2
  v_and_b32 v22, 3, v2
  v_lshlrev_b32 v23, 2, v20
  v_add_u32 v23, v23, v21
  s_mov_b32 s51, 320
  v_mul_lo_u32 v24, s51, v23
  v_lshlrev_b32 v25, 3, v22
  v_add_u32 v24, v24, v25
  v_and_b32 v25, 1, v20
  v_lshlrev_b32 v25, 5, v25
  v_add_u32 v10, v24, v25
  v_xor_b32 v25, 32, v25
  v_add_u32 v11, v24, v25
  v_add_u32 v12, 61440, v10
  v_add_u32 v13, 61440, v11
  s_mul_i32 s32, s46, 1966080
  s_mul_i32 s51, s48, 320
  s_add_u32 s32, s32, s51
  s_lshl_b32 s51, s47, 2
  s_add_u32 s51, s51, s28
  s_mul_i32 s33, s51, 393216
  s_mul_i32 s52, s46, 98304
  s_add_u32 s33, s33, s52
  s_lshr_b32 s52, s45, 2
  s_mul_i32 s52, s52, 24
  s_mul_i32 s53, s28, 6
  s_add_u32 s52, s52, s53
  v_add_u32 v20, s52, v2
  s_mov_b32 s53, 21846
  v_mul_lo_u32 v21, s53, v20
  v_lshrrev_b32 v21, 16, v21
  v_mul_u32_u24 v22, 3, v21
  v_sub_u32 v22, v20, v22
  v_lshlrev_b32 v22, 7, v22
  s_mov_b32 s53, 1280
  v_mul_lo_u32 v21, s53, v21
  v_add_u32 v21, v21, v22
  v_add_u32 v21, 4096, v21
  v_cmp_gt_u32 vcc, 6, v2
  v_mov_b32 v22, 0x7ff00000
  s_nop 0
  v_cndmask_b32 v9, v22, v21, vcc
  s_mul_i32 s52, s48, 320
  s_and_b32 s52, s52, 0xffffff80
  s_mul_i32 s35, s46, 1966080
  s_add_u32 s35, s35, s52
  s_mul_i32 s34, s46, 2621440
  s_lshl_b32 s52, s51, 1
  s_mul_i32 s52, s52, 20480
  s_add_u32 s34, s34, s52
  s_mul_i32 s52, s48, 5120
  s_add_u32 s34, s34, s52
  s_and_b32 s100, s2, 7
  s_lshr_b32 s101, s2, 3
  s_add_u32 s96, s42, 0x20000
  s_addc_u32 s97, s43, 0
  s_mov_b32 s98, 0x3000
  s_mov_b32 s99, 0x20000
  s_getreg_b32 s94, hwreg(HW_REG_XCC_ID)
  s_and_b32 s94, s94, 15
  s_add_u32 s94, s94, 1
  s_waitcnt vmcnt(0) lgkmcnt(0)
  s_barrier
  v_lshrrev_b32 v250, 6, v0
  s_nop 0
  v_readfirstlane_b32 s88, v250
  s_nop 3
  s_cmp_lg_u32 s88, 0
  s_cbranch_scc1 L_xb_other_c0
  v_and_b32 v250, 31, v0
  v_lshlrev_b32 v250, 2, v250
  s_lshl_b32 s89, s100, 7
  v_add_u32 v250, s89, v250
  s_mov_b32 s90, 0
L_xb_ag_c0:
  s_mov_b32 s91, 6144
  buffer_load_dword v251, v250, s[96:99], s91 offen sc1
  s_waitcnt vmcnt(0)
  v_cmp_eq_u32 vcc, 0, v251
  s_add_u32 s90, s90, 1
  s_cmp_ge_u32 s90, 0x20000
  s_cbranch_scc1 L_xb_agd_c0
  s_cbranch_vccz L_xb_agd_c0
  s_sleep 2
  s_branch L_xb_ag_c0
L_xb_agd_c0:
  v_cmp_ne_u32 vcc, s94, v251
  s_nop 4
  s_mov_b32 s95, 1
  s_cbranch_vccz L_xb_agf_c0
  s_mov_b32 s95, 0
L_xb_agf_c0:
  s_lshl_b32 s90, s101, 2
  s_add_u32 s90, s90, s89
  s_add_u32 s90, s90, 2048
  v_mov_b32 v251, 1
  v_mov_b32 v252, s90
  s_cmp_eq_u32 s95, 1
  s_cbranch_scc0 L_xb_slow_c0
  v_cmp_eq_u32 vcc, 0, v0
  s_and_saveexec_b64 s[92:93], vcc
  buffer_store_dword v251, v252, s[96:99], 0 offen
  s_mov_b64 exec, s[92:93]
  s_branch L_xb_poll_c0
L_xb_slow_c0:
  buffer_wbl2 sc1
  s_waitcnt vmcnt(0)
  v_cmp_eq_u32 vcc, 0, v0
  s_and_saveexec_b64 s[92:93], vcc
  buffer_store_dword v251, v252, s[96:99], 0 offen sc1
  s_mov_b64 exec, s[92:93]
L_xb_poll_c0:
  s_add_u32 m0, s31, 0
  s_nop 0
  buffer_load_dwordx4 v14, s[8:11], s32 offen offset:0 lds
  buffer_load_dwordx4 v15, s[8:11], s32 offen offset:1024 lds
  buffer_load_dwordx4 v16, s[8:11], s32 offen offset:2048 lds
  buffer_load_dwordx4 v17, s[8:11], s32 offen offset:3072 lds
  s_add_u32 m0, s31, 4096
  s_nop 0
  buffer_load_dwordx4 v18, s[8:11], s32 offen lds
  s_add_u32 s32, s32, 81920
  s_add_u32 m0, s31, 20480
  s_nop 0
  buffer_load_dwordx4 v14, s[8:11], s32 offen offset:0 lds
  buffer_load_dwordx4 v15, s[8:11], s32 offen offset:1024 lds
  buffer_load_dwordx4 v16, s[8:11], s32 offen offset:2048 lds
  buffer_load_dwordx4 v17, s[8:11], s32 offen offset:3072 lds
  s_add_u32 m0, s31, 24576
  s_nop 0
  buffer_load_dwordx4 v18, s[8:11], s32 offen lds
  s_add_u32 s32, s32, 81920
  s_add_u32 m0, s31, 40960
  s_nop 0
  buffer_load_dwordx4 v14, s[8:11], s32 offen offset:0 lds
  buffer_load_dwordx4 v15, s[8:11], s32 offen offset:1024 lds
  buffer_load_dwordx4 v16, s[8:11], s32 offen offset:2048 lds
  buffer_load_dwordx4 v17, s[8:11], s32 offen offset:3072 lds
  s_add_u32 m0, s31, 45056
  s_nop 0
  buffer_load_dwordx4 v18, s[8:11], s32 offen lds
  s_add_u32 s32, s32, 81920
  s_add_u32 m0, s31, 61440
  s_nop 0
  buffer_load_dwordx4 v14, s[8:11], s32 offen offset:0 lds
  buffer_load_dwordx4 v15, s[8:11], s32 offen offset:1024 lds
  buffer_load_dwordx4 v16, s[8:11], s32 offen offset:2048 lds
  buffer_load_dwordx4 v17, s[8:11], s32 offen offset:3072 lds
  s_add_u32 m0, s31, 65536
  s_nop 0
  buffer_load_dwordx4 v18, s[8:11], s32 offen lds
  s_add_u32 s32, s32, 81920
  s_mov_b32 s90, 0
  s_mov_b32 s91, 2048
L_xb_pl_c0:
  buffer_load_dword v251, v250, s[96:99], s91 offen sc1
  s_waitcnt vmcnt(0)
  v_cmp_ne_u32 vcc, 1, v251
  s_add_u32 s90, s90, 1
  s_cmp_ge_u32 s90, 0x20000
  s_cbranch_scc1 L_xb_done_c0
  s_cbranch_vccz L_xb_done_c0
  s_sleep 1
  s_branch L_xb_pl_c0
L_xb_done_c0:
  s_cmp_eq_u32 s95, 1
  s_cbranch_scc1 L_xb_join_c0
  buffer_inv sc1
  s_waitcnt vmcnt(0)
  s_branch L_xb_join_c0
L_xb_other_c0:
  s_add_u32 m0, s31, 0
  s_nop 0
  buffer_load_dwordx4 v14, s[8:11], s32 offen offset:0 lds
  buffer_load_dwordx4 v15, s[8:11], s32 offen offset:1024 lds
  buffer_load_dwordx4 v16, s[8:11], s32 offen offset:2048 lds
  buffer_load_dwordx4 v17, s[8:11], s32 offen offset:3072 lds
  s_add_u32 m0, s31, 4096
  s_nop 0
  buffer_load_dwordx4 v18, s[8:11], s32 offen lds
  s_add_u32 s32, s32, 81920
  s_add_u32 m0, s31, 20480
  s_nop 0
  buffer_load_dwordx4 v14, s[8:11], s32 offen offset:0 lds
  buffer_load_dwordx4 v15, s[8:11], s32 offen offset:1024 lds
  buffer_load_dwordx4 v16, s[8:11], s32 offen offset:2048 lds
  buffer_load_dwordx4 v17, s[8:11], s32 offen offset:3072 lds
  s_add_u32 m0, s31, 24576
  s_nop 0
  buffer_load_dwordx4 v18, s[8:11], s32 offen lds
  s_add_u32 s32, s32, 81920
  s_add_u32 m0, s31, 40960
  s_nop 0
  buffer_load_dwordx4 v14, s[8:11], s32 offen offset:0 lds
  buffer_load_dwordx4 v15, s[8:11], s32 offen offset:1024 lds
  buffer_load_dwordx4 v16, s[8:11], s32 offen offset:2048 lds
  buffer_load_dwordx4 v17, s[8:11], s32 offen offset:3072 lds
  s_add_u32 m0, s31, 45056
  s_nop 0
  buffer_load_dwordx4 v18, s[8:11], s32 offen lds
  s_add_u32 s32, s32, 81920
  s_add_u32 m0, s31, 61440
  s_nop 0
  buffer_load_dwordx4 v14, s[8:11], s32 offen offset:0 lds
  buffer_load_dwordx4 v15, s[8:11], s32 offen offset:1024 lds
  buffer_load_dwordx4 v16, s[8:11], s32 offen offset:2048 lds
  buffer_load_dwordx4 v17, s[8:11], s32 offen offset:3072 lds
  s_add_u32 m0, s31, 65536
  s_nop 0
  buffer_load_dwordx4 v18, s[8:11], s32 offen lds
  s_add_u32 s32, s32, 81920
L_xb_join_c0:
  s_barrier
  buffer_load_dwordx4 a[128:131], v19, s[12:15], s33 offen offset:0
  buffer_load_dwordx4 a[132:135], v19, s[12:15], s33 offen offset:1024
  s_add_u32 s33, s33, 2048
  buffer_load_dwordx4 a[136:139], v19, s[12:15], s33 offen offset:0
  buffer_load_dwordx4 a[140:143], v19, s[12:15], s33 offen offset:1024
  s_add_u32 s33, s33, 2048
  buffer_load_dwordx4 a[144:147], v19, s[12:15], s33 offen offset:0
  buffer_load_dwordx4 a[148:151], v19, s[12:15], s33 offen offset:1024
  s_add_u32 s33, s33, 2048
  buffer_load_dwordx4 a[152:155], v19, s[12:15], s33 offen offset:0
  buffer_load_dwordx4 a[156:159], v19, s[12:15], s33 offen offset:1024
  s_add_u32 s33, s33, 2048
  s_waitcnt vmcnt(6)
  s_barrier
  ds_read_b64_tr_b16 a[80:81], v10 offset:0
  ds_read_b64_tr_b16 a[82:83], v10 offset:5120
  ds_read_b64_tr_b16 a[84:85], v11 offset:0
  ds_read_b64_tr_b16 a[86:87], v11 offset:5120
  ds_read_b64_tr_b16 a[88:89], v10 offset:64
  ds_read_b64_tr_b16 a[90:91], v10 offset:5184
  ds_read_b64_tr_b16 a[92:93], v11 offset:64
  ds_read_b64_tr_b16 a[94:95], v11 offset:5184
  ds_read_b64_tr_b16 a[96:97], v10 offset:128
  ds_read_b64_tr_b16 a[98:99], v10 offset:5248
  ds_read_b64_tr_b16 a[100:101], v11 offset:128
  ds_read_b64_tr_b16 a[102:103], v11 offset:5248
  ds_read_b64_tr_b16 a[104:105], v10 offset:192
  ds_read_b64_tr_b16 a[106:107], v10 offset:5312
  s_waitcnt vmcnt(6)
  s_barrier
  s_waitcnt lgkmcnt(12)
  v_mfma_f32_16x16x32_bf16 a[0:3], a[80:83], a[128:131], 0
  ds_read_b64_tr_b16 a[108:109], v11 offset:192
  buffer_load_dwordx4 a[160:163], v19, s[12:15], s33 offen offset:0
  v_mfma_f32_16x16x32_bf16 a[4:7], a[80:83], a[132:135], 0
  s_waitcnt lgkmcnt(11)
  ds_read_b64_tr_b16 a[110:111], v11 offset:5312
  v_mfma_f32_16x16x32_bf16 a[8:11], a[84:87], a[128:131], 0
  ds_read_b64_tr_b16 a[112:113], v10 offset:256
  buffer_load_dwordx4 a[164:167], v19, s[12:15], s33 offen offset:1024
  v_mfma_f32_16x16x32_bf16 a[12:15], a[84:87], a[132:135], 0
  s_waitcnt lgkmcnt(11)
  ds_read_b64_tr_b16 a[114:115], v10 offset:5376
  v_mfma_f32_16x16x32_bf16 a[16:19], a[88:91], a[128:131], 0
  s_add_u32 s33, s33, 2048
  ds_read_b64_tr_b16 a[116:117], v11 offset:256
  buffer_load_dwordx4 a[168:171], v19, s[12:15], s33 offen offset:0
  v_mfma_f32_16x16x32_bf16 a[20:23], a[88:91], a[132:135], 0
  s_waitcnt lgkmcnt(11)
  ds_read_b64_tr_b16 a[118:119], v11 offset:5376
  v_mfma_f32_16x16x32_bf16 a[24:27], a[92:95], a[128:131], 0
  ds_read_b64_tr_b16 a[120:121], v10 offset:10240
  buffer_load_dwordx4 a[172:175], v19, s[12:15], s33 offen offset:1024
  v_mfma_f32_16x16x32_bf16 a[28:31], a[92:95], a[132:135], 0
  s_waitcnt lgkmcnt(11)
  ds_read_b64_tr_b16 a[122:123], v10 offset:15360
  v_mfma_f32_16x16x32_bf16 a[32:35], a[96:99], a[128:131], 0
  s_add_u32 s33, s33, 2048
  ds_read_b64_tr_b16 a[124:125], v11 offset:10240
  buffer_load_dwordx4 a[176:179], v19, s[12:15], s33 offen offset:0
  v_mfma_f32_16x16x32_bf16 a[36:39], a[96:99], a[132:135], 0
  s_waitcnt lgkmcnt(11)
  ds_read_b64_tr_b16 a[126:127], v11 offset:15360
  v_mfma_f32_16x16x32_bf16 a[40:43], a[100:103], a[128:131], 0
  ds_read_b64_tr_b16 a[80:81], v10 offset:10304
  buffer_load_dwordx4 a[180:183], v19, s[12:15], s33 offen offset:1024
  v_mfma_f32_16x16x32_bf16 a[44:47], a[100:103], a[132:135], 0
  s_waitcnt lgkmcnt(11)
  ds_read_b64_tr_b16 a[82:83], v10 offset:15424
  v_mfma_f32_16x16x32_bf16 a[48:51], a[104:107], a[128:131], 0
  s_add_u32 s33, s33, 2048
  ds_read_b64_tr_b16 a[84:85], v11 offset:10304
  buffer_load_dwordx4 a[184:187], v19, s[12:15], s33 offen offset:0
  v_mfma_f32_16x16x32_bf16 a[52:55], a[104:107], a[132:135], 0
  s_waitcnt lgkmcnt(11)
  ds_read_b64_tr_b16 a[86:87], v11 offset:15424
  v_mfma_f32_16x16x32_bf16 a[56:59], a[108:111], a[128:131], 0
  ds_read_b64_tr_b16 a[88:89], v10 offset:10368
  buffer_load_dwordx4 a[188:191], v19, s[12:15], s33 offen offset:1024
  v_mfma_f32_16x16x32_bf16 a[60:63], a[108:111], a[132:135], 0
  s_waitcnt lgkmcnt(11)
  ds_read_b64_tr_b16 a[90:91], v10 offset:15488
  v_mfma_f32_16x16x32_bf16 a[64:67], a[112:115], a[128:131], 0
  s_add_u32 s33, s33, 2048
  ds_read_b64_tr_b16 a[92:93], v11 offset:10368
  v_mfma_f32_16x16x32_bf16 a[68:71], a[112:115], a[132:135], 0
  s_waitcnt lgkmcnt(11)
  ds_read_b64_tr_b16 a[94:95], v11 offset:15488
  v_mfma_f32_16x16x32_bf16 a[72:75], a[116:119], a[128:131], 0
  s_waitcnt vmcnt(12)
  ds_read_b64_tr_b16 a[96:97], v10 offset:10432
  v_mfma_f32_16x16x32_bf16 a[76:79], a[116:119], a[132:135], 0
  s_waitcnt lgkmcnt(11)
  ds_read_b64_tr_b16 a[98:99], v10 offset:15552
  v_mfma_f32_16x16x32_bf16 a[0:3], a[120:123], a[136:139], a[0:3]
  s_add_u32 m0, s31, 81920
  ds_read_b64_tr_b16 a[100:101], v11 offset:10432
  buffer_load_dwordx4 v14, s[8:11], s32 offen offset:0 lds
  v_mfma_f32_16x16x32_bf16 a[4:7], a[120:123], a[140:143], a[4:7]
  s_waitcnt lgkmcnt(11)
  ds_read_b64_tr_b16 a[102:103], v11 offset:15552
  v_mfma_f32_16x16x32_bf16 a[8:11], a[124:127], a[136:139], a[8:11]
  ds_read_b64_tr_b16 a[104:105], v10 offset:10496
  buffer_load_dwordx4 v15, s[8:11], s32 offen offset:1024 lds
  v_mfma_f32_16x16x32_bf16 a[12:15], a[124:127], a[140:143], a[12:15]
  s_waitcnt lgkmcnt(11)
  ds_read_b64_tr_b16 a[106:107], v10 offset:15616
  v_mfma_f32_16x16x32_bf16 a[16:19], a[80:83], a[136:139], a[16:19]
  ds_read_b64_tr_b16 a[108:109], v11 offset:10496
  buffer_load_dwordx4 v16, s[8:11], s32 offen offset:2048 lds
  v_mfma_f32_16x16x32_bf16 a[20:23], a[80:83], a[140:143], a[20:23]
  s_waitcnt lgkmcnt(11)
  ds_read_b64_tr_b16 a[110:111], v11 offset:15616
  v_mfma_f32_16x16x32_bf16 a[24:27], a[84:87], a[136:139], a[24:27]
  ds_read_b64_tr_b16 a[112:113], v10 offset:20480
  buffer_load_dwordx4 v17, s[8:11], s32 offen offset:3072 lds
  v_mfma_f32_16x16x32_bf16 a[28:31], a[84:87], a[140:143], a[28:31]
  s_waitcnt lgkmcnt(11)
  ds_read_b64_tr_b16 a[114:115], v10 offset:25600
  v_mfma_f32_16x16x32_bf16 a[32:35], a[88:91], a[136:139], a[32:35]
  s_add_u32 m0, s31, 86016
  ds_read_b64_tr_b16 a[116:117], v11 offset:20480
  buffer_load_dwordx4 v18, s[8:11], s32 offen lds
  v_mfma_f32_16x16x32_bf16 a[36:39], a[88:91], a[140:143], a[36:39]
  s_waitcnt lgkmcnt(11)
  ds_read_b64_tr_b16 a[118:119], v11 offset:25600
  v_mfma_f32_16x16x32_bf16 a[40:43], a[92:95], a[136:139], a[40:43]
  s_add_u32 s32, s32, 81920
  ds_read_b64_tr_b16 a[120:121], v10 offset:20544
  buffer_load_dwordx4 a[192:195], v19, s[12:15], s33 offen offset:0
  v_mfma_f32_16x16x32_bf16 a[44:47], a[92:95], a[140:143], a[44:47]
  s_waitcnt lgkmcnt(11)
  ds_read_b64_tr_b16 a[122:123], v10 offset:25664
  v_mfma_f32_16x16x32_bf16 a[48:51], a[96:99], a[136:139], a[48:51]
  ds_read_b64_tr_b16 a[124:125], v11 offset:20544
  buffer_load_dwordx4 a[196:199], v19, s[12:15], s33 offen offset:1024
  v_mfma_f32_16x16x32_bf16 a[52:55], a[96:99], a[140:143], a[52:55]
  s_waitcnt lgkmcnt(11)
  ds_read_b64_tr_b16 a[126:127], v11 offset:25664
  v_mfma_f32_16x16x32_bf16 a[56:59], a[100:103], a[136:139], a[56:59]
  s_add_u32 s33, s33, 2048
  ds_read_b64_tr_b16 a[80:81], v10 offset:20608
  v_mfma_f32_16x16x32_bf16 a[60:63], a[100:103], a[140:143], a[60:63]
  s_waitcnt lgkmcnt(11)
  ds_read_b64_tr_b16 a[82:83], v10 offset:25728
  v_mfma_f32_16x16x32_bf16 a[64:67], a[104:107], a[136:139], a[64:67]
  ds_read_b64_tr_b16 a[84:85], v11 offset:20608
  v_mfma_f32_16x16x32_bf16 a[68:71], a[104:107], a[140:143], a[68:71]
  s_waitcnt lgkmcnt(11)
  ds_read_b64_tr_b16 a[86:87], v11 offset:25728
  v_mfma_f32_16x16x32_bf16 a[72:75], a[108:111], a[136:139], a[72:75]
  ds_read_b64_tr_b16 a[88:89], v10 offset:20672
  v_mfma_f32_16x16x32_bf16 a[76:79], a[108:111], a[140:143], a[76:79]
  ds_read_b64_tr_b16 a[90:91], v10 offset:25792
  s_waitcnt vmcnt(17)
  s_barrier
  s_waitcnt lgkmcnt(12)
  v_mfma_f32_16x16x32_bf16 a[0:3], a[112:115], a[144:147], a[0:3]
  ds_read_b64_tr_b16 a[92:93], v11 offset:20672
  buffer_load_dwordx4 a[200:203], v19, s[12:15], s33 offen offset:0
  v_mfma_f32_16x16x32_bf16 a[4:7], a[112:115], a[148:151], a[4:7]
  s_waitcnt lgkmcnt(11)
  ds_read_b64_tr_b16 a[94:95], v11 offset:25792
  v_mfma_f32_16x16x32_bf16 a[8:11], a[116:119], a[144:147], a[8:11]
  ds_read_b64_tr_b16 a[96:97], v10 offset:20736
  buffer_load_dwordx4 a[204:207], v19, s[12:15], s33 offen offset:1024
  v_mfma_f32_16x16x32_bf16 a[12:15], a[116:119], a[148:151], a[12:15]
  s_waitcnt lgkmcnt(11)
  ds_read_b64_tr_b16 a[98:99], v10 offset:25856
  v_mfma_f32_16x16x32_bf16 a[16:19], a[120:123], a[144:147], a[16:19]
  s_add_u32 s33, s33, 2048
  ds_read_b64_tr_b16 a[100:101], v11 offset:20736
  v_mfma_f32_16x16x32_bf16 a[20:23], a[120:123], a[148:151], a[20:23]
  s_waitcnt lgkmcnt(11)
  ds_read_b64_tr_b16 a[102:103], v11 offset:25856
  v_mfma_f32_16x16x32_bf16 a[24:27], a[124:127], a[144:147], a[24:27]
  s_add_u32 m0, s31, 102400
  ds_read_b64_tr_b16 a[104:105], v10 offset:30720
  buffer_load_dwordx4 v14, s[8:11], s32 offen offset:0 lds
  v_mfma_f32_16x16x32_bf16 a[28:31], a[124:127], a[148:151], a[28:31]
  s_waitcnt lgkmcnt(11)
  ds_read_b64_tr_b16 a[106:107], v10 offset:35840
  v_mfma_f32_16x16x32_bf16 a[32:35], a[80:83], a[144:147], a[32:35]
  ds_read_b64_tr_b16 a[108:109], v11 offset:30720
  buffer_load_dwordx4 v15, s[8:11], s32 offen offset:1024 lds
  v_mfma_f32_16x16x32_bf16 a[36:39], a[80:83], a[148:151], a[36:39]
  s_waitcnt lgkmcnt(11)
  ds_read_b64_tr_b16 a[110:111], v11 offset:35840
  v_mfma_f32_16x16x32_bf16 a[40:43], a[84:87], a[144:147], a[40:43]
  ds_read_b64_tr_b16 a[112:113], v10 offset:30784
  buffer_load_dwordx4 v16, s[8:11], s32 offen offset:2048 lds
  v_mfma_f32_16x16x32_bf16 a[44:47], a[84:87], a[148:151], a[44:47]
  s_waitcnt lgkmcnt(11)
  ds_read_b64_tr_b16 a[114:115], v10 offset:35904
  v_mfma_f32_16x16x32_bf16 a[48:51], a[88:91], a[144:147], a[48:51]
  ds_read_b64_tr_b16 a[116:117], v11 offset:30784
  buffer_load_dwordx4 v17, s[8:11], s32 offen offset:3072 lds
  v_mfma_f32_16x16x32_bf16 a[52:55], a[88:91], a[148:151], a[52:55]
  s_waitcnt lgkmcnt(11)
  ds_read_b64_tr_b16 a[118:119], v11 offset:35904
  v_mfma_f32_16x16x32_bf16 a[56:59], a[92:95], a[144:147], a[56:59]
  s_add_u32 m0, s31, 106496
  ds_read_b64_tr_b16 a[120:121], v10 offset:30848
  buffer_load_dwordx4 v18, s[8:11], s32 offen lds
  v_mfma_f32_16x16x32_bf16 a[60:63], a[92:95], a[148:151], a[60:63]
  s_waitcnt lgkmcnt(11)
  ds_read_b64_tr_b16 a[122:123], v10 offset:35968
  v_mfma_f32_16x16x32_bf16 a[64:67], a[96:99], a[144:147], a[64:67]
  s_add_u32 s32, s32, 81920
  ds_read_b64_tr_b16 a[124:125], v11 offset:30848
  buffer_load_dwordx4 a[208:211], v19, s[12:15], s33 offen offset:0
  v_mfma_f32_16x16x32_bf16 a[68:71], a[96:99], a[148:151], a[68:71]
  s_waitcnt lgkmcnt(11)
  ds_read_b64_tr_b16 a[126:127], v11 offset:35968
  v_mfma_f32_16x16x32_bf16 a[72:75], a[100:103], a[144:147], a[72:75]
  s_waitcnt vmcnt(23)
  ds_read_b64_tr_b16 a[80:81], v10 offset:30912
  buffer_load_dwordx4 a[212:215], v19, s[12:15], s33 offen offset:1024
  v_mfma_f32_16x16x32_bf16 a[76:79], a[100:103], a[148:151], a[76:79]
  s_waitcnt lgkmcnt(11)
  ds_read_b64_tr_b16 a[82:83], v10 offset:36032
  v_mfma_f32_16x16x32_bf16 a[0:3], a[104:107], a[152:155], a[0:3]
  s_add_u32 s33, s33, 2048
  ds_read_b64_tr_b16 a[84:85], v11 offset:30912
  buffer_load_dwordx4 a[216:219], v19, s[12:15], s33 offen offset:0
  v_mfma_f32_16x16x32_bf16 a[4:7], a[104:107], a[156:159], a[4:7]
  s_waitcnt lgkmcnt(11)
  ds_read_b64_tr_b16 a[86:87], v11 offset:36032
  v_mfma_f32_16x16x32_bf16 a[8:11], a[108:111], a[152:155], a[8:11]
  ds_read_b64_tr_b16 a[88:89], v10 offset:30976
  buffer_load_dwordx4 a[220:223], v19, s[12:15], s33 offen offset:1024
  v_mfma_f32_16x16x32_bf16 a[12:15], a[108:111], a[156:159], a[12:15]
  s_waitcnt lgkmcnt(11)
  ds_read_b64_tr_b16 a[90:91], v10 offset:36096
  v_mfma_f32_16x16x32_bf16 a[16:19], a[112:115], a[152:155], a[16:19]
  s_add_u32 s33, s33, 2048
  ds_read_b64_tr_b16 a[92:93], v11 offset:30976
  v_mfma_f32_16x16x32_bf16 a[20:23], a[112:115], a[156:159], a[20:23]
  s_waitcnt lgkmcnt(11)
  ds_read_b64_tr_b16 a[94:95], v11 offset:36096
  v_mfma_f32_16x16x32_bf16 a[24:27], a[116:119], a[152:155], a[24:27]
  s_add_u32 m0, s31, 0
  ds_read_b64_tr_b16 a[96:97], v10 offset:40960
  buffer_load_dwordx4 v14, s[8:11], s32 offen offset:0 lds
  v_mfma_f32_16x16x32_bf16 a[28:31], a[116:119], a[156:159], a[28:31]
  s_waitcnt lgkmcnt(11)
  ds_read_b64_tr_b16 a[98:99], v10 offset:46080
  v_mfma_f32_16x16x32_bf16 a[32:35], a[120:123], a[152:155], a[32:35]
  ds_read_b64_tr_b16 a[100:101], v11 offset:40960
  buffer_load_dwordx4 v15, s[8:11], s32 offen offset:1024 lds
  v_mfma_f32_16x16x32_bf16 a[36:39], a[120:123], a[156:159], a[36:39]
  s_waitcnt lgkmcnt(11)
  ds_read_b64_tr_b16 a[102:103], v11 offset:46080
  v_mfma_f32_16x16x32_bf16 a[40:43], a[124:127], a[152:155], a[40:43]
  ds_read_b64_tr_b16 a[104:105], v10 offset:41024
  buffer_load_dwordx4 v16, s[8:11], s32 offen offset:2048 lds
  v_mfma_f32_16x16x32_bf16 a[44:47], a[124:127], a[156:159], a[44:47]
  s_waitcnt lgkmcnt(11)
  ds_read_b64_tr_b16 a[106:107], v10 offset:46144
  v_mfma_f32_16x16x32_bf16 a[48:51], a[80:83], a[152:155], a[48:51]
  ds_read_b64_tr_b16 a[108:109], v11 offset:41024
  buffer_load_dwordx4 v17, s[8:11], s32 offen offset:3072 lds
  v_mfma_f32_16x16x32_bf16 a[52:55], a[80:83], a[156:159], a[52:55]
  s_waitcnt lgkmcnt(11)
  ds_read_b64_tr_b16 a[110:111], v11 offset:46144
  v_mfma_f32_16x16x32_bf16 a[56:59], a[84:87], a[152:155], a[56:59]
  s_add_u32 m0, s31, 4096
  ds_read_b64_tr_b16 a[112:113], v10 offset:41088
  buffer_load_dwordx4 v18, s[8:11], s32 offen lds
  v_mfma_f32_16x16x32_bf16 a[60:63], a[84:87], a[156:159], a[60:63]
  s_waitcnt lgkmcnt(11)
  ds_read_b64_tr_b16 a[114:115], v10 offset:46208
  v_mfma_f32_16x16x32_bf16 a[64:67], a[88:91], a[152:155], a[64:67]
  s_add_u32 s32, s32, 81920
  ds_read_b64_tr_b16 a[116:117], v11 offset:41088
  buffer_load_dwordx4 a[128:131], v19, s[12:15], s33 offen offset:0
  v_mfma_f32_16x16x32_bf16 a[68:71], a[88:91], a[156:159], a[68:71]
  s_waitcnt lgkmcnt(11)
  ds_read_b64_tr_b16 a[118:119], v11 offset:46208
  v_mfma_f32_16x16x32_bf16 a[72:75], a[92:95], a[152:155], a[72:75]
  ds_read_b64_tr_b16 a[120:121], v10 offset:41152
  buffer_load_dwordx4 a[132:135], v19, s[12:15], s33 offen offset:1024
  v_mfma_f32_16x16x32_bf16 a[76:79], a[92:95], a[156:159], a[76:79]
  s_add_u32 s33, s33, 2048
  ds_read_b64_tr_b16 a[122:123], v10 offset:46272
  s_waitcnt vmcnt(31)
  s_barrier
  s_waitcnt lgkmcnt(12)
  v_mfma_f32_16x16x32_bf16 a[0:3], a[96:99], a[160:163], a[0:3]
  ds_read_b64_tr_b16 a[124:125], v11 offset:41152
  buffer_load_dwordx4 a[136:139], v19, s[12:15], s33 offen offset:0
  v_mfma_f32_16x16x32_bf16 a[4:7], a[96:99], a[164:167], a[4:7]
  s_waitcnt lgkmcnt(11)
  ds_read_b64_tr_b16 a[126:127], v11 offset:46272
  v_mfma_f32_16x16x32_bf16 a[8:11], a[100:103], a[160:163], a[8:11]
  ds_read_b64_tr_b16 a[80:81], v10 offset:41216
  v_mfma_f32_16x16x32_bf16 a[12:15], a[100:103], a[164:167], a[12:15]
  s_waitcnt lgkmcnt(11)
  ds_read_b64_tr_b16 a[82:83], v10 offset:46336
  buffer_load_dwordx4 a[140:143], v19, s[12:15], s33 offen offset:1024
  v_mfma_f32_16x16x32_bf16 a[16:19], a[104:107], a[160:163], a[16:19]
  s_add_u32 s33, s33, 2048
  ds_read_b64_tr_b16 a[84:85], v11 offset:41216
  v_mfma_f32_16x16x32_bf16 a[20:23], a[104:107], a[164:167], a[20:23]
  s_waitcnt lgkmcnt(11)
  ds_read_b64_tr_b16 a[86:87], v11 offset:46336
  v_mfma_f32_16x16x32_bf16 a[24:27], a[108:111], a[160:163], a[24:27]
  s_add_u32 m0, s31, 20480
  ds_read_b64_tr_b16 a[88:89], v10 offset:51200
  buffer_load_dwordx4 v14, s[8:11], s32 offen offset:0 lds
  v_mfma_f32_16x16x32_bf16 a[28:31], a[108:111], a[164:167], a[28:31]
  s_waitcnt lgkmcnt(11)
  ds_read_b64_tr_b16 a[90:91], v10 offset:56320
  v_mfma_f32_16x16x32_bf16 a[32:35], a[112:115], a[160:163], a[32:35]
  ds_read_b64_tr_b16 a[92:93], v11 offset:51200
  v_mfma_f32_16x16x32_bf16 a[36:39], a[112:115], a[164:167], a[36:39]
  s_waitcnt lgkmcnt(11)
  ds_read_b64_tr_b16 a[94:95], v11 offset:56320
  buffer_load_dwordx4 v15, s[8:11], s32 offen offset:1024 lds
  v_mfma_f32_16x16x32_bf16 a[40:43], a[116:119], a[160:163], a[40:43]
  ds_read_b64_tr_b16 a[96:97], v10 offset:51264
  v_mfma_f32_16x16x32_bf16 a[44:47], a[116:119], a[164:167], a[44:47]
  s_waitcnt lgkmcnt(11)
  ds_read_b64_tr_b16 a[98:99], v10 offset:56384
  v_mfma_f32_16x16x32_bf16 a[48:51], a[120:123], a[160:163], a[48:51]
  ds_read_b64_tr_b16 a[100:101], v11 offset:51264
  buffer_load_dwordx4 v16, s[8:11], s32 offen offset:2048 lds
  v_mfma_f32_16x16x32_bf16 a[52:55], a[120:123], a[164:167], a[52:55]
  s_waitcnt lgkmcnt(11)
  ds_read_b64_tr_b16 a[102:103], v11 offset:56384
  v_mfma_f32_16x16x32_bf16 a[56:59], a[124:127], a[160:163], a[56:59]
  ds_read_b64_tr_b16 a[104:105], v10 offset:51328
  v_mfma_f32_16x16x32_bf16 a[60:63], a[124:127], a[164:167], a[60:63]
  s_waitcnt lgkmcnt(11)
  ds_read_b64_tr_b16 a[106:107], v10 offset:56448
  buffer_load_dwordx4 v17, s[8:11], s32 offen offset:3072 lds
  v_mfma_f32_16x16x32_bf16 a[64:67], a[80:83], a[160:163], a[64:67]
  s_add_u32 m0, s31, 24576
  ds_read_b64_tr_b16 a[108:109], v11 offset:51328
  v_mfma_f32_16x16x32_bf16 a[68:71], a[80:83], a[164:167], a[68:71]
  s_waitcnt lgkmcnt(11)
  ds_read_b64_tr_b16 a[110:111], v11 offset:56448
  v_mfma_f32_16x16x32_bf16 a[72:75], a[84:87], a[160:163], a[72:75]
  s_waitcnt vmcnt(35)
  ds_read_b64_tr_b16 a[112:113], v10 offset:51392
  buffer_load_dwordx4 v18, s[8:11], s32 offen lds
  v_mfma_f32_16x16x32_bf16 a[76:79], a[84:87], a[164:167], a[76:79]
  s_waitcnt lgkmcnt(11)
  ds_read_b64_tr_b16 a[114:115], v10 offset:56512
  v_mfma_f32_16x16x32_bf16 a[0:3], a[88:91], a[168:171], a[0:3]
  s_add_u32 s32, s32, 81920
  ds_read_b64_tr_b16 a[116:117], v11 offset:51392
  v_mfma_f32_16x16x32_bf16 a[4:7], a[88:91], a[172:175], a[4:7]
  s_waitcnt lgkmcnt(11)
  ds_read_b64_tr_b16 a[118:119], v11 offset:56512
  buffer_load_dwordx4 a[144:147], v19, s[12:15], s33 offen offset:0
  v_mfma_f32_16x16x32_bf16 a[8:11], a[92:95], a[168:171], a[8:11]
  ds_read_b64_tr_b16 a[120:121], v10 offset:51456
  v_mfma_f32_16x16x32_bf16 a[12:15], a[92:95], a[172:175], a[12:15]
  s_waitcnt lgkmcnt(11)
  ds_read_b64_tr_b16 a[122:123], v10 offset:56576
  v_mfma_f32_16x16x32_bf16 a[16:19], a[96:99], a[168:171], a[16:19]
  ds_read_b64_tr_b16 a[124:125], v11 offset:51456
  buffer_load_dwordx4 a[148:151], v19, s[12:15], s33 offen offset:1024
  v_mfma_f32_16x16x32_bf16 a[20:23], a[96:99], a[172:175], a[20:23]
  s_waitcnt lgkmcnt(11)
  ds_read_b64_tr_b16 a[126:127], v11 offset:56576
  v_mfma_f32_16x16x32_bf16 a[24:27], a[100:103], a[168:171], a[24:27]
  s_add_u32 s33, s33, 2048
  ds_read_b64_tr_b16 a[80:81], v12 offset:0
  v_mfma_f32_16x16x32_bf16 a[28:31], a[100:103], a[172:175], a[28:31]
  s_waitcnt lgkmcnt(11)
  ds_read_b64_tr_b16 a[82:83], v12 offset:5120
  buffer_load_dwordx4 a[152:155], v19, s[12:15], s33 offen offset:0
  v_mfma_f32_16x16x32_bf16 a[32:35], a[104:107], a[168:171], a[32:35]
  ds_read_b64_tr_b16 a[84:85], v13 offset:0
  v_mfma_f32_16x16x32_bf16 a[36:39], a[104:107], a[172:175], a[36:39]
  s_waitcnt lgkmcnt(11)
  ds_read_b64_tr_b16 a[86:87], v13 offset:5120
  v_mfma_f32_16x16x32_bf16 a[40:43], a[108:111], a[168:171], a[40:43]
  ds_read_b64_tr_b16 a[88:89], v12 offset:64
  buffer_load_dwordx4 a[156:159], v19, s[12:15], s33 offen offset:1024
  v_mfma_f32_16x16x32_bf16 a[44:47], a[108:111], a[172:175], a[44:47]
  s_waitcnt lgkmcnt(11)
  ds_read_b64_tr_b16 a[90:91], v12 offset:5184
  v_mfma_f32_16x16x32_bf16 a[48:51], a[112:115], a[168:171], a[48:51]
  s_add_u32 s33, s33, 2048
  ds_read_b64_tr_b16 a[92:93], v13 offset:64
  v_mfma_f32_16x16x32_bf16 a[52:55], a[112:115], a[172:175], a[52:55]
  s_waitcnt lgkmcnt(11)
  ds_read_b64_tr_b16 a[94:95], v13 offset:5184
  v_mfma_f32_16x16x32_bf16 a[56:59], a[116:119], a[168:171], a[56:59]
  ds_read_b64_tr_b16 a[96:97], v12 offset:128
  v_mfma_f32_16x16x32_bf16 a[60:63], a[116:119], a[172:175], a[60:63]
  s_waitcnt lgkmcnt(11)
  ds_read_b64_tr_b16 a[98:99], v12 offset:5248
  v_mfma_f32_16x16x32_bf16 a[64:67], a[120:123], a[168:171], a[64:67]
  s_waitcnt vmcnt(31)
  ds_read_b64_tr_b16 a[100:101], v13 offset:128
  v_mfma_f32_16x16x32_bf16 a[68:71], a[120:123], a[172:175], a[68:71]
  s_waitcnt lgkmcnt(11)
  ds_read_b64_tr_b16 a[102:103], v13 offset:5248
  v_mfma_f32_16x16x32_bf16 a[72:75], a[124:127], a[168:171], a[72:75]
  s_barrier
  ds_read_b64_tr_b16 a[104:105], v12 offset:192
  v_mfma_f32_16x16x32_bf16 a[76:79], a[124:127], a[172:175], a[76:79]
  s_waitcnt lgkmcnt(11)
  ds_read_b64_tr_b16 a[106:107], v12 offset:5312
  v_mfma_f32_16x16x32_bf16 a[0:3], a[80:83], a[176:179], a[0:3]
  s_add_u32 m0, s31, 40960
  ds_read_b64_tr_b16 a[108:109], v13 offset:192
  buffer_load_dwordx4 v14, s[8:11], s32 offen offset:0 lds
  v_mfma_f32_16x16x32_bf16 a[4:7], a[80:83], a[180:183], a[4:7]
  s_waitcnt lgkmcnt(11)
  ds_read_b64_tr_b16 a[110:111], v13 offset:5312
  v_mfma_f32_16x16x32_bf16 a[8:11], a[84:87], a[176:179], a[8:11]
  ds_read_b64_tr_b16 a[112:113], v12 offset:256
  v_mfma_f32_16x16x32_bf16 a[12:15], a[84:87], a[180:183], a[12:15]
  s_waitcnt lgkmcnt(11)
  ds_read_b64_tr_b16 a[114:115], v12 offset:5376
  v_mfma_f32_16x16x32_bf16 a[16:19], a[88:91], a[176:179], a[16:19]
  ds_read_b64_tr_b16 a[116:117], v13 offset:256
  buffer_load_dwordx4 v15, s[8:11], s32 offen offset:1024 lds
  v_mfma_f32_16x16x32_bf16 a[20:23], a[88:91], a[180:183], a[20:23]
  s_waitcnt lgkmcnt(11)
  ds_read_b64_tr_b16 a[118:119], v13 offset:5376
  v_mfma_f32_16x16x32_bf16 a[24:27], a[92:95], a[176:179], a[24:27]
  ds_read_b64_tr_b16 a[120:121], v12 offset:10240
  v_mfma_f32_16x16x32_bf16 a[28:31], a[92:95], a[180:183], a[28:31]
  s_waitcnt lgkmcnt(11)
  ds_read_b64_tr_b16 a[122:123], v12 offset:15360
  v_mfma_f32_16x16x32_bf16 a[32:35], a[96:99], a[176:179], a[32:35]
  ds_read_b64_tr_b16 a[124:125], v13 offset:10240
  buffer_load_dwordx4 v16, s[8:11], s32 offen offset:2048 lds
  v_mfma_f32_16x16x32_bf16 a[36:39], a[96:99], a[180:183], a[36:39]
  s_waitcnt lgkmcnt(11)
  ds_read_b64_tr_b16 a[126:127], v13 offset:15360
  v_mfma_f32_16x16x32_bf16 a[40:43], a[100:103], a[176:179], a[40:43]
  ds_read_b64_tr_b16 a[80:81], v12 offset:10304
  v_mfma_f32_16x16x32_bf16 a[44:47], a[100:103], a[180:183], a[44:47]
  s_waitcnt lgkmcnt(11)
  ds_read_b64_tr_b16 a[82:83], v12 offset:15424
  v_mfma_f32_16x16x32_bf16 a[48:51], a[104:107], a[176:179], a[48:51]
  ds_read_b64_tr_b16 a[84:85], v13 offset:10304
  buffer_load_dwordx4 v17, s[8:11], s32 offen offset:3072 lds
  v_mfma_f32_16x16x32_bf16 a[52:55], a[104:107], a[180:183], a[52:55]
  s_waitcnt lgkmcnt(11)
  ds_read_b64_tr_b16 a[86:87], v13 offset:15424
  v_mfma_f32_16x16x32_bf16 a[56:59], a[108:111], a[176:179], a[56:59]
  s_add_u32 m0, s31, 45056
  ds_read_b64_tr_b16 a[88:89], v12 offset:10368
  v_mfma_f32_16x16x32_bf16 a[60:63], a[108:111], a[180:183], a[60:63]
  s_waitcnt lgkmcnt(11)
  ds_read_b64_tr_b16 a[90:91], v12 offset:15488
  v_mfma_f32_16x16x32_bf16 a[64:67], a[112:115], a[176:179], a[64:67]
  ds_read_b64_tr_b16 a[92:93], v13 offset:10368
  buffer_load_dwordx4 v18, s[8:11], s32 offen lds
  v_mfma_f32_16x16x32_bf16 a[68:71], a[112:115], a[180:183], a[68:71]
  s_waitcnt lgkmcnt(11)
  ds_read_b64_tr_b16 a[94:95], v13 offset:15488
  v_mfma_f32_16x16x32_bf16 a[72:75], a[116:119], a[176:179], a[72:75]
  s_waitcnt vmcnt(41)
  ds_read_b64_tr_b16 a[96:97], v12 offset:10432
  v_mfma_f32_16x16x32_bf16 a[76:79], a[116:119], a[180:183], a[76:79]
  s_waitcnt lgkmcnt(11)
  ds_read_b64_tr_b16 a[98:99], v12 offset:15552
  v_mfma_f32_16x16x32_bf16 a[0:3], a[120:123], a[184:187], a[0:3]
  s_add_u32 s32, s32, 81920
  ds_read_b64_tr_b16 a[100:101], v13 offset:10432
  buffer_load_dwordx4 a[160:163], v19, s[12:15], s33 offen offset:0
  v_mfma_f32_16x16x32_bf16 a[4:7], a[120:123], a[188:191], a[4:7]
  s_waitcnt lgkmcnt(11)
  ds_read_b64_tr_b16 a[102:103], v13 offset:15552
  v_mfma_f32_16x16x32_bf16 a[8:11], a[124:127], a[184:187], a[8:11]
  ds_read_b64_tr_b16 a[104:105], v12 offset:10496
  v_mfma_f32_16x16x32_bf16 a[12:15], a[124:127], a[188:191], a[12:15]
  s_waitcnt lgkmcnt(11)
  ds_read_b64_tr_b16 a[106:107], v12 offset:15616
  v_mfma_f32_16x16x32_bf16 a[16:19], a[80:83], a[184:187], a[16:19]
  ds_read_b64_tr_b16 a[108:109], v13 offset:10496
  buffer_load_dwordx4 a[164:167], v19, s[12:15], s33 offen offset:1024
  v_mfma_f32_16x16x32_bf16 a[20:23], a[80:83], a[188:191], a[20:23]
  s_waitcnt lgkmcnt(11)
  ds_read_b64_tr_b16 a[110:111], v13 offset:15616
  v_mfma_f32_16x16x32_bf16 a[24:27], a[84:87], a[184:187], a[24:27]
  s_add_u32 s33, s33, 2048
  ds_read_b64_tr_b16 a[112:113], v12 offset:20480
  v_mfma_f32_16x16x32_bf16 a[28:31], a[84:87], a[188:191], a[28:31]
  s_waitcnt lgkmcnt(11)
  ds_read_b64_tr_b16 a[114:115], v12 offset:25600
  v_mfma_f32_16x16x32_bf16 a[32:35], a[88:91], a[184:187], a[32:35]
  ds_read_b64_tr_b16 a[116:117], v13 offset:20480
  buffer_load_dwordx4 a[168:171], v19, s[12:15], s33 offen offset:0
  v_mfma_f32_16x16x32_bf16 a[36:39], a[88:91], a[188:191], a[36:39]
  s_waitcnt lgkmcnt(11)
  ds_read_b64_tr_b16 a[118:119], v13 offset:25600
  v_mfma_f32_16x16x32_bf16 a[40:43], a[92:95], a[184:187], a[40:43]
  ds_read_b64_tr_b16 a[120:121], v12 offset:20544
  v_mfma_f32_16x16x32_bf16 a[44:47], a[92:95], a[188:191], a[44:47]
  s_waitcnt lgkmcnt(11)
  ds_read_b64_tr_b16 a[122:123], v12 offset:25664
  v_mfma_f32_16x16x32_bf16 a[48:51], a[96:99], a[184:187], a[48:51]
  ds_read_b64_tr_b16 a[124:125], v13 offset:20544
  buffer_load_dwordx4 a[172:175], v19, s[12:15], s33 offen offset:1024
  v_mfma_f32_16x16x32_bf16 a[52:55], a[96:99], a[188:191], a[52:55]
  s_waitcnt lgkmcnt(11)
  ds_read_b64_tr_b16 a[126:127], v13 offset:25664
  v_mfma_f32_16x16x32_bf16 a[56:59], a[100:103], a[184:187], a[56:59]
  s_add_u32 s33, s33, 2048
  ds_read_b64_tr_b16 a[80:81], v12 offset:20608
  v_mfma_f32_16x16x32_bf16 a[60:63], a[100:103], a[188:191], a[60:63]
  s_waitcnt lgkmcnt(11)
  ds_read_b64_tr_b16 a[82:83], v12 offset:25728
  v_mfma_f32_16x16x32_bf16 a[64:67], a[104:107], a[184:187], a[64:67]
  s_waitcnt vmcnt(31)
  ds_read_b64_tr_b16 a[84:85], v13 offset:20608
  v_mfma_f32_16x16x32_bf16 a[68:71], a[104:107], a[188:191], a[68:71]
  s_waitcnt lgkmcnt(11)
  ds_read_b64_tr_b16 a[86:87], v13 offset:25728
  v_mfma_f32_16x16x32_bf16 a[72:75], a[108:111], a[184:187], a[72:75]
  s_barrier
  ds_read_b64_tr_b16 a[88:89], v12 offset:20672
  v_mfma_f32_16x16x32_bf16 a[76:79], a[108:111], a[188:191], a[76:79]
  s_waitcnt lgkmcnt(11)
  ds_read_b64_tr_b16 a[90:91], v12 offset:25792
  v_mfma_f32_16x16x32_bf16 a[0:3], a[112:115], a[192:195], a[0:3]
  s_add_u32 m0, s31, 61440
  ds_read_b64_tr_b16 a[92:93], v13 offset:20672
  buffer_load_dwordx4 v14, s[8:11], s32 offen offset:0 lds
  v_mfma_f32_16x16x32_bf16 a[4:7], a[112:115], a[196:199], a[4:7]
  s_waitcnt lgkmcnt(11)
  ds_read_b64_tr_b16 a[94:95], v13 offset:25792
  v_mfma_f32_16x16x32_bf16 a[8:11], a[116:119], a[192:195], a[8:11]
  ds_read_b64_tr_b16 a[96:97], v12 offset:20736
  v_mfma_f32_16x16x32_bf16 a[12:15], a[116:119], a[196:199], a[12:15]
  s_waitcnt lgkmcnt(11)
  ds_read_b64_tr_b16 a[98:99], v12 offset:25856
  v_mfma_f32_16x16x32_bf16 a[16:19], a[120:123], a[192:195], a[16:19]
  ds_read_b64_tr_b16 a[100:101], v13 offset:20736
  buffer_load_dwordx4 v15, s[8:11], s32 offen offset:1024 lds
  v_mfma_f32_16x16x32_bf16 a[20:23], a[120:123], a[196:199], a[20:23]
  s_waitcnt lgkmcnt(11)
  ds_read_b64_tr_b16 a[102:103], v13 offset:25856
  v_mfma_f32_16x16x32_bf16 a[24:27], a[124:127], a[192:195], a[24:27]
  ds_read_b64_tr_b16 a[104:105], v12 offset:30720
  v_mfma_f32_16x16x32_bf16 a[28:31], a[124:127], a[196:199], a[28:31]
  s_waitcnt lgkmcnt(11)
  ds_read_b64_tr_b16 a[106:107], v12 offset:35840
  v_mfma_f32_16x16x32_bf16 a[32:35], a[80:83], a[192:195], a[32:35]
  ds_read_b64_tr_b16 a[108:109], v13 offset:30720
  buffer_load_dwordx4 v16, s[8:11], s32 offen offset:2048 lds
  v_mfma_f32_16x16x32_bf16 a[36:39], a[80:83], a[196:199], a[36:39]
  s_waitcnt lgkmcnt(11)
  ds_read_b64_tr_b16 a[110:111], v13 offset:35840
  v_mfma_f32_16x16x32_bf16 a[40:43], a[84:87], a[192:195], a[40:43]
  ds_read_b64_tr_b16 a[112:113], v12 offset:30784
  v_mfma_f32_16x16x32_bf16 a[44:47], a[84:87], a[196:199], a[44:47]
  s_waitcnt lgkmcnt(11)
  ds_read_b64_tr_b16 a[114:115], v12 offset:35904
  v_mfma_f32_16x16x32_bf16 a[48:51], a[88:91], a[192:195], a[48:51]
  ds_read_b64_tr_b16 a[116:117], v13 offset:30784
  buffer_load_dwordx4 v17, s[8:11], s32 offen offset:3072 lds
  v_mfma_f32_16x16x32_bf16 a[52:55], a[88:91], a[196:199], a[52:55]
  s_waitcnt lgkmcnt(11)
  ds_read_b64_tr_b16 a[118:119], v13 offset:35904
  v_mfma_f32_16x16x32_bf16 a[56:59], a[92:95], a[192:195], a[56:59]
  s_add_u32 m0, s31, 65536
  ds_read_b64_tr_b16 a[120:121], v12 offset:30848
  v_mfma_f32_16x16x32_bf16 a[60:63], a[92:95], a[196:199], a[60:63]
  s_waitcnt lgkmcnt(11)
  ds_read_b64_tr_b16 a[122:123], v12 offset:35968
  v_mfma_f32_16x16x32_bf16 a[64:67], a[96:99], a[192:195], a[64:67]
  ds_read_b64_tr_b16 a[124:125], v13 offset:30848
  buffer_load_dwordx4 v18, s[8:11], s32 offen lds
  v_mfma_f32_16x16x32_bf16 a[68:71], a[96:99], a[196:199], a[68:71]
  s_waitcnt lgkmcnt(11)
  ds_read_b64_tr_b16 a[126:127], v13 offset:35968
  v_mfma_f32_16x16x32_bf16 a[72:75], a[100:103], a[192:195], a[72:75]
  s_waitcnt vmcnt(41)
  ds_read_b64_tr_b16 a[80:81], v12 offset:30912
  v_mfma_f32_16x16x32_bf16 a[76:79], a[100:103], a[196:199], a[76:79]
  s_waitcnt lgkmcnt(11)
  ds_read_b64_tr_b16 a[82:83], v12 offset:36032
  v_mfma_f32_16x16x32_bf16 a[0:3], a[104:107], a[200:203], a[0:3]
  s_add_u32 s32, s32, 81920
  ds_read_b64_tr_b16 a[84:85], v13 offset:30912
  buffer_load_dwordx4 a[176:179], v19, s[12:15], s33 offen offset:0
  v_mfma_f32_16x16x32_bf16 a[4:7], a[104:107], a[204:207], a[4:7]
  s_waitcnt lgkmcnt(11)
  ds_read_b64_tr_b16 a[86:87], v13 offset:36032
  v_mfma_f32_16x16x32_bf16 a[8:11], a[108:111], a[200:203], a[8:11]
  ds_read_b64_tr_b16 a[88:89], v12 offset:30976
  v_mfma_f32_16x16x32_bf16 a[12:15], a[108:111], a[204:207], a[12:15]
  s_waitcnt lgkmcnt(11)
  ds_read_b64_tr_b16 a[90:91], v12 offset:36096
  v_mfma_f32_16x16x32_bf16 a[16:19], a[112:115], a[200:203], a[16:19]
  ds_read_b64_tr_b16 a[92:93], v13 offset:30976
  buffer_load_dwordx4 a[180:183], v19, s[12:15], s33 offen offset:1024
  v_mfma_f32_16x16x32_bf16 a[20:23], a[112:115], a[204:207], a[20:23]
  s_waitcnt lgkmcnt(11)
  ds_read_b64_tr_b16 a[94:95], v13 offset:36096
  v_mfma_f32_16x16x32_bf16 a[24:27], a[116:119], a[200:203], a[24:27]
  s_add_u32 s33, s33, 2048
  ds_read_b64_tr_b16 a[96:97], v12 offset:40960
  v_mfma_f32_16x16x32_bf16 a[28:31], a[116:119], a[204:207], a[28:31]
  s_waitcnt lgkmcnt(11)
  ds_read_b64_tr_b16 a[98:99], v12 offset:46080
  v_mfma_f32_16x16x32_bf16 a[32:35], a[120:123], a[200:203], a[32:35]
  ds_read_b64_tr_b16 a[100:101], v13 offset:40960
  buffer_load_dwordx4 a[184:187], v19, s[12:15], s33 offen offset:0
  v_mfma_f32_16x16x32_bf16 a[36:39], a[120:123], a[204:207], a[36:39]
  s_waitcnt lgkmcnt(11)
  ds_read_b64_tr_b16 a[102:103], v13 offset:46080
  v_mfma_f32_16x16x32_bf16 a[40:43], a[124:127], a[200:203], a[40:43]
  ds_read_b64_tr_b16 a[104:105], v12 offset:41024
  v_mfma_f32_16x16x32_bf16 a[44:47], a[124:127], a[204:207], a[44:47]
  s_waitcnt lgkmcnt(11)
  ds_read_b64_tr_b16 a[106:107], v12 offset:46144
  v_mfma_f32_16x16x32_bf16 a[48:51], a[80:83], a[200:203], a[48:51]
  ds_read_b64_tr_b16 a[108:109], v13 offset:41024
  buffer_load_dwordx4 a[188:191], v19, s[12:15], s33 offen offset:1024
  v_mfma_f32_16x16x32_bf16 a[52:55], a[80:83], a[204:207], a[52:55]
  s_waitcnt lgkmcnt(11)
  ds_read_b64_tr_b16 a[110:111], v13 offset:46144
  v_mfma_f32_16x16x32_bf16 a[56:59], a[84:87], a[200:203], a[56:59]
  s_add_u32 s33, s33, 2048
  ds_read_b64_tr_b16 a[112:113], v12 offset:41088
  v_mfma_f32_16x16x32_bf16 a[60:63], a[84:87], a[204:207], a[60:63]
  s_waitcnt lgkmcnt(11)
  ds_read_b64_tr_b16 a[114:115], v12 offset:46208
  v_mfma_f32_16x16x32_bf16 a[64:67], a[88:91], a[200:203], a[64:67]
  s_waitcnt vmcnt(31)
  ds_read_b64_tr_b16 a[116:117], v13 offset:41088
  v_mfma_f32_16x16x32_bf16 a[68:71], a[88:91], a[204:207], a[68:71]
  s_waitcnt lgkmcnt(11)
  ds_read_b64_tr_b16 a[118:119], v13 offset:46208
  v_mfma_f32_16x16x32_bf16 a[72:75], a[92:95], a[200:203], a[72:75]
  s_barrier
  ds_read_b64_tr_b16 a[120:121], v12 offset:41152
  v_mfma_f32_16x16x32_bf16 a[76:79], a[92:95], a[204:207], a[76:79]
  s_waitcnt lgkmcnt(11)
  ds_read_b64_tr_b16 a[122:123], v12 offset:46272
  v_mfma_f32_16x16x32_bf16 a[0:3], a[96:99], a[208:211], a[0:3]
  s_add_u32 m0, s31, 81920
  ds_read_b64_tr_b16 a[124:125], v13 offset:41152
  buffer_load_dwordx4 v14, s[8:11], s32 offen offset:0 lds
  v_mfma_f32_16x16x32_bf16 a[4:7], a[96:99], a[212:215], a[4:7]
  s_waitcnt lgkmcnt(11)
  ds_read_b64_tr_b16 a[126:127], v13 offset:46272
  v_mfma_f32_16x16x32_bf16 a[8:11], a[100:103], a[208:211], a[8:11]
  ds_read_b64_tr_b16 a[80:81], v12 offset:41216
  v_mfma_f32_16x16x32_bf16 a[12:15], a[100:103], a[212:215], a[12:15]
  s_waitcnt lgkmcnt(11)
  ds_read_b64_tr_b16 a[82:83], v12 offset:46336
  v_mfma_f32_16x16x32_bf16 a[16:19], a[104:107], a[208:211], a[16:19]
  ds_read_b64_tr_b16 a[84:85], v13 offset:41216
  buffer_load_dwordx4 v15, s[8:11], s32 offen offset:1024 lds
  v_mfma_f32_16x16x32_bf16 a[20:23], a[104:107], a[212:215], a[20:23]
  s_waitcnt lgkmcnt(11)
  ds_read_b64_tr_b16 a[86:87], v13 offset:46336
  v_mfma_f32_16x16x32_bf16 a[24:27], a[108:111], a[208:211], a[24:27]
  ds_read_b64_tr_b16 a[88:89], v12 offset:51200
  v_mfma_f32_16x16x32_bf16 a[28:31], a[108:111], a[212:215], a[28:31]
  s_waitcnt lgkmcnt(11)
  ds_read_b64_tr_b16 a[90:91], v12 offset:56320
  v_mfma_f32_16x16x32_bf16 a[32:35], a[112:115], a[208:211], a[32:35]
  ds_read_b64_tr_b16 a[92:93], v13 offset:51200
  buffer_load_dwordx4 v16, s[8:11], s32 offen offset:2048 lds
  v_mfma_f32_16x16x32_bf16 a[36:39], a[112:115], a[212:215], a[36:39]
  s_waitcnt lgkmcnt(11)
  ds_read_b64_tr_b16 a[94:95], v13 offset:56320
  v_mfma_f32_16x16x32_bf16 a[40:43], a[116:119], a[208:211], a[40:43]
  ds_read_b64_tr_b16 a[96:97], v12 offset:51264
  v_mfma_f32_16x16x32_bf16 a[44:47], a[116:119], a[212:215], a[44:47]
  s_waitcnt lgkmcnt(11)
  ds_read_b64_tr_b16 a[98:99], v12 offset:56384
  v_mfma_f32_16x16x32_bf16 a[48:51], a[120:123], a[208:211], a[48:51]
  ds_read_b64_tr_b16 a[100:101], v13 offset:51264
  buffer_load_dwordx4 v17, s[8:11], s32 offen offset:3072 lds
  v_mfma_f32_16x16x32_bf16 a[52:55], a[120:123], a[212:215], a[52:55]
  s_waitcnt lgkmcnt(11)
  ds_read_b64_tr_b16 a[102:103], v13 offset:56384
  v_mfma_f32_16x16x32_bf16 a[56:59], a[124:127], a[208:211], a[56:59]
  s_add_u32 m0, s31, 86016
  ds_read_b64_tr_b16 a[104:105], v12 offset:51328
  v_mfma_f32_16x16x32_bf16 a[60:63], a[124:127], a[212:215], a[60:63]
  s_waitcnt lgkmcnt(11)
  ds_read_b64_tr_b16 a[106:107], v12 offset:56448
  v_mfma_f32_16x16x32_bf16 a[64:67], a[80:83], a[208:211], a[64:67]
  ds_read_b64_tr_b16 a[108:109], v13 offset:51328
  buffer_load_dwordx4 v18, s[8:11], s32 offen lds
  v_mfma_f32_16x16x32_bf16 a[68:71], a[80:83], a[212:215], a[68:71]
  s_waitcnt lgkmcnt(11)
  ds_read_b64_tr_b16 a[110:111], v13 offset:56448
  v_mfma_f32_16x16x32_bf16 a[72:75], a[84:87], a[208:211], a[72:75]
  s_waitcnt vmcnt(41)
  ds_read_b64_tr_b16 a[112:113], v12 offset:51392
  v_mfma_f32_16x16x32_bf16 a[76:79], a[84:87], a[212:215], a[76:79]
  s_waitcnt lgkmcnt(11)
  ds_read_b64_tr_b16 a[114:115], v12 offset:56512
  v_mfma_f32_16x16x32_bf16 a[0:3], a[88:91], a[216:219], a[0:3]
  s_add_u32 s32, s32, 81920
  ds_read_b64_tr_b16 a[116:117], v13 offset:51392
  buffer_load_dwordx4 a[192:195], v19, s[12:15], s33 offen offset:0
  v_mfma_f32_16x16x32_bf16 a[4:7], a[88:91], a[220:223], a[4:7]
  s_waitcnt lgkmcnt(11)
  ds_read_b64_tr_b16 a[118:119], v13 offset:56512
  v_mfma_f32_16x16x32_bf16 a[8:11], a[92:95], a[216:219], a[8:11]
  ds_read_b64_tr_b16 a[120:121], v12 offset:51456
  v_mfma_f32_16x16x32_bf16 a[12:15], a[92:95], a[220:223], a[12:15]
  s_waitcnt lgkmcnt(11)
  ds_read_b64_tr_b16 a[122:123], v12 offset:56576
  v_mfma_f32_16x16x32_bf16 a[16:19], a[96:99], a[216:219], a[16:19]
  ds_read_b64_tr_b16 a[124:125], v13 offset:51456
  buffer_load_dwordx4 a[196:199], v19, s[12:15], s33 offen offset:1024
  v_mfma_f32_16x16x32_bf16 a[20:23], a[96:99], a[220:223], a[20:23]
  s_waitcnt lgkmcnt(11)
  ds_read_b64_tr_b16 a[126:127], v13 offset:56576
  v_mfma_f32_16x16x32_bf16 a[24:27], a[100:103], a[216:219], a[24:27]
  s_add_u32 s33, s33, 2048
  ds_read_b64_tr_b16 a[80:81], v10 offset:0
  v_mfma_f32_16x16x32_bf16 a[28:31], a[100:103], a[220:223], a[28:31]
  s_waitcnt lgkmcnt(11)
  ds_read_b64_tr_b16 a[82:83], v10 offset:5120
  v_mfma_f32_16x16x32_bf16 a[32:35], a[104:107], a[216:219], a[32:35]
  ds_read_b64_tr_b16 a[84:85], v11 offset:0
  buffer_load_dwordx4 a[200:203], v19, s[12:15], s33 offen offset:0
  v_mfma_f32_16x16x32_bf16 a[36:39], a[104:107], a[220:223], a[36:39]
  s_waitcnt lgkmcnt(11)
  ds_read_b64_tr_b16 a[86:87], v11 offset:5120
  v_mfma_f32_16x16x32_bf16 a[40:43], a[108:111], a[216:219], a[40:43]
  ds_read_b64_tr_b16 a[88:89], v10 offset:64
  v_mfma_f32_16x16x32_bf16 a[44:47], a[108:111], a[220:223], a[44:47]
  s_waitcnt lgkmcnt(11)
  ds_read_b64_tr_b16 a[90:91], v10 offset:5184
  v_mfma_f32_16x16x32_bf16 a[48:51], a[112:115], a[216:219], a[48:51]
  ds_read_b64_tr_b16 a[92:93], v11 offset:64
  buffer_load_dwordx4 a[204:207], v19, s[12:15], s33 offen offset:1024
  v_mfma_f32_16x16x32_bf16 a[52:55], a[112:115], a[220:223], a[52:55]
  s_waitcnt lgkmcnt(11)
  ds_read_b64_tr_b16 a[94:95], v11 offset:5184
  v_mfma_f32_16x16x32_bf16 a[56:59], a[116:119], a[216:219], a[56:59]
  s_add_u32 s33, s33, 2048
  ds_read_b64_tr_b16 a[96:97], v10 offset:128
  v_mfma_f32_16x16x32_bf16 a[60:63], a[116:119], a[220:223], a[60:63]
  s_waitcnt lgkmcnt(11)
  ds_read_b64_tr_b16 a[98:99], v10 offset:5248
  v_mfma_f32_16x16x32_bf16 a[64:67], a[120:123], a[216:219], a[64:67]
  s_waitcnt vmcnt(31)
  ds_read_b64_tr_b16 a[100:101], v11 offset:128
  v_mfma_f32_16x16x32_bf16 a[68:71], a[120:123], a[220:223], a[68:71]
  s_waitcnt lgkmcnt(11)
  ds_read_b64_tr_b16 a[102:103], v11 offset:5248
  v_mfma_f32_16x16x32_bf16 a[72:75], a[124:127], a[216:219], a[72:75]
  s_barrier
  ds_read_b64_tr_b16 a[104:105], v10 offset:192
  v_mfma_f32_16x16x32_bf16 a[76:79], a[124:127], a[220:223], a[76:79]
  s_waitcnt lgkmcnt(11)
  ds_read_b64_tr_b16 a[106:107], v10 offset:5312
  s_mov_b32 s36, 2
.p2align 6
L_k3_loop:
  v_mfma_f32_16x16x32_bf16 a[0:3], a[80:83], a[128:131], a[0:3]
  s_add_u32 m0, s31, 102400
  ds_read_b64_tr_b16 a[108:109], v11 offset:192
  buffer_load_dwordx4 v14, s[8:11], s32 offen offset:0 lds
  v_mfma_f32_16x16x32_bf16 a[4:7], a[80:83], a[132:135], a[4:7]
  s_waitcnt lgkmcnt(11)
  ds_read_b64_tr_b16 a[110:111], v11 offset:5312
  v_mfma_f32_16x16x32_bf16 a[8:11], a[84:87], a[128:131], a[8:11]
  ds_read_b64_tr_b16 a[112:113], v10 offset:256
  v_mfma_f32_16x16x32_bf16 a[12:15], a[84:87], a[132:135], a[12:15]
  s_waitcnt lgkmcnt(11)
  ds_read_b64_tr_b16 a[114:115], v10 offset:5376
  v_mfma_f32_16x16x32_bf16 a[16:19], a[88:91], a[128:131], a[16:19]
  ds_read_b64_tr_b16 a[116:117], v11 offset:256
  buffer_load_dwordx4 v15, s[8:11], s32 offen offset:1024 lds
  v_mfma_f32_16x16x32_bf16 a[20:23], a[88:91], a[132:135], a[20:23]
  s_waitcnt lgkmcnt(11)
  ds_read_b64_tr_b16 a[118:119], v11 offset:5376
  v_mfma_f32_16x16x32_bf16 a[24:27], a[92:95], a[128:131], a[24:27]
  ds_read_b64_tr_b16 a[120:121], v10 offset:10240
  v_mfma_f32_16x16x32_bf16 a[28:31], a[92:95], a[132:135], a[28:31]
  s_waitcnt lgkmcnt(11)
  ds_read_b64_tr_b16 a[122:123], v10 offset:15360
  v_mfma_f32_16x16x32_bf16 a[32:35], a[96:99], a[128:131], a[32:35]
  ds_read_b64_tr_b16 a[124:125], v11 offset:10240
  buffer_load_dwordx4 v16, s[8:11], s32 offen offset:2048 lds
  v_mfma_f32_16x16x32_bf16 a[36:39], a[96:99], a[132:135], a[36:39]
  s_waitcnt lgkmcnt(11)
  ds_read_b64_tr_b16 a[126:127], v11 offset:15360
  v_mfma_f32_16x16x32_bf16 a[40:43], a[100:103], a[128:131], a[40:43]
  ds_read_b64_tr_b16 a[80:81], v10 offset:10304
  v_mfma_f32_16x16x32_bf16 a[44:47], a[100:103], a[132:135], a[44:47]
  s_waitcnt lgkmcnt(11)
  ds_read_b64_tr_b16 a[82:83], v10 offset:15424
  v_mfma_f32_16x16x32_bf16 a[48:51], a[104:107], a[128:131], a[48:51]
  ds_read_b64_tr_b16 a[84:85], v11 offset:10304
  buffer_load_dwordx4 v17, s[8:11], s32 offen offset:3072 lds
  v_mfma_f32_16x16x32_bf16 a[52:55], a[104:107], a[132:135], a[52:55]
  s_waitcnt lgkmcnt(11)
  ds_read_b64_tr_b16 a[86:87], v11 offset:15424
  v_mfma_f32_16x16x32_bf16 a[56:59], a[108:111], a[128:131], a[56:59]
  s_add_u32 m0, s31, 106496
  ds_read_b64_tr_b16 a[88:89], v10 offset:10368
  v_mfma_f32_16x16x32_bf16 a[60:63], a[108:111], a[132:135], a[60:63]
  s_waitcnt lgkmcnt(11)
  ds_read_b64_tr_b16 a[90:91], v10 offset:15488
  v_mfma_f32_16x16x32_bf16 a[64:67], a[112:115], a[128:131], a[64:67]
  ds_read_b64_tr_b16 a[92:93], v11 offset:10368
  buffer_load_dwordx4 v18, s[8:11], s32 offen lds
  v_mfma_f32_16x16x32_bf16 a[68:71], a[112:115], a[132:135], a[68:71]
  s_waitcnt lgkmcnt(11)
  ds_read_b64_tr_b16 a[94:95], v11 offset:15488
  v_mfma_f32_16x16x32_bf16 a[72:75], a[116:119], a[128:131], a[72:75]
  s_waitcnt vmcnt(41)
  ds_read_b64_tr_b16 a[96:97], v10 offset:10432
  v_mfma_f32_16x16x32_bf16 a[76:79], a[116:119], a[132:135], a[76:79]
  s_waitcnt lgkmcnt(11)
  ds_read_b64_tr_b16 a[98:99], v10 offset:15552
  v_mfma_f32_16x16x32_bf16 a[0:3], a[120:123], a[136:139], a[0:3]
  s_add_u32 s32, s32, 81920
  ds_read_b64_tr_b16 a[100:101], v11 offset:10432
  buffer_load_dwordx4 a[208:211], v19, s[12:15], s33 offen offset:0
  v_mfma_f32_16x16x32_bf16 a[4:7], a[120:123], a[140:143], a[4:7]
  s_waitcnt lgkmcnt(11)
  ds_read_b64_tr_b16 a[102:103], v11 offset:15552
  v_mfma_f32_16x16x32_bf16 a[8:11], a[124:127], a[136:139], a[8:11]
  ds_read_b64_tr_b16 a[104:105], v10 offset:10496
  v_mfma_f32_16x16x32_bf16 a[12:15], a[124:127], a[140:143], a[12:15]
  s_waitcnt lgkmcnt(11)
  ds_read_b64_tr_b16 a[106:107], v10 offset:15616
  v_mfma_f32_16x16x32_bf16 a[16:19], a[80:83], a[136:139], a[16:19]
  ds_read_b64_tr_b16 a[108:109], v11 offset:10496
  buffer_load_dwordx4 a[212:215], v19, s[12:15], s33 offen offset:1024
  v_mfma_f32_16x16x32_bf16 a[20:23], a[80:83], a[140:143], a[20:23]
  s_waitcnt lgkmcnt(11)
  ds_read_b64_tr_b16 a[110:111], v11 offset:15616
  v_mfma_f32_16x16x32_bf16 a[24:27], a[84:87], a[136:139], a[24:27]
  s_add_u32 s33, s33, 2048
  ds_read_b64_tr_b16 a[112:113], v10 offset:20480
  v_mfma_f32_16x16x32_bf16 a[28:31], a[84:87], a[140:143], a[28:31]
  s_waitcnt lgkmcnt(11)
  ds_read_b64_tr_b16 a[114:115], v10 offset:25600
  v_mfma_f32_16x16x32_bf16 a[32:35], a[88:91], a[136:139], a[32:35]
  ds_read_b64_tr_b16 a[116:117], v11 offset:20480
  buffer_load_dwordx4 a[216:219], v19, s[12:15], s33 offen offset:0
  v_mfma_f32_16x16x32_bf16 a[36:39], a[88:91], a[140:143], a[36:39]
  s_waitcnt lgkmcnt(11)
  ds_read_b64_tr_b16 a[118:119], v11 offset:25600
  v_mfma_f32_16x16x32_bf16 a[40:43], a[92:95], a[136:139], a[40:43]
  ds_read_b64_tr_b16 a[120:121], v10 offset:20544
  v_mfma_f32_16x16x32_bf16 a[44:47], a[92:95], a[140:143], a[44:47]
  s_waitcnt lgkmcnt(11)
  ds_read_b64_tr_b16 a[122:123], v10 offset:25664
  v_mfma_f32_16x16x32_bf16 a[48:51], a[96:99], a[136:139], a[48:51]
  ds_read_b64_tr_b16 a[124:125], v11 offset:20544
  buffer_load_dwordx4 a[220:223], v19, s[12:15], s33 offen offset:1024
  v_mfma_f32_16x16x32_bf16 a[52:55], a[96:99], a[140:143], a[52:55]
  s_waitcnt lgkmcnt(11)
  ds_read_b64_tr_b16 a[126:127], v11 offset:25664
  v_mfma_f32_16x16x32_bf16 a[56:59], a[100:103], a[136:139], a[56:59]
  s_add_u32 s33, s33, 2048
  ds_read_b64_tr_b16 a[80:81], v10 offset:20608
  v_mfma_f32_16x16x32_bf16 a[60:63], a[100:103], a[140:143], a[60:63]
  s_waitcnt lgkmcnt(11)
  ds_read_b64_tr_b16 a[82:83], v10 offset:25728
  v_mfma_f32_16x16x32_bf16 a[64:67], a[104:107], a[136:139], a[64:67]
  s_waitcnt vmcnt(31)
  ds_read_b64_tr_b16 a[84:85], v11 offset:20608
  v_mfma_f32_16x16x32_bf16 a[68:71], a[104:107], a[140:143], a[68:71]
  s_waitcnt lgkmcnt(11)
  ds_read_b64_tr_b16 a[86:87], v11 offset:25728
  v_mfma_f32_16x16x32_bf16 a[72:75], a[108:111], a[136:139], a[72:75]
  s_barrier
  ds_read_b64_tr_b16 a[88:89], v10 offset:20672
  v_mfma_f32_16x16x32_bf16 a[76:79], a[108:111], a[140:143], a[76:79]
  s_waitcnt lgkmcnt(11)
  ds_read_b64_tr_b16 a[90:91], v10 offset:25792
  v_mfma_f32_16x16x32_bf16 a[0:3], a[112:115], a[144:147], a[0:3]
  s_add_u32 m0, s31, 0
  ds_read_b64_tr_b16 a[92:93], v11 offset:20672
  buffer_load_dwordx4 v14, s[8:11], s32 offen offset:0 lds
  v_mfma_f32_16x16x32_bf16 a[4:7], a[112:115], a[148:151], a[4:7]
  s_waitcnt lgkmcnt(11)
  ds_read_b64_tr_b16 a[94:95], v11 offset:25792
  v_mfma_f32_16x16x32_bf16 a[8:11], a[116:119], a[144:147], a[8:11]
  ds_read_b64_tr_b16 a[96:97], v10 offset:20736
  v_mfma_f32_16x16x32_bf16 a[12:15], a[116:119], a[148:151], a[12:15]
  s_waitcnt lgkmcnt(11)
  ds_read_b64_tr_b16 a[98:99], v10 offset:25856
  v_mfma_f32_16x16x32_bf16 a[16:19], a[120:123], a[144:147], a[16:19]
  ds_read_b64_tr_b16 a[100:101], v11 offset:20736
  buffer_load_dwordx4 v15, s[8:11], s32 offen offset:1024 lds
  v_mfma_f32_16x16x32_bf16 a[20:23], a[120:123], a[148:151], a[20:23]
  s_waitcnt lgkmcnt(11)
  ds_read_b64_tr_b16 a[102:103], v11 offset:25856
  v_mfma_f32_16x16x32_bf16 a[24:27], a[124:127], a[144:147], a[24:27]
  ds_read_b64_tr_b16 a[104:105], v10 offset:30720
  v_mfma_f32_16x16x32_bf16 a[28:31], a[124:127], a[148:151], a[28:31]
  s_waitcnt lgkmcnt(11)
  ds_read_b64_tr_b16 a[106:107], v10 offset:35840
  v_mfma_f32_16x16x32_bf16 a[32:35], a[80:83], a[144:147], a[32:35]
  ds_read_b64_tr_b16 a[108:109], v11 offset:30720
  buffer_load_dwordx4 v16, s[8:11], s32 offen offset:2048 lds
  v_mfma_f32_16x16x32_bf16 a[36:39], a[80:83], a[148:151], a[36:39]
  s_waitcnt lgkmcnt(11)
  ds_read_b64_tr_b16 a[110:111], v11 offset:35840
  v_mfma_f32_16x16x32_bf16 a[40:43], a[84:87], a[144:147], a[40:43]
  ds_read_b64_tr_b16 a[112:113], v10 offset:30784
  v_mfma_f32_16x16x32_bf16 a[44:47], a[84:87], a[148:151], a[44:47]
  s_waitcnt lgkmcnt(11)
  ds_read_b64_tr_b16 a[114:115], v10 offset:35904
  v_mfma_f32_16x16x32_bf16 a[48:51], a[88:91], a[144:147], a[48:51]
  ds_read_b64_tr_b16 a[116:117], v11 offset:30784
  buffer_load_dwordx4 v17, s[8:11], s32 offen offset:3072 lds
  v_mfma_f32_16x16x32_bf16 a[52:55], a[88:91], a[148:151], a[52:55]
  s_waitcnt lgkmcnt(11)
  ds_read_b64_tr_b16 a[118:119], v11 offset:35904
  v_mfma_f32_16x16x32_bf16 a[56:59], a[92:95], a[144:147], a[56:59]
  s_add_u32 m0, s31, 4096
  ds_read_b64_tr_b16 a[120:121], v10 offset:30848
  v_mfma_f32_16x16x32_bf16 a[60:63], a[92:95], a[148:151], a[60:63]
  s_waitcnt lgkmcnt(11)
  ds_read_b64_tr_b16 a[122:123], v10 offset:35968
  v_mfma_f32_16x16x32_bf16 a[64:67], a[96:99], a[144:147], a[64:67]
  ds_read_b64_tr_b16 a[124:125], v11 offset:30848
  buffer_load_dwordx4 v18, s[8:11], s32 offen lds
  v_mfma_f32_16x16x32_bf16 a[68:71], a[96:99], a[148:151], a[68:71]
  s_waitcnt lgkmcnt(11)
  ds_read_b64_tr_b16 a[126:127], v11 offset:35968
  v_mfma_f32_16x16x32_bf16 a[72:75], a[100:103], a[144:147], a[72:75]
  s_waitcnt vmcnt(41)
  ds_read_b64_tr_b16 a[80:81], v10 offset:30912
  v_mfma_f32_16x16x32_bf16 a[76:79], a[100:103], a[148:151], a[76:79]
  s_waitcnt lgkmcnt(11)
  ds_read_b64_tr_b16 a[82:83], v10 offset:36032
  v_mfma_f32_16x16x32_bf16 a[0:3], a[104:107], a[152:155], a[0:3]
  s_add_u32 s32, s32, 81920
  ds_read_b64_tr_b16 a[84:85], v11 offset:30912
  buffer_load_dwordx4 a[128:131], v19, s[12:15], s33 offen offset:0
  v_mfma_f32_16x16x32_bf16 a[4:7], a[104:107], a[156:159], a[4:7]
  s_waitcnt lgkmcnt(11)
  ds_read_b64_tr_b16 a[86:87], v11 offset:36032
  v_mfma_f32_16x16x32_bf16 a[8:11], a[108:111], a[152:155], a[8:11]
  ds_read_b64_tr_b16 a[88:89], v10 offset:30976
  v_mfma_f32_16x16x32_bf16 a[12:15], a[108:111], a[156:159], a[12:15]
  s_waitcnt lgkmcnt(11)
  ds_read_b64_tr_b16 a[90:91], v10 offset:36096
  v_mfma_f32_16x16x32_bf16 a[16:19], a[112:115], a[152:155], a[16:19]
  ds_read_b64_tr_b16 a[92:93], v11 offset:30976
  buffer_load_dwordx4 a[132:135], v19, s[12:15], s33 offen offset:1024
  v_mfma_f32_16x16x32_bf16 a[20:23], a[112:115], a[156:159], a[20:23]
  s_waitcnt lgkmcnt(11)
  ds_read_b64_tr_b16 a[94:95], v11 offset:36096
  v_mfma_f32_16x16x32_bf16 a[24:27], a[116:119], a[152:155], a[24:27]
  s_add_u32 s33, s33, 2048
  ds_read_b64_tr_b16 a[96:97], v10 offset:40960
  v_mfma_f32_16x16x32_bf16 a[28:31], a[116:119], a[156:159], a[28:31]
  s_waitcnt lgkmcnt(11)
  ds_read_b64_tr_b16 a[98:99], v10 offset:46080
  v_mfma_f32_16x16x32_bf16 a[32:35], a[120:123], a[152:155], a[32:35]
  ds_read_b64_tr_b16 a[100:101], v11 offset:40960
  buffer_load_dwordx4 a[136:139], v19, s[12:15], s33 offen offset:0
  v_mfma_f32_16x16x32_bf16 a[36:39], a[120:123], a[156:159], a[36:39]
  s_waitcnt lgkmcnt(11)
  ds_read_b64_tr_b16 a[102:103], v11 offset:46080
  v_mfma_f32_16x16x32_bf16 a[40:43], a[124:127], a[152:155], a[40:43]
  ds_read_b64_tr_b16 a[104:105], v10 offset:41024
  v_mfma_f32_16x16x32_bf16 a[44:47], a[124:127], a[156:159], a[44:47]
  s_waitcnt lgkmcnt(11)
  ds_read_b64_tr_b16 a[106:107], v10 offset:46144
  v_mfma_f32_16x16x32_bf16 a[48:51], a[80:83], a[152:155], a[48:51]
  ds_read_b64_tr_b16 a[108:109], v11 offset:41024
  buffer_load_dwordx4 a[140:143], v19, s[12:15], s33 offen offset:1024
  v_mfma_f32_16x16x32_bf16 a[52:55], a[80:83], a[156:159], a[52:55]
  s_waitcnt lgkmcnt(11)
  ds_read_b64_tr_b16 a[110:111], v11 offset:46144
  v_mfma_f32_16x16x32_bf16 a[56:59], a[84:87], a[152:155], a[56:59]
  s_add_u32 s33, s33, 2048
  ds_read_b64_tr_b16 a[112:113], v10 offset:41088
  v_mfma_f32_16x16x32_bf16 a[60:63], a[84:87], a[156:159], a[60:63]
  s_waitcnt lgkmcnt(11)
  ds_read_b64_tr_b16 a[114:115], v10 offset:46208
  v_mfma_f32_16x16x32_bf16 a[64:67], a[88:91], a[152:155], a[64:67]
  s_waitcnt vmcnt(31)
  ds_read_b64_tr_b16 a[116:117], v11 offset:41088
  v_mfma_f32_16x16x32_bf16 a[68:71], a[88:91], a[156:159], a[68:71]
  s_waitcnt lgkmcnt(11)
  ds_read_b64_tr_b16 a[118:119], v11 offset:46208
  v_mfma_f32_16x16x32_bf16 a[72:75], a[92:95], a[152:155], a[72:75]
  s_barrier
  ds_read_b64_tr_b16 a[120:121], v10 offset:41152
  v_mfma_f32_16x16x32_bf16 a[76:79], a[92:95], a[156:159], a[76:79]
  s_waitcnt lgkmcnt(11)
  ds_read_b64_tr_b16 a[122:123], v10 offset:46272
  v_mfma_f32_16x16x32_bf16 a[0:3], a[96:99], a[160:163], a[0:3]
  s_add_u32 m0, s31, 20480
  ds_read_b64_tr_b16 a[124:125], v11 offset:41152
  buffer_load_dwordx4 v14, s[8:11], s32 offen offset:0 lds
  v_mfma_f32_16x16x32_bf16 a[4:7], a[96:99], a[164:167], a[4:7]
  s_waitcnt lgkmcnt(11)
  ds_read_b64_tr_b16 a[126:127], v11 offset:46272
  v_mfma_f32_16x16x32_bf16 a[8:11], a[100:103], a[160:163], a[8:11]
  ds_read_b64_tr_b16 a[80:81], v10 offset:41216
  v_mfma_f32_16x16x32_bf16 a[12:15], a[100:103], a[164:167], a[12:15]
  s_waitcnt lgkmcnt(11)
  ds_read_b64_tr_b16 a[82:83], v10 offset:46336
  v_mfma_f32_16x16x32_bf16 a[16:19], a[104:107], a[160:163], a[16:19]
  ds_read_b64_tr_b16 a[84:85], v11 offset:41216
  buffer_load_dwordx4 v15, s[8:11], s32 offen offset:1024 lds
  v_mfma_f32_16x16x32_bf16 a[20:23], a[104:107], a[164:167], a[20:23]
  s_waitcnt lgkmcnt(11)
  ds_read_b64_tr_b16 a[86:87], v11 offset:46336
  v_mfma_f32_16x16x32_bf16 a[24:27], a[108:111], a[160:163], a[24:27]
  ds_read_b64_tr_b16 a[88:89], v10 offset:51200
  v_mfma_f32_16x16x32_bf16 a[28:31], a[108:111], a[164:167], a[28:31]
  s_waitcnt lgkmcnt(11)
  ds_read_b64_tr_b16 a[90:91], v10 offset:56320
  v_mfma_f32_16x16x32_bf16 a[32:35], a[112:115], a[160:163], a[32:35]
  ds_read_b64_tr_b16 a[92:93], v11 offset:51200
  buffer_load_dwordx4 v16, s[8:11], s32 offen offset:2048 lds
  v_mfma_f32_16x16x32_bf16 a[36:39], a[112:115], a[164:167], a[36:39]
  s_waitcnt lgkmcnt(11)
  ds_read_b64_tr_b16 a[94:95], v11 offset:56320
  v_mfma_f32_16x16x32_bf16 a[40:43], a[116:119], a[160:163], a[40:43]
  ds_read_b64_tr_b16 a[96:97], v10 offset:51264
  v_mfma_f32_16x16x32_bf16 a[44:47], a[116:119], a[164:167], a[44:47]
  s_waitcnt lgkmcnt(11)
  ds_read_b64_tr_b16 a[98:99], v10 offset:56384
  v_mfma_f32_16x16x32_bf16 a[48:51], a[120:123], a[160:163], a[48:51]
  ds_read_b64_tr_b16 a[100:101], v11 offset:51264
  buffer_load_dwordx4 v17, s[8:11], s32 offen offset:3072 lds
  v_mfma_f32_16x16x32_bf16 a[52:55], a[120:123], a[164:167], a[52:55]
  s_waitcnt lgkmcnt(11)
  ds_read_b64_tr_b16 a[102:103], v11 offset:56384
  v_mfma_f32_16x16x32_bf16 a[56:59], a[124:127], a[160:163], a[56:59]
  s_add_u32 m0, s31, 24576
  ds_read_b64_tr_b16 a[104:105], v10 offset:51328
  v_mfma_f32_16x16x32_bf16 a[60:63], a[124:127], a[164:167], a[60:63]
  s_waitcnt lgkmcnt(11)
  ds_read_b64_tr_b16 a[106:107], v10 offset:56448
  v_mfma_f32_16x16x32_bf16 a[64:67], a[80:83], a[160:163], a[64:67]
  ds_read_b64_tr_b16 a[108:109], v11 offset:51328
  buffer_load_dwordx4 v18, s[8:11], s32 offen lds
  v_mfma_f32_16x16x32_bf16 a[68:71], a[80:83], a[164:167], a[68:71]
  s_waitcnt lgkmcnt(11)
  ds_read_b64_tr_b16 a[110:111], v11 offset:56448
  v_mfma_f32_16x16x32_bf16 a[72:75], a[84:87], a[160:163], a[72:75]
  s_waitcnt vmcnt(41)
  ds_read_b64_tr_b16 a[112:113], v10 offset:51392
  v_mfma_f32_16x16x32_bf16 a[76:79], a[84:87], a[164:167], a[76:79]
  s_waitcnt lgkmcnt(11)
  ds_read_b64_tr_b16 a[114:115], v10 offset:56512
  v_mfma_f32_16x16x32_bf16 a[0:3], a[88:91], a[168:171], a[0:3]
  s_add_u32 s32, s32, 81920
  ds_read_b64_tr_b16 a[116:117], v11 offset:51392
  buffer_load_dwordx4 a[144:147], v19, s[12:15], s33 offen offset:0
  v_mfma_f32_16x16x32_bf16 a[4:7], a[88:91], a[172:175], a[4:7]
  s_waitcnt lgkmcnt(11)
  ds_read_b64_tr_b16 a[118:119], v11 offset:56512
  v_mfma_f32_16x16x32_bf16 a[8:11], a[92:95], a[168:171], a[8:11]
  ds_read_b64_tr_b16 a[120:121], v10 offset:51456
  v_mfma_f32_16x16x32_bf16 a[12:15], a[92:95], a[172:175], a[12:15]
  s_waitcnt lgkmcnt(11)
  ds_read_b64_tr_b16 a[122:123], v10 offset:56576
  v_mfma_f32_16x16x32_bf16 a[16:19], a[96:99], a[168:171], a[16:19]
  ds_read_b64_tr_b16 a[124:125], v11 offset:51456
  buffer_load_dwordx4 a[148:151], v19, s[12:15], s33 offen offset:1024
  v_mfma_f32_16x16x32_bf16 a[20:23], a[96:99], a[172:175], a[20:23]
  s_waitcnt lgkmcnt(11)
  ds_read_b64_tr_b16 a[126:127], v11 offset:56576
  v_mfma_f32_16x16x32_bf16 a[24:27], a[100:103], a[168:171], a[24:27]
  s_add_u32 s33, s33, 2048
  ds_read_b64_tr_b16 a[80:81], v12 offset:0
  v_mfma_f32_16x16x32_bf16 a[28:31], a[100:103], a[172:175], a[28:31]
  s_waitcnt lgkmcnt(11)
  ds_read_b64_tr_b16 a[82:83], v12 offset:5120
  v_mfma_f32_16x16x32_bf16 a[32:35], a[104:107], a[168:171], a[32:35]
  ds_read_b64_tr_b16 a[84:85], v13 offset:0
  buffer_load_dwordx4 a[152:155], v19, s[12:15], s33 offen offset:0
  v_mfma_f32_16x16x32_bf16 a[36:39], a[104:107], a[172:175], a[36:39]
  s_waitcnt lgkmcnt(11)
  ds_read_b64_tr_b16 a[86:87], v13 offset:5120
  v_mfma_f32_16x16x32_bf16 a[40:43], a[108:111], a[168:171], a[40:43]
  ds_read_b64_tr_b16 a[88:89], v12 offset:64
  v_mfma_f32_16x16x32_bf16 a[44:47], a[108:111], a[172:175], a[44:47]
  s_waitcnt lgkmcnt(11)
  ds_read_b64_tr_b16 a[90:91], v12 offset:5184
  v_mfma_f32_16x16x32_bf16 a[48:51], a[112:115], a[168:171], a[48:51]
  ds_read_b64_tr_b16 a[92:93], v13 offset:64
  buffer_load_dwordx4 a[156:159], v19, s[12:15], s33 offen offset:1024
  v_mfma_f32_16x16x32_bf16 a[52:55], a[112:115], a[172:175], a[52:55]
  s_waitcnt lgkmcnt(11)
  ds_read_b64_tr_b16 a[94:95], v13 offset:5184
  v_mfma_f32_16x16x32_bf16 a[56:59], a[116:119], a[168:171], a[56:59]
  s_add_u32 s33, s33, 2048
  ds_read_b64_tr_b16 a[96:97], v12 offset:128
  v_mfma_f32_16x16x32_bf16 a[60:63], a[116:119], a[172:175], a[60:63]
  s_waitcnt lgkmcnt(11)
  ds_read_b64_tr_b16 a[98:99], v12 offset:5248
  v_mfma_f32_16x16x32_bf16 a[64:67], a[120:123], a[168:171], a[64:67]
  s_waitcnt vmcnt(31)
  ds_read_b64_tr_b16 a[100:101], v13 offset:128
  v_mfma_f32_16x16x32_bf16 a[68:71], a[120:123], a[172:175], a[68:71]
  s_waitcnt lgkmcnt(11)
  ds_read_b64_tr_b16 a[102:103], v13 offset:5248
  v_mfma_f32_16x16x32_bf16 a[72:75], a[124:127], a[168:171], a[72:75]
  s_barrier
  ds_read_b64_tr_b16 a[104:105], v12 offset:192
  v_mfma_f32_16x16x32_bf16 a[76:79], a[124:127], a[172:175], a[76:79]
  s_waitcnt lgkmcnt(11)
  ds_read_b64_tr_b16 a[106:107], v12 offset:5312
  v_mfma_f32_16x16x32_bf16 a[0:3], a[80:83], a[176:179], a[0:3]
  s_add_u32 m0, s31, 40960
  ds_read_b64_tr_b16 a[108:109], v13 offset:192
  buffer_load_dwordx4 v14, s[8:11], s32 offen offset:0 lds
  v_mfma_f32_16x16x32_bf16 a[4:7], a[80:83], a[180:183], a[4:7]
  s_waitcnt lgkmcnt(11)
  ds_read_b64_tr_b16 a[110:111], v13 offset:5312
  v_mfma_f32_16x16x32_bf16 a[8:11], a[84:87], a[176:179], a[8:11]
  ds_read_b64_tr_b16 a[112:113], v12 offset:256
  v_mfma_f32_16x16x32_bf16 a[12:15], a[84:87], a[180:183], a[12:15]
  s_waitcnt lgkmcnt(11)
  ds_read_b64_tr_b16 a[114:115], v12 offset:5376
  v_mfma_f32_16x16x32_bf16 a[16:19], a[88:91], a[176:179], a[16:19]
  ds_read_b64_tr_b16 a[116:117], v13 offset:256
  buffer_load_dwordx4 v15, s[8:11], s32 offen offset:1024 lds
  v_mfma_f32_16x16x32_bf16 a[20:23], a[88:91], a[180:183], a[20:23]
  s_waitcnt lgkmcnt(11)
  ds_read_b64_tr_b16 a[118:119], v13 offset:5376
  v_mfma_f32_16x16x32_bf16 a[24:27], a[92:95], a[176:179], a[24:27]
  ds_read_b64_tr_b16 a[120:121], v12 offset:10240
  v_mfma_f32_16x16x32_bf16 a[28:31], a[92:95], a[180:183], a[28:31]
  s_waitcnt lgkmcnt(11)
  ds_read_b64_tr_b16 a[122:123], v12 offset:15360
  v_mfma_f32_16x16x32_bf16 a[32:35], a[96:99], a[176:179], a[32:35]
  ds_read_b64_tr_b16 a[124:125], v13 offset:10240
  buffer_load_dwordx4 v16, s[8:11], s32 offen offset:2048 lds
  v_mfma_f32_16x16x32_bf16 a[36:39], a[96:99], a[180:183], a[36:39]
  s_waitcnt lgkmcnt(11)
  ds_read_b64_tr_b16 a[126:127], v13 offset:15360
  v_mfma_f32_16x16x32_bf16 a[40:43], a[100:103], a[176:179], a[40:43]
  ds_read_b64_tr_b16 a[80:81], v12 offset:10304
  v_mfma_f32_16x16x32_bf16 a[44:47], a[100:103], a[180:183], a[44:47]
  s_waitcnt lgkmcnt(11)
  ds_read_b64_tr_b16 a[82:83], v12 offset:15424
  v_mfma_f32_16x16x32_bf16 a[48:51], a[104:107], a[176:179], a[48:51]
  ds_read_b64_tr_b16 a[84:85], v13 offset:10304
  buffer_load_dwordx4 v17, s[8:11], s32 offen offset:3072 lds
  v_mfma_f32_16x16x32_bf16 a[52:55], a[104:107], a[180:183], a[52:55]
  s_waitcnt lgkmcnt(11)
  ds_read_b64_tr_b16 a[86:87], v13 offset:15424
  v_mfma_f32_16x16x32_bf16 a[56:59], a[108:111], a[176:179], a[56:59]
  s_add_u32 m0, s31, 45056
  ds_read_b64_tr_b16 a[88:89], v12 offset:10368
  v_mfma_f32_16x16x32_bf16 a[60:63], a[108:111], a[180:183], a[60:63]
  s_waitcnt lgkmcnt(11)
  ds_read_b64_tr_b16 a[90:91], v12 offset:15488
  v_mfma_f32_16x16x32_bf16 a[64:67], a[112:115], a[176:179], a[64:67]
  ds_read_b64_tr_b16 a[92:93], v13 offset:10368
  buffer_load_dwordx4 v18, s[8:11], s32 offen lds
  v_mfma_f32_16x16x32_bf16 a[68:71], a[112:115], a[180:183], a[68:71]
  s_waitcnt lgkmcnt(11)
  ds_read_b64_tr_b16 a[94:95], v13 offset:15488
  v_mfma_f32_16x16x32_bf16 a[72:75], a[116:119], a[176:179], a[72:75]
  s_waitcnt vmcnt(41)
  ds_read_b64_tr_b16 a[96:97], v12 offset:10432
  v_mfma_f32_16x16x32_bf16 a[76:79], a[116:119], a[180:183], a[76:79]
  s_waitcnt lgkmcnt(11)
  ds_read_b64_tr_b16 a[98:99], v12 offset:15552
  v_mfma_f32_16x16x32_bf16 a[0:3], a[120:123], a[184:187], a[0:3]
  s_add_u32 s32, s32, 81920
  ds_read_b64_tr_b16 a[100:101], v13 offset:10432
  buffer_load_dwordx4 a[160:163], v19, s[12:15], s33 offen offset:0
  v_mfma_f32_16x16x32_bf16 a[4:7], a[120:123], a[188:191], a[4:7]
  s_waitcnt lgkmcnt(11)
  ds_read_b64_tr_b16 a[102:103], v13 offset:15552
  v_mfma_f32_16x16x32_bf16 a[8:11], a[124:127], a[184:187], a[8:11]
  ds_read_b64_tr_b16 a[104:105], v12 offset:10496
  v_mfma_f32_16x16x32_bf16 a[12:15], a[124:127], a[188:191], a[12:15]
  s_waitcnt lgkmcnt(11)
  ds_read_b64_tr_b16 a[106:107], v12 offset:15616
  v_mfma_f32_16x16x32_bf16 a[16:19], a[80:83], a[184:187], a[16:19]
  ds_read_b64_tr_b16 a[108:109], v13 offset:10496
  buffer_load_dwordx4 a[164:167], v19, s[12:15], s33 offen offset:1024
  v_mfma_f32_16x16x32_bf16 a[20:23], a[80:83], a[188:191], a[20:23]
  s_waitcnt lgkmcnt(11)
  ds_read_b64_tr_b16 a[110:111], v13 offset:15616
  v_mfma_f32_16x16x32_bf16 a[24:27], a[84:87], a[184:187], a[24:27]
  s_add_u32 s33, s33, 2048
  ds_read_b64_tr_b16 a[112:113], v12 offset:20480
  v_mfma_f32_16x16x32_bf16 a[28:31], a[84:87], a[188:191], a[28:31]
  s_waitcnt lgkmcnt(11)
  ds_read_b64_tr_b16 a[114:115], v12 offset:25600
  v_mfma_f32_16x16x32_bf16 a[32:35], a[88:91], a[184:187], a[32:35]
  ds_read_b64_tr_b16 a[116:117], v13 offset:20480
  buffer_load_dwordx4 a[168:171], v19, s[12:15], s33 offen offset:0
  v_mfma_f32_16x16x32_bf16 a[36:39], a[88:91], a[188:191], a[36:39]
  s_waitcnt lgkmcnt(11)
  ds_read_b64_tr_b16 a[118:119], v13 offset:25600
  v_mfma_f32_16x16x32_bf16 a[40:43], a[92:95], a[184:187], a[40:43]
  ds_read_b64_tr_b16 a[120:121], v12 offset:20544
  v_mfma_f32_16x16x32_bf16 a[44:47], a[92:95], a[188:191], a[44:47]
  s_waitcnt lgkmcnt(11)
  ds_read_b64_tr_b16 a[122:123], v12 offset:25664
  v_mfma_f32_16x16x32_bf16 a[48:51], a[96:99], a[184:187], a[48:51]
  ds_read_b64_tr_b16 a[124:125], v13 offset:20544
  buffer_load_dwordx4 a[172:175], v19, s[12:15], s33 offen offset:1024
  v_mfma_f32_16x16x32_bf16 a[52:55], a[96:99], a[188:191], a[52:55]
  s_waitcnt lgkmcnt(11)
  ds_read_b64_tr_b16 a[126:127], v13 offset:25664
  v_mfma_f32_16x16x32_bf16 a[56:59], a[100:103], a[184:187], a[56:59]
  s_add_u32 s33, s33, 2048
  ds_read_b64_tr_b16 a[80:81], v12 offset:20608
  v_mfma_f32_16x16x32_bf16 a[60:63], a[100:103], a[188:191], a[60:63]
  s_waitcnt lgkmcnt(11)
  ds_read_b64_tr_b16 a[82:83], v12 offset:25728
  v_mfma_f32_16x16x32_bf16 a[64:67], a[104:107], a[184:187], a[64:67]
  s_waitcnt vmcnt(31)
  ds_read_b64_tr_b16 a[84:85], v13 offset:20608
  v_mfma_f32_16x16x32_bf16 a[68:71], a[104:107], a[188:191], a[68:71]
  s_waitcnt lgkmcnt(11)
  ds_read_b64_tr_b16 a[86:87], v13 offset:25728
  v_mfma_f32_16x16x32_bf16 a[72:75], a[108:111], a[184:187], a[72:75]
  s_barrier
  ds_read_b64_tr_b16 a[88:89], v12 offset:20672
  v_mfma_f32_16x16x32_bf16 a[76:79], a[108:111], a[188:191], a[76:79]
  s_waitcnt lgkmcnt(11)
  ds_read_b64_tr_b16 a[90:91], v12 offset:25792
  v_mfma_f32_16x16x32_bf16 a[0:3], a[112:115], a[192:195], a[0:3]
  s_add_u32 m0, s31, 61440
  ds_read_b64_tr_b16 a[92:93], v13 offset:20672
  buffer_load_dwordx4 v14, s[8:11], s32 offen offset:0 lds
  v_mfma_f32_16x16x32_bf16 a[4:7], a[112:115], a[196:199], a[4:7]
  s_waitcnt lgkmcnt(11)
  ds_read_b64_tr_b16 a[94:95], v13 offset:25792
  v_mfma_f32_16x16x32_bf16 a[8:11], a[116:119], a[192:195], a[8:11]
  ds_read_b64_tr_b16 a[96:97], v12 offset:20736
  v_mfma_f32_16x16x32_bf16 a[12:15], a[116:119], a[196:199], a[12:15]
  s_waitcnt lgkmcnt(11)
  ds_read_b64_tr_b16 a[98:99], v12 offset:25856
  v_mfma_f32_16x16x32_bf16 a[16:19], a[120:123], a[192:195], a[16:19]
  ds_read_b64_tr_b16 a[100:101], v13 offset:20736
  buffer_load_dwordx4 v15, s[8:11], s32 offen offset:1024 lds
  v_mfma_f32_16x16x32_bf16 a[20:23], a[120:123], a[196:199], a[20:23]
  s_waitcnt lgkmcnt(11)
  ds_read_b64_tr_b16 a[102:103], v13 offset:25856
  v_mfma_f32_16x16x32_bf16 a[24:27], a[124:127], a[192:195], a[24:27]
  ds_read_b64_tr_b16 a[104:105], v12 offset:30720
  v_mfma_f32_16x16x32_bf16 a[28:31], a[124:127], a[196:199], a[28:31]
  s_waitcnt lgkmcnt(11)
  ds_read_b64_tr_b16 a[106:107], v12 offset:35840
  v_mfma_f32_16x16x32_bf16 a[32:35], a[80:83], a[192:195], a[32:35]
  ds_read_b64_tr_b16 a[108:109], v13 offset:30720
  buffer_load_dwordx4 v16, s[8:11], s32 offen offset:2048 lds
  v_mfma_f32_16x16x32_bf16 a[36:39], a[80:83], a[196:199], a[36:39]
  s_waitcnt lgkmcnt(11)
  ds_read_b64_tr_b16 a[110:111], v13 offset:35840
  v_mfma_f32_16x16x32_bf16 a[40:43], a[84:87], a[192:195], a[40:43]
  ds_read_b64_tr_b16 a[112:113], v12 offset:30784
  v_mfma_f32_16x16x32_bf16 a[44:47], a[84:87], a[196:199], a[44:47]
  s_waitcnt lgkmcnt(11)
  ds_read_b64_tr_b16 a[114:115], v12 offset:35904
  v_mfma_f32_16x16x32_bf16 a[48:51], a[88:91], a[192:195], a[48:51]
  ds_read_b64_tr_b16 a[116:117], v13 offset:30784
  buffer_load_dwordx4 v17, s[8:11], s32 offen offset:3072 lds
  v_mfma_f32_16x16x32_bf16 a[52:55], a[88:91], a[196:199], a[52:55]
  s_waitcnt lgkmcnt(11)
  ds_read_b64_tr_b16 a[118:119], v13 offset:35904
  v_mfma_f32_16x16x32_bf16 a[56:59], a[92:95], a[192:195], a[56:59]
  s_add_u32 m0, s31, 65536
  ds_read_b64_tr_b16 a[120:121], v12 offset:30848
  v_mfma_f32_16x16x32_bf16 a[60:63], a[92:95], a[196:199], a[60:63]
  s_waitcnt lgkmcnt(11)
  ds_read_b64_tr_b16 a[122:123], v12 offset:35968
  v_mfma_f32_16x16x32_bf16 a[64:67], a[96:99], a[192:195], a[64:67]
  ds_read_b64_tr_b16 a[124:125], v13 offset:30848
  buffer_load_dwordx4 v18, s[8:11], s32 offen lds
  v_mfma_f32_16x16x32_bf16 a[68:71], a[96:99], a[196:199], a[68:71]
  s_waitcnt lgkmcnt(11)
  ds_read_b64_tr_b16 a[126:127], v13 offset:35968
  v_mfma_f32_16x16x32_bf16 a[72:75], a[100:103], a[192:195], a[72:75]
  s_waitcnt vmcnt(41)
  ds_read_b64_tr_b16 a[80:81], v12 offset:30912
  v_mfma_f32_16x16x32_bf16 a[76:79], a[100:103], a[196:199], a[76:79]
  s_waitcnt lgkmcnt(11)
  ds_read_b64_tr_b16 a[82:83], v12 offset:36032
  v_mfma_f32_16x16x32_bf16 a[0:3], a[104:107], a[200:203], a[0:3]
  s_add_u32 s32, s32, 81920
  ds_read_b64_tr_b16 a[84:85], v13 offset:30912
  buffer_load_dwordx4 a[176:179], v19, s[12:15], s33 offen offset:0
  v_mfma_f32_16x16x32_bf16 a[4:7], a[104:107], a[204:207], a[4:7]
  s_waitcnt lgkmcnt(11)
  ds_read_b64_tr_b16 a[86:87], v13 offset:36032
  v_mfma_f32_16x16x32_bf16 a[8:11], a[108:111], a[200:203], a[8:11]
  ds_read_b64_tr_b16 a[88:89], v12 offset:30976
  v_mfma_f32_16x16x32_bf16 a[12:15], a[108:111], a[204:207], a[12:15]
  s_waitcnt lgkmcnt(11)
  ds_read_b64_tr_b16 a[90:91], v12 offset:36096
  v_mfma_f32_16x16x32_bf16 a[16:19], a[112:115], a[200:203], a[16:19]
  ds_read_b64_tr_b16 a[92:93], v13 offset:30976
  buffer_load_dwordx4 a[180:183], v19, s[12:15], s33 offen offset:1024
  v_mfma_f32_16x16x32_bf16 a[20:23], a[112:115], a[204:207], a[20:23]
  s_waitcnt lgkmcnt(11)
  ds_read_b64_tr_b16 a[94:95], v13 offset:36096
  v_mfma_f32_16x16x32_bf16 a[24:27], a[116:119], a[200:203], a[24:27]
  s_add_u32 s33, s33, 2048
  ds_read_b64_tr_b16 a[96:97], v12 offset:40960
  v_mfma_f32_16x16x32_bf16 a[28:31], a[116:119], a[204:207], a[28:31]
  s_waitcnt lgkmcnt(11)
  ds_read_b64_tr_b16 a[98:99], v12 offset:46080
  v_mfma_f32_16x16x32_bf16 a[32:35], a[120:123], a[200:203], a[32:35]
  ds_read_b64_tr_b16 a[100:101], v13 offset:40960
  buffer_load_dwordx4 a[184:187], v19, s[12:15], s33 offen offset:0
  v_mfma_f32_16x16x32_bf16 a[36:39], a[120:123], a[204:207], a[36:39]
  s_waitcnt lgkmcnt(11)
  ds_read_b64_tr_b16 a[102:103], v13 offset:46080
  v_mfma_f32_16x16x32_bf16 a[40:43], a[124:127], a[200:203], a[40:43]
  ds_read_b64_tr_b16 a[104:105], v12 offset:41024
  v_mfma_f32_16x16x32_bf16 a[44:47], a[124:127], a[204:207], a[44:47]
  s_waitcnt lgkmcnt(11)
  ds_read_b64_tr_b16 a[106:107], v12 offset:46144
  v_mfma_f32_16x16x32_bf16 a[48:51], a[80:83], a[200:203], a[48:51]
  ds_read_b64_tr_b16 a[108:109], v13 offset:41024
  buffer_load_dwordx4 a[188:191], v19, s[12:15], s33 offen offset:1024
  v_mfma_f32_16x16x32_bf16 a[52:55], a[80:83], a[204:207], a[52:55]
  s_waitcnt lgkmcnt(11)
  ds_read_b64_tr_b16 a[110:111], v13 offset:46144
  v_mfma_f32_16x16x32_bf16 a[56:59], a[84:87], a[200:203], a[56:59]
  s_add_u32 s33, s33, 2048
  ds_read_b64_tr_b16 a[112:113], v12 offset:41088
  v_mfma_f32_16x16x32_bf16 a[60:63], a[84:87], a[204:207], a[60:63]
  s_waitcnt lgkmcnt(11)
  ds_read_b64_tr_b16 a[114:115], v12 offset:46208
  v_mfma_f32_16x16x32_bf16 a[64:67], a[88:91], a[200:203], a[64:67]
  s_waitcnt vmcnt(31)
  ds_read_b64_tr_b16 a[116:117], v13 offset:41088
  v_mfma_f32_16x16x32_bf16 a[68:71], a[88:91], a[204:207], a[68:71]
  s_waitcnt lgkmcnt(11)
  ds_read_b64_tr_b16 a[118:119], v13 offset:46208
  v_mfma_f32_16x16x32_bf16 a[72:75], a[92:95], a[200:203], a[72:75]
  s_barrier
  ds_read_b64_tr_b16 a[120:121], v12 offset:41152
  v_mfma_f32_16x16x32_bf16 a[76:79], a[92:95], a[204:207], a[76:79]
  s_waitcnt lgkmcnt(11)
  ds_read_b64_tr_b16 a[122:123], v12 offset:46272
  v_mfma_f32_16x16x32_bf16 a[0:3], a[96:99], a[208:211], a[0:3]
  s_add_u32 m0, s31, 81920
  ds_read_b64_tr_b16 a[124:125], v13 offset:41152
  buffer_load_dwordx4 v14, s[8:11], s32 offen offset:0 lds
  v_mfma_f32_16x16x32_bf16 a[4:7], a[96:99], a[212:215], a[4:7]
  s_waitcnt lgkmcnt(11)
  ds_read_b64_tr_b16 a[126:127], v13 offset:46272
  v_mfma_f32_16x16x32_bf16 a[8:11], a[100:103], a[208:211], a[8:11]
  ds_read_b64_tr_b16 a[80:81], v12 offset:41216
  v_mfma_f32_16x16x32_bf16 a[12:15], a[100:103], a[212:215], a[12:15]
  s_waitcnt lgkmcnt(11)
  ds_read_b64_tr_b16 a[82:83], v12 offset:46336
  v_mfma_f32_16x16x32_bf16 a[16:19], a[104:107], a[208:211], a[16:19]
  ds_read_b64_tr_b16 a[84:85], v13 offset:41216
  buffer_load_dwordx4 v15, s[8:11], s32 offen offset:1024 lds
  v_mfma_f32_16x16x32_bf16 a[20:23], a[104:107], a[212:215], a[20:23]
  s_waitcnt lgkmcnt(11)
  ds_read_b64_tr_b16 a[86:87], v13 offset:46336
  v_mfma_f32_16x16x32_bf16 a[24:27], a[108:111], a[208:211], a[24:27]
  ds_read_b64_tr_b16 a[88:89], v12 offset:51200
  v_mfma_f32_16x16x32_bf16 a[28:31], a[108:111], a[212:215], a[28:31]
  s_waitcnt lgkmcnt(11)
  ds_read_b64_tr_b16 a[90:91], v12 offset:56320
  v_mfma_f32_16x16x32_bf16 a[32:35], a[112:115], a[208:211], a[32:35]
  ds_read_b64_tr_b16 a[92:93], v13 offset:51200
  buffer_load_dwordx4 v16, s[8:11], s32 offen offset:2048 lds
  v_mfma_f32_16x16x32_bf16 a[36:39], a[112:115], a[212:215], a[36:39]
  s_waitcnt lgkmcnt(11)
  ds_read_b64_tr_b16 a[94:95], v13 offset:56320
  v_mfma_f32_16x16x32_bf16 a[40:43], a[116:119], a[208:211], a[40:43]
  ds_read_b64_tr_b16 a[96:97], v12 offset:51264
  v_mfma_f32_16x16x32_bf16 a[44:47], a[116:119], a[212:215], a[44:47]
  s_waitcnt lgkmcnt(11)
  ds_read_b64_tr_b16 a[98:99], v12 offset:56384
  v_mfma_f32_16x16x32_bf16 a[48:51], a[120:123], a[208:211], a[48:51]
  ds_read_b64_tr_b16 a[100:101], v13 offset:51264
  buffer_load_dwordx4 v17, s[8:11], s32 offen offset:3072 lds
  v_mfma_f32_16x16x32_bf16 a[52:55], a[120:123], a[212:215], a[52:55]
  s_waitcnt lgkmcnt(11)
  ds_read_b64_tr_b16 a[102:103], v13 offset:56384
  v_mfma_f32_16x16x32_bf16 a[56:59], a[124:127], a[208:211], a[56:59]
  s_add_u32 m0, s31, 86016
  ds_read_b64_tr_b16 a[104:105], v12 offset:51328
  v_mfma_f32_16x16x32_bf16 a[60:63], a[124:127], a[212:215], a[60:63]
  s_waitcnt lgkmcnt(11)
  ds_read_b64_tr_b16 a[106:107], v12 offset:56448
  v_mfma_f32_16x16x32_bf16 a[64:67], a[80:83], a[208:211], a[64:67]
  ds_read_b64_tr_b16 a[108:109], v13 offset:51328
  buffer_load_dwordx4 v18, s[8:11], s32 offen lds
  v_mfma_f32_16x16x32_bf16 a[68:71], a[80:83], a[212:215], a[68:71]
  s_waitcnt lgkmcnt(11)
  ds_read_b64_tr_b16 a[110:111], v13 offset:56448
  v_mfma_f32_16x16x32_bf16 a[72:75], a[84:87], a[208:211], a[72:75]
  s_waitcnt vmcnt(41)
  ds_read_b64_tr_b16 a[112:113], v12 offset:51392
  v_mfma_f32_16x16x32_bf16 a[76:79], a[84:87], a[212:215], a[76:79]
  s_waitcnt lgkmcnt(11)
  ds_read_b64_tr_b16 a[114:115], v12 offset:56512
  v_mfma_f32_16x16x32_bf16 a[0:3], a[88:91], a[216:219], a[0:3]
  s_add_u32 s32, s32, 81920
  ds_read_b64_tr_b16 a[116:117], v13 offset:51392
  buffer_load_dwordx4 a[192:195], v19, s[12:15], s33 offen offset:0
  v_mfma_f32_16x16x32_bf16 a[4:7], a[88:91], a[220:223], a[4:7]
  s_waitcnt lgkmcnt(11)
  ds_read_b64_tr_b16 a[118:119], v13 offset:56512
  v_mfma_f32_16x16x32_bf16 a[8:11], a[92:95], a[216:219], a[8:11]
  ds_read_b64_tr_b16 a[120:121], v12 offset:51456
  v_mfma_f32_16x16x32_bf16 a[12:15], a[92:95], a[220:223], a[12:15]
  s_waitcnt lgkmcnt(11)
  ds_read_b64_tr_b16 a[122:123], v12 offset:56576
  v_mfma_f32_16x16x32_bf16 a[16:19], a[96:99], a[216:219], a[16:19]
  ds_read_b64_tr_b16 a[124:125], v13 offset:51456
  buffer_load_dwordx4 a[196:199], v19, s[12:15], s33 offen offset:1024
  v_mfma_f32_16x16x32_bf16 a[20:23], a[96:99], a[220:223], a[20:23]
  s_waitcnt lgkmcnt(11)
  ds_read_b64_tr_b16 a[126:127], v13 offset:56576
  v_mfma_f32_16x16x32_bf16 a[24:27], a[100:103], a[216:219], a[24:27]
  s_add_u32 s33, s33, 2048
  ds_read_b64_tr_b16 a[80:81], v10 offset:0
  v_mfma_f32_16x16x32_bf16 a[28:31], a[100:103], a[220:223], a[28:31]
  s_waitcnt lgkmcnt(11)
  ds_read_b64_tr_b16 a[82:83], v10 offset:5120
  v_mfma_f32_16x16x32_bf16 a[32:35], a[104:107], a[216:219], a[32:35]
  ds_read_b64_tr_b16 a[84:85], v11 offset:0
  buffer_load_dwordx4 a[200:203], v19, s[12:15], s33 offen offset:0
  v_mfma_f32_16x16x32_bf16 a[36:39], a[104:107], a[220:223], a[36:39]
  s_waitcnt lgkmcnt(11)
  ds_read_b64_tr_b16 a[86:87], v11 offset:5120
  v_mfma_f32_16x16x32_bf16 a[40:43], a[108:111], a[216:219], a[40:43]
  ds_read_b64_tr_b16 a[88:89], v10 offset:64
  v_mfma_f32_16x16x32_bf16 a[44:47], a[108:111], a[220:223], a[44:47]
  s_waitcnt lgkmcnt(11)
  ds_read_b64_tr_b16 a[90:91], v10 offset:5184
  v_mfma_f32_16x16x32_bf16 a[48:51], a[112:115], a[216:219], a[48:51]
  ds_read_b64_tr_b16 a[92:93], v11 offset:64
  buffer_load_dwordx4 a[204:207], v19, s[12:15], s33 offen offset:1024
  v_mfma_f32_16x16x32_bf16 a[52:55], a[112:115], a[220:223], a[52:55]
  s_waitcnt lgkmcnt(11)
  ds_read_b64_tr_b16 a[94:95], v11 offset:5184
  v_mfma_f32_16x16x32_bf16 a[56:59], a[116:119], a[216:219], a[56:59]
  s_add_u32 s33, s33, 2048
  ds_read_b64_tr_b16 a[96:97], v10 offset:128
  v_mfma_f32_16x16x32_bf16 a[60:63], a[116:119], a[220:223], a[60:63]
  s_waitcnt lgkmcnt(11)
  ds_read_b64_tr_b16 a[98:99], v10 offset:5248
  v_mfma_f32_16x16x32_bf16 a[64:67], a[120:123], a[216:219], a[64:67]
  s_waitcnt vmcnt(31)
  ds_read_b64_tr_b16 a[100:101], v11 offset:128
  v_mfma_f32_16x16x32_bf16 a[68:71], a[120:123], a[220:223], a[68:71]
  s_waitcnt lgkmcnt(11)
  ds_read_b64_tr_b16 a[102:103], v11 offset:5248
  v_mfma_f32_16x16x32_bf16 a[72:75], a[124:127], a[216:219], a[72:75]
  s_barrier
  ds_read_b64_tr_b16 a[104:105], v10 offset:192
  v_mfma_f32_16x16x32_bf16 a[76:79], a[124:127], a[220:223], a[76:79]
  s_waitcnt lgkmcnt(11)
  ds_read_b64_tr_b16 a[106:107], v10 offset:5312
  s_sub_u32 s36, s36, 1
  s_cmp_lg_u32 s36, 0
  s_cbranch_scc1 L_k3_loop
  v_mfma_f32_16x16x32_bf16 a[0:3], a[80:83], a[128:131], a[0:3]
  s_add_u32 m0, s31, 102400
  ds_read_b64_tr_b16 a[108:109], v11 offset:192
  buffer_load_dwordx4 v14, s[8:11], s32 offen offset:0 lds
  v_mfma_f32_16x16x32_bf16 a[4:7], a[80:83], a[132:135], a[4:7]
  s_waitcnt lgkmcnt(11)
  ds_read_b64_tr_b16 a[110:111], v11 offset:5312
  v_mfma_f32_16x16x32_bf16 a[8:11], a[84:87], a[128:131], a[8:11]
  ds_read_b64_tr_b16 a[112:113], v10 offset:256
  v_mfma_f32_16x16x32_bf16 a[12:15], a[84:87], a[132:135], a[12:15]
  s_waitcnt lgkmcnt(11)
  ds_read_b64_tr_b16 a[114:115], v10 offset:5376
  v_mfma_f32_16x16x32_bf16 a[16:19], a[88:91], a[128:131], a[16:19]
  ds_read_b64_tr_b16 a[116:117], v11 offset:256
  buffer_load_dwordx4 v15, s[8:11], s32 offen offset:1024 lds
  v_mfma_f32_16x16x32_bf16 a[20:23], a[88:91], a[132:135], a[20:23]
  s_waitcnt lgkmcnt(11)
  ds_read_b64_tr_b16 a[118:119], v11 offset:5376
  v_mfma_f32_16x16x32_bf16 a[24:27], a[92:95], a[128:131], a[24:27]
  ds_read_b64_tr_b16 a[120:121], v10 offset:10240
  v_mfma_f32_16x16x32_bf16 a[28:31], a[92:95], a[132:135], a[28:31]
  s_waitcnt lgkmcnt(11)
  ds_read_b64_tr_b16 a[122:123], v10 offset:15360
  v_mfma_f32_16x16x32_bf16 a[32:35], a[96:99], a[128:131], a[32:35]
  ds_read_b64_tr_b16 a[124:125], v11 offset:10240
  buffer_load_dwordx4 v16, s[8:11], s32 offen offset:2048 lds
  v_mfma_f32_16x16x32_bf16 a[36:39], a[96:99], a[132:135], a[36:39]
  s_waitcnt lgkmcnt(11)
  ds_read_b64_tr_b16 a[126:127], v11 offset:15360
  v_mfma_f32_16x16x32_bf16 a[40:43], a[100:103], a[128:131], a[40:43]
  ds_read_b64_tr_b16 a[80:81], v10 offset:10304
  v_mfma_f32_16x16x32_bf16 a[44:47], a[100:103], a[132:135], a[44:47]
  s_waitcnt lgkmcnt(11)
  ds_read_b64_tr_b16 a[82:83], v10 offset:15424
  v_mfma_f32_16x16x32_bf16 a[48:51], a[104:107], a[128:131], a[48:51]
  ds_read_b64_tr_b16 a[84:85], v11 offset:10304
  buffer_load_dwordx4 v17, s[8:11], s32 offen offset:3072 lds
  v_mfma_f32_16x16x32_bf16 a[52:55], a[104:107], a[132:135], a[52:55]
  s_waitcnt lgkmcnt(11)
  ds_read_b64_tr_b16 a[86:87], v11 offset:15424
  v_mfma_f32_16x16x32_bf16 a[56:59], a[108:111], a[128:131], a[56:59]
  s_add_u32 m0, s31, 106496
  ds_read_b64_tr_b16 a[88:89], v10 offset:10368
  v_mfma_f32_16x16x32_bf16 a[60:63], a[108:111], a[132:135], a[60:63]
  s_waitcnt lgkmcnt(11)
  ds_read_b64_tr_b16 a[90:91], v10 offset:15488
  v_mfma_f32_16x16x32_bf16 a[64:67], a[112:115], a[128:131], a[64:67]
  ds_read_b64_tr_b16 a[92:93], v11 offset:10368
  buffer_load_dwordx4 v18, s[8:11], s32 offen lds
  v_mfma_f32_16x16x32_bf16 a[68:71], a[112:115], a[132:135], a[68:71]
  s_waitcnt lgkmcnt(11)
  ds_read_b64_tr_b16 a[94:95], v11 offset:15488
  v_mfma_f32_16x16x32_bf16 a[72:75], a[116:119], a[128:131], a[72:75]
  s_waitcnt vmcnt(41)
  ds_read_b64_tr_b16 a[96:97], v10 offset:10432
  v_mfma_f32_16x16x32_bf16 a[76:79], a[116:119], a[132:135], a[76:79]
  s_waitcnt lgkmcnt(11)
  ds_read_b64_tr_b16 a[98:99], v10 offset:15552
  v_mfma_f32_16x16x32_bf16 a[0:3], a[120:123], a[136:139], a[0:3]
  s_add_u32 s32, s32, 81920
  ds_read_b64_tr_b16 a[100:101], v11 offset:10432
  buffer_load_dwordx4 a[208:211], v19, s[12:15], s33 offen offset:0
  v_mfma_f32_16x16x32_bf16 a[4:7], a[120:123], a[140:143], a[4:7]
  s_waitcnt lgkmcnt(11)
  ds_read_b64_tr_b16 a[102:103], v11 offset:15552
  v_mfma_f32_16x16x32_bf16 a[8:11], a[124:127], a[136:139], a[8:11]
  ds_read_b64_tr_b16 a[104:105], v10 offset:10496
  v_mfma_f32_16x16x32_bf16 a[12:15], a[124:127], a[140:143], a[12:15]
  s_waitcnt lgkmcnt(11)
  ds_read_b64_tr_b16 a[106:107], v10 offset:15616
  v_mfma_f32_16x16x32_bf16 a[16:19], a[80:83], a[136:139], a[16:19]
  ds_read_b64_tr_b16 a[108:109], v11 offset:10496
  buffer_load_dwordx4 a[212:215], v19, s[12:15], s33 offen offset:1024
  v_mfma_f32_16x16x32_bf16 a[20:23], a[80:83], a[140:143], a[20:23]
  s_waitcnt lgkmcnt(11)
  ds_read_b64_tr_b16 a[110:111], v11 offset:15616
  v_mfma_f32_16x16x32_bf16 a[24:27], a[84:87], a[136:139], a[24:27]
  s_add_u32 s33, s33, 2048
  ds_read_b64_tr_b16 a[112:113], v10 offset:20480
  v_mfma_f32_16x16x32_bf16 a[28:31], a[84:87], a[140:143], a[28:31]
  s_waitcnt lgkmcnt(11)
  ds_read_b64_tr_b16 a[114:115], v10 offset:25600
  v_mfma_f32_16x16x32_bf16 a[32:35], a[88:91], a[136:139], a[32:35]
  ds_read_b64_tr_b16 a[116:117], v11 offset:20480
  buffer_load_dwordx4 a[216:219], v19, s[12:15], s33 offen offset:0
  v_mfma_f32_16x16x32_bf16 a[36:39], a[88:91], a[140:143], a[36:39]
  s_waitcnt lgkmcnt(11)
  ds_read_b64_tr_b16 a[118:119], v11 offset:25600
  v_mfma_f32_16x16x32_bf16 a[40:43], a[92:95], a[136:139], a[40:43]
  ds_read_b64_tr_b16 a[120:121], v10 offset:20544
  v_mfma_f32_16x16x32_bf16 a[44:47], a[92:95], a[140:143], a[44:47]
  s_waitcnt lgkmcnt(11)
  ds_read_b64_tr_b16 a[122:123], v10 offset:25664
  v_mfma_f32_16x16x32_bf16 a[48:51], a[96:99], a[136:139], a[48:51]
  ds_read_b64_tr_b16 a[124:125], v11 offset:20544
  buffer_load_dwordx4 a[220:223], v19, s[12:15], s33 offen offset:1024
  v_mfma_f32_16x16x32_bf16 a[52:55], a[96:99], a[140:143], a[52:55]
  s_waitcnt lgkmcnt(11)
  ds_read_b64_tr_b16 a[126:127], v11 offset:25664
  v_mfma_f32_16x16x32_bf16 a[56:59], a[100:103], a[136:139], a[56:59]
  s_add_u32 s33, s33, 2048
  ds_read_b64_tr_b16 a[80:81], v10 offset:20608
  v_mfma_f32_16x16x32_bf16 a[60:63], a[100:103], a[140:143], a[60:63]
  s_waitcnt lgkmcnt(11)
  ds_read_b64_tr_b16 a[82:83], v10 offset:25728
  v_mfma_f32_16x16x32_bf16 a[64:67], a[104:107], a[136:139], a[64:67]
  s_waitcnt vmcnt(31)
  ds_read_b64_tr_b16 a[84:85], v11 offset:20608
  v_mfma_f32_16x16x32_bf16 a[68:71], a[104:107], a[140:143], a[68:71]
  s_waitcnt lgkmcnt(11)
  ds_read_b64_tr_b16 a[86:87], v11 offset:25728
  v_mfma_f32_16x16x32_bf16 a[72:75], a[108:111], a[136:139], a[72:75]
  s_barrier
  ds_read_b64_tr_b16 a[88:89], v10 offset:20672
  v_mfma_f32_16x16x32_bf16 a[76:79], a[108:111], a[140:143], a[76:79]
  s_waitcnt lgkmcnt(11)
  ds_read_b64_tr_b16 a[90:91], v10 offset:25792
  v_mfma_f32_16x16x32_bf16 a[0:3], a[112:115], a[144:147], a[0:3]
  ds_read_b64_tr_b16 a[92:93], v11 offset:20672
  v_mfma_f32_16x16x32_bf16 a[4:7], a[112:115], a[148:151], a[4:7]
  s_waitcnt lgkmcnt(11)
  ds_read_b64_tr_b16 a[94:95], v11 offset:25792
  v_mfma_f32_16x16x32_bf16 a[8:11], a[116:119], a[144:147], a[8:11]
  ds_read_b64_tr_b16 a[96:97], v10 offset:20736
  v_mfma_f32_16x16x32_bf16 a[12:15], a[116:119], a[148:151], a[12:15]
  s_waitcnt lgkmcnt(11)
  ds_read_b64_tr_b16 a[98:99], v10 offset:25856
  v_mfma_f32_16x16x32_bf16 a[16:19], a[120:123], a[144:147], a[16:19]
  ds_read_b64_tr_b16 a[100:101], v11 offset:20736
  v_mfma_f32_16x16x32_bf16 a[20:23], a[120:123], a[148:151], a[20:23]
  s_waitcnt lgkmcnt(11)
  ds_read_b64_tr_b16 a[102:103], v11 offset:25856
  v_mfma_f32_16x16x32_bf16 a[24:27], a[124:127], a[144:147], a[24:27]
  ds_read_b64_tr_b16 a[104:105], v10 offset:30720
  v_mfma_f32_16x16x32_bf16 a[28:31], a[124:127], a[148:151], a[28:31]
  s_waitcnt lgkmcnt(11)
  ds_read_b64_tr_b16 a[106:107], v10 offset:35840
  v_mfma_f32_16x16x32_bf16 a[32:35], a[80:83], a[144:147], a[32:35]
  ds_read_b64_tr_b16 a[108:109], v11 offset:30720
  v_mfma_f32_16x16x32_bf16 a[36:39], a[80:83], a[148:151], a[36:39]
  s_waitcnt lgkmcnt(11)
  ds_read_b64_tr_b16 a[110:111], v11 offset:35840
  v_mfma_f32_16x16x32_bf16 a[40:43], a[84:87], a[144:147], a[40:43]
  ds_read_b64_tr_b16 a[112:113], v10 offset:30784
  v_mfma_f32_16x16x32_bf16 a[44:47], a[84:87], a[148:151], a[44:47]
  s_waitcnt lgkmcnt(11)
  ds_read_b64_tr_b16 a[114:115], v10 offset:35904
  v_mfma_f32_16x16x32_bf16 a[48:51], a[88:91], a[144:147], a[48:51]
  ds_read_b64_tr_b16 a[116:117], v11 offset:30784
  v_mfma_f32_16x16x32_bf16 a[52:55], a[88:91], a[148:151], a[52:55]
  s_waitcnt lgkmcnt(11)
  ds_read_b64_tr_b16 a[118:119], v11 offset:35904
  v_mfma_f32_16x16x32_bf16 a[56:59], a[92:95], a[144:147], a[56:59]
  ds_read_b64_tr_b16 a[120:121], v10 offset:30848
  v_mfma_f32_16x16x32_bf16 a[60:63], a[92:95], a[148:151], a[60:63]
  s_waitcnt lgkmcnt(11)
  ds_read_b64_tr_b16 a[122:123], v10 offset:35968
  v_mfma_f32_16x16x32_bf16 a[64:67], a[96:99], a[144:147], a[64:67]
  ds_read_b64_tr_b16 a[124:125], v11 offset:30848
  v_mfma_f32_16x16x32_bf16 a[68:71], a[96:99], a[148:151], a[68:71]
  s_waitcnt lgkmcnt(11)
  ds_read_b64_tr_b16 a[126:127], v11 offset:35968
  v_mfma_f32_16x16x32_bf16 a[72:75], a[100:103], a[144:147], a[72:75]
  s_waitcnt vmcnt(36)
  ds_read_b64_tr_b16 a[80:81], v10 offset:30912
  v_mfma_f32_16x16x32_bf16 a[76:79], a[100:103], a[148:151], a[76:79]
  s_waitcnt lgkmcnt(11)
  ds_read_b64_tr_b16 a[82:83], v10 offset:36032
  v_mfma_f32_16x16x32_bf16 a[0:3], a[104:107], a[152:155], a[0:3]
  ds_read_b64_tr_b16 a[84:85], v11 offset:30912
  v_mfma_f32_16x16x32_bf16 a[4:7], a[104:107], a[156:159], a[4:7]
  s_waitcnt lgkmcnt(11)
  ds_read_b64_tr_b16 a[86:87], v11 offset:36032
  v_mfma_f32_16x16x32_bf16 a[8:11], a[108:111], a[152:155], a[8:11]
  ds_read_b64_tr_b16 a[88:89], v10 offset:30976
  v_mfma_f32_16x16x32_bf16 a[12:15], a[108:111], a[156:159], a[12:15]
  s_waitcnt lgkmcnt(11)
  ds_read_b64_tr_b16 a[90:91], v10 offset:36096
  v_mfma_f32_16x16x32_bf16 a[16:19], a[112:115], a[152:155], a[16:19]
  ds_read_b64_tr_b16 a[92:93], v11 offset:30976
  v_mfma_f32_16x16x32_bf16 a[20:23], a[112:115], a[156:159], a[20:23]
  s_waitcnt lgkmcnt(11)
  ds_read_b64_tr_b16 a[94:95], v11 offset:36096
  v_mfma_f32_16x16x32_bf16 a[24:27], a[116:119], a[152:155], a[24:27]
  ds_read_b64_tr_b16 a[96:97], v10 offset:40960
  v_mfma_f32_16x16x32_bf16 a[28:31], a[116:119], a[156:159], a[28:31]
  s_waitcnt lgkmcnt(11)
  ds_read_b64_tr_b16 a[98:99], v10 offset:46080
  v_mfma_f32_16x16x32_bf16 a[32:35], a[120:123], a[152:155], a[32:35]
  ds_read_b64_tr_b16 a[100:101], v11 offset:40960
  v_mfma_f32_16x16x32_bf16 a[36:39], a[120:123], a[156:159], a[36:39]
  s_waitcnt lgkmcnt(11)
  ds_read_b64_tr_b16 a[102:103], v11 offset:46080
  v_mfma_f32_16x16x32_bf16 a[40:43], a[124:127], a[152:155], a[40:43]
  ds_read_b64_tr_b16 a[104:105], v10 offset:41024
  v_mfma_f32_16x16x32_bf16 a[44:47], a[124:127], a[156:159], a[44:47]
  s_waitcnt lgkmcnt(11)
  ds_read_b64_tr_b16 a[106:107], v10 offset:46144
  v_mfma_f32_16x16x32_bf16 a[48:51], a[80:83], a[152:155], a[48:51]
  ds_read_b64_tr_b16 a[108:109], v11 offset:41024
  v_mfma_f32_16x16x32_bf16 a[52:55], a[80:83], a[156:159], a[52:55]
  s_waitcnt lgkmcnt(11)
  ds_read_b64_tr_b16 a[110:111], v11 offset:46144
  v_mfma_f32_16x16x32_bf16 a[56:59], a[84:87], a[152:155], a[56:59]
  ds_read_b64_tr_b16 a[112:113], v10 offset:41088
  v_mfma_f32_16x16x32_bf16 a[60:63], a[84:87], a[156:159], a[60:63]
  s_waitcnt lgkmcnt(11)
  ds_read_b64_tr_b16 a[114:115], v10 offset:46208
  v_mfma_f32_16x16x32_bf16 a[64:67], a[88:91], a[152:155], a[64:67]
  s_waitcnt vmcnt(22)
  ds_read_b64_tr_b16 a[116:117], v11 offset:41088
  v_mfma_f32_16x16x32_bf16 a[68:71], a[88:91], a[156:159], a[68:71]
  s_waitcnt lgkmcnt(11)
  ds_read_b64_tr_b16 a[118:119], v11 offset:46208
  v_mfma_f32_16x16x32_bf16 a[72:75], a[92:95], a[152:155], a[72:75]
  s_barrier
  ds_read_b64_tr_b16 a[120:121], v10 offset:41152
  v_mfma_f32_16x16x32_bf16 a[76:79], a[92:95], a[156:159], a[76:79]
  s_waitcnt lgkmcnt(11)
  ds_read_b64_tr_b16 a[122:123], v10 offset:46272
  v_mfma_f32_16x16x32_bf16 a[0:3], a[96:99], a[160:163], a[0:3]
  ds_read_b64_tr_b16 a[124:125], v11 offset:41152
  v_mfma_f32_16x16x32_bf16 a[4:7], a[96:99], a[164:167], a[4:7]
  s_waitcnt lgkmcnt(11)
  ds_read_b64_tr_b16 a[126:127], v11 offset:46272
  v_mfma_f32_16x16x32_bf16 a[8:11], a[100:103], a[160:163], a[8:11]
  ds_read_b64_tr_b16 a[80:81], v10 offset:41216
  v_mfma_f32_16x16x32_bf16 a[12:15], a[100:103], a[164:167], a[12:15]
  s_waitcnt lgkmcnt(11)
  ds_read_b64_tr_b16 a[82:83], v10 offset:46336
  v_mfma_f32_16x16x32_bf16 a[16:19], a[104:107], a[160:163], a[16:19]
  ds_read_b64_tr_b16 a[84:85], v11 offset:41216
  v_mfma_f32_16x16x32_bf16 a[20:23], a[104:107], a[164:167], a[20:23]
  s_waitcnt lgkmcnt(11)
  ds_read_b64_tr_b16 a[86:87], v11 offset:46336
  v_mfma_f32_16x16x32_bf16 a[24:27], a[108:111], a[160:163], a[24:27]
  ds_read_b64_tr_b16 a[88:89], v10 offset:51200
  v_mfma_f32_16x16x32_bf16 a[28:31], a[108:111], a[164:167], a[28:31]
  s_waitcnt lgkmcnt(11)
  ds_read_b64_tr_b16 a[90:91], v10 offset:56320
  v_mfma_f32_16x16x32_bf16 a[32:35], a[112:115], a[160:163], a[32:35]
  ds_read_b64_tr_b16 a[92:93], v11 offset:51200
  v_mfma_f32_16x16x32_bf16 a[36:39], a[112:115], a[164:167], a[36:39]
  s_waitcnt lgkmcnt(11)
  ds_read_b64_tr_b16 a[94:95], v11 offset:56320
  v_mfma_f32_16x16x32_bf16 a[40:43], a[116:119], a[160:163], a[40:43]
  ds_read_b64_tr_b16 a[96:97], v10 offset:51264
  v_mfma_f32_16x16x32_bf16 a[44:47], a[116:119], a[164:167], a[44:47]
  s_waitcnt lgkmcnt(11)
  ds_read_b64_tr_b16 a[98:99], v10 offset:56384
  v_mfma_f32_16x16x32_bf16 a[48:51], a[120:123], a[160:163], a[48:51]
  ds_read_b64_tr_b16 a[100:101], v11 offset:51264
  v_mfma_f32_16x16x32_bf16 a[52:55], a[120:123], a[164:167], a[52:55]
  s_waitcnt lgkmcnt(11)
  ds_read_b64_tr_b16 a[102:103], v11 offset:56384
  v_mfma_f32_16x16x32_bf16 a[56:59], a[124:127], a[160:163], a[56:59]
  ds_read_b64_tr_b16 a[104:105], v10 offset:51328
  v_mfma_f32_16x16x32_bf16 a[60:63], a[124:127], a[164:167], a[60:63]
  s_waitcnt lgkmcnt(11)
  ds_read_b64_tr_b16 a[106:107], v10 offset:56448
  v_mfma_f32_16x16x32_bf16 a[64:67], a[80:83], a[160:163], a[64:67]
  ds_read_b64_tr_b16 a[108:109], v11 offset:51328
  v_mfma_f32_16x16x32_bf16 a[68:71], a[80:83], a[164:167], a[68:71]
  s_waitcnt lgkmcnt(11)
  ds_read_b64_tr_b16 a[110:111], v11 offset:56448
  v_mfma_f32_16x16x32_bf16 a[72:75], a[84:87], a[160:163], a[72:75]
  s_waitcnt vmcnt(27)
  ds_read_b64_tr_b16 a[112:113], v10 offset:51392
  v_mfma_f32_16x16x32_bf16 a[76:79], a[84:87], a[164:167], a[76:79]
  s_waitcnt lgkmcnt(11)
  ds_read_b64_tr_b16 a[114:115], v10 offset:56512
  v_mfma_f32_16x16x32_bf16 a[0:3], a[88:91], a[168:171], a[0:3]
  ds_read_b64_tr_b16 a[116:117], v11 offset:51392
  v_mfma_f32_16x16x32_bf16 a[4:7], a[88:91], a[172:175], a[4:7]
  s_waitcnt lgkmcnt(11)
  ds_read_b64_tr_b16 a[118:119], v11 offset:56512
  v_mfma_f32_16x16x32_bf16 a[8:11], a[92:95], a[168:171], a[8:11]
  ds_read_b64_tr_b16 a[120:121], v10 offset:51456
  v_mfma_f32_16x16x32_bf16 a[12:15], a[92:95], a[172:175], a[12:15]
  s_waitcnt lgkmcnt(11)
  ds_read_b64_tr_b16 a[122:123], v10 offset:56576
  v_mfma_f32_16x16x32_bf16 a[16:19], a[96:99], a[168:171], a[16:19]
  ds_read_b64_tr_b16 a[124:125], v11 offset:51456
  v_mfma_f32_16x16x32_bf16 a[20:23], a[96:99], a[172:175], a[20:23]
  s_waitcnt lgkmcnt(11)
  ds_read_b64_tr_b16 a[126:127], v11 offset:56576
  v_mfma_f32_16x16x32_bf16 a[24:27], a[100:103], a[168:171], a[24:27]
  ds_read_b64_tr_b16 a[80:81], v12 offset:0
  v_mfma_f32_16x16x32_bf16 a[28:31], a[100:103], a[172:175], a[28:31]
  s_waitcnt lgkmcnt(11)
  ds_read_b64_tr_b16 a[82:83], v12 offset:5120
  v_mfma_f32_16x16x32_bf16 a[32:35], a[104:107], a[168:171], a[32:35]
  ds_read_b64_tr_b16 a[84:85], v13 offset:0
  v_mfma_f32_16x16x32_bf16 a[36:39], a[104:107], a[172:175], a[36:39]
  s_waitcnt lgkmcnt(11)
  ds_read_b64_tr_b16 a[86:87], v13 offset:5120
  v_mfma_f32_16x16x32_bf16 a[40:43], a[108:111], a[168:171], a[40:43]
  ds_read_b64_tr_b16 a[88:89], v12 offset:64
  v_mfma_f32_16x16x32_bf16 a[44:47], a[108:111], a[172:175], a[44:47]
  s_waitcnt lgkmcnt(11)
  ds_read_b64_tr_b16 a[90:91], v12 offset:5184
  v_mfma_f32_16x16x32_bf16 a[48:51], a[112:115], a[168:171], a[48:51]
  ds_read_b64_tr_b16 a[92:93], v13 offset:64
  v_mfma_f32_16x16x32_bf16 a[52:55], a[112:115], a[172:175], a[52:55]
  s_waitcnt lgkmcnt(11)
  ds_read_b64_tr_b16 a[94:95], v13 offset:5184
  v_mfma_f32_16x16x32_bf16 a[56:59], a[116:119], a[168:171], a[56:59]
  ds_read_b64_tr_b16 a[96:97], v12 offset:128
  v_mfma_f32_16x16x32_bf16 a[60:63], a[116:119], a[172:175], a[60:63]
  s_waitcnt lgkmcnt(11)
  ds_read_b64_tr_b16 a[98:99], v12 offset:5248
  v_mfma_f32_16x16x32_bf16 a[64:67], a[120:123], a[168:171], a[64:67]
  s_waitcnt vmcnt(13)
  ds_read_b64_tr_b16 a[100:101], v13 offset:128
  v_mfma_f32_16x16x32_bf16 a[68:71], a[120:123], a[172:175], a[68:71]
  s_waitcnt lgkmcnt(11)
  ds_read_b64_tr_b16 a[102:103], v13 offset:5248
  v_mfma_f32_16x16x32_bf16 a[72:75], a[124:127], a[168:171], a[72:75]
  s_barrier
  ds_read_b64_tr_b16 a[104:105], v12 offset:192
  v_mfma_f32_16x16x32_bf16 a[76:79], a[124:127], a[172:175], a[76:79]
  s_waitcnt lgkmcnt(11)
  ds_read_b64_tr_b16 a[106:107], v12 offset:5312
  v_mfma_f32_16x16x32_bf16 a[0:3], a[80:83], a[176:179], a[0:3]
  ds_read_b64_tr_b16 a[108:109], v13 offset:192
  v_mfma_f32_16x16x32_bf16 a[4:7], a[80:83], a[180:183], a[4:7]
  s_waitcnt lgkmcnt(11)
  ds_read_b64_tr_b16 a[110:111], v13 offset:5312
  v_mfma_f32_16x16x32_bf16 a[8:11], a[84:87], a[176:179], a[8:11]
  ds_read_b64_tr_b16 a[112:113], v12 offset:256
  v_mfma_f32_16x16x32_bf16 a[12:15], a[84:87], a[180:183], a[12:15]
  s_waitcnt lgkmcnt(11)
  ds_read_b64_tr_b16 a[114:115], v12 offset:5376
  v_mfma_f32_16x16x32_bf16 a[16:19], a[88:91], a[176:179], a[16:19]
  ds_read_b64_tr_b16 a[116:117], v13 offset:256
  v_mfma_f32_16x16x32_bf16 a[20:23], a[88:91], a[180:183], a[20:23]
  s_waitcnt lgkmcnt(11)
  ds_read_b64_tr_b16 a[118:119], v13 offset:5376
  v_mfma_f32_16x16x32_bf16 a[24:27], a[92:95], a[176:179], a[24:27]
  ds_read_b64_tr_b16 a[120:121], v12 offset:10240
  v_mfma_f32_16x16x32_bf16 a[28:31], a[92:95], a[180:183], a[28:31]
  s_waitcnt lgkmcnt(11)
  ds_read_b64_tr_b16 a[122:123], v12 offset:15360
  v_mfma_f32_16x16x32_bf16 a[32:35], a[96:99], a[176:179], a[32:35]
  ds_read_b64_tr_b16 a[124:125], v13 offset:10240
  v_mfma_f32_16x16x32_bf16 a[36:39], a[96:99], a[180:183], a[36:39]
  s_waitcnt lgkmcnt(11)
  ds_read_b64_tr_b16 a[126:127], v13 offset:15360
  v_mfma_f32_16x16x32_bf16 a[40:43], a[100:103], a[176:179], a[40:43]
  ds_read_b64_tr_b16 a[80:81], v12 offset:10304
  v_mfma_f32_16x16x32_bf16 a[44:47], a[100:103], a[180:183], a[44:47]
  s_waitcnt lgkmcnt(11)
  ds_read_b64_tr_b16 a[82:83], v12 offset:15424
  v_mfma_f32_16x16x32_bf16 a[48:51], a[104:107], a[176:179], a[48:51]
  ds_read_b64_tr_b16 a[84:85], v13 offset:10304
  v_mfma_f32_16x16x32_bf16 a[52:55], a[104:107], a[180:183], a[52:55]
  s_waitcnt lgkmcnt(11)
  ds_read_b64_tr_b16 a[86:87], v13 offset:15424
  v_mfma_f32_16x16x32_bf16 a[56:59], a[108:111], a[176:179], a[56:59]
  ds_read_b64_tr_b16 a[88:89], v12 offset:10368
  v_mfma_f32_16x16x32_bf16 a[60:63], a[108:111], a[180:183], a[60:63]
  s_waitcnt lgkmcnt(11)
  ds_read_b64_tr_b16 a[90:91], v12 offset:15488
  v_mfma_f32_16x16x32_bf16 a[64:67], a[112:115], a[176:179], a[64:67]
  ds_read_b64_tr_b16 a[92:93], v13 offset:10368
  v_mfma_f32_16x16x32_bf16 a[68:71], a[112:115], a[180:183], a[68:71]
  s_waitcnt lgkmcnt(11)
  ds_read_b64_tr_b16 a[94:95], v13 offset:15488
  v_mfma_f32_16x16x32_bf16 a[72:75], a[116:119], a[176:179], a[72:75]
  s_waitcnt vmcnt(18)
  ds_read_b64_tr_b16 a[96:97], v12 offset:10432
  v_mfma_f32_16x16x32_bf16 a[76:79], a[116:119], a[180:183], a[76:79]
  s_waitcnt lgkmcnt(11)
  ds_read_b64_tr_b16 a[98:99], v12 offset:15552
  v_mfma_f32_16x16x32_bf16 a[0:3], a[120:123], a[184:187], a[0:3]
  ds_read_b64_tr_b16 a[100:101], v13 offset:10432
  v_mfma_f32_16x16x32_bf16 a[4:7], a[120:123], a[188:191], a[4:7]
  s_waitcnt lgkmcnt(11)
  ds_read_b64_tr_b16 a[102:103], v13 offset:15552
  v_mfma_f32_16x16x32_bf16 a[8:11], a[124:127], a[184:187], a[8:11]
  ds_read_b64_tr_b16 a[104:105], v12 offset:10496
  v_mfma_f32_16x16x32_bf16 a[12:15], a[124:127], a[188:191], a[12:15]
  s_waitcnt lgkmcnt(11)
  ds_read_b64_tr_b16 a[106:107], v12 offset:15616
  v_mfma_f32_16x16x32_bf16 a[16:19], a[80:83], a[184:187], a[16:19]
  ds_read_b64_tr_b16 a[108:109], v13 offset:10496
  v_mfma_f32_16x16x32_bf16 a[20:23], a[80:83], a[188:191], a[20:23]
  s_waitcnt lgkmcnt(11)
  ds_read_b64_tr_b16 a[110:111], v13 offset:15616
  v_mfma_f32_16x16x32_bf16 a[24:27], a[84:87], a[184:187], a[24:27]
  ds_read_b64_tr_b16 a[112:113], v12 offset:20480
  v_mfma_f32_16x16x32_bf16 a[28:31], a[84:87], a[188:191], a[28:31]
  s_waitcnt lgkmcnt(11)
  ds_read_b64_tr_b16 a[114:115], v12 offset:25600
  v_mfma_f32_16x16x32_bf16 a[32:35], a[88:91], a[184:187], a[32:35]
  ds_read_b64_tr_b16 a[116:117], v13 offset:20480
  v_mfma_f32_16x16x32_bf16 a[36:39], a[88:91], a[188:191], a[36:39]
  s_waitcnt lgkmcnt(11)
  ds_read_b64_tr_b16 a[118:119], v13 offset:25600
  v_mfma_f32_16x16x32_bf16 a[40:43], a[92:95], a[184:187], a[40:43]
  ds_read_b64_tr_b16 a[120:121], v12 offset:20544
  v_mfma_f32_16x16x32_bf16 a[44:47], a[92:95], a[188:191], a[44:47]
  s_waitcnt lgkmcnt(11)
  ds_read_b64_tr_b16 a[122:123], v12 offset:25664
  v_mfma_f32_16x16x32_bf16 a[48:51], a[96:99], a[184:187], a[48:51]
  ds_read_b64_tr_b16 a[124:125], v13 offset:20544
  v_mfma_f32_16x16x32_bf16 a[52:55], a[96:99], a[188:191], a[52:55]
  s_waitcnt lgkmcnt(11)
  ds_read_b64_tr_b16 a[126:127], v13 offset:25664
  v_mfma_f32_16x16x32_bf16 a[56:59], a[100:103], a[184:187], a[56:59]
  ds_read_b64_tr_b16 a[80:81], v12 offset:20608
  v_mfma_f32_16x16x32_bf16 a[60:63], a[100:103], a[188:191], a[60:63]
  s_waitcnt lgkmcnt(11)
  ds_read_b64_tr_b16 a[82:83], v12 offset:25728
  v_mfma_f32_16x16x32_bf16 a[64:67], a[104:107], a[184:187], a[64:67]
  s_waitcnt vmcnt(4)
  ds_read_b64_tr_b16 a[84:85], v13 offset:20608
  v_mfma_f32_16x16x32_bf16 a[68:71], a[104:107], a[188:191], a[68:71]
  s_waitcnt lgkmcnt(11)
  ds_read_b64_tr_b16 a[86:87], v13 offset:25728
  v_mfma_f32_16x16x32_bf16 a[72:75], a[108:111], a[184:187], a[72:75]
  s_barrier
  ds_read_b64_tr_b16 a[88:89], v12 offset:20672
  v_mfma_f32_16x16x32_bf16 a[76:79], a[108:111], a[188:191], a[76:79]
  s_waitcnt lgkmcnt(11)
  ds_read_b64_tr_b16 a[90:91], v12 offset:25792
  v_mfma_f32_16x16x32_bf16 a[0:3], a[112:115], a[192:195], a[0:3]
  ds_read_b64_tr_b16 a[92:93], v13 offset:20672
  v_mfma_f32_16x16x32_bf16 a[4:7], a[112:115], a[196:199], a[4:7]
  s_waitcnt lgkmcnt(11)
  ds_read_b64_tr_b16 a[94:95], v13 offset:25792
  v_mfma_f32_16x16x32_bf16 a[8:11], a[116:119], a[192:195], a[8:11]
  ds_read_b64_tr_b16 a[96:97], v12 offset:20736
  v_mfma_f32_16x16x32_bf16 a[12:15], a[116:119], a[196:199], a[12:15]
  s_waitcnt lgkmcnt(11)
  ds_read_b64_tr_b16 a[98:99], v12 offset:25856
  v_mfma_f32_16x16x32_bf16 a[16:19], a[120:123], a[192:195], a[16:19]
  ds_read_b64_tr_b16 a[100:101], v13 offset:20736
  v_mfma_f32_16x16x32_bf16 a[20:23], a[120:123], a[196:199], a[20:23]
  s_waitcnt lgkmcnt(11)
  ds_read_b64_tr_b16 a[102:103], v13 offset:25856
  v_mfma_f32_16x16x32_bf16 a[24:27], a[124:127], a[192:195], a[24:27]
  ds_read_b64_tr_b16 a[104:105], v12 offset:30720
  v_mfma_f32_16x16x32_bf16 a[28:31], a[124:127], a[196:199], a[28:31]
  s_waitcnt lgkmcnt(11)
  ds_read_b64_tr_b16 a[106:107], v12 offset:35840
  v_mfma_f32_16x16x32_bf16 a[32:35], a[80:83], a[192:195], a[32:35]
  ds_read_b64_tr_b16 a[108:109], v13 offset:30720
  v_mfma_f32_16x16x32_bf16 a[36:39], a[80:83], a[196:199], a[36:39]
  s_waitcnt lgkmcnt(11)
  ds_read_b64_tr_b16 a[110:111], v13 offset:35840
  v_mfma_f32_16x16x32_bf16 a[40:43], a[84:87], a[192:195], a[40:43]
  ds_read_b64_tr_b16 a[112:113], v12 offset:30784
  v_mfma_f32_16x16x32_bf16 a[44:47], a[84:87], a[196:199], a[44:47]
  s_waitcnt lgkmcnt(11)
  ds_read_b64_tr_b16 a[114:115], v12 offset:35904
  v_mfma_f32_16x16x32_bf16 a[48:51], a[88:91], a[192:195], a[48:51]
  ds_read_b64_tr_b16 a[116:117], v13 offset:30784
  v_mfma_f32_16x16x32_bf16 a[52:55], a[88:91], a[196:199], a[52:55]
  s_waitcnt lgkmcnt(11)
  ds_read_b64_tr_b16 a[118:119], v13 offset:35904
  v_mfma_f32_16x16x32_bf16 a[56:59], a[92:95], a[192:195], a[56:59]
  ds_read_b64_tr_b16 a[120:121], v12 offset:30848
  v_mfma_f32_16x16x32_bf16 a[60:63], a[92:95], a[196:199], a[60:63]
  s_waitcnt lgkmcnt(11)
  ds_read_b64_tr_b16 a[122:123], v12 offset:35968
  v_mfma_f32_16x16x32_bf16 a[64:67], a[96:99], a[192:195], a[64:67]
  ds_read_b64_tr_b16 a[124:125], v13 offset:30848
  v_mfma_f32_16x16x32_bf16 a[68:71], a[96:99], a[196:199], a[68:71]
  s_waitcnt lgkmcnt(11)
  ds_read_b64_tr_b16 a[126:127], v13 offset:35968
  v_mfma_f32_16x16x32_bf16 a[72:75], a[100:103], a[192:195], a[72:75]
  s_waitcnt vmcnt(9)
  ds_read_b64_tr_b16 a[80:81], v12 offset:30912
  v_mfma_f32_16x16x32_bf16 a[76:79], a[100:103], a[196:199], a[76:79]
  s_waitcnt lgkmcnt(11)
  ds_read_b64_tr_b16 a[82:83], v12 offset:36032
  v_mfma_f32_16x16x32_bf16 a[0:3], a[104:107], a[200:203], a[0:3]
  ds_read_b64_tr_b16 a[84:85], v13 offset:30912
  v_mfma_f32_16x16x32_bf16 a[4:7], a[104:107], a[204:207], a[4:7]
  s_waitcnt lgkmcnt(11)
  ds_read_b64_tr_b16 a[86:87], v13 offset:36032
  v_mfma_f32_16x16x32_bf16 a[8:11], a[108:111], a[200:203], a[8:11]
  ds_read_b64_tr_b16 a[88:89], v12 offset:30976
  v_mfma_f32_16x16x32_bf16 a[12:15], a[108:111], a[204:207], a[12:15]
  s_waitcnt lgkmcnt(11)
  ds_read_b64_tr_b16 a[90:91], v12 offset:36096
  v_mfma_f32_16x16x32_bf16 a[16:19], a[112:115], a[200:203], a[16:19]
  ds_read_b64_tr_b16 a[92:93], v13 offset:30976
  v_mfma_f32_16x16x32_bf16 a[20:23], a[112:115], a[204:207], a[20:23]
  s_waitcnt lgkmcnt(11)
  ds_read_b64_tr_b16 a[94:95], v13 offset:36096
  v_mfma_f32_16x16x32_bf16 a[24:27], a[116:119], a[200:203], a[24:27]
  ds_read_b64_tr_b16 a[96:97], v12 offset:40960
  v_mfma_f32_16x16x32_bf16 a[28:31], a[116:119], a[204:207], a[28:31]
  s_waitcnt lgkmcnt(11)
  ds_read_b64_tr_b16 a[98:99], v12 offset:46080
  v_mfma_f32_16x16x32_bf16 a[32:35], a[120:123], a[200:203], a[32:35]
  ds_read_b64_tr_b16 a[100:101], v13 offset:40960
  v_mfma_f32_16x16x32_bf16 a[36:39], a[120:123], a[204:207], a[36:39]
  s_waitcnt lgkmcnt(11)
  ds_read_b64_tr_b16 a[102:103], v13 offset:46080
  v_mfma_f32_16x16x32_bf16 a[40:43], a[124:127], a[200:203], a[40:43]
  ds_read_b64_tr_b16 a[104:105], v12 offset:41024
  v_mfma_f32_16x16x32_bf16 a[44:47], a[124:127], a[204:207], a[44:47]
  s_waitcnt lgkmcnt(11)
  ds_read_b64_tr_b16 a[106:107], v12 offset:46144
  v_mfma_f32_16x16x32_bf16 a[48:51], a[80:83], a[200:203], a[48:51]
  ds_read_b64_tr_b16 a[108:109], v13 offset:41024
  v_mfma_f32_16x16x32_bf16 a[52:55], a[80:83], a[204:207], a[52:55]
  s_waitcnt lgkmcnt(11)
  ds_read_b64_tr_b16 a[110:111], v13 offset:46144
  v_mfma_f32_16x16x32_bf16 a[56:59], a[84:87], a[200:203], a[56:59]
  ds_read_b64_tr_b16 a[112:113], v12 offset:41088
  v_mfma_f32_16x16x32_bf16 a[60:63], a[84:87], a[204:207], a[60:63]
  s_waitcnt lgkmcnt(11)
  ds_read_b64_tr_b16 a[114:115], v12 offset:46208
  v_mfma_f32_16x16x32_bf16 a[64:67], a[88:91], a[200:203], a[64:67]
  s_waitcnt vmcnt(2)
  ds_read_b64_tr_b16 a[116:117], v13 offset:41088
  v_mfma_f32_16x16x32_bf16 a[68:71], a[88:91], a[204:207], a[68:71]
  s_waitcnt lgkmcnt(11)
  ds_read_b64_tr_b16 a[118:119], v13 offset:46208
  v_mfma_f32_16x16x32_bf16 a[72:75], a[92:95], a[200:203], a[72:75]
  s_barrier
  ds_read_b64_tr_b16 a[120:121], v12 offset:41152
  v_mfma_f32_16x16x32_bf16 a[76:79], a[92:95], a[204:207], a[76:79]
  s_waitcnt lgkmcnt(11)
  ds_read_b64_tr_b16 a[122:123], v12 offset:46272
  v_mfma_f32_16x16x32_bf16 a[0:3], a[96:99], a[208:211], a[0:3]
  ds_read_b64_tr_b16 a[124:125], v13 offset:41152
  v_mfma_f32_16x16x32_bf16 a[4:7], a[96:99], a[212:215], a[4:7]
  s_waitcnt lgkmcnt(11)
  ds_read_b64_tr_b16 a[126:127], v13 offset:46272
  v_mfma_f32_16x16x32_bf16 a[8:11], a[100:103], a[208:211], a[8:11]
  ds_read_b64_tr_b16 a[80:81], v12 offset:41216
  v_mfma_f32_16x16x32_bf16 a[12:15], a[100:103], a[212:215], a[12:15]
  s_waitcnt lgkmcnt(11)
  ds_read_b64_tr_b16 a[82:83], v12 offset:46336
  v_mfma_f32_16x16x32_bf16 a[16:19], a[104:107], a[208:211], a[16:19]
  ds_read_b64_tr_b16 a[84:85], v13 offset:41216
  v_mfma_f32_16x16x32_bf16 a[20:23], a[104:107], a[212:215], a[20:23]
  s_waitcnt lgkmcnt(11)
  ds_read_b64_tr_b16 a[86:87], v13 offset:46336
  v_mfma_f32_16x16x32_bf16 a[24:27], a[108:111], a[208:211], a[24:27]
  ds_read_b64_tr_b16 a[88:89], v12 offset:51200
  v_mfma_f32_16x16x32_bf16 a[28:31], a[108:111], a[212:215], a[28:31]
  s_waitcnt lgkmcnt(11)
  ds_read_b64_tr_b16 a[90:91], v12 offset:56320
  v_mfma_f32_16x16x32_bf16 a[32:35], a[112:115], a[208:211], a[32:35]
  ds_read_b64_tr_b16 a[92:93], v13 offset:51200
  v_mfma_f32_16x16x32_bf16 a[36:39], a[112:115], a[212:215], a[36:39]
  s_waitcnt lgkmcnt(11)
  ds_read_b64_tr_b16 a[94:95], v13 offset:56320
  v_mfma_f32_16x16x32_bf16 a[40:43], a[116:119], a[208:211], a[40:43]
  ds_read_b64_tr_b16 a[96:97], v12 offset:51264
  v_mfma_f32_16x16x32_bf16 a[44:47], a[116:119], a[212:215], a[44:47]
  s_waitcnt lgkmcnt(11)
  ds_read_b64_tr_b16 a[98:99], v12 offset:56384
  v_mfma_f32_16x16x32_bf16 a[48:51], a[120:123], a[208:211], a[48:51]
  ds_read_b64_tr_b16 a[100:101], v13 offset:51264
  v_mfma_f32_16x16x32_bf16 a[52:55], a[120:123], a[212:215], a[52:55]
  s_waitcnt lgkmcnt(11)
  ds_read_b64_tr_b16 a[102:103], v13 offset:56384
  v_mfma_f32_16x16x32_bf16 a[56:59], a[124:127], a[208:211], a[56:59]
  ds_read_b64_tr_b16 a[104:105], v12 offset:51328
  v_mfma_f32_16x16x32_bf16 a[60:63], a[124:127], a[212:215], a[60:63]
  s_waitcnt lgkmcnt(11)
  ds_read_b64_tr_b16 a[106:107], v12 offset:56448
  v_mfma_f32_16x16x32_bf16 a[64:67], a[80:83], a[208:211], a[64:67]
  ds_read_b64_tr_b16 a[108:109], v13 offset:51328
  v_mfma_f32_16x16x32_bf16 a[68:71], a[80:83], a[212:215], a[68:71]
  s_waitcnt lgkmcnt(11)
  ds_read_b64_tr_b16 a[110:111], v13 offset:56448
  v_mfma_f32_16x16x32_bf16 a[72:75], a[84:87], a[208:211], a[72:75]
  s_waitcnt vmcnt(0)
  ds_read_b64_tr_b16 a[112:113], v12 offset:51392
  v_mfma_f32_16x16x32_bf16 a[76:79], a[84:87], a[212:215], a[76:79]
  s_waitcnt lgkmcnt(11)
  ds_read_b64_tr_b16 a[114:115], v12 offset:56512
  v_mfma_f32_16x16x32_bf16 a[0:3], a[88:91], a[216:219], a[0:3]
  ds_read_b64_tr_b16 a[116:117], v13 offset:51392
  v_mfma_f32_16x16x32_bf16 a[4:7], a[88:91], a[220:223], a[4:7]
  s_waitcnt lgkmcnt(11)
  ds_read_b64_tr_b16 a[118:119], v13 offset:56512
  v_mfma_f32_16x16x32_bf16 a[8:11], a[92:95], a[216:219], a[8:11]
  ds_read_b64_tr_b16 a[120:121], v12 offset:51456
  v_mfma_f32_16x16x32_bf16 a[12:15], a[92:95], a[220:223], a[12:15]
  s_waitcnt lgkmcnt(11)
  ds_read_b64_tr_b16 a[122:123], v12 offset:56576
  v_mfma_f32_16x16x32_bf16 a[16:19], a[96:99], a[216:219], a[16:19]
  ds_read_b64_tr_b16 a[124:125], v13 offset:51456
  v_mfma_f32_16x16x32_bf16 a[20:23], a[96:99], a[220:223], a[20:23]
  s_waitcnt lgkmcnt(11)
  ds_read_b64_tr_b16 a[126:127], v13 offset:56576
  v_mfma_f32_16x16x32_bf16 a[24:27], a[100:103], a[216:219], a[24:27]
  v_mfma_f32_16x16x32_bf16 a[28:31], a[100:103], a[220:223], a[28:31]
  s_waitcnt lgkmcnt(10)
  v_mfma_f32_16x16x32_bf16 a[32:35], a[104:107], a[216:219], a[32:35]
  v_mfma_f32_16x16x32_bf16 a[36:39], a[104:107], a[220:223], a[36:39]
  s_waitcnt lgkmcnt(8)
  v_mfma_f32_16x16x32_bf16 a[40:43], a[108:111], a[216:219], a[40:43]
  v_mfma_f32_16x16x32_bf16 a[44:47], a[108:111], a[220:223], a[44:47]
  s_waitcnt lgkmcnt(6)
  v_mfma_f32_16x16x32_bf16 a[48:51], a[112:115], a[216:219], a[48:51]
  v_mfma_f32_16x16x32_bf16 a[52:55], a[112:115], a[220:223], a[52:55]
  s_waitcnt lgkmcnt(4)
  v_mfma_f32_16x16x32_bf16 a[56:59], a[116:119], a[216:219], a[56:59]
  v_mfma_f32_16x16x32_bf16 a[60:63], a[116:119], a[220:223], a[60:63]
  s_waitcnt lgkmcnt(2)
  v_mfma_f32_16x16x32_bf16 a[64:67], a[120:123], a[216:219], a[64:67]
  v_mfma_f32_16x16x32_bf16 a[68:71], a[120:123], a[220:223], a[68:71]
  s_waitcnt lgkmcnt(0)
  v_mfma_f32_16x16x32_bf16 a[72:75], a[124:127], a[216:219], a[72:75]
  v_mfma_f32_16x16x32_bf16 a[76:79], a[124:127], a[220:223], a[76:79]
  s_nop 7
  v_accvgpr_read_b32 v24, a0
  v_accvgpr_read_b32 v28, a8
  v_accvgpr_read_b32 v25, a1
  v_accvgpr_read_b32 v29, a9
  v_accvgpr_read_b32 v26, a2
  v_accvgpr_read_b32 v30, a10
  v_accvgpr_read_b32 v27, a3
  v_accvgpr_read_b32 v31, a11
  v_cvt_pk_bf16_f32 v32, v24, v25
  v_cvt_pk_bf16_f32 v33, v26, v27
  v_cvt_pk_bf16_f32 v34, v28, v29
  v_cvt_pk_bf16_f32 v35, v30, v31
  buffer_store_dwordx4 v[32:35], v19, s[16:19], s34 offen offset:0 sc1
  v_accvgpr_read_b32 v36, a16
  v_accvgpr_read_b32 v40, a24
  v_accvgpr_read_b32 v37, a17
  v_accvgpr_read_b32 v41, a25
  v_accvgpr_read_b32 v38, a18
  v_accvgpr_read_b32 v42, a26
  v_accvgpr_read_b32 v39, a19
  v_accvgpr_read_b32 v43, a27
  v_cvt_pk_bf16_f32 v44, v36, v37
  v_cvt_pk_bf16_f32 v45, v38, v39
  v_cvt_pk_bf16_f32 v46, v40, v41
  v_cvt_pk_bf16_f32 v47, v42, v43
  buffer_store_dwordx4 v[44:47], v19, s[16:19], s34 offen offset:1024 sc1
  v_accvgpr_read_b32 v48, a32
  v_accvgpr_read_b32 v52, a40
  v_accvgpr_read_b32 v49, a33
  v_accvgpr_read_b32 v53, a41
  v_accvgpr_read_b32 v50, a34
  v_accvgpr_read_b32 v54, a42
  v_accvgpr_read_b32 v51, a35
  v_accvgpr_read_b32 v55, a43
  v_cvt_pk_bf16_f32 v56, v48, v49
  v_cvt_pk_bf16_f32 v57, v50, v51
  v_cvt_pk_bf16_f32 v58, v52, v53
  v_cvt_pk_bf16_f32 v59, v54, v55
  buffer_store_dwordx4 v[56:59], v19, s[16:19], s34 offen offset:2048 sc1
  v_accvgpr_read_b32 v60, a48
  v_accvgpr_read_b32 v64, a56
  v_accvgpr_read_b32 v61, a49
  v_accvgpr_read_b32 v65, a57
  v_accvgpr_read_b32 v62, a50
  v_accvgpr_read_b32 v66, a58
  v_accvgpr_read_b32 v63, a51
  v_accvgpr_read_b32 v67, a59
  v_cvt_pk_bf16_f32 v68, v60, v61
  v_cvt_pk_bf16_f32 v69, v62, v63
  v_cvt_pk_bf16_f32 v70, v64, v65
  v_cvt_pk_bf16_f32 v71, v66, v67
  buffer_store_dwordx4 v[68:71], v19, s[16:19], s34 offen offset:3072 sc1
  v_accvgpr_read_b32 v24, a64
  v_accvgpr_read_b32 v28, a72
  v_accvgpr_read_b32 v25, a65
  v_accvgpr_read_b32 v29, a73
  v_accvgpr_read_b32 v26, a66
  v_accvgpr_read_b32 v30, a74
  v_accvgpr_read_b32 v27, a67
  v_accvgpr_read_b32 v31, a75
  v_cvt_pk_bf16_f32 v32, v24, v25
  v_cvt_pk_bf16_f32 v33, v26, v27
  v_cvt_pk_bf16_f32 v34, v28, v29
  v_cvt_pk_bf16_f32 v35, v30, v31
  s_add_u32 s34, s34, 4096
  buffer_store_dwordx4 v[32:35], v19, s[16:19], s34 offen offset:0 sc1
  s_add_u32 s34, s34, 16384
  v_accvgpr_read_b32 v36, a4
  v_accvgpr_read_b32 v40, a12
  v_accvgpr_read_b32 v37, a5
  v_accvgpr_read_b32 v41, a13
  v_accvgpr_read_b32 v38, a6
  v_accvgpr_read_b32 v42, a14
  v_accvgpr_read_b32 v39, a7
  v_accvgpr_read_b32 v43, a15
  v_cvt_pk_bf16_f32 v44, v36, v37
  v_cvt_pk_bf16_f32 v45, v38, v39
  v_cvt_pk_bf16_f32 v46, v40, v41
  v_cvt_pk_bf16_f32 v47, v42, v43
  buffer_store_dwordx4 v[44:47], v19, s[16:19], s34 offen offset:0 sc1
  v_accvgpr_read_b32 v48, a20
  v_accvgpr_read_b32 v52, a28
  v_accvgpr_read_b32 v49, a21
  v_accvgpr_read_b32 v53, a29
  v_accvgpr_read_b32 v50, a22
  v_accvgpr_read_b32 v54, a30
  v_accvgpr_read_b32 v51, a23
  v_accvgpr_read_b32 v55, a31
  v_cvt_pk_bf16_f32 v56, v48, v49
  v_cvt_pk_bf16_f32 v57, v50, v51
  v_cvt_pk_bf16_f32 v58, v52, v53
  v_cvt_pk_bf16_f32 v59, v54, v55
  buffer_store_dwordx4 v[56:59], v19, s[16:19], s34 offen offset:1024 sc1
  v_accvgpr_read_b32 v60, a36
  v_accvgpr_read_b32 v64, a44
  v_accvgpr_read_b32 v61, a37
  v_accvgpr_read_b32 v65, a45
  v_accvgpr_read_b32 v62, a38
  v_accvgpr_read_b32 v66, a46
  v_accvgpr_read_b32 v63, a39
  v_accvgpr_read_b32 v67, a47
  v_cvt_pk_bf16_f32 v68, v60, v61
  v_cvt_pk_bf16_f32 v69, v62, v63
  v_cvt_pk_bf16_f32 v70, v64, v65
  v_cvt_pk_bf16_f32 v71, v66, v67
  buffer_store_dwordx4 v[68:71], v19, s[16:19], s34 offen offset:2048 sc1
  v_accvgpr_read_b32 v24, a52
  v_accvgpr_read_b32 v28, a60
  v_accvgpr_read_b32 v25, a53
  v_accvgpr_read_b32 v29, a61
  v_accvgpr_read_b32 v26, a54
  v_accvgpr_read_b32 v30, a62
  v_accvgpr_read_b32 v27, a55
  v_accvgpr_read_b32 v31, a63
  v_cvt_pk_bf16_f32 v32, v24, v25
  v_cvt_pk_bf16_f32 v33, v26, v27
  v_cvt_pk_bf16_f32 v34, v28, v29
  v_cvt_pk_bf16_f32 v35, v30, v31
  buffer_store_dwordx4 v[32:35], v19, s[16:19], s34 offen offset:3072 sc1
  v_accvgpr_read_b32 v36, a68
  v_accvgpr_read_b32 v40, a76
  v_accvgpr_read_b32 v37, a69
  v_accvgpr_read_b32 v41, a77
  v_accvgpr_read_b32 v38, a70
  v_accvgpr_read_b32 v42, a78
  v_accvgpr_read_b32 v39, a71
  v_accvgpr_read_b32 v43, a79
  v_cvt_pk_bf16_f32 v44, v36, v37
  v_cvt_pk_bf16_f32 v45, v38, v39
  v_cvt_pk_bf16_f32 v46, v40, v41
  v_cvt_pk_bf16_f32 v47, v42, v43
  s_add_u32 s34, s34, 4096
  buffer_store_dwordx4 v[44:47], v19, s[16:19], s34 offen offset:0 sc1
  s_waitcnt vmcnt(0) lgkmcnt(0)
  s_barrier
  s_lshl_b32 s90, s2, 2
  s_add_u32 s90, s90, 8192
  v_mov_b32 v250, 1
  v_mov_b32 v251, s90
  v_cmp_eq_u32 vcc, 0, v0
  s_and_saveexec_b64 s[92:93], vcc
  s_cbranch_execz L_gb_a_e
  buffer_store_dword v250, v251, s[96:99], 0 offen sc1
L_gb_a_e:
  s_mov_b64 exec, s[92:93]
  s_load_dwordx2 s[42:43], s[0:1], 104
  s_load_dwordx2 s[4:5], s[0:1], 0
  s_load_dwordx2 s[8:9], s[0:1], 104
  s_load_dwordx2 s[10:11], s[0:1], 48
  s_load_dwordx2 s[54:55], s[0:1], 56
  s_load_dwordx2 s[74:75], s[0:1], 88
  s_waitcnt lgkmcnt(0)
  s_and_b32 s3, s2, 7
  s_lshr_b32 s60, s2, 3
  s_lshl_b32 s61, s3, 5
  s_add_u32 s72, s61, s60
  s_mov_b32 s63, 0
  s_mov_b32 s12, s4
  s_mov_b32 s13, s5
  s_mov_b32 s14, 0x280000
  s_mov_b32 s15, 0x20000
  s_add_u32 s16, s8, 0x10000
  s_addc_u32 s17, s9, 0
  s_mov_b32 s18, 0x3c00
  s_mov_b32 s19, 0x20000
  s_add_u32 s20, s8, 0x3800000
  s_addc_u32 s21, s9, 0
  s_mov_b32 s22, 0x280000
  s_mov_b32 s23, 0x20000
  s_add_u32 s44, s8, 0x2000000
  s_addc_u32 s45, s9, 0
  s_mov_b32 s46, 0xa00000
  s_mov_b32 s47, 0x20000
  s_add_u32 s48, s8, 0x3400000
  s_addc_u32 s49, s9, 0
  s_mov_b32 s50, 0x280000
  s_mov_b32 s51, 0x20000
  v_lshrrev_b32 v1, 6, v0
  v_and_b32 v2, 63, v0
  v_readfirstlane_b32 s24, v1
  v_and_b32 v3, 7, v2
  v_bfe_u32 v4, v2, 3, 2
  v_lshrrev_b32 v5, 5, v2
  v_lshlrev_b32 v18, 8, v4
  v_lshlrev_b32 v19, 4, v3
  v_add_u32 v18, v18, v19
  s_and_b32 s33, s72, 1
  s_lshl_b32 s33, s33, 7
  v_add_u32 v18, s33, v18
  s_mov_b32 s30, 2621440
  v_mul_lo_u32 v6, s30, v5
  v_add_u32 v6, v6, v18
  s_lshr_b32 s34, s72, 1
  s_mul_i32 s52, s34, 20480
  s_mul_i32 s53, s24, 5120
  s_add_u32 s52, s52, s53
  v_mov_b32 v11, v6
  s_mov_b32 s30, 1280
  v_mul_lo_u32 v6, s30, v3
  v_lshlrev_b32 v7, 5, v5
  v_add_u32 v6, v6, v7
  v_lshlrev_b32 v7, 3, v4
  v_add_u32 v6, v6, v7
  s_mul_i32 s25, s72, 10240
  s_mul_i32 s26, s24, 320
  s_add_u32 s25, s25, s26
  buffer_load_dwordx2 v[104:105], v6, s[12:15], s25 offen offset:0
  buffer_load_dwordx2 v[106:107], v6, s[12:15], s25 offen offset:64
  buffer_load_dwordx2 v[108:109], v6, s[12:15], s25 offen offset:128
  buffer_load_dwordx2 v[110:111], v6, s[12:15], s25 offen offset:192
  buffer_load_dwordx2 v[112:113], v6, s[12:15], s25 offen offset:256
  v_lshlrev_b32 v8, 6, v5
  v_lshlrev_b32 v10, 4, v4
  v_add_u32 v8, v8, v10
  s_mul_i32 s27, s24, 640
  s_add_u32 s28, s27, 5120
  buffer_load_dwordx4 v[116:119], v8, s[16:19], s28 offen offset:0
  buffer_load_dwordx4 v[120:123], v8, s[16:19], s28 offen offset:128
  buffer_load_dwordx4 v[124:127], v8, s[16:19], s28 offen offset:256
  buffer_load_dwordx4 v[128:131], v8, s[16:19], s28 offen offset:384
  buffer_load_dwordx4 v[132:135], v8, s[16:19], s28 offen offset:512
  s_add_u32 s28, s27, 7680
  buffer_load_dwordx4 v[136:139], v8, s[16:19], s28 offen offset:0
  buffer_load_dwordx4 v[140:143], v8, s[16:19], s28 offen offset:128
  buffer_load_dwordx4 v[144:147], v8, s[16:19], s28 offen offset:256
  buffer_load_dwordx4 v[148:151], v8, s[16:19], s28 offen offset:384
  buffer_load_dwordx4 v[152:155], v8, s[16:19], s28 offen offset:512
  s_add_u32 s28, s27, 10240
  buffer_load_dwordx4 v[156:159], v8, s[16:19], s28 offen offset:0
  buffer_load_dwordx4 v[160:163], v8, s[16:19], s28 offen offset:128
  buffer_load_dwordx4 v[164:167], v8, s[16:19], s28 offen offset:256
  buffer_load_dwordx4 v[168:171], v8, s[16:19], s28 offen offset:384
  buffer_load_dwordx4 v[172:175], v8, s[16:19], s28 offen offset:512
  v_mov_b32 v206, v1
  v_mov_b32 v207, v2
  v_mov_b32 v1, v206
  v_mov_b32 v2, v207
  v_lshlrev_b32 v210, 4, v2
  s_cmp_lg_u32 s24, 0
  s_cbranch_scc1 L_gb_j_e
  v_lshlrev_b32 v250, 2, v0
  s_mov_b32 s90, 0
  s_mov_b32 s91, 8192
L_gb_p_e:
  buffer_load_dword v246, v250, s[96:99], s91 offen offset:0 sc1
  buffer_load_dword v247, v250, s[96:99], s91 offen offset:256 sc1
  buffer_load_dword v248, v250, s[96:99], s91 offen offset:512 sc1
  buffer_load_dword v249, v250, s[96:99], s91 offen offset:768 sc1
  s_waitcnt vmcnt(0)
  v_and_b32 v246, v246, v247
  v_and_b32 v248, v248, v249
  v_and_b32 v246, v246, v248
  v_cmp_ne_u32 vcc, 1, v246
  s_add_u32 s90, s90, 1
  s_cmp_ge_u32 s90, 0x20000
  s_cbranch_scc1 L_gb_j_e
  s_cbranch_vccz L_gb_j_e
  s_sleep 10
  s_branch L_gb_p_e
L_gb_j_e:
  s_barrier
  buffer_load_dwordx4 v[64:67], v11, s[44:47], s52 offen offset:0 sc1
  buffer_load_dwordx4 v[68:71], v11, s[44:47], s52 offen offset:1024 sc1
  buffer_load_dwordx4 v[72:75], v11, s[44:47], s52 offen offset:2048 sc1
  buffer_load_dwordx4 v[76:79], v11, s[44:47], s52 offen offset:3072 sc1
  s_add_u32 s52, s52, 4096
  buffer_load_dwordx4 v[80:83], v11, s[44:47], s52 offen offset:0 sc1
  s_add_u32 s52, s52, 5238784
  buffer_load_dwordx4 v[84:87], v11, s[44:47], s52 offen offset:0 sc1
  buffer_load_dwordx4 v[88:91], v11, s[44:47], s52 offen offset:1024 sc1
  buffer_load_dwordx4 v[92:95], v11, s[44:47], s52 offen offset:2048 sc1
  buffer_load_dwordx4 v[96:99], v11, s[44:47], s52 offen offset:3072 sc1
  s_add_u32 s52, s52, 4096
  buffer_load_dwordx4 v[100:103], v11, s[44:47], s52 offen offset:0 sc1
  s_waitcnt vmcnt(4)
  v_lshlrev_b32 v20, 16, v64
  v_and_b32 v21, 0xffff0000, v64
  v_lshlrev_b32 v60, 16, v84
  v_and_b32 v61, 0xffff0000, v84
  v_add_f32 v20, v20, v60
  v_add_f32 v21, v21, v61
  v_lshlrev_b32 v22, 16, v65
  v_and_b32 v23, 0xffff0000, v65
  v_lshlrev_b32 v60, 16, v85
  v_and_b32 v61, 0xffff0000, v85
  v_add_f32 v22, v22, v60
  v_add_f32 v23, v23, v61
  v_lshlrev_b32 v40, 16, v66
  v_and_b32 v41, 0xffff0000, v66
  v_lshlrev_b32 v60, 16, v86
  v_and_b32 v61, 0xffff0000, v86
  v_add_f32 v40, v40, v60
  v_add_f32 v41, v41, v61
  v_lshlrev_b32 v42, 16, v67
  v_and_b32 v43, 0xffff0000, v67
  v_lshlrev_b32 v60, 16, v87
  v_and_b32 v61, 0xffff0000, v87
  v_add_f32 v42, v42, v60
  v_add_f32 v43, v43, v61
  s_waitcnt vmcnt(3)
  v_lshlrev_b32 v24, 16, v68
  v_and_b32 v25, 0xffff0000, v68
  v_lshlrev_b32 v60, 16, v88
  v_and_b32 v61, 0xffff0000, v88
  v_add_f32 v24, v24, v60
  v_add_f32 v25, v25, v61
  v_lshlrev_b32 v26, 16, v69
  v_and_b32 v27, 0xffff0000, v69
  v_lshlrev_b32 v60, 16, v89
  v_and_b32 v61, 0xffff0000, v89
  v_add_f32 v26, v26, v60
  v_add_f32 v27, v27, v61
  v_lshlrev_b32 v44, 16, v70
  v_and_b32 v45, 0xffff0000, v70
  v_lshlrev_b32 v60, 16, v90
  v_and_b32 v61, 0xffff0000, v90
  v_add_f32 v44, v44, v60
  v_add_f32 v45, v45, v61
  v_lshlrev_b32 v46, 16, v71
  v_and_b32 v47, 0xffff0000, v71
  v_lshlrev_b32 v60, 16, v91
  v_and_b32 v61, 0xffff0000, v91
  v_add_f32 v46, v46, v60
  v_add_f32 v47, v47, v61
  s_waitcnt vmcnt(2)
  v_lshlrev_b32 v28, 16, v72
  v_and_b32 v29, 0xffff0000, v72
  v_lshlrev_b32 v60, 16, v92
  v_and_b32 v61, 0xffff0000, v92
  v_add_f32 v28, v28, v60
  v_add_f32 v29, v29, v61
  v_lshlrev_b32 v30, 16, v73
  v_and_b32 v31, 0xffff0000, v73
  v_lshlrev_b32 v60, 16, v93
  v_and_b32 v61, 0xffff0000, v93
  v_add_f32 v30, v30, v60
  v_add_f32 v31, v31, v61
  v_lshlrev_b32 v48, 16, v74
  v_and_b32 v49, 0xffff0000, v74
  v_lshlrev_b32 v60, 16, v94
  v_and_b32 v61, 0xffff0000, v94
  v_add_f32 v48, v48, v60
  v_add_f32 v49, v49, v61
  v_lshlrev_b32 v50, 16, v75
  v_and_b32 v51, 0xffff0000, v75
  v_lshlrev_b32 v60, 16, v95
  v_and_b32 v61, 0xffff0000, v95
  v_add_f32 v50, v50, v60
  v_add_f32 v51, v51, v61
  s_waitcnt vmcnt(1)
  v_lshlrev_b32 v32, 16, v76
  v_and_b32 v33, 0xffff0000, v76
  v_lshlrev_b32 v60, 16, v96
  v_and_b32 v61, 0xffff0000, v96
  v_add_f32 v32, v32, v60
  v_add_f32 v33, v33, v61
  v_lshlrev_b32 v34, 16, v77
  v_and_b32 v35, 0xffff0000, v77
  v_lshlrev_b32 v60, 16, v97
  v_and_b32 v61, 0xffff0000, v97
  v_add_f32 v34, v34, v60
  v_add_f32 v35, v35, v61
  v_lshlrev_b32 v52, 16, v78
  v_and_b32 v53, 0xffff0000, v78
  v_lshlrev_b32 v60, 16, v98
  v_and_b32 v61, 0xffff0000, v98
  v_add_f32 v52, v52, v60
  v_add_f32 v53, v53, v61
  v_lshlrev_b32 v54, 16, v79
  v_and_b32 v55, 0xffff0000, v79
  v_lshlrev_b32 v60, 16, v99
  v_and_b32 v61, 0xffff0000, v99
  v_add_f32 v54, v54, v60
  v_add_f32 v55, v55, v61
  s_waitcnt vmcnt(0)
  v_lshlrev_b32 v36, 16, v80
  v_and_b32 v37, 0xffff0000, v80
  v_lshlrev_b32 v60, 16, v100
  v_and_b32 v61, 0xffff0000, v100
  v_add_f32 v36, v36, v60
  v_add_f32 v37, v37, v61
  v_lshlrev_b32 v38, 16, v81
  v_and_b32 v39, 0xffff0000, v81
  v_lshlrev_b32 v60, 16, v101
  v_and_b32 v61, 0xffff0000, v101
  v_add_f32 v38, v38, v60
  v_add_f32 v39, v39, v61
  v_lshlrev_b32 v56, 16, v82
  v_and_b32 v57, 0xffff0000, v82
  v_lshlrev_b32 v60, 16, v102
  v_and_b32 v61, 0xffff0000, v102
  v_add_f32 v56, v56, v60
  v_add_f32 v57, v57, v61
  v_lshlrev_b32 v58, 16, v83
  v_and_b32 v59, 0xffff0000, v83
  v_lshlrev_b32 v60, 16, v103
  v_and_b32 v61, 0xffff0000, v103
  v_add_f32 v58, v58, v60
  v_add_f32 v59, v59, v61
  s_nop 0
  v_permlane32_swap_b32 v20, v40
  v_permlane32_swap_b32 v21, v41
  v_permlane32_swap_b32 v22, v42
  v_permlane32_swap_b32 v23, v43
  v_permlane32_swap_b32 v24, v44
  v_permlane32_swap_b32 v25, v45
  v_permlane32_swap_b32 v26, v46
  v_permlane32_swap_b32 v27, v47
  v_permlane32_swap_b32 v28, v48
  v_permlane32_swap_b32 v29, v49
  v_permlane32_swap_b32 v30, v50
  v_permlane32_swap_b32 v31, v51
  v_permlane32_swap_b32 v32, v52
  v_permlane32_swap_b32 v33, v53
  v_permlane32_swap_b32 v34, v54
  v_permlane32_swap_b32 v35, v55
  v_permlane32_swap_b32 v36, v56
  v_permlane32_swap_b32 v37, v57
  v_permlane32_swap_b32 v38, v58
  v_permlane32_swap_b32 v39, v59
  v_add_f32 v20, v20, v40
  v_add_f32 v21, v21, v41
  v_add_f32 v22, v22, v42
  v_add_f32 v23, v23, v43
  v_add_f32 v24, v24, v44
  v_add_f32 v25, v25, v45
  v_add_f32 v26, v26, v46
  v_add_f32 v27, v27, v47
  v_add_f32 v28, v28, v48
  v_add_f32 v29, v29, v49
  v_add_f32 v30, v30, v50
  v_add_f32 v31, v31, v51
  v_add_f32 v32, v32, v52
  v_add_f32 v33, v33, v53
  v_add_f32 v34, v34, v54
  v_add_f32 v35, v35, v55
  v_add_f32 v36, v36, v56
  v_add_f32 v37, v37, v57
  v_add_f32 v38, v38, v58
  v_add_f32 v39, v39, v59
  s_waitcnt vmcnt(20)
  v_lshlrev_b32 v60, 16, v104
  v_and_b32 v61, 0xffff0000, v104
  v_lshlrev_b32 v62, 16, v105
  v_and_b32 v63, 0xffff0000, v105
  v_fma_f32 v20, v20, v116, v60
  v_fma_f32 v21, v21, v117, v61
  v_fma_f32 v22, v22, v118, v62
  v_fma_f32 v23, v23, v119, v63
  v_lshlrev_b32 v60, 16, v106
  v_and_b32 v61, 0xffff0000, v106
  v_lshlrev_b32 v62, 16, v107
  v_and_b32 v63, 0xffff0000, v107
  v_fma_f32 v24, v24, v120, v60
  v_fma_f32 v25, v25, v121, v61
  v_fma_f32 v26, v26, v122, v62
  v_fma_f32 v27, v27, v123, v63
  v_lshlrev_b32 v60, 16, v108
  v_and_b32 v61, 0xffff0000, v108
  v_lshlrev_b32 v62, 16, v109
  v_and_b32 v63, 0xffff0000, v109
  v_fma_f32 v28, v28, v124, v60
  v_fma_f32 v29, v29, v125, v61
  v_fma_f32 v30, v30, v126, v62
  v_fma_f32 v31, v31, v127, v63
  v_lshlrev_b32 v60, 16, v110
  v_and_b32 v61, 0xffff0000, v110
  v_lshlrev_b32 v62, 16, v111
  v_and_b32 v63, 0xffff0000, v111
  v_fma_f32 v32, v32, v128, v60
  v_fma_f32 v33, v33, v129, v61
  v_fma_f32 v34, v34, v130, v62
  v_fma_f32 v35, v35, v131, v63
  v_lshlrev_b32 v60, 16, v112
  v_and_b32 v61, 0xffff0000, v112
  v_lshlrev_b32 v62, 16, v113
  v_and_b32 v63, 0xffff0000, v113
  v_fma_f32 v36, v36, v132, v60
  v_fma_f32 v37, v37, v133, v61
  v_fma_f32 v38, v38, v134, v62
  v_fma_f32 v39, v39, v135, v63
  v_lshlrev_b32 v19, 3, v5
  v_add_u32 v19, v19, v18
  s_mul_i32 s52, s34, 20480
  s_mul_i32 s53, s24, 5120
  s_add_u32 s52, s52, s53
  v_cvt_pk_bf16_f32 v40, v20, v21
  v_cvt_pk_bf16_f32 v41, v22, v23
  buffer_store_dwordx2 v[40:41], v19, s[48:51], s52 offen offset:0 sc1
  v_lshlrev_b32 v20, 16, v40
  v_and_b32 v21, 0xffff0000, v40
  v_lshlrev_b32 v22, 16, v41
  v_and_b32 v23, 0xffff0000, v41
  v_cvt_pk_bf16_f32 v42, v24, v25
  v_cvt_pk_bf16_f32 v43, v26, v27
  buffer_store_dwordx2 v[42:43], v19, s[48:51], s52 offen offset:1024 sc1
  v_lshlrev_b32 v24, 16, v42
  v_and_b32 v25, 0xffff0000, v42
  v_lshlrev_b32 v26, 16, v43
  v_and_b32 v27, 0xffff0000, v43
  v_cvt_pk_bf16_f32 v44, v28, v29
  v_cvt_pk_bf16_f32 v45, v30, v31
  buffer_store_dwordx2 v[44:45], v19, s[48:51], s52 offen offset:2048 sc1
  v_lshlrev_b32 v28, 16, v44
  v_and_b32 v29, 0xffff0000, v44
  v_lshlrev_b32 v30, 16, v45
  v_and_b32 v31, 0xffff0000, v45
  v_cvt_pk_bf16_f32 v46, v32, v33
  v_cvt_pk_bf16_f32 v47, v34, v35
  buffer_store_dwordx2 v[46:47], v19, s[48:51], s52 offen offset:3072 sc1
  v_lshlrev_b32 v32, 16, v46
  v_and_b32 v33, 0xffff0000, v46
  v_lshlrev_b32 v34, 16, v47
  v_and_b32 v35, 0xffff0000, v47
  v_cvt_pk_bf16_f32 v48, v36, v37
  v_cvt_pk_bf16_f32 v49, v38, v39
  s_add_u32 s52, s52, 4096
  buffer_store_dwordx2 v[48:49], v19, s[48:51], s52 offen offset:0 sc1
  v_lshlrev_b32 v36, 16, v48
  v_and_b32 v37, 0xffff0000, v48
  v_lshlrev_b32 v38, 16, v49
  v_and_b32 v39, 0xffff0000, v49
  v_lshlrev_b32 v9, 2, v3
  v_add_u32 v9, 98304, v9
  v_add_f32 v10, v20, v21
  v_add_f32 v12, v22, v23
  v_add_f32 v10, v10, v24
  v_add_f32 v12, v12, v25
  v_add_f32 v10, v10, v26
  v_add_f32 v12, v12, v27
  v_add_f32 v10, v10, v28
  v_add_f32 v12, v12, v29
  v_add_f32 v10, v10, v30
  v_add_f32 v12, v12, v31
  v_add_f32 v10, v10, v32
  v_add_f32 v12, v12, v33
  v_add_f32 v10, v10, v34
  v_add_f32 v12, v12, v35
  v_add_f32 v10, v10, v36
  v_add_f32 v12, v12, v37
  v_add_f32 v10, v10, v38
  v_add_f32 v12, v12, v39
  v_add_f32 v10, v10, v12
  s_nop 1
  v_add_f32_dpp v10, v10, v10 row_ror:8 row_mask:0xf bank_mask:0xf
  v_mov_b32 v12, v10
  s_nop 1
  v_permlane16_swap_b32 v10, v12
  v_add_f32 v10, v10, v12
  v_mov_b32 v12, v10
  s_nop 1
  v_permlane32_swap_b32 v10, v12
  v_add_f32 v10, v10, v12
  s_lshl_b32 s40, s24, 5
  v_add_u32 v13, s40, v9
  ds_write_b32 v13, v10 offset:0
  s_waitcnt lgkmcnt(0)
  s_barrier
  ds_read_b32 v14, v9 offset:0
  ds_read_b32 v15, v9 offset:32
  ds_read_b32 v16, v9 offset:64
  ds_read_b32 v17, v9 offset:96
  s_waitcnt lgkmcnt(0)
  v_add_f32 v10, v14, v15
  v_add_f32 v12, v16, v17
  v_add_f32 v10, v10, v12
  s_mov_b32 s41, 0x3acccccd
  v_mul_f32 v10, s41, v10
  v_sub_f32 v20, v20, v10
  v_sub_f32 v21, v21, v10
  v_sub_f32 v22, v22, v10
  v_sub_f32 v23, v23, v10
  v_sub_f32 v24, v24, v10
  v_sub_f32 v25, v25, v10
  v_sub_f32 v26, v26, v10
  v_sub_f32 v27, v27, v10
  v_sub_f32 v28, v28, v10
  v_sub_f32 v29, v29, v10
  v_sub_f32 v30, v30, v10
  v_sub_f32 v31, v31, v10
  v_sub_f32 v32, v32, v10
  v_sub_f32 v33, v33, v10
  v_sub_f32 v34, v34, v10
  v_sub_f32 v35, v35, v10
  v_sub_f32 v36, v36, v10
  v_sub_f32 v37, v37, v10
  v_sub_f32 v38, v38, v10
  v_sub_f32 v39, v39, v10
  v_mul_f32 v11, v20, v20
  v_mul_f32 v12, v21, v21
  v_fmac_f32 v11, v22, v22
  v_fmac_f32 v12, v23, v23
  v_fmac_f32 v11, v24, v24
  v_fmac_f32 v12, v25, v25
  v_fmac_f32 v11, v26, v26
  v_fmac_f32 v12, v27, v27
  v_fmac_f32 v11, v28, v28
  v_fmac_f32 v12, v29, v29
  v_fmac_f32 v11, v30, v30
  v_fmac_f32 v12, v31, v31
  v_fmac_f32 v11, v32, v32
  v_fmac_f32 v12, v33, v33
  v_fmac_f32 v11, v34, v34
  v_fmac_f32 v12, v35, v35
  v_fmac_f32 v11, v36, v36
  v_fmac_f32 v12, v37, v37
  v_fmac_f32 v11, v38, v38
  v_fmac_f32 v12, v39, v39
  v_add_f32 v11, v11, v12
  s_nop 1
  v_add_f32_dpp v11, v11, v11 row_ror:8 row_mask:0xf bank_mask:0xf
  v_mov_b32 v12, v11
  s_nop 1
  v_permlane16_swap_b32 v11, v12
  v_add_f32 v11, v11, v12
  v_mov_b32 v12, v11
  s_nop 1
  v_permlane32_swap_b32 v11, v12
  v_add_f32 v11, v11, v12
  ds_write_b32 v13, v11 offset:128
  s_waitcnt lgkmcnt(0)
  s_barrier
  ds_read_b32 v14, v9 offset:128
  ds_read_b32 v15, v9 offset:160
  ds_read_b32 v16, v9 offset:192
  ds_read_b32 v17, v9 offset:224
  s_waitcnt lgkmcnt(0)
  v_add_f32 v11, v14, v15
  v_add_f32 v12, v16, v17
  v_add_f32 v11, v11, v12
  s_mov_b32 s42, 0x3727c5ac
  v_mov_b32 v12, s42
  v_fmac_f32 v12, s41, v11
  v_rsq_f32 v11, v12
  s_nop 0
  s_lshr_b32 s32, s72, 3
  s_mul_i32 s32, s32, 81920
  s_bfe_u32 s33, s72, 0x20001
  s_lshl_b32 s33, s33, 10
  s_add_u32 s32, s32, s33
  s_mul_i32 s33, s24, 20480
  s_add_u32 s32, s32, s33
  s_waitcnt vmcnt(15)
  v_mul_f32 v20, v20, v156
  v_fma_f32 v20, v20, v11, v136
  v_mul_f32 v21, v21, v157
  v_fma_f32 v21, v21, v11, v137
  v_mul_f32 v22, v22, v158
  v_fma_f32 v22, v22, v11, v138
  v_mul_f32 v23, v23, v159
  v_fma_f32 v23, v23, v11, v139
  v_cvt_pk_bf16_f32 v52, v20, v21
  v_cvt_pk_bf16_f32 v53, v22, v23
  buffer_store_dwordx2 v[52:53], v19, s[20:23], s32 offen sc1
  s_add_u32 s32, s32, 4096
  v_mul_f32 v24, v24, v160
  v_fma_f32 v24, v24, v11, v140
  v_mul_f32 v25, v25, v161
  v_fma_f32 v25, v25, v11, v141
  v_mul_f32 v26, v26, v162
  v_fma_f32 v26, v26, v11, v142
  v_mul_f32 v27, v27, v163
  v_fma_f32 v27, v27, v11, v143
  v_cvt_pk_bf16_f32 v54, v24, v25
  v_cvt_pk_bf16_f32 v55, v26, v27
  buffer_store_dwordx2 v[54:55], v19, s[20:23], s32 offen sc1
  s_add_u32 s32, s32, 4096
  v_mul_f32 v28, v28, v164
  v_fma_f32 v28, v28, v11, v144
  v_mul_f32 v29, v29, v165
  v_fma_f32 v29, v29, v11, v145
  v_mul_f32 v30, v30, v166
  v_fma_f32 v30, v30, v11, v146
  v_mul_f32 v31, v31, v167
  v_fma_f32 v31, v31, v11, v147
  v_cvt_pk_bf16_f32 v52, v28, v29
  v_cvt_pk_bf16_f32 v53, v30, v31
  buffer_store_dwordx2 v[52:53], v19, s[20:23], s32 offen sc1
  s_add_u32 s32, s32, 4096
  v_mul_f32 v32, v32, v168
  v_fma_f32 v32, v32, v11, v148
  v_mul_f32 v33, v33, v169
  v_fma_f32 v33, v33, v11, v149
  v_mul_f32 v34, v34, v170
  v_fma_f32 v34, v34, v11, v150
  v_mul_f32 v35, v35, v171
  v_fma_f32 v35, v35, v11, v151
  v_cvt_pk_bf16_f32 v54, v32, v33
  v_cvt_pk_bf16_f32 v55, v34, v35
  buffer_store_dwordx2 v[54:55], v19, s[20:23], s32 offen sc1
  s_add_u32 s32, s32, 4096
  v_mul_f32 v36, v36, v172
  v_fma_f32 v36, v36, v11, v152
  v_mul_f32 v37, v37, v173
  v_fma_f32 v37, v37, v11, v153
  v_mul_f32 v38, v38, v174
  v_fma_f32 v38, v38, v11, v154
  v_mul_f32 v39, v39, v175
  v_fma_f32 v39, v39, v11, v155
  v_cvt_pk_bf16_f32 v52, v36, v37
  v_cvt_pk_bf16_f32 v53, v38, v39
  buffer_store_dwordx2 v[52:53], v19, s[20:23], s32 offen sc1
  s_mov_b32 s4, s10
  s_mov_b32 s5, s11
  s_mov_b32 s6, s54
  s_mov_b32 s7, s55
  s_mov_b32 s42, s8
  s_mov_b32 s43, s9
  v_lshrrev_b32 v1, 6, v0
  v_and_b32 v2, 63, v0
  v_readfirstlane_b32 s28, v1
  s_add_u32 s16, s42, 0x3800000
  s_addc_u32 s17, s43, 0
  s_mov_b32 s18, 0x280000
  s_mov_b32 s19, 0x20000
  s_add_u32 s20, s42, 0x3c00000
  s_addc_u32 s21, s43, 0
  s_mov_b32 s22, 0x600000
  s_mov_b32 s23, 0x20000
  s_and_b32 s56, s28, 1
  s_cmp_eq_u32 s56, 0
  s_cselect_b32 s8, s4, s6
  s_cselect_b32 s9, s5, s7
  s_mov_b32 s10, 0x1e0000
  s_mov_b32 s11, 0x20000
  s_and_b32 s46, s2, 7
  s_lshr_b32 s47, s2, 3
  s_mul_i32 s31, s56, 28672
  s_lshr_b32 s57, s28, 1
  s_lshl_b32 s58, s57, 11
  s_add_u32 s31, s31, s58
  v_lshlrev_b32 v20, 4, v2
  v_lshrrev_b32 v44, 3, v2
  v_and_b32 v45, 7, v2
  v_and_b32 v46, 6, v44
  v_xor_b32 v45, v45, v46
  v_lshlrev_b32 v45, 4, v45
  s_mov_b32 s50, 3072
  v_mul_lo_u32 v44, s50, v44
  v_add_u32 v18, v44, v45
  v_add_u32 v19, 23552, v18
  v_lshrrev_b32 v44, 4, v2
  v_bfe_u32 v45, v2, 2, 2
  v_and_b32 v46, 3, v2
  v_lshlrev_b32 v47, 2, v44
  v_add_u32 v47, v47, v45
  v_lshlrev_b32 v48, 7, v47
  v_and_b32 v49, 6, v47
  v_lshrrev_b32 v50, 1, v46
  v_lshlrev_b32 v50, 4, v50
  v_add_u32 v48, v48, v50
  v_and_b32 v50, 1, v46
  v_lshlrev_b32 v50, 3, v50
  v_add_u32 v48, v48, v50
  v_xor_b32 v50, 0, v49
  v_lshlrev_b32 v50, 4, v50
  v_add_u32 v10, v48, v50
  v_add_u32 v14, 28672, v10
  v_xor_b32 v50, 2, v49
  v_lshlrev_b32 v50, 4, v50
  v_add_u32 v11, v48, v50
  v_add_u32 v15, 28672, v11
  v_xor_b32 v50, 4, v49
  v_lshlrev_b32 v50, 4, v50
  v_add_u32 v12, v48, v50
  v_add_u32 v16, 28672, v12
  v_xor_b32 v50, 6, v49
  v_lshlrev_b32 v50, 4, v50
  v_add_u32 v13, v48, v50
  v_add_u32 v17, 28672, v13
  s_mul_i32 s32, s57, 49152
  s_lshl_b32 s51, s47, 7
  s_add_u32 s32, s32, s51
  s_lshl_b32 s51, s46, 2
  s_add_u32 s51, s51, s28
  s_mul_i32 s33, s51, 81920
  s_mul_i32 s34, s51, 196608
  s_lshl_b32 s59, s47, 13
  s_add_u32 s34, s34, s59
  s_add_u32 s64, s42, 0x5400000
  s_addc_u32 s65, s43, 0
  s_mov_b32 s66, 0x1e0000
  s_mov_b32 s67, 0x20000
  s_mul_i32 s68, s28, 5120
  s_lshr_b32 s70, s2, 3
  s_and_b32 s70, s70, 7
  s_mul_i32 s69, s70, 245760
  s_mul_i32 s70, s28, 61440
  s_add_u32 s69, s69, s70
  s_add_u32 s69, s69, 0
  v_add_u32 v21, 4096, v20
  s_waitcnt vmcnt(0) lgkmcnt(0)
  s_barrier
  v_lshrrev_b32 v250, 6, v0
  s_nop 0
  v_readfirstlane_b32 s88, v250
  s_nop 3
  s_cmp_lg_u32 s88, 0
  s_cbranch_scc1 L_xb_join_d0
  v_and_b32 v250, 31, v0
  v_lshlrev_b32 v250, 2, v250
  s_lshl_b32 s89, s100, 7
  v_add_u32 v250, s89, v250
  s_lshl_b32 s90, s101, 2
  s_add_u32 s90, s90, s89
  s_add_u32 s90, s90, 0
  v_mov_b32 v251, 1
  v_mov_b32 v252, s90
  s_cmp_eq_u32 s95, 1
  s_cbranch_scc0 L_xb_slow_d0
  v_cmp_eq_u32 vcc, 0, v0
  s_and_saveexec_b64 s[92:93], vcc
  buffer_store_dword v251, v252, s[96:99], 0 offen
  s_mov_b64 exec, s[92:93]
  s_branch L_xb_poll_d0
L_xb_slow_d0:
  buffer_wbl2 sc1
  s_waitcnt vmcnt(0)
  v_cmp_eq_u32 vcc, 0, v0
  s_and_saveexec_b64 s[92:93], vcc
  buffer_store_dword v251, v252, s[96:99], 0 offen sc1
  s_mov_b64 exec, s[92:93]
L_xb_poll_d0:
  s_mov_b32 s90, 0
  s_mov_b32 s91, 0
L_xb_pl_d0:
  buffer_load_dword v251, v250, s[96:99], s91 offen sc1
  s_waitcnt vmcnt(0)
  v_cmp_ne_u32 vcc, 1, v251
  s_add_u32 s90, s90, 1
  s_cmp_ge_u32 s90, 0x20000
  s_cbranch_scc1 L_xb_done_d0
  s_cbranch_vccz L_xb_done_d0
  s_sleep 1
  s_branch L_xb_pl_d0
L_xb_done_d0:
  s_cmp_eq_u32 s95, 1
  s_cbranch_scc1 L_xb_join_d0
  buffer_inv sc1
  s_waitcnt vmcnt(0)
L_xb_join_d0:
  s_barrier
  s_cmp_ge_u32 s2, 192
  s_cbranch_scc1 L_kd_skip5
  s_add_u32 m0, s31, 0
  s_nop 0
  buffer_load_dwordx4 v18, s[8:11], s32 offen offset:0 lds
  buffer_load_dwordx4 v19, s[8:11], s32 offen offset:1024 lds
  s_add_u32 s32, s32, 98304
  buffer_load_dwordx4 v[64:67], v20, s[16:19], s33 offen offset:0
  buffer_load_dwordx4 v[68:71], v20, s[16:19], s33 offen offset:1024
  buffer_load_dwordx4 v[72:75], v20, s[16:19], s33 offen offset:2048
  buffer_load_dwordx4 v[76:79], v20, s[16:19], s33 offen offset:3072
  s_add_u32 s33, s33, 4096
  s_add_u32 m0, s31, 4096
  s_nop 0
  buffer_load_dwordx4 v18, s[8:11], s32 offen offset:0 lds
  buffer_load_dwordx4 v19, s[8:11], s32 offen offset:1024 lds
  s_add_u32 s32, s32, 98304
  buffer_load_dwordx4 v[80:83], v20, s[16:19], s33 offen offset:0
  buffer_load_dwordx4 v[84:87], v20, s[16:19], s33 offen offset:1024
  buffer_load_dwordx4 v[88:91], v20, s[16:19], s33 offen offset:2048
  buffer_load_dwordx4 v[92:95], v20, s[16:19], s33 offen offset:3072
  s_add_u32 s33, s33, 4096
  s_add_u32 m0, s31, 8192
  s_nop 0
  buffer_load_dwordx4 v18, s[8:11], s32 offen offset:0 lds
  buffer_load_dwordx4 v19, s[8:11], s32 offen offset:1024 lds
  s_add_u32 s32, s32, 98304
  buffer_load_dwordx4 v[96:99], v20, s[16:19], s33 offen offset:0
  buffer_load_dwordx4 v[100:103], v20, s[16:19], s33 offen offset:1024
  buffer_load_dwordx4 v[104:107], v20, s[16:19], s33 offen offset:2048
  buffer_load_dwordx4 v[108:111], v20, s[16:19], s33 offen offset:3072
  s_add_u32 s33, s33, 4096
  s_waitcnt vmcnt(12)
  s_barrier
  ds_read_b64_tr_b16 a[128:129], v10 offset:0
  ds_read_b64_tr_b16 a[130:131], v10 offset:2048
  ds_read_b64_tr_b16 a[132:133], v11 offset:0
  ds_read_b64_tr_b16 a[134:135], v11 offset:2048
  ds_read_b64_tr_b16 a[136:137], v12 offset:0
  ds_read_b64_tr_b16 a[138:139], v12 offset:2048
  ds_read_b64_tr_b16 a[140:141], v13 offset:0
  ds_read_b64_tr_b16 a[142:143], v13 offset:2048
  ds_read_b64_tr_b16 a[144:145], v14 offset:0
  ds_read_b64_tr_b16 a[146:147], v14 offset:2048
  s_waitcnt vmcnt(10)
  s_barrier
  s_waitcnt lgkmcnt(8)
  v_mfma_f32_16x16x32_bf16 a[0:3], a[128:131], v[64:67], 0
  ds_read_b64_tr_b16 a[148:149], v15 offset:0
  ds_read_b64_tr_b16 a[150:151], v15 offset:2048
  v_mfma_f32_16x16x32_bf16 a[4:7], a[128:131], v[68:71], 0
  s_add_u32 m0, s31, 12288
  v_mfma_f32_16x16x32_bf16 a[8:11], a[128:131], v[72:75], 0
  buffer_load_dwordx4 v18, s[8:11], s32 offen offset:0 lds
  v_mfma_f32_16x16x32_bf16 a[12:15], a[128:131], v[76:79], 0
  s_waitcnt lgkmcnt(8)
  v_mfma_f32_16x16x32_bf16 a[16:19], a[132:135], v[64:67], 0
  ds_read_b64_tr_b16 a[152:153], v16 offset:0
  ds_read_b64_tr_b16 a[154:155], v16 offset:2048
  v_mfma_f32_16x16x32_bf16 a[20:23], a[132:135], v[68:71], 0
  buffer_load_dwordx4 v19, s[8:11], s32 offen offset:1024 lds
  v_mfma_f32_16x16x32_bf16 a[24:27], a[132:135], v[72:75], 0
  s_add_u32 s32, s32, 98304
  v_mfma_f32_16x16x32_bf16 a[28:31], a[132:135], v[76:79], 0
  s_waitcnt lgkmcnt(8)
  v_mfma_f32_16x16x32_bf16 a[32:35], a[136:139], v[64:67], 0
  ds_read_b64_tr_b16 a[156:157], v17 offset:0
  ds_read_b64_tr_b16 a[158:159], v17 offset:2048
  v_mfma_f32_16x16x32_bf16 a[36:39], a[136:139], v[68:71], 0
  buffer_load_dwordx4 v[112:115], v20, s[16:19], s33 offen offset:0
  v_mfma_f32_16x16x32_bf16 a[40:43], a[136:139], v[72:75], 0
  v_mfma_f32_16x16x32_bf16 a[44:47], a[136:139], v[76:79], 0
  s_waitcnt lgkmcnt(8)
  v_mfma_f32_16x16x32_bf16 a[48:51], a[140:143], v[64:67], 0
  ds_read_b64_tr_b16 a[128:129], v10 offset:4096
  ds_read_b64_tr_b16 a[130:131], v10 offset:6144
  v_mfma_f32_16x16x32_bf16 a[52:55], a[140:143], v[68:71], 0
  buffer_load_dwordx4 v[116:119], v20, s[16:19], s33 offen offset:1024
  v_mfma_f32_16x16x32_bf16 a[56:59], a[140:143], v[72:75], 0
  v_mfma_f32_16x16x32_bf16 a[60:63], a[140:143], v[76:79], 0
  s_waitcnt lgkmcnt(8)
  v_mfma_f32_16x16x32_bf16 a[64:67], a[144:147], v[64:67], 0
  ds_read_b64_tr_b16 a[132:133], v11 offset:4096
  ds_read_b64_tr_b16 a[134:135], v11 offset:6144
  v_mfma_f32_16x16x32_bf16 a[68:71], a[144:147], v[68:71], 0
  buffer_load_dwordx4 v[120:123], v20, s[16:19], s33 offen offset:2048
  v_mfma_f32_16x16x32_bf16 a[72:75], a[144:147], v[72:75], 0
  v_mfma_f32_16x16x32_bf16 a[76:79], a[144:147], v[76:79], 0
  s_waitcnt lgkmcnt(8)
  v_mfma_f32_16x16x32_bf16 a[80:83], a[148:151], v[64:67], 0
  ds_read_b64_tr_b16 a[136:137], v12 offset:4096
  ds_read_b64_tr_b16 a[138:139], v12 offset:6144
  v_mfma_f32_16x16x32_bf16 a[84:87], a[148:151], v[68:71], 0
  buffer_load_dwordx4 v[124:127], v20, s[16:19], s33 offen offset:3072
  v_mfma_f32_16x16x32_bf16 a[88:91], a[148:151], v[72:75], 0
  s_add_u32 s33, s33, 4096
  v_mfma_f32_16x16x32_bf16 a[92:95], a[148:151], v[76:79], 0
  s_waitcnt lgkmcnt(8)
  v_mfma_f32_16x16x32_bf16 a[96:99], a[152:155], v[64:67], 0
  s_add_u32 m0, s31, 16384
  ds_read_b64_tr_b16 a[140:141], v13 offset:4096
  ds_read_b64_tr_b16 a[142:143], v13 offset:6144
  v_mfma_f32_16x16x32_bf16 a[100:103], a[152:155], v[68:71], 0
  buffer_load_dwordx4 v18, s[8:11], s32 offen offset:0 lds
  v_mfma_f32_16x16x32_bf16 a[104:107], a[152:155], v[72:75], 0
  v_mfma_f32_16x16x32_bf16 a[108:111], a[152:155], v[76:79], 0
  s_waitcnt lgkmcnt(8)
  v_mfma_f32_16x16x32_bf16 a[112:115], a[156:159], v[64:67], 0
  ds_read_b64_tr_b16 a[144:145], v14 offset:4096
  ds_read_b64_tr_b16 a[146:147], v14 offset:6144
  v_mfma_f32_16x16x32_bf16 a[116:119], a[156:159], v[68:71], 0
  buffer_load_dwordx4 v19, s[8:11], s32 offen offset:1024 lds
  v_mfma_f32_16x16x32_bf16 a[120:123], a[156:159], v[72:75], 0
  s_add_u32 s32, s32, 98304
  v_mfma_f32_16x16x32_bf16 a[124:127], a[156:159], v[76:79], 0
  s_waitcnt vmcnt(12)
  s_barrier
  s_waitcnt lgkmcnt(8)
  v_mfma_f32_16x16x32_bf16 a[0:3], a[128:131], v[80:83], a[0:3]
  ds_read_b64_tr_b16 a[148:149], v15 offset:4096
  ds_read_b64_tr_b16 a[150:151], v15 offset:6144
  v_mfma_f32_16x16x32_bf16 a[4:7], a[128:131], v[84:87], a[4:7]
  buffer_load_dwordx4 v[128:131], v20, s[16:19], s33 offen offset:0
  v_mfma_f32_16x16x32_bf16 a[8:11], a[128:131], v[88:91], a[8:11]
  v_mfma_f32_16x16x32_bf16 a[12:15], a[128:131], v[92:95], a[12:15]
  s_waitcnt lgkmcnt(8)
  buffer_load_dwordx4 v[132:135], v20, s[16:19], s33 offen offset:1024
  v_mfma_f32_16x16x32_bf16 a[16:19], a[132:135], v[80:83], a[16:19]
  ds_read_b64_tr_b16 a[152:153], v16 offset:4096
  ds_read_b64_tr_b16 a[154:155], v16 offset:6144
  v_mfma_f32_16x16x32_bf16 a[20:23], a[132:135], v[84:87], a[20:23]
  buffer_load_dwordx4 v[136:139], v20, s[16:19], s33 offen offset:2048
  v_mfma_f32_16x16x32_bf16 a[24:27], a[132:135], v[88:91], a[24:27]
  v_mfma_f32_16x16x32_bf16 a[28:31], a[132:135], v[92:95], a[28:31]
  s_waitcnt lgkmcnt(8)
  buffer_load_dwordx4 v[140:143], v20, s[16:19], s33 offen offset:3072
  v_mfma_f32_16x16x32_bf16 a[32:35], a[136:139], v[80:83], a[32:35]
  s_add_u32 s33, s33, 4096
  ds_read_b64_tr_b16 a[156:157], v17 offset:4096
  ds_read_b64_tr_b16 a[158:159], v17 offset:6144
  v_mfma_f32_16x16x32_bf16 a[36:39], a[136:139], v[84:87], a[36:39]
  s_add_u32 m0, s31, 20480
  v_mfma_f32_16x16x32_bf16 a[40:43], a[136:139], v[88:91], a[40:43]
  buffer_load_dwordx4 v18, s[8:11], s32 offen offset:0 lds
  v_mfma_f32_16x16x32_bf16 a[44:47], a[136:139], v[92:95], a[44:47]
  s_waitcnt lgkmcnt(8)
  v_mfma_f32_16x16x32_bf16 a[48:51], a[140:143], v[80:83], a[48:51]
  ds_read_b64_tr_b16 a[128:129], v10 offset:8192
  ds_read_b64_tr_b16 a[130:131], v10 offset:10240
  v_mfma_f32_16x16x32_bf16 a[52:55], a[140:143], v[84:87], a[52:55]
  buffer_load_dwordx4 v19, s[8:11], s32 offen offset:1024 lds
  v_mfma_f32_16x16x32_bf16 a[56:59], a[140:143], v[88:91], a[56:59]
  s_add_u32 s32, s32, 98304
  v_mfma_f32_16x16x32_bf16 a[60:63], a[140:143], v[92:95], a[60:63]
  s_waitcnt lgkmcnt(8)
  buffer_load_dwordx4 v[144:147], v20, s[16:19], s33 offen offset:0
  v_mfma_f32_16x16x32_bf16 a[64:67], a[144:147], v[80:83], a[64:67]
  ds_read_b64_tr_b16 a[132:133], v11 offset:8192
  ds_read_b64_tr_b16 a[134:135], v11 offset:10240
  v_mfma_f32_16x16x32_bf16 a[68:71], a[144:147], v[84:87], a[68:71]
  buffer_load_dwordx4 v[148:151], v20, s[16:19], s33 offen offset:1024
  v_mfma_f32_16x16x32_bf16 a[72:75], a[144:147], v[88:91], a[72:75]
  v_mfma_f32_16x16x32_bf16 a[76:79], a[144:147], v[92:95], a[76:79]
  s_waitcnt lgkmcnt(8)
  buffer_load_dwordx4 v[152:155], v20, s[16:19], s33 offen offset:2048
  v_mfma_f32_16x16x32_bf16 a[80:83], a[148:151], v[80:83], a[80:83]
  ds_read_b64_tr_b16 a[136:137], v12 offset:8192
  ds_read_b64_tr_b16 a[138:139], v12 offset:10240
  v_mfma_f32_16x16x32_bf16 a[84:87], a[148:151], v[84:87], a[84:87]
  buffer_load_dwordx4 v[156:159], v20, s[16:19], s33 offen offset:3072
  v_mfma_f32_16x16x32_bf16 a[88:91], a[148:151], v[88:91], a[88:91]
  s_add_u32 s33, s33, 4096
  v_mfma_f32_16x16x32_bf16 a[92:95], a[148:151], v[92:95], a[92:95]
  s_waitcnt lgkmcnt(8)
  v_mfma_f32_16x16x32_bf16 a[96:99], a[152:155], v[80:83], a[96:99]
  ds_read_b64_tr_b16 a[140:141], v13 offset:8192
  ds_read_b64_tr_b16 a[142:143], v13 offset:10240
  v_mfma_f32_16x16x32_bf16 a[100:103], a[152:155], v[84:87], a[100:103]
  v_mfma_f32_16x16x32_bf16 a[104:107], a[152:155], v[88:91], a[104:107]
  v_mfma_f32_16x16x32_bf16 a[108:111], a[152:155], v[92:95], a[108:111]
  s_waitcnt lgkmcnt(8)
  v_mfma_f32_16x16x32_bf16 a[112:115], a[156:159], v[80:83], a[112:115]
  ds_read_b64_tr_b16 a[144:145], v14 offset:8192
  ds_read_b64_tr_b16 a[146:147], v14 offset:10240
  v_mfma_f32_16x16x32_bf16 a[116:119], a[156:159], v[84:87], a[116:119]
  v_mfma_f32_16x16x32_bf16 a[120:123], a[156:159], v[88:91], a[120:123]
  v_mfma_f32_16x16x32_bf16 a[124:127], a[156:159], v[92:95], a[124:127]
  s_waitcnt vmcnt(10)
  s_barrier
  s_waitcnt lgkmcnt(8)
  v_mfma_f32_16x16x32_bf16 a[0:3], a[128:131], v[96:99], a[0:3]
  ds_read_b64_tr_b16 a[148:149], v15 offset:8192
  ds_read_b64_tr_b16 a[150:151], v15 offset:10240
  v_mfma_f32_16x16x32_bf16 a[4:7], a[128:131], v[100:103], a[4:7]
  s_add_u32 m0, s31, 24576
  v_mfma_f32_16x16x32_bf16 a[8:11], a[128:131], v[104:107], a[8:11]
  buffer_load_dwordx4 v18, s[8:11], s32 offen offset:0 lds
  v_mfma_f32_16x16x32_bf16 a[12:15], a[128:131], v[108:111], a[12:15]
  s_waitcnt lgkmcnt(8)
  v_mfma_f32_16x16x32_bf16 a[16:19], a[132:135], v[96:99], a[16:19]
  ds_read_b64_tr_b16 a[152:153], v16 offset:8192
  ds_read_b64_tr_b16 a[154:155], v16 offset:10240
  v_mfma_f32_16x16x32_bf16 a[20:23], a[132:135], v[100:103], a[20:23]
  buffer_load_dwordx4 v19, s[8:11], s32 offen offset:1024 lds
  v_mfma_f32_16x16x32_bf16 a[24:27], a[132:135], v[104:107], a[24:27]
  s_add_u32 s32, s32, 98304
  v_mfma_f32_16x16x32_bf16 a[28:31], a[132:135], v[108:111], a[28:31]
  s_waitcnt lgkmcnt(8)
  buffer_load_dwordx4 v[160:163], v20, s[16:19], s33 offen offset:0
  v_mfma_f32_16x16x32_bf16 a[32:35], a[136:139], v[96:99], a[32:35]
  ds_read_b64_tr_b16 a[156:157], v17 offset:8192
  ds_read_b64_tr_b16 a[158:159], v17 offset:10240
  v_mfma_f32_16x16x32_bf16 a[36:39], a[136:139], v[100:103], a[36:39]
  buffer_load_dwordx4 v[164:167], v20, s[16:19], s33 offen offset:1024
  v_mfma_f32_16x16x32_bf16 a[40:43], a[136:139], v[104:107], a[40:43]
  v_mfma_f32_16x16x32_bf16 a[44:47], a[136:139], v[108:111], a[44:47]
  s_waitcnt lgkmcnt(8)
  buffer_load_dwordx4 v[168:171], v20, s[16:19], s33 offen offset:2048
  v_mfma_f32_16x16x32_bf16 a[48:51], a[140:143], v[96:99], a[48:51]
  ds_read_b64_tr_b16 a[128:129], v10 offset:12288
  ds_read_b64_tr_b16 a[130:131], v10 offset:14336
  v_mfma_f32_16x16x32_bf16 a[52:55], a[140:143], v[100:103], a[52:55]
  buffer_load_dwordx4 v[172:175], v20, s[16:19], s33 offen offset:3072
  v_mfma_f32_16x16x32_bf16 a[56:59], a[140:143], v[104:107], a[56:59]
  s_add_u32 s33, s33, 4096
  v_mfma_f32_16x16x32_bf16 a[60:63], a[140:143], v[108:111], a[60:63]
  s_waitcnt lgkmcnt(8)
  v_mfma_f32_16x16x32_bf16 a[64:67], a[144:147], v[96:99], a[64:67]
  s_add_u32 m0, s31, 0
  ds_read_b64_tr_b16 a[132:133], v11 offset:12288
  ds_read_b64_tr_b16 a[134:135], v11 offset:14336
  v_mfma_f32_16x16x32_bf16 a[68:71], a[144:147], v[100:103], a[68:71]
  buffer_load_dwordx4 v18, s[8:11], s32 offen offset:0 lds
  v_mfma_f32_16x16x32_bf16 a[72:75], a[144:147], v[104:107], a[72:75]
  v_mfma_f32_16x16x32_bf16 a[76:79], a[144:147], v[108:111], a[76:79]
  s_waitcnt lgkmcnt(8)
  buffer_load_dwordx4 v19, s[8:11], s32 offen offset:1024 lds
  v_mfma_f32_16x16x32_bf16 a[80:83], a[148:151], v[96:99], a[80:83]
  s_add_u32 s32, s32, 98304
  ds_read_b64_tr_b16 a[136:137], v12 offset:12288
  ds_read_b64_tr_b16 a[138:139], v12 offset:14336
  v_mfma_f32_16x16x32_bf16 a[84:87], a[148:151], v[100:103], a[84:87]
  v_mfma_f32_16x16x32_bf16 a[88:91], a[148:151], v[104:107], a[88:91]
  v_mfma_f32_16x16x32_bf16 a[92:95], a[148:151], v[108:111], a[92:95]
  s_waitcnt lgkmcnt(8)
  v_mfma_f32_16x16x32_bf16 a[96:99], a[152:155], v[96:99], a[96:99]
  ds_read_b64_tr_b16 a[140:141], v13 offset:12288
  ds_read_b64_tr_b16 a[142:143], v13 offset:14336
  v_mfma_f32_16x16x32_bf16 a[100:103], a[152:155], v[100:103], a[100:103]
  v_mfma_f32_16x16x32_bf16 a[104:107], a[152:155], v[104:107], a[104:107]
  v_mfma_f32_16x16x32_bf16 a[108:111], a[152:155], v[108:111], a[108:111]
  s_waitcnt lgkmcnt(8)
  v_mfma_f32_16x16x32_bf16 a[112:115], a[156:159], v[96:99], a[112:115]
  ds_read_b64_tr_b16 a[144:145], v14 offset:12288
  ds_read_b64_tr_b16 a[146:147], v14 offset:14336
  v_mfma_f32_16x16x32_bf16 a[116:119], a[156:159], v[100:103], a[116:119]
  v_mfma_f32_16x16x32_bf16 a[120:123], a[156:159], v[104:107], a[120:123]
  s_waitcnt vmcnt(20)
  v_mfma_f32_16x16x32_bf16 a[124:127], a[156:159], v[108:111], a[124:127]
  s_waitcnt lgkmcnt(8)
  v_mfma_f32_16x16x32_bf16 a[0:3], a[128:131], v[112:115], a[0:3]
  ds_read_b64_tr_b16 a[148:149], v15 offset:12288
  ds_read_b64_tr_b16 a[150:151], v15 offset:14336
  v_mfma_f32_16x16x32_bf16 a[4:7], a[128:131], v[116:119], a[4:7]
  buffer_load_dwordx4 v[176:179], v20, s[16:19], s33 offen offset:0
  v_mfma_f32_16x16x32_bf16 a[8:11], a[128:131], v[120:123], a[8:11]
  buffer_load_dwordx4 v[180:183], v20, s[16:19], s33 offen offset:1024
  v_mfma_f32_16x16x32_bf16 a[12:15], a[128:131], v[124:127], a[12:15]
  s_waitcnt lgkmcnt(8)
  buffer_load_dwordx4 v[184:187], v20, s[16:19], s33 offen offset:2048
  v_mfma_f32_16x16x32_bf16 a[16:19], a[132:135], v[112:115], a[16:19]
  ds_read_b64_tr_b16 a[152:153], v16 offset:12288
  ds_read_b64_tr_b16 a[154:155], v16 offset:14336
  v_mfma_f32_16x16x32_bf16 a[20:23], a[132:135], v[116:119], a[20:23]
  buffer_load_dwordx4 v[188:191], v20, s[16:19], s33 offen offset:3072
  v_mfma_f32_16x16x32_bf16 a[24:27], a[132:135], v[120:123], a[24:27]
  s_add_u32 s33, s33, 4096
  v_mfma_f32_16x16x32_bf16 a[28:31], a[132:135], v[124:127], a[28:31]
  s_waitcnt lgkmcnt(8)
  v_mfma_f32_16x16x32_bf16 a[32:35], a[136:139], v[112:115], a[32:35]
  s_add_u32 m0, s31, 4096
  ds_read_b64_tr_b16 a[156:157], v17 offset:12288
  ds_read_b64_tr_b16 a[158:159], v17 offset:14336
  v_mfma_f32_16x16x32_bf16 a[36:39], a[136:139], v[116:119], a[36:39]
  buffer_load_dwordx4 v18, s[8:11], s32 offen offset:0 lds
  v_mfma_f32_16x16x32_bf16 a[40:43], a[136:139], v[120:123], a[40:43]
  buffer_load_dwordx4 v19, s[8:11], s32 offen offset:1024 lds
  v_mfma_f32_16x16x32_bf16 a[44:47], a[136:139], v[124:127], a[44:47]
  s_waitcnt lgkmcnt(8)
  v_mfma_f32_16x16x32_bf16 a[48:51], a[140:143], v[112:115], a[48:51]
  s_add_u32 s32, s32, 98304
  ds_read_b64_tr_b16 a[128:129], v10 offset:16384
  ds_read_b64_tr_b16 a[130:131], v10 offset:18432
  v_mfma_f32_16x16x32_bf16 a[52:55], a[140:143], v[116:119], a[52:55]
  buffer_load_dwordx4 v[192:195], v20, s[16:19], s33 offen offset:0
  v_mfma_f32_16x16x32_bf16 a[56:59], a[140:143], v[120:123], a[56:59]
  buffer_load_dwordx4 v[196:199], v20, s[16:19], s33 offen offset:1024
  v_mfma_f32_16x16x32_bf16 a[60:63], a[140:143], v[124:127], a[60:63]
  s_waitcnt lgkmcnt(8)
  buffer_load_dwordx4 v[200:203], v20, s[16:19], s33 offen offset:2048
  v_mfma_f32_16x16x32_bf16 a[64:67], a[144:147], v[112:115], a[64:67]
  ds_read_b64_tr_b16 a[132:133], v11 offset:16384
  ds_read_b64_tr_b16 a[134:135], v11 offset:18432
  v_mfma_f32_16x16x32_bf16 a[68:71], a[144:147], v[116:119], a[68:71]
  buffer_load_dwordx4 v[204:207], v20, s[16:19], s33 offen offset:3072
  v_mfma_f32_16x16x32_bf16 a[72:75], a[144:147], v[120:123], a[72:75]
  s_add_u32 s33, s33, 4096
  v_mfma_f32_16x16x32_bf16 a[76:79], a[144:147], v[124:127], a[76:79]
  s_waitcnt lgkmcnt(8)
  v_mfma_f32_16x16x32_bf16 a[80:83], a[148:151], v[112:115], a[80:83]
  s_add_u32 m0, s68, 61440
  ds_read_b64_tr_b16 a[136:137], v12 offset:16384
  ds_read_b64_tr_b16 a[138:139], v12 offset:18432
  v_mfma_f32_16x16x32_bf16 a[84:87], a[148:151], v[116:119], a[84:87]
  buffer_load_dwordx4 v20, s[64:67], s69 offen offset:0 lds
  v_mfma_f32_16x16x32_bf16 a[88:91], a[148:151], v[120:123], a[88:91]
  buffer_load_dwordx4 v20, s[64:67], s69 offen offset:1024 lds
  v_mfma_f32_16x16x32_bf16 a[92:95], a[148:151], v[124:127], a[92:95]
  s_waitcnt lgkmcnt(8)
  buffer_load_dwordx4 v20, s[64:67], s69 offen offset:2048 lds
  v_mfma_f32_16x16x32_bf16 a[96:99], a[152:155], v[112:115], a[96:99]
  ds_read_b64_tr_b16 a[140:141], v13 offset:16384
  ds_read_b64_tr_b16 a[142:143], v13 offset:18432
  v_mfma_f32_16x16x32_bf16 a[100:103], a[152:155], v[116:119], a[100:103]
  buffer_load_dwordx4 v20, s[64:67], s69 offen offset:3072 lds
  v_mfma_f32_16x16x32_bf16 a[104:107], a[152:155], v[120:123], a[104:107]
  v_mfma_f32_16x16x32_bf16 a[108:111], a[152:155], v[124:127], a[108:111]
  s_waitcnt lgkmcnt(8)
  v_mfma_f32_16x16x32_bf16 a[112:115], a[156:159], v[112:115], a[112:115]
  ds_read_b64_tr_b16 a[144:145], v14 offset:16384
  ds_read_b64_tr_b16 a[146:147], v14 offset:18432
  v_mfma_f32_16x16x32_bf16 a[116:119], a[156:159], v[116:119], a[116:119]
  s_waitcnt vmcnt(20)
  v_mfma_f32_16x16x32_bf16 a[120:123], a[156:159], v[120:123], a[120:123]
  s_barrier
  v_mfma_f32_16x16x32_bf16 a[124:127], a[156:159], v[124:127], a[124:127]
  s_waitcnt lgkmcnt(8)
  v_mfma_f32_16x16x32_bf16 a[0:3], a[128:131], v[128:131], a[0:3]
  ds_read_b64_tr_b16 a[148:149], v15 offset:16384
  ds_read_b64_tr_b16 a[150:151], v15 offset:18432
  v_mfma_f32_16x16x32_bf16 a[4:7], a[128:131], v[132:135], a[4:7]
  s_add_u32 m0, s31, 8192
  v_mfma_f32_16x16x32_bf16 a[8:11], a[128:131], v[136:139], a[8:11]
  buffer_load_dwordx4 v18, s[8:11], s32 offen offset:0 lds
  v_mfma_f32_16x16x32_bf16 a[12:15], a[128:131], v[140:143], a[12:15]
  s_waitcnt lgkmcnt(8)
  v_mfma_f32_16x16x32_bf16 a[16:19], a[132:135], v[128:131], a[16:19]
  ds_read_b64_tr_b16 a[152:153], v16 offset:16384
  ds_read_b64_tr_b16 a[154:155], v16 offset:18432
  v_mfma_f32_16x16x32_bf16 a[20:23], a[132:135], v[132:135], a[20:23]
  v_mfma_f32_16x16x32_bf16 a[24:27], a[132:135], v[136:139], a[24:27]
  buffer_load_dwordx4 v19, s[8:11], s32 offen offset:1024 lds
  v_mfma_f32_16x16x32_bf16 a[28:31], a[132:135], v[140:143], a[28:31]
  s_waitcnt lgkmcnt(8)
  v_mfma_f32_16x16x32_bf16 a[32:35], a[136:139], v[128:131], a[32:35]
  s_add_u32 s32, s32, 98304
  ds_read_b64_tr_b16 a[156:157], v17 offset:16384
  ds_read_b64_tr_b16 a[158:159], v17 offset:18432
  v_mfma_f32_16x16x32_bf16 a[36:39], a[136:139], v[132:135], a[36:39]
  v_mfma_f32_16x16x32_bf16 a[40:43], a[136:139], v[136:139], a[40:43]
  buffer_load_dwordx4 v[208:211], v20, s[16:19], s33 offen offset:0
  v_mfma_f32_16x16x32_bf16 a[44:47], a[136:139], v[140:143], a[44:47]
  s_waitcnt lgkmcnt(8)
  v_mfma_f32_16x16x32_bf16 a[48:51], a[140:143], v[128:131], a[48:51]
  ds_read_b64_tr_b16 a[128:129], v10 offset:20480
  ds_read_b64_tr_b16 a[130:131], v10 offset:22528
  v_mfma_f32_16x16x32_bf16 a[52:55], a[140:143], v[132:135], a[52:55]
  v_mfma_f32_16x16x32_bf16 a[56:59], a[140:143], v[136:139], a[56:59]
  buffer_load_dwordx4 v[212:215], v20, s[16:19], s33 offen offset:1024
  v_mfma_f32_16x16x32_bf16 a[60:63], a[140:143], v[140:143], a[60:63]
  s_waitcnt lgkmcnt(8)
  v_mfma_f32_16x16x32_bf16 a[64:67], a[144:147], v[128:131], a[64:67]
  ds_read_b64_tr_b16 a[132:133], v11 offset:20480
  ds_read_b64_tr_b16 a[134:135], v11 offset:22528
  v_mfma_f32_16x16x32_bf16 a[68:71], a[144:147], v[132:135], a[68:71]
  v_mfma_f32_16x16x32_bf16 a[72:75], a[144:147], v[136:139], a[72:75]
  buffer_load_dwordx4 v[216:219], v20, s[16:19], s33 offen offset:2048
  v_mfma_f32_16x16x32_bf16 a[76:79], a[144:147], v[140:143], a[76:79]
  s_waitcnt lgkmcnt(8)
  v_mfma_f32_16x16x32_bf16 a[80:83], a[148:151], v[128:131], a[80:83]
  ds_read_b64_tr_b16 a[136:137], v12 offset:20480
  ds_read_b64_tr_b16 a[138:139], v12 offset:22528
  v_mfma_f32_16x16x32_bf16 a[84:87], a[148:151], v[132:135], a[84:87]
  v_mfma_f32_16x16x32_bf16 a[88:91], a[148:151], v[136:139], a[88:91]
  buffer_load_dwordx4 v[220:223], v20, s[16:19], s33 offen offset:3072
  v_mfma_f32_16x16x32_bf16 a[92:95], a[148:151], v[140:143], a[92:95]
  s_waitcnt lgkmcnt(8)
  v_mfma_f32_16x16x32_bf16 a[96:99], a[152:155], v[128:131], a[96:99]
  s_add_u32 s33, s33, 4096
  ds_read_b64_tr_b16 a[140:141], v13 offset:20480
  ds_read_b64_tr_b16 a[142:143], v13 offset:22528
  v_mfma_f32_16x16x32_bf16 a[100:103], a[152:155], v[132:135], a[100:103]
  s_add_u32 m0, s68, 65536
  v_mfma_f32_16x16x32_bf16 a[104:107], a[152:155], v[136:139], a[104:107]
  buffer_load_dwordx4 v21, s[64:67], s69 offen lds
  v_mfma_f32_16x16x32_bf16 a[108:111], a[152:155], v[140:143], a[108:111]
  s_waitcnt lgkmcnt(8)
  v_mfma_f32_16x16x32_bf16 a[112:115], a[156:159], v[128:131], a[112:115]
  s_add_u32 s69, s69, 5120
  ds_read_b64_tr_b16 a[144:145], v14 offset:20480
  ds_read_b64_tr_b16 a[146:147], v14 offset:22528
  v_mfma_f32_16x16x32_bf16 a[116:119], a[156:159], v[132:135], a[116:119]
  v_mfma_f32_16x16x32_bf16 a[120:123], a[156:159], v[136:139], a[120:123]
  s_waitcnt vmcnt(29)
  v_mfma_f32_16x16x32_bf16 a[124:127], a[156:159], v[140:143], a[124:127]
  s_waitcnt lgkmcnt(8)
  v_mfma_f32_16x16x32_bf16 a[0:3], a[128:131], v[144:147], a[0:3]
  ds_read_b64_tr_b16 a[148:149], v15 offset:20480
  ds_read_b64_tr_b16 a[150:151], v15 offset:22528
  v_mfma_f32_16x16x32_bf16 a[4:7], a[128:131], v[148:151], a[4:7]
  s_add_u32 m0, s31, 12288
  v_mfma_f32_16x16x32_bf16 a[8:11], a[128:131], v[152:155], a[8:11]
  buffer_load_dwordx4 v18, s[8:11], s32 offen offset:0 lds
  v_mfma_f32_16x16x32_bf16 a[12:15], a[128:131], v[156:159], a[12:15]
  s_waitcnt lgkmcnt(8)
  v_mfma_f32_16x16x32_bf16 a[16:19], a[132:135], v[144:147], a[16:19]
  ds_read_b64_tr_b16 a[152:153], v16 offset:20480
  ds_read_b64_tr_b16 a[154:155], v16 offset:22528
  v_mfma_f32_16x16x32_bf16 a[20:23], a[132:135], v[148:151], a[20:23]
  buffer_load_dwordx4 v19, s[8:11], s32 offen offset:1024 lds
  v_mfma_f32_16x16x32_bf16 a[24:27], a[132:135], v[152:155], a[24:27]
  s_add_u32 s32, s32, 98304
  v_mfma_f32_16x16x32_bf16 a[28:31], a[132:135], v[156:159], a[28:31]
  s_waitcnt lgkmcnt(8)
  buffer_load_dwordx4 v[64:67], v20, s[16:19], s33 offen offset:0
  v_mfma_f32_16x16x32_bf16 a[32:35], a[136:139], v[144:147], a[32:35]
  ds_read_b64_tr_b16 a[156:157], v17 offset:20480
  ds_read_b64_tr_b16 a[158:159], v17 offset:22528
  v_mfma_f32_16x16x32_bf16 a[36:39], a[136:139], v[148:151], a[36:39]
  buffer_load_dwordx4 v[68:71], v20, s[16:19], s33 offen offset:1024
  v_mfma_f32_16x16x32_bf16 a[40:43], a[136:139], v[152:155], a[40:43]
  v_mfma_f32_16x16x32_bf16 a[44:47], a[136:139], v[156:159], a[44:47]
  s_waitcnt lgkmcnt(8)
  buffer_load_dwordx4 v[72:75], v20, s[16:19], s33 offen offset:2048
  v_mfma_f32_16x16x32_bf16 a[48:51], a[140:143], v[144:147], a[48:51]
  ds_read_b64_tr_b16 a[128:129], v10 offset:24576
  ds_read_b64_tr_b16 a[130:131], v10 offset:26624
  v_mfma_f32_16x16x32_bf16 a[52:55], a[140:143], v[148:151], a[52:55]
  buffer_load_dwordx4 v[76:79], v20, s[16:19], s33 offen offset:3072
  v_mfma_f32_16x16x32_bf16 a[56:59], a[140:143], v[152:155], a[56:59]
  s_add_u32 s33, s33, 4096
  v_mfma_f32_16x16x32_bf16 a[60:63], a[140:143], v[156:159], a[60:63]
  s_waitcnt lgkmcnt(8)
  v_mfma_f32_16x16x32_bf16 a[64:67], a[144:147], v[144:147], a[64:67]
  s_add_u32 m0, s68, 81920
  ds_read_b64_tr_b16 a[132:133], v11 offset:24576
  ds_read_b64_tr_b16 a[134:135], v11 offset:26624
  v_mfma_f32_16x16x32_bf16 a[68:71], a[144:147], v[148:151], a[68:71]
  buffer_load_dwordx4 v20, s[64:67], s69 offen offset:0 lds
  v_mfma_f32_16x16x32_bf16 a[72:75], a[144:147], v[152:155], a[72:75]
  v_mfma_f32_16x16x32_bf16 a[76:79], a[144:147], v[156:159], a[76:79]
  s_waitcnt lgkmcnt(8)
  buffer_load_dwordx4 v20, s[64:67], s69 offen offset:1024 lds
  v_mfma_f32_16x16x32_bf16 a[80:83], a[148:151], v[144:147], a[80:83]
  ds_read_b64_tr_b16 a[136:137], v12 offset:24576
  ds_read_b64_tr_b16 a[138:139], v12 offset:26624
  v_mfma_f32_16x16x32_bf16 a[84:87], a[148:151], v[148:151], a[84:87]
  buffer_load_dwordx4 v20, s[64:67], s69 offen offset:2048 lds
  v_mfma_f32_16x16x32_bf16 a[88:91], a[148:151], v[152:155], a[88:91]
  v_mfma_f32_16x16x32_bf16 a[92:95], a[148:151], v[156:159], a[92:95]
  s_waitcnt lgkmcnt(8)
  buffer_load_dwordx4 v20, s[64:67], s69 offen offset:3072 lds
  v_mfma_f32_16x16x32_bf16 a[96:99], a[152:155], v[144:147], a[96:99]
  ds_read_b64_tr_b16 a[140:141], v13 offset:24576
  ds_read_b64_tr_b16 a[142:143], v13 offset:26624
  v_mfma_f32_16x16x32_bf16 a[100:103], a[152:155], v[148:151], a[100:103]
  v_mfma_f32_16x16x32_bf16 a[104:107], a[152:155], v[152:155], a[104:107]
  v_mfma_f32_16x16x32_bf16 a[108:111], a[152:155], v[156:159], a[108:111]
  s_waitcnt lgkmcnt(8)
  v_mfma_f32_16x16x32_bf16 a[112:115], a[156:159], v[144:147], a[112:115]
  ds_read_b64_tr_b16 a[144:145], v14 offset:24576
  ds_read_b64_tr_b16 a[146:147], v14 offset:26624
  v_mfma_f32_16x16x32_bf16 a[116:119], a[156:159], v[148:151], a[116:119]
  s_waitcnt vmcnt(25)
  v_mfma_f32_16x16x32_bf16 a[120:123], a[156:159], v[152:155], a[120:123]
  s_barrier
  v_mfma_f32_16x16x32_bf16 a[124:127], a[156:159], v[156:159], a[124:127]
  s_waitcnt lgkmcnt(8)
  v_mfma_f32_16x16x32_bf16 a[0:3], a[128:131], v[160:163], a[0:3]
  ds_read_b64_tr_b16 a[148:149], v15 offset:24576
  ds_read_b64_tr_b16 a[150:151], v15 offset:26624
  v_mfma_f32_16x16x32_bf16 a[4:7], a[128:131], v[164:167], a[4:7]
  s_add_u32 m0, s31, 16384
  v_mfma_f32_16x16x32_bf16 a[8:11], a[128:131], v[168:171], a[8:11]
  buffer_load_dwordx4 v18, s[8:11], s32 offen offset:0 lds
  v_mfma_f32_16x16x32_bf16 a[12:15], a[128:131], v[172:175], a[12:15]
  s_waitcnt lgkmcnt(8)
  v_mfma_f32_16x16x32_bf16 a[16:19], a[132:135], v[160:163], a[16:19]
  ds_read_b64_tr_b16 a[152:153], v16 offset:24576
  ds_read_b64_tr_b16 a[154:155], v16 offset:26624
  v_mfma_f32_16x16x32_bf16 a[20:23], a[132:135], v[164:167], a[20:23]
  v_mfma_f32_16x16x32_bf16 a[24:27], a[132:135], v[168:171], a[24:27]
  buffer_load_dwordx4 v19, s[8:11], s32 offen offset:1024 lds
  v_mfma_f32_16x16x32_bf16 a[28:31], a[132:135], v[172:175], a[28:31]
  s_waitcnt lgkmcnt(8)
  v_mfma_f32_16x16x32_bf16 a[32:35], a[136:139], v[160:163], a[32:35]
  s_add_u32 s32, s32, 98304
  ds_read_b64_tr_b16 a[156:157], v17 offset:24576
  ds_read_b64_tr_b16 a[158:159], v17 offset:26624
  v_mfma_f32_16x16x32_bf16 a[36:39], a[136:139], v[164:167], a[36:39]
  v_mfma_f32_16x16x32_bf16 a[40:43], a[136:139], v[168:171], a[40:43]
  buffer_load_dwordx4 v[80:83], v20, s[16:19], s33 offen offset:0
  v_mfma_f32_16x16x32_bf16 a[44:47], a[136:139], v[172:175], a[44:47]
  s_waitcnt lgkmcnt(8)
  v_mfma_f32_16x16x32_bf16 a[48:51], a[140:143], v[160:163], a[48:51]
  ds_read_b64_tr_b16 a[128:129], v10 offset:0
  ds_read_b64_tr_b16 a[130:131], v10 offset:2048
  v_mfma_f32_16x16x32_bf16 a[52:55], a[140:143], v[164:167], a[52:55]
  v_mfma_f32_16x16x32_bf16 a[56:59], a[140:143], v[168:171], a[56:59]
  buffer_load_dwordx4 v[84:87], v20, s[16:19], s33 offen offset:1024
  v_mfma_f32_16x16x32_bf16 a[60:63], a[140:143], v[172:175], a[60:63]
  s_waitcnt lgkmcnt(8)
  v_mfma_f32_16x16x32_bf16 a[64:67], a[144:147], v[160:163], a[64:67]
  ds_read_b64_tr_b16 a[132:133], v11 offset:0
  ds_read_b64_tr_b16 a[134:135], v11 offset:2048
  v_mfma_f32_16x16x32_bf16 a[68:71], a[144:147], v[164:167], a[68:71]
  v_mfma_f32_16x16x32_bf16 a[72:75], a[144:147], v[168:171], a[72:75]
  buffer_load_dwordx4 v[88:91], v20, s[16:19], s33 offen offset:2048
  v_mfma_f32_16x16x32_bf16 a[76:79], a[144:147], v[172:175], a[76:79]
  s_waitcnt lgkmcnt(8)
  v_mfma_f32_16x16x32_bf16 a[80:83], a[148:151], v[160:163], a[80:83]
  ds_read_b64_tr_b16 a[136:137], v12 offset:0
  ds_read_b64_tr_b16 a[138:139], v12 offset:2048
  v_mfma_f32_16x16x32_bf16 a[84:87], a[148:151], v[164:167], a[84:87]
  v_mfma_f32_16x16x32_bf16 a[88:91], a[148:151], v[168:171], a[88:91]
  buffer_load_dwordx4 v[92:95], v20, s[16:19], s33 offen offset:3072
  v_mfma_f32_16x16x32_bf16 a[92:95], a[148:151], v[172:175], a[92:95]
  s_waitcnt lgkmcnt(8)
  v_mfma_f32_16x16x32_bf16 a[96:99], a[152:155], v[160:163], a[96:99]
  s_add_u32 s33, s33, 4096
  ds_read_b64_tr_b16 a[140:141], v13 offset:0
  ds_read_b64_tr_b16 a[142:143], v13 offset:2048
  v_mfma_f32_16x16x32_bf16 a[100:103], a[152:155], v[164:167], a[100:103]
  s_add_u32 m0, s68, 86016
  v_mfma_f32_16x16x32_bf16 a[104:107], a[152:155], v[168:171], a[104:107]
  buffer_load_dwordx4 v21, s[64:67], s69 offen lds
  v_mfma_f32_16x16x32_bf16 a[108:111], a[152:155], v[172:175], a[108:111]
  s_waitcnt lgkmcnt(8)
  v_mfma_f32_16x16x32_bf16 a[112:115], a[156:159], v[160:163], a[112:115]
  s_add_u32 s69, s69, 5120
  ds_read_b64_tr_b16 a[144:145], v14 offset:0
  ds_read_b64_tr_b16 a[146:147], v14 offset:2048
  v_mfma_f32_16x16x32_bf16 a[116:119], a[156:159], v[164:167], a[116:119]
  v_mfma_f32_16x16x32_bf16 a[120:123], a[156:159], v[168:171], a[120:123]
  s_waitcnt vmcnt(34)
  v_mfma_f32_16x16x32_bf16 a[124:127], a[156:159], v[172:175], a[124:127]
  s_waitcnt lgkmcnt(8)
  v_mfma_f32_16x16x32_bf16 a[0:3], a[128:131], v[176:179], a[0:3]
  ds_read_b64_tr_b16 a[148:149], v15 offset:0
  ds_read_b64_tr_b16 a[150:151], v15 offset:2048
  v_mfma_f32_16x16x32_bf16 a[4:7], a[128:131], v[180:183], a[4:7]
  s_add_u32 m0, s31, 20480
  v_mfma_f32_16x16x32_bf16 a[8:11], a[128:131], v[184:187], a[8:11]
  buffer_load_dwordx4 v18, s[8:11], s32 offen offset:0 lds
  v_mfma_f32_16x16x32_bf16 a[12:15], a[128:131], v[188:191], a[12:15]
  s_waitcnt lgkmcnt(8)
  v_mfma_f32_16x16x32_bf16 a[16:19], a[132:135], v[176:179], a[16:19]
  ds_read_b64_tr_b16 a[152:153], v16 offset:0
  ds_read_b64_tr_b16 a[154:155], v16 offset:2048
  v_mfma_f32_16x16x32_bf16 a[20:23], a[132:135], v[180:183], a[20:23]
  buffer_load_dwordx4 v19, s[8:11], s32 offen offset:1024 lds
  v_mfma_f32_16x16x32_bf16 a[24:27], a[132:135], v[184:187], a[24:27]
  s_add_u32 s32, s32, 98304
  v_mfma_f32_16x16x32_bf16 a[28:31], a[132:135], v[188:191], a[28:31]
  s_waitcnt lgkmcnt(8)
  buffer_load_dwordx4 v[96:99], v20, s[16:19], s33 offen offset:0
  v_mfma_f32_16x16x32_bf16 a[32:35], a[136:139], v[176:179], a[32:35]
  ds_read_b64_tr_b16 a[156:157], v17 offset:0
  ds_read_b64_tr_b16 a[158:159], v17 offset:2048
  v_mfma_f32_16x16x32_bf16 a[36:39], a[136:139], v[180:183], a[36:39]
  buffer_load_dwordx4 v[100:103], v20, s[16:19], s33 offen offset:1024
  v_mfma_f32_16x16x32_bf16 a[40:43], a[136:139], v[184:187], a[40:43]
  v_mfma_f32_16x16x32_bf16 a[44:47], a[136:139], v[188:191], a[44:47]
  s_waitcnt lgkmcnt(8)
  buffer_load_dwordx4 v[104:107], v20, s[16:19], s33 offen offset:2048
  v_mfma_f32_16x16x32_bf16 a[48:51], a[140:143], v[176:179], a[48:51]
  ds_read_b64_tr_b16 a[128:129], v10 offset:4096
  ds_read_b64_tr_b16 a[130:131], v10 offset:6144
  v_mfma_f32_16x16x32_bf16 a[52:55], a[140:143], v[180:183], a[52:55]
  buffer_load_dwordx4 v[108:111], v20, s[16:19], s33 offen offset:3072
  v_mfma_f32_16x16x32_bf16 a[56:59], a[140:143], v[184:187], a[56:59]
  s_add_u32 s33, s33, 4096
  v_mfma_f32_16x16x32_bf16 a[60:63], a[140:143], v[188:191], a[60:63]
  s_waitcnt lgkmcnt(8)
  v_mfma_f32_16x16x32_bf16 a[64:67], a[144:147], v[176:179], a[64:67]
  s_add_u32 m0, s68, 102400
  ds_read_b64_tr_b16 a[132:133], v11 offset:4096
  ds_read_b64_tr_b16 a[134:135], v11 offset:6144
  v_mfma_f32_16x16x32_bf16 a[68:71], a[144:147], v[180:183], a[68:71]
  buffer_load_dwordx4 v20, s[64:67], s69 offen offset:0 lds
  v_mfma_f32_16x16x32_bf16 a[72:75], a[144:147], v[184:187], a[72:75]
  v_mfma_f32_16x16x32_bf16 a[76:79], a[144:147], v[188:191], a[76:79]
  s_waitcnt lgkmcnt(8)
  buffer_load_dwordx4 v20, s[64:67], s69 offen offset:1024 lds
  v_mfma_f32_16x16x32_bf16 a[80:83], a[148:151], v[176:179], a[80:83]
  ds_read_b64_tr_b16 a[136:137], v12 offset:4096
  ds_read_b64_tr_b16 a[138:139], v12 offset:6144
  v_mfma_f32_16x16x32_bf16 a[84:87], a[148:151], v[180:183], a[84:87]
  buffer_load_dwordx4 v20, s[64:67], s69 offen offset:2048 lds
  v_mfma_f32_16x16x32_bf16 a[88:91], a[148:151], v[184:187], a[88:91]
  v_mfma_f32_16x16x32_bf16 a[92:95], a[148:151], v[188:191], a[92:95]
  s_waitcnt lgkmcnt(8)
  buffer_load_dwordx4 v20, s[64:67], s69 offen offset:3072 lds
  v_mfma_f32_16x16x32_bf16 a[96:99], a[152:155], v[176:179], a[96:99]
  ds_read_b64_tr_b16 a[140:141], v13 offset:4096
  ds_read_b64_tr_b16 a[142:143], v13 offset:6144
  v_mfma_f32_16x16x32_bf16 a[100:103], a[152:155], v[180:183], a[100:103]
  v_mfma_f32_16x16x32_bf16 a[104:107], a[152:155], v[184:187], a[104:107]
  v_mfma_f32_16x16x32_bf16 a[108:111], a[152:155], v[188:191], a[108:111]
  s_waitcnt lgkmcnt(8)
  v_mfma_f32_16x16x32_bf16 a[112:115], a[156:159], v[176:179], a[112:115]
  ds_read_b64_tr_b16 a[144:145], v14 offset:4096
  ds_read_b64_tr_b16 a[146:147], v14 offset:6144
  v_mfma_f32_16x16x32_bf16 a[116:119], a[156:159], v[180:183], a[116:119]
  s_waitcnt vmcnt(25)
  v_mfma_f32_16x16x32_bf16 a[120:123], a[156:159], v[184:187], a[120:123]
  s_barrier
  v_mfma_f32_16x16x32_bf16 a[124:127], a[156:159], v[188:191], a[124:127]
  s_waitcnt lgkmcnt(8)
  v_mfma_f32_16x16x32_bf16 a[0:3], a[128:131], v[192:195], a[0:3]
  ds_read_b64_tr_b16 a[148:149], v15 offset:4096
  ds_read_b64_tr_b16 a[150:151], v15 offset:6144
  v_mfma_f32_16x16x32_bf16 a[4:7], a[128:131], v[196:199], a[4:7]
  s_add_u32 m0, s31, 24576
  v_mfma_f32_16x16x32_bf16 a[8:11], a[128:131], v[200:203], a[8:11]
  buffer_load_dwordx4 v18, s[8:11], s32 offen offset:0 lds
  v_mfma_f32_16x16x32_bf16 a[12:15], a[128:131], v[204:207], a[12:15]
  s_waitcnt lgkmcnt(8)
  v_mfma_f32_16x16x32_bf16 a[16:19], a[132:135], v[192:195], a[16:19]
  ds_read_b64_tr_b16 a[152:153], v16 offset:4096
  ds_read_b64_tr_b16 a[154:155], v16 offset:6144
  v_mfma_f32_16x16x32_bf16 a[20:23], a[132:135], v[196:199], a[20:23]
  v_mfma_f32_16x16x32_bf16 a[24:27], a[132:135], v[200:203], a[24:27]
  buffer_load_dwordx4 v19, s[8:11], s32 offen offset:1024 lds
  v_mfma_f32_16x16x32_bf16 a[28:31], a[132:135], v[204:207], a[28:31]
  s_waitcnt lgkmcnt(8)
  v_mfma_f32_16x16x32_bf16 a[32:35], a[136:139], v[192:195], a[32:35]
  s_add_u32 s32, s32, 98304
  ds_read_b64_tr_b16 a[156:157], v17 offset:4096
  ds_read_b64_tr_b16 a[158:159], v17 offset:6144
  v_mfma_f32_16x16x32_bf16 a[36:39], a[136:139], v[196:199], a[36:39]
  v_mfma_f32_16x16x32_bf16 a[40:43], a[136:139], v[200:203], a[40:43]
  buffer_load_dwordx4 v[112:115], v20, s[16:19], s33 offen offset:0
  v_mfma_f32_16x16x32_bf16 a[44:47], a[136:139], v[204:207], a[44:47]
  s_waitcnt lgkmcnt(8)
  v_mfma_f32_16x16x32_bf16 a[48:51], a[140:143], v[192:195], a[48:51]
  ds_read_b64_tr_b16 a[128:129], v10 offset:8192
  ds_read_b64_tr_b16 a[130:131], v10 offset:10240
  v_mfma_f32_16x16x32_bf16 a[52:55], a[140:143], v[196:199], a[52:55]
  v_mfma_f32_16x16x32_bf16 a[56:59], a[140:143], v[200:203], a[56:59]
  buffer_load_dwordx4 v[116:119], v20, s[16:19], s33 offen offset:1024
  v_mfma_f32_16x16x32_bf16 a[60:63], a[140:143], v[204:207], a[60:63]
  s_waitcnt lgkmcnt(8)
  v_mfma_f32_16x16x32_bf16 a[64:67], a[144:147], v[192:195], a[64:67]
  ds_read_b64_tr_b16 a[132:133], v11 offset:8192
  ds_read_b64_tr_b16 a[134:135], v11 offset:10240
  v_mfma_f32_16x16x32_bf16 a[68:71], a[144:147], v[196:199], a[68:71]
  v_mfma_f32_16x16x32_bf16 a[72:75], a[144:147], v[200:203], a[72:75]
  buffer_load_dwordx4 v[120:123], v20, s[16:19], s33 offen offset:2048
  v_mfma_f32_16x16x32_bf16 a[76:79], a[144:147], v[204:207], a[76:79]
  s_waitcnt lgkmcnt(8)
  v_mfma_f32_16x16x32_bf16 a[80:83], a[148:151], v[192:195], a[80:83]
  ds_read_b64_tr_b16 a[136:137], v12 offset:8192
  ds_read_b64_tr_b16 a[138:139], v12 offset:10240
  v_mfma_f32_16x16x32_bf16 a[84:87], a[148:151], v[196:199], a[84:87]
  v_mfma_f32_16x16x32_bf16 a[88:91], a[148:151], v[200:203], a[88:91]
  buffer_load_dwordx4 v[124:127], v20, s[16:19], s33 offen offset:3072
  v_mfma_f32_16x16x32_bf16 a[92:95], a[148:151], v[204:207], a[92:95]
  s_waitcnt lgkmcnt(8)
  v_mfma_f32_16x16x32_bf16 a[96:99], a[152:155], v[192:195], a[96:99]
  s_add_u32 s33, s33, 4096
  ds_read_b64_tr_b16 a[140:141], v13 offset:8192
  ds_read_b64_tr_b16 a[142:143], v13 offset:10240
  v_mfma_f32_16x16x32_bf16 a[100:103], a[152:155], v[196:199], a[100:103]
  s_add_u32 m0, s68, 106496
  v_mfma_f32_16x16x32_bf16 a[104:107], a[152:155], v[200:203], a[104:107]
  buffer_load_dwordx4 v21, s[64:67], s69 offen lds
  v_mfma_f32_16x16x32_bf16 a[108:111], a[152:155], v[204:207], a[108:111]
  s_waitcnt lgkmcnt(8)
  v_mfma_f32_16x16x32_bf16 a[112:115], a[156:159], v[192:195], a[112:115]
  s_add_u32 s69, s69, 5120
  ds_read_b64_tr_b16 a[144:145], v14 offset:8192
  ds_read_b64_tr_b16 a[146:147], v14 offset:10240
  v_mfma_f32_16x16x32_bf16 a[116:119], a[156:159], v[196:199], a[116:119]
  v_mfma_f32_16x16x32_bf16 a[120:123], a[156:159], v[200:203], a[120:123]
  s_waitcnt vmcnt(35)
  v_mfma_f32_16x16x32_bf16 a[124:127], a[156:159], v[204:207], a[124:127]
  s_waitcnt lgkmcnt(8)
  v_mfma_f32_16x16x32_bf16 a[0:3], a[128:131], v[208:211], a[0:3]
  ds_read_b64_tr_b16 a[148:149], v15 offset:8192
  ds_read_b64_tr_b16 a[150:151], v15 offset:10240
  v_mfma_f32_16x16x32_bf16 a[4:7], a[128:131], v[212:215], a[4:7]
  s_add_u32 m0, s31, 0
  v_mfma_f32_16x16x32_bf16 a[8:11], a[128:131], v[216:219], a[8:11]
  buffer_load_dwordx4 v18, s[8:11], s32 offen offset:0 lds
  v_mfma_f32_16x16x32_bf16 a[12:15], a[128:131], v[220:223], a[12:15]
  s_waitcnt lgkmcnt(8)
  v_mfma_f32_16x16x32_bf16 a[16:19], a[132:135], v[208:211], a[16:19]
  ds_read_b64_tr_b16 a[152:153], v16 offset:8192
  ds_read_b64_tr_b16 a[154:155], v16 offset:10240
  v_mfma_f32_16x16x32_bf16 a[20:23], a[132:135], v[212:215], a[20:23]
  buffer_load_dwordx4 v19, s[8:11], s32 offen offset:1024 lds
  v_mfma_f32_16x16x32_bf16 a[24:27], a[132:135], v[216:219], a[24:27]
  s_add_u32 s32, s32, 98304
  v_mfma_f32_16x16x32_bf16 a[28:31], a[132:135], v[220:223], a[28:31]
  s_waitcnt lgkmcnt(8)
  buffer_load_dwordx4 v[128:131], v20, s[16:19], s33 offen offset:0
  v_mfma_f32_16x16x32_bf16 a[32:35], a[136:139], v[208:211], a[32:35]
  ds_read_b64_tr_b16 a[156:157], v17 offset:8192
  ds_read_b64_tr_b16 a[158:159], v17 offset:10240
  v_mfma_f32_16x16x32_bf16 a[36:39], a[136:139], v[212:215], a[36:39]
  buffer_load_dwordx4 v[132:135], v20, s[16:19], s33 offen offset:1024
  v_mfma_f32_16x16x32_bf16 a[40:43], a[136:139], v[216:219], a[40:43]
  v_mfma_f32_16x16x32_bf16 a[44:47], a[136:139], v[220:223], a[44:47]
  s_waitcnt lgkmcnt(8)
  buffer_load_dwordx4 v[136:139], v20, s[16:19], s33 offen offset:2048
  v_mfma_f32_16x16x32_bf16 a[48:51], a[140:143], v[208:211], a[48:51]
  ds_read_b64_tr_b16 a[128:129], v10 offset:12288
  ds_read_b64_tr_b16 a[130:131], v10 offset:14336
  v_mfma_f32_16x16x32_bf16 a[52:55], a[140:143], v[212:215], a[52:55]
  buffer_load_dwordx4 v[140:143], v20, s[16:19], s33 offen offset:3072
  v_mfma_f32_16x16x32_bf16 a[56:59], a[140:143], v[216:219], a[56:59]
  s_add_u32 s33, s33, 4096
  v_mfma_f32_16x16x32_bf16 a[60:63], a[140:143], v[220:223], a[60:63]
  s_waitcnt lgkmcnt(8)
  v_mfma_f32_16x16x32_bf16 a[64:67], a[144:147], v[208:211], a[64:67]
  s_add_u32 m0, s68, 122880
  ds_read_b64_tr_b16 a[132:133], v11 offset:12288
  ds_read_b64_tr_b16 a[134:135], v11 offset:14336
  v_mfma_f32_16x16x32_bf16 a[68:71], a[144:147], v[212:215], a[68:71]
  buffer_load_dwordx4 v20, s[64:67], s69 offen offset:0 lds
  v_mfma_f32_16x16x32_bf16 a[72:75], a[144:147], v[216:219], a[72:75]
  v_mfma_f32_16x16x32_bf16 a[76:79], a[144:147], v[220:223], a[76:79]
  s_waitcnt lgkmcnt(8)
  buffer_load_dwordx4 v20, s[64:67], s69 offen offset:1024 lds
  v_mfma_f32_16x16x32_bf16 a[80:83], a[148:151], v[208:211], a[80:83]
  ds_read_b64_tr_b16 a[136:137], v12 offset:12288
  ds_read_b64_tr_b16 a[138:139], v12 offset:14336
  v_mfma_f32_16x16x32_bf16 a[84:87], a[148:151], v[212:215], a[84:87]
  buffer_load_dwordx4 v20, s[64:67], s69 offen offset:2048 lds
  v_mfma_f32_16x16x32_bf16 a[88:91], a[148:151], v[216:219], a[88:91]
  v_mfma_f32_16x16x32_bf16 a[92:95], a[148:151], v[220:223], a[92:95]
  s_waitcnt lgkmcnt(8)
  buffer_load_dwordx4 v20, s[64:67], s69 offen offset:3072 lds
  v_mfma_f32_16x16x32_bf16 a[96:99], a[152:155], v[208:211], a[96:99]
  ds_read_b64_tr_b16 a[140:141], v13 offset:12288
  ds_read_b64_tr_b16 a[142:143], v13 offset:14336
  v_mfma_f32_16x16x32_bf16 a[100:103], a[152:155], v[212:215], a[100:103]
  v_mfma_f32_16x16x32_bf16 a[104:107], a[152:155], v[216:219], a[104:107]
  v_mfma_f32_16x16x32_bf16 a[108:111], a[152:155], v[220:223], a[108:111]
  s_waitcnt lgkmcnt(8)
  v_mfma_f32_16x16x32_bf16 a[112:115], a[156:159], v[208:211], a[112:115]
  ds_read_b64_tr_b16 a[144:145], v14 offset:12288
  ds_read_b64_tr_b16 a[146:147], v14 offset:14336
  v_mfma_f32_16x16x32_bf16 a[116:119], a[156:159], v[212:215], a[116:119]
  s_waitcnt vmcnt(25)
  v_mfma_f32_16x16x32_bf16 a[120:123], a[156:159], v[216:219], a[120:123]
  s_barrier
  v_mfma_f32_16x16x32_bf16 a[124:127], a[156:159], v[220:223], a[124:127]
  s_waitcnt lgkmcnt(8)
  v_mfma_f32_16x16x32_bf16 a[0:3], a[128:131], v[64:67], a[0:3]
  ds_read_b64_tr_b16 a[148:149], v15 offset:12288
  ds_read_b64_tr_b16 a[150:151], v15 offset:14336
  v_mfma_f32_16x16x32_bf16 a[4:7], a[128:131], v[68:71], a[4:7]
  s_add_u32 m0, s31, 4096
  v_mfma_f32_16x16x32_bf16 a[8:11], a[128:131], v[72:75], a[8:11]
  buffer_load_dwordx4 v18, s[8:11], s32 offen offset:0 lds
  v_mfma_f32_16x16x32_bf16 a[12:15], a[128:131], v[76:79], a[12:15]
  s_waitcnt lgkmcnt(8)
  v_mfma_f32_16x16x32_bf16 a[16:19], a[132:135], v[64:67], a[16:19]
  ds_read_b64_tr_b16 a[152:153], v16 offset:12288
  ds_read_b64_tr_b16 a[154:155], v16 offset:14336
  v_mfma_f32_16x16x32_bf16 a[20:23], a[132:135], v[68:71], a[20:23]
  v_mfma_f32_16x16x32_bf16 a[24:27], a[132:135], v[72:75], a[24:27]
  buffer_load_dwordx4 v19, s[8:11], s32 offen offset:1024 lds
  v_mfma_f32_16x16x32_bf16 a[28:31], a[132:135], v[76:79], a[28:31]
  s_waitcnt lgkmcnt(8)
  v_mfma_f32_16x16x32_bf16 a[32:35], a[136:139], v[64:67], a[32:35]
  s_add_u32 s32, s32, 98304
  ds_read_b64_tr_b16 a[156:157], v17 offset:12288
  ds_read_b64_tr_b16 a[158:159], v17 offset:14336
  v_mfma_f32_16x16x32_bf16 a[36:39], a[136:139], v[68:71], a[36:39]
  v_mfma_f32_16x16x32_bf16 a[40:43], a[136:139], v[72:75], a[40:43]
  buffer_load_dwordx4 v[144:147], v20, s[16:19], s33 offen offset:0
  v_mfma_f32_16x16x32_bf16 a[44:47], a[136:139], v[76:79], a[44:47]
  s_waitcnt lgkmcnt(8)
  v_mfma_f32_16x16x32_bf16 a[48:51], a[140:143], v[64:67], a[48:51]
  ds_read_b64_tr_b16 a[128:129], v10 offset:16384
  ds_read_b64_tr_b16 a[130:131], v10 offset:18432
  v_mfma_f32_16x16x32_bf16 a[52:55], a[140:143], v[68:71], a[52:55]
  v_mfma_f32_16x16x32_bf16 a[56:59], a[140:143], v[72:75], a[56:59]
  buffer_load_dwordx4 v[148:151], v20, s[16:19], s33 offen offset:1024
  v_mfma_f32_16x16x32_bf16 a[60:63], a[140:143], v[76:79], a[60:63]
  s_waitcnt lgkmcnt(8)
  v_mfma_f32_16x16x32_bf16 a[64:67], a[144:147], v[64:67], a[64:67]
  ds_read_b64_tr_b16 a[132:133], v11 offset:16384
  ds_read_b64_tr_b16 a[134:135], v11 offset:18432
  v_mfma_f32_16x16x32_bf16 a[68:71], a[144:147], v[68:71], a[68:71]
  v_mfma_f32_16x16x32_bf16 a[72:75], a[144:147], v[72:75], a[72:75]
  buffer_load_dwordx4 v[152:155], v20, s[16:19], s33 offen offset:2048
  v_mfma_f32_16x16x32_bf16 a[76:79], a[144:147], v[76:79], a[76:79]
  s_waitcnt lgkmcnt(8)
  v_mfma_f32_16x16x32_bf16 a[80:83], a[148:151], v[64:67], a[80:83]
  ds_read_b64_tr_b16 a[136:137], v12 offset:16384
  ds_read_b64_tr_b16 a[138:139], v12 offset:18432
  v_mfma_f32_16x16x32_bf16 a[84:87], a[148:151], v[68:71], a[84:87]
  v_mfma_f32_16x16x32_bf16 a[88:91], a[148:151], v[72:75], a[88:91]
  buffer_load_dwordx4 v[156:159], v20, s[16:19], s33 offen offset:3072
  v_mfma_f32_16x16x32_bf16 a[92:95], a[148:151], v[76:79], a[92:95]
  s_waitcnt lgkmcnt(8)
  v_mfma_f32_16x16x32_bf16 a[96:99], a[152:155], v[64:67], a[96:99]
  s_add_u32 s33, s33, 4096
  ds_read_b64_tr_b16 a[140:141], v13 offset:16384
  ds_read_b64_tr_b16 a[142:143], v13 offset:18432
  v_mfma_f32_16x16x32_bf16 a[100:103], a[152:155], v[68:71], a[100:103]
  s_add_u32 m0, s68, 126976
  v_mfma_f32_16x16x32_bf16 a[104:107], a[152:155], v[72:75], a[104:107]
  buffer_load_dwordx4 v21, s[64:67], s69 offen lds
  v_mfma_f32_16x16x32_bf16 a[108:111], a[152:155], v[76:79], a[108:111]
  s_waitcnt lgkmcnt(8)
  v_mfma_f32_16x16x32_bf16 a[112:115], a[156:159], v[64:67], a[112:115]
  s_add_u32 s69, s69, 5120
  ds_read_b64_tr_b16 a[144:145], v14 offset:16384
  ds_read_b64_tr_b16 a[146:147], v14 offset:18432
  v_mfma_f32_16x16x32_bf16 a[116:119], a[156:159], v[68:71], a[116:119]
  v_mfma_f32_16x16x32_bf16 a[120:123], a[156:159], v[72:75], a[120:123]
  s_waitcnt vmcnt(35)
  v_mfma_f32_16x16x32_bf16 a[124:127], a[156:159], v[76:79], a[124:127]
  s_waitcnt lgkmcnt(8)
  v_mfma_f32_16x16x32_bf16 a[0:3], a[128:131], v[80:83], a[0:3]
  ds_read_b64_tr_b16 a[148:149], v15 offset:16384
  ds_read_b64_tr_b16 a[150:151], v15 offset:18432
  v_mfma_f32_16x16x32_bf16 a[4:7], a[128:131], v[84:87], a[4:7]
  s_add_u32 m0, s31, 8192
  v_mfma_f32_16x16x32_bf16 a[8:11], a[128:131], v[88:91], a[8:11]
  buffer_load_dwordx4 v18, s[8:11], s32 offen offset:0 lds
  v_mfma_f32_16x16x32_bf16 a[12:15], a[128:131], v[92:95], a[12:15]
  s_waitcnt lgkmcnt(8)
  v_mfma_f32_16x16x32_bf16 a[16:19], a[132:135], v[80:83], a[16:19]
  ds_read_b64_tr_b16 a[152:153], v16 offset:16384
  ds_read_b64_tr_b16 a[154:155], v16 offset:18432
  v_mfma_f32_16x16x32_bf16 a[20:23], a[132:135], v[84:87], a[20:23]
  v_mfma_f32_16x16x32_bf16 a[24:27], a[132:135], v[88:91], a[24:27]
  buffer_load_dwordx4 v19, s[8:11], s32 offen offset:1024 lds
  v_mfma_f32_16x16x32_bf16 a[28:31], a[132:135], v[92:95], a[28:31]
  s_waitcnt lgkmcnt(8)
  v_mfma_f32_16x16x32_bf16 a[32:35], a[136:139], v[80:83], a[32:35]
  s_add_u32 s32, s32, 98304
  ds_read_b64_tr_b16 a[156:157], v17 offset:16384
  ds_read_b64_tr_b16 a[158:159], v17 offset:18432
  v_mfma_f32_16x16x32_bf16 a[36:39], a[136:139], v[84:87], a[36:39]
  v_mfma_f32_16x16x32_bf16 a[40:43], a[136:139], v[88:91], a[40:43]
  buffer_load_dwordx4 v[160:163], v20, s[16:19], s33 offen offset:0
  v_mfma_f32_16x16x32_bf16 a[44:47], a[136:139], v[92:95], a[44:47]
  s_waitcnt lgkmcnt(8)
  v_mfma_f32_16x16x32_bf16 a[48:51], a[140:143], v[80:83], a[48:51]
  ds_read_b64_tr_b16 a[128:129], v10 offset:20480
  ds_read_b64_tr_b16 a[130:131], v10 offset:22528
  v_mfma_f32_16x16x32_bf16 a[52:55], a[140:143], v[84:87], a[52:55]
  v_mfma_f32_16x16x32_bf16 a[56:59], a[140:143], v[88:91], a[56:59]
  buffer_load_dwordx4 v[164:167], v20, s[16:19], s33 offen offset:1024
  v_mfma_f32_16x16x32_bf16 a[60:63], a[140:143], v[92:95], a[60:63]
  s_waitcnt lgkmcnt(8)
  v_mfma_f32_16x16x32_bf16 a[64:67], a[144:147], v[80:83], a[64:67]
  ds_read_b64_tr_b16 a[132:133], v11 offset:20480
  ds_read_b64_tr_b16 a[134:135], v11 offset:22528
  v_mfma_f32_16x16x32_bf16 a[68:71], a[144:147], v[84:87], a[68:71]
  v_mfma_f32_16x16x32_bf16 a[72:75], a[144:147], v[88:91], a[72:75]
  buffer_load_dwordx4 v[168:171], v20, s[16:19], s33 offen offset:2048
  v_mfma_f32_16x16x32_bf16 a[76:79], a[144:147], v[92:95], a[76:79]
  s_waitcnt lgkmcnt(8)
  v_mfma_f32_16x16x32_bf16 a[80:83], a[148:151], v[80:83], a[80:83]
  ds_read_b64_tr_b16 a[136:137], v12 offset:20480
  ds_read_b64_tr_b16 a[138:139], v12 offset:22528
  v_mfma_f32_16x16x32_bf16 a[84:87], a[148:151], v[84:87], a[84:87]
  v_mfma_f32_16x16x32_bf16 a[88:91], a[148:151], v[88:91], a[88:91]
  buffer_load_dwordx4 v[172:175], v20, s[16:19], s33 offen offset:3072
  v_mfma_f32_16x16x32_bf16 a[92:95], a[148:151], v[92:95], a[92:95]
  s_waitcnt lgkmcnt(8)
  v_mfma_f32_16x16x32_bf16 a[96:99], a[152:155], v[80:83], a[96:99]
  s_add_u32 s33, s33, 4096
  ds_read_b64_tr_b16 a[140:141], v13 offset:20480
  ds_read_b64_tr_b16 a[142:143], v13 offset:22528
  v_mfma_f32_16x16x32_bf16 a[100:103], a[152:155], v[84:87], a[100:103]
  v_mfma_f32_16x16x32_bf16 a[104:107], a[152:155], v[88:91], a[104:107]
  v_mfma_f32_16x16x32_bf16 a[108:111], a[152:155], v[92:95], a[108:111]
  s_waitcnt lgkmcnt(8)
  v_mfma_f32_16x16x32_bf16 a[112:115], a[156:159], v[80:83], a[112:115]
  ds_read_b64_tr_b16 a[144:145], v14 offset:20480
  ds_read_b64_tr_b16 a[146:147], v14 offset:22528
  v_mfma_f32_16x16x32_bf16 a[116:119], a[156:159], v[84:87], a[116:119]
  s_waitcnt vmcnt(21)
  v_mfma_f32_16x16x32_bf16 a[120:123], a[156:159], v[88:91], a[120:123]
  s_barrier
  v_mfma_f32_16x16x32_bf16 a[124:127], a[156:159], v[92:95], a[124:127]
  s_waitcnt lgkmcnt(8)
  v_mfma_f32_16x16x32_bf16 a[0:3], a[128:131], v[96:99], a[0:3]
  ds_read_b64_tr_b16 a[148:149], v15 offset:20480
  ds_read_b64_tr_b16 a[150:151], v15 offset:22528
  v_mfma_f32_16x16x32_bf16 a[4:7], a[128:131], v[100:103], a[4:7]
  s_add_u32 m0, s31, 12288
  v_mfma_f32_16x16x32_bf16 a[8:11], a[128:131], v[104:107], a[8:11]
  buffer_load_dwordx4 v18, s[8:11], s32 offen offset:0 lds
  v_mfma_f32_16x16x32_bf16 a[12:15], a[128:131], v[108:111], a[12:15]
  s_waitcnt lgkmcnt(8)
  v_mfma_f32_16x16x32_bf16 a[16:19], a[132:135], v[96:99], a[16:19]
  ds_read_b64_tr_b16 a[152:153], v16 offset:20480
  ds_read_b64_tr_b16 a[154:155], v16 offset:22528
  v_mfma_f32_16x16x32_bf16 a[20:23], a[132:135], v[100:103], a[20:23]
  v_mfma_f32_16x16x32_bf16 a[24:27], a[132:135], v[104:107], a[24:27]
  buffer_load_dwordx4 v19, s[8:11], s32 offen offset:1024 lds
  v_mfma_f32_16x16x32_bf16 a[28:31], a[132:135], v[108:111], a[28:31]
  s_waitcnt lgkmcnt(8)
  v_mfma_f32_16x16x32_bf16 a[32:35], a[136:139], v[96:99], a[32:35]
  s_add_u32 s32, s32, 98304
  ds_read_b64_tr_b16 a[156:157], v17 offset:20480
  ds_read_b64_tr_b16 a[158:159], v17 offset:22528
  v_mfma_f32_16x16x32_bf16 a[36:39], a[136:139], v[100:103], a[36:39]
  v_mfma_f32_16x16x32_bf16 a[40:43], a[136:139], v[104:107], a[40:43]
  buffer_load_dwordx4 v[176:179], v20, s[16:19], s33 offen offset:0
  v_mfma_f32_16x16x32_bf16 a[44:47], a[136:139], v[108:111], a[44:47]
  s_waitcnt lgkmcnt(8)
  v_mfma_f32_16x16x32_bf16 a[48:51], a[140:143], v[96:99], a[48:51]
  ds_read_b64_tr_b16 a[128:129], v10 offset:24576
  ds_read_b64_tr_b16 a[130:131], v10 offset:26624
  v_mfma_f32_16x16x32_bf16 a[52:55], a[140:143], v[100:103], a[52:55]
  v_mfma_f32_16x16x32_bf16 a[56:59], a[140:143], v[104:107], a[56:59]
  buffer_load_dwordx4 v[180:183], v20, s[16:19], s33 offen offset:1024
  v_mfma_f32_16x16x32_bf16 a[60:63], a[140:143], v[108:111], a[60:63]
  s_waitcnt lgkmcnt(8)
  v_mfma_f32_16x16x32_bf16 a[64:67], a[144:147], v[96:99], a[64:67]
  ds_read_b64_tr_b16 a[132:133], v11 offset:24576
  ds_read_b64_tr_b16 a[134:135], v11 offset:26624
  v_mfma_f32_16x16x32_bf16 a[68:71], a[144:147], v[100:103], a[68:71]
  v_mfma_f32_16x16x32_bf16 a[72:75], a[144:147], v[104:107], a[72:75]
  buffer_load_dwordx4 v[184:187], v20, s[16:19], s33 offen offset:2048
  v_mfma_f32_16x16x32_bf16 a[76:79], a[144:147], v[108:111], a[76:79]
  s_waitcnt lgkmcnt(8)
  v_mfma_f32_16x16x32_bf16 a[80:83], a[148:151], v[96:99], a[80:83]
  ds_read_b64_tr_b16 a[136:137], v12 offset:24576
  ds_read_b64_tr_b16 a[138:139], v12 offset:26624
  v_mfma_f32_16x16x32_bf16 a[84:87], a[148:151], v[100:103], a[84:87]
  v_mfma_f32_16x16x32_bf16 a[88:91], a[148:151], v[104:107], a[88:91]
  buffer_load_dwordx4 v[188:191], v20, s[16:19], s33 offen offset:3072
  v_mfma_f32_16x16x32_bf16 a[92:95], a[148:151], v[108:111], a[92:95]
  s_waitcnt lgkmcnt(8)
  v_mfma_f32_16x16x32_bf16 a[96:99], a[152:155], v[96:99], a[96:99]
  s_add_u32 s33, s33, 4096
  ds_read_b64_tr_b16 a[140:141], v13 offset:24576
  ds_read_b64_tr_b16 a[142:143], v13 offset:26624
  v_mfma_f32_16x16x32_bf16 a[100:103], a[152:155], v[100:103], a[100:103]
  v_mfma_f32_16x16x32_bf16 a[104:107], a[152:155], v[104:107], a[104:107]
  v_mfma_f32_16x16x32_bf16 a[108:111], a[152:155], v[108:111], a[108:111]
  s_waitcnt lgkmcnt(8)
  v_mfma_f32_16x16x32_bf16 a[112:115], a[156:159], v[96:99], a[112:115]
  ds_read_b64_tr_b16 a[144:145], v14 offset:24576
  ds_read_b64_tr_b16 a[146:147], v14 offset:26624
  v_mfma_f32_16x16x32_bf16 a[116:119], a[156:159], v[100:103], a[116:119]
  v_mfma_f32_16x16x32_bf16 a[120:123], a[156:159], v[104:107], a[120:123]
  s_waitcnt vmcnt(30)
  v_mfma_f32_16x16x32_bf16 a[124:127], a[156:159], v[108:111], a[124:127]
  s_waitcnt lgkmcnt(8)
  v_mfma_f32_16x16x32_bf16 a[0:3], a[128:131], v[112:115], a[0:3]
  ds_read_b64_tr_b16 a[148:149], v15 offset:24576
  ds_read_b64_tr_b16 a[150:151], v15 offset:26624
  v_mfma_f32_16x16x32_bf16 a[4:7], a[128:131], v[116:119], a[4:7]
  s_add_u32 m0, s31, 16384
  v_mfma_f32_16x16x32_bf16 a[8:11], a[128:131], v[120:123], a[8:11]
  buffer_load_dwordx4 v18, s[8:11], s32 offen offset:0 lds
  v_mfma_f32_16x16x32_bf16 a[12:15], a[128:131], v[124:127], a[12:15]
  s_waitcnt lgkmcnt(8)
  v_mfma_f32_16x16x32_bf16 a[16:19], a[132:135], v[112:115], a[16:19]
  ds_read_b64_tr_b16 a[152:153], v16 offset:24576
  ds_read_b64_tr_b16 a[154:155], v16 offset:26624
  v_mfma_f32_16x16x32_bf16 a[20:23], a[132:135], v[116:119], a[20:23]
  v_mfma_f32_16x16x32_bf16 a[24:27], a[132:135], v[120:123], a[24:27]
  buffer_load_dwordx4 v19, s[8:11], s32 offen offset:1024 lds
  v_mfma_f32_16x16x32_bf16 a[28:31], a[132:135], v[124:127], a[28:31]
  s_waitcnt lgkmcnt(8)
  v_mfma_f32_16x16x32_bf16 a[32:35], a[136:139], v[112:115], a[32:35]
  s_add_u32 s32, s32, 98304
  ds_read_b64_tr_b16 a[156:157], v17 offset:24576
  ds_read_b64_tr_b16 a[158:159], v17 offset:26624
  v_mfma_f32_16x16x32_bf16 a[36:39], a[136:139], v[116:119], a[36:39]
  v_mfma_f32_16x16x32_bf16 a[40:43], a[136:139], v[120:123], a[40:43]
  buffer_load_dwordx4 v[192:195], v20, s[16:19], s33 offen offset:0
  v_mfma_f32_16x16x32_bf16 a[44:47], a[136:139], v[124:127], a[44:47]
  s_waitcnt lgkmcnt(8)
  v_mfma_f32_16x16x32_bf16 a[48:51], a[140:143], v[112:115], a[48:51]
  ds_read_b64_tr_b16 a[128:129], v10 offset:0
  ds_read_b64_tr_b16 a[130:131], v10 offset:2048
  v_mfma_f32_16x16x32_bf16 a[52:55], a[140:143], v[116:119], a[52:55]
  v_mfma_f32_16x16x32_bf16 a[56:59], a[140:143], v[120:123], a[56:59]
  buffer_load_dwordx4 v[196:199], v20, s[16:19], s33 offen offset:1024
  v_mfma_f32_16x16x32_bf16 a[60:63], a[140:143], v[124:127], a[60:63]
  s_waitcnt lgkmcnt(8)
  v_mfma_f32_16x16x32_bf16 a[64:67], a[144:147], v[112:115], a[64:67]
  ds_read_b64_tr_b16 a[132:133], v11 offset:0
  ds_read_b64_tr_b16 a[134:135], v11 offset:2048
  v_mfma_f32_16x16x32_bf16 a[68:71], a[144:147], v[116:119], a[68:71]
  v_mfma_f32_16x16x32_bf16 a[72:75], a[144:147], v[120:123], a[72:75]
  buffer_load_dwordx4 v[200:203], v20, s[16:19], s33 offen offset:2048
  v_mfma_f32_16x16x32_bf16 a[76:79], a[144:147], v[124:127], a[76:79]
  s_waitcnt lgkmcnt(8)
  v_mfma_f32_16x16x32_bf16 a[80:83], a[148:151], v[112:115], a[80:83]
  ds_read_b64_tr_b16 a[136:137], v12 offset:0
  ds_read_b64_tr_b16 a[138:139], v12 offset:2048
  v_mfma_f32_16x16x32_bf16 a[84:87], a[148:151], v[116:119], a[84:87]
  v_mfma_f32_16x16x32_bf16 a[88:91], a[148:151], v[120:123], a[88:91]
  buffer_load_dwordx4 v[204:207], v20, s[16:19], s33 offen offset:3072
  v_mfma_f32_16x16x32_bf16 a[92:95], a[148:151], v[124:127], a[92:95]
  s_waitcnt lgkmcnt(8)
  v_mfma_f32_16x16x32_bf16 a[96:99], a[152:155], v[112:115], a[96:99]
  s_add_u32 s33, s33, 4096
  ds_read_b64_tr_b16 a[140:141], v13 offset:0
  ds_read_b64_tr_b16 a[142:143], v13 offset:2048
  v_mfma_f32_16x16x32_bf16 a[100:103], a[152:155], v[116:119], a[100:103]
  v_mfma_f32_16x16x32_bf16 a[104:107], a[152:155], v[120:123], a[104:107]
  v_mfma_f32_16x16x32_bf16 a[108:111], a[152:155], v[124:127], a[108:111]
  s_waitcnt lgkmcnt(8)
  v_mfma_f32_16x16x32_bf16 a[112:115], a[156:159], v[112:115], a[112:115]
  ds_read_b64_tr_b16 a[144:145], v14 offset:0
  ds_read_b64_tr_b16 a[146:147], v14 offset:2048
  v_mfma_f32_16x16x32_bf16 a[116:119], a[156:159], v[116:119], a[116:119]
  s_waitcnt vmcnt(16)
  v_mfma_f32_16x16x32_bf16 a[120:123], a[156:159], v[120:123], a[120:123]
  s_barrier
  v_mfma_f32_16x16x32_bf16 a[124:127], a[156:159], v[124:127], a[124:127]
  s_waitcnt lgkmcnt(8)
  v_mfma_f32_16x16x32_bf16 a[0:3], a[128:131], v[128:131], a[0:3]
  ds_read_b64_tr_b16 a[148:149], v15 offset:0
  ds_read_b64_tr_b16 a[150:151], v15 offset:2048
  v_mfma_f32_16x16x32_bf16 a[4:7], a[128:131], v[132:135], a[4:7]
  s_add_u32 m0, s31, 20480
  v_mfma_f32_16x16x32_bf16 a[8:11], a[128:131], v[136:139], a[8:11]
  buffer_load_dwordx4 v18, s[8:11], s32 offen offset:0 lds
  v_mfma_f32_16x16x32_bf16 a[12:15], a[128:131], v[140:143], a[12:15]
  s_waitcnt lgkmcnt(8)
  v_mfma_f32_16x16x32_bf16 a[16:19], a[132:135], v[128:131], a[16:19]
  ds_read_b64_tr_b16 a[152:153], v16 offset:0
  ds_read_b64_tr_b16 a[154:155], v16 offset:2048
  v_mfma_f32_16x16x32_bf16 a[20:23], a[132:135], v[132:135], a[20:23]
  v_mfma_f32_16x16x32_bf16 a[24:27], a[132:135], v[136:139], a[24:27]
  buffer_load_dwordx4 v19, s[8:11], s32 offen offset:1024 lds
  v_mfma_f32_16x16x32_bf16 a[28:31], a[132:135], v[140:143], a[28:31]
  s_waitcnt lgkmcnt(8)
  v_mfma_f32_16x16x32_bf16 a[32:35], a[136:139], v[128:131], a[32:35]
  s_add_u32 s32, s32, 98304
  ds_read_b64_tr_b16 a[156:157], v17 offset:0
  ds_read_b64_tr_b16 a[158:159], v17 offset:2048
  v_mfma_f32_16x16x32_bf16 a[36:39], a[136:139], v[132:135], a[36:39]
  v_mfma_f32_16x16x32_bf16 a[40:43], a[136:139], v[136:139], a[40:43]
  buffer_load_dwordx4 v[208:211], v20, s[16:19], s33 offen offset:0
  v_mfma_f32_16x16x32_bf16 a[44:47], a[136:139], v[140:143], a[44:47]
  s_waitcnt lgkmcnt(8)
  v_mfma_f32_16x16x32_bf16 a[48:51], a[140:143], v[128:131], a[48:51]
  ds_read_b64_tr_b16 a[128:129], v10 offset:4096
  ds_read_b64_tr_b16 a[130:131], v10 offset:6144
  v_mfma_f32_16x16x32_bf16 a[52:55], a[140:143], v[132:135], a[52:55]
  v_mfma_f32_16x16x32_bf16 a[56:59], a[140:143], v[136:139], a[56:59]
  buffer_load_dwordx4 v[212:215], v20, s[16:19], s33 offen offset:1024
  v_mfma_f32_16x16x32_bf16 a[60:63], a[140:143], v[140:143], a[60:63]
  s_waitcnt lgkmcnt(8)
  v_mfma_f32_16x16x32_bf16 a[64:67], a[144:147], v[128:131], a[64:67]
  ds_read_b64_tr_b16 a[132:133], v11 offset:4096
  ds_read_b64_tr_b16 a[134:135], v11 offset:6144
  v_mfma_f32_16x16x32_bf16 a[68:71], a[144:147], v[132:135], a[68:71]
  v_mfma_f32_16x16x32_bf16 a[72:75], a[144:147], v[136:139], a[72:75]
  buffer_load_dwordx4 v[216:219], v20, s[16:19], s33 offen offset:2048
  v_mfma_f32_16x16x32_bf16 a[76:79], a[144:147], v[140:143], a[76:79]
  s_waitcnt lgkmcnt(8)
  v_mfma_f32_16x16x32_bf16 a[80:83], a[148:151], v[128:131], a[80:83]
  ds_read_b64_tr_b16 a[136:137], v12 offset:4096
  ds_read_b64_tr_b16 a[138:139], v12 offset:6144
  v_mfma_f32_16x16x32_bf16 a[84:87], a[148:151], v[132:135], a[84:87]
  v_mfma_f32_16x16x32_bf16 a[88:91], a[148:151], v[136:139], a[88:91]
  buffer_load_dwordx4 v[220:223], v20, s[16:19], s33 offen offset:3072
  v_mfma_f32_16x16x32_bf16 a[92:95], a[148:151], v[140:143], a[92:95]
  s_waitcnt lgkmcnt(8)
  v_mfma_f32_16x16x32_bf16 a[96:99], a[152:155], v[128:131], a[96:99]
  s_add_u32 s33, s33, 4096
  ds_read_b64_tr_b16 a[140:141], v13 offset:4096
  ds_read_b64_tr_b16 a[142:143], v13 offset:6144
  v_mfma_f32_16x16x32_bf16 a[100:103], a[152:155], v[132:135], a[100:103]
  v_mfma_f32_16x16x32_bf16 a[104:107], a[152:155], v[136:139], a[104:107]
  v_mfma_f32_16x16x32_bf16 a[108:111], a[152:155], v[140:143], a[108:111]
  s_waitcnt lgkmcnt(8)
  v_mfma_f32_16x16x32_bf16 a[112:115], a[156:159], v[128:131], a[112:115]
  ds_read_b64_tr_b16 a[144:145], v14 offset:4096
  ds_read_b64_tr_b16 a[146:147], v14 offset:6144
  v_mfma_f32_16x16x32_bf16 a[116:119], a[156:159], v[132:135], a[116:119]
  v_mfma_f32_16x16x32_bf16 a[120:123], a[156:159], v[136:139], a[120:123]
  s_waitcnt vmcnt(25)
  v_mfma_f32_16x16x32_bf16 a[124:127], a[156:159], v[140:143], a[124:127]
  s_waitcnt lgkmcnt(8)
  v_mfma_f32_16x16x32_bf16 a[0:3], a[128:131], v[144:147], a[0:3]
  ds_read_b64_tr_b16 a[148:149], v15 offset:4096
  ds_read_b64_tr_b16 a[150:151], v15 offset:6144
  v_mfma_f32_16x16x32_bf16 a[4:7], a[128:131], v[148:151], a[4:7]
  v_mfma_f32_16x16x32_bf16 a[8:11], a[128:131], v[152:155], a[8:11]
  v_mfma_f32_16x16x32_bf16 a[12:15], a[128:131], v[156:159], a[12:15]
  s_waitcnt lgkmcnt(8)
  v_mfma_f32_16x16x32_bf16 a[16:19], a[132:135], v[144:147], a[16:19]
  ds_read_b64_tr_b16 a[152:153], v16 offset:4096
  ds_read_b64_tr_b16 a[154:155], v16 offset:6144
  v_mfma_f32_16x16x32_bf16 a[20:23], a[132:135], v[148:151], a[20:23]
  v_mfma_f32_16x16x32_bf16 a[24:27], a[132:135], v[152:155], a[24:27]
  v_mfma_f32_16x16x32_bf16 a[28:31], a[132:135], v[156:159], a[28:31]
  s_waitcnt lgkmcnt(8)
  v_mfma_f32_16x16x32_bf16 a[32:35], a[136:139], v[144:147], a[32:35]
  ds_read_b64_tr_b16 a[156:157], v17 offset:4096
  ds_read_b64_tr_b16 a[158:159], v17 offset:6144
  v_mfma_f32_16x16x32_bf16 a[36:39], a[136:139], v[148:151], a[36:39]
  v_mfma_f32_16x16x32_bf16 a[40:43], a[136:139], v[152:155], a[40:43]
  v_mfma_f32_16x16x32_bf16 a[44:47], a[136:139], v[156:159], a[44:47]
  s_waitcnt lgkmcnt(8)
  v_mfma_f32_16x16x32_bf16 a[48:51], a[140:143], v[144:147], a[48:51]
  ds_read_b64_tr_b16 a[128:129], v10 offset:8192
  ds_read_b64_tr_b16 a[130:131], v10 offset:10240
  v_mfma_f32_16x16x32_bf16 a[52:55], a[140:143], v[148:151], a[52:55]
  v_mfma_f32_16x16x32_bf16 a[56:59], a[140:143], v[152:155], a[56:59]
  v_mfma_f32_16x16x32_bf16 a[60:63], a[140:143], v[156:159], a[60:63]
  s_waitcnt lgkmcnt(8)
  v_mfma_f32_16x16x32_bf16 a[64:67], a[144:147], v[144:147], a[64:67]
  ds_read_b64_tr_b16 a[132:133], v11 offset:8192
  ds_read_b64_tr_b16 a[134:135], v11 offset:10240
  v_mfma_f32_16x16x32_bf16 a[68:71], a[144:147], v[148:151], a[68:71]
  v_mfma_f32_16x16x32_bf16 a[72:75], a[144:147], v[152:155], a[72:75]
  v_mfma_f32_16x16x32_bf16 a[76:79], a[144:147], v[156:159], a[76:79]
  s_waitcnt lgkmcnt(8)
  v_mfma_f32_16x16x32_bf16 a[80:83], a[148:151], v[144:147], a[80:83]
  ds_read_b64_tr_b16 a[136:137], v12 offset:8192
  ds_read_b64_tr_b16 a[138:139], v12 offset:10240
  v_mfma_f32_16x16x32_bf16 a[84:87], a[148:151], v[148:151], a[84:87]
  v_mfma_f32_16x16x32_bf16 a[88:91], a[148:151], v[152:155], a[88:91]
  v_mfma_f32_16x16x32_bf16 a[92:95], a[148:151], v[156:159], a[92:95]
  s_waitcnt lgkmcnt(8)
  v_mfma_f32_16x16x32_bf16 a[96:99], a[152:155], v[144:147], a[96:99]
  ds_read_b64_tr_b16 a[140:141], v13 offset:8192
  ds_read_b64_tr_b16 a[142:143], v13 offset:10240
  v_mfma_f32_16x16x32_bf16 a[100:103], a[152:155], v[148:151], a[100:103]
  v_mfma_f32_16x16x32_bf16 a[104:107], a[152:155], v[152:155], a[104:107]
  v_mfma_f32_16x16x32_bf16 a[108:111], a[152:155], v[156:159], a[108:111]
  s_waitcnt lgkmcnt(8)
  v_mfma_f32_16x16x32_bf16 a[112:115], a[156:159], v[144:147], a[112:115]
  ds_read_b64_tr_b16 a[144:145], v14 offset:8192
  ds_read_b64_tr_b16 a[146:147], v14 offset:10240
  v_mfma_f32_16x16x32_bf16 a[116:119], a[156:159], v[148:151], a[116:119]
  s_waitcnt vmcnt(10)
  v_mfma_f32_16x16x32_bf16 a[120:123], a[156:159], v[152:155], a[120:123]
  s_barrier
  v_mfma_f32_16x16x32_bf16 a[124:127], a[156:159], v[156:159], a[124:127]
  s_waitcnt lgkmcnt(8)
  v_mfma_f32_16x16x32_bf16 a[0:3], a[128:131], v[160:163], a[0:3]
  ds_read_b64_tr_b16 a[148:149], v15 offset:8192
  ds_read_b64_tr_b16 a[150:151], v15 offset:10240
  v_mfma_f32_16x16x32_bf16 a[4:7], a[128:131], v[164:167], a[4:7]
  v_mfma_f32_16x16x32_bf16 a[8:11], a[128:131], v[168:171], a[8:11]
  v_mfma_f32_16x16x32_bf16 a[12:15], a[128:131], v[172:175], a[12:15]
  s_waitcnt lgkmcnt(8)
  v_mfma_f32_16x16x32_bf16 a[16:19], a[132:135], v[160:163], a[16:19]
  ds_read_b64_tr_b16 a[152:153], v16 offset:8192
  ds_read_b64_tr_b16 a[154:155], v16 offset:10240
  v_mfma_f32_16x16x32_bf16 a[20:23], a[132:135], v[164:167], a[20:23]
  v_mfma_f32_16x16x32_bf16 a[24:27], a[132:135], v[168:171], a[24:27]
  v_mfma_f32_16x16x32_bf16 a[28:31], a[132:135], v[172:175], a[28:31]
  s_waitcnt lgkmcnt(8)
  v_mfma_f32_16x16x32_bf16 a[32:35], a[136:139], v[160:163], a[32:35]
  ds_read_b64_tr_b16 a[156:157], v17 offset:8192
  ds_read_b64_tr_b16 a[158:159], v17 offset:10240
  v_mfma_f32_16x16x32_bf16 a[36:39], a[136:139], v[164:167], a[36:39]
  v_mfma_f32_16x16x32_bf16 a[40:43], a[136:139], v[168:171], a[40:43]
  v_mfma_f32_16x16x32_bf16 a[44:47], a[136:139], v[172:175], a[44:47]
  s_waitcnt lgkmcnt(8)
  v_mfma_f32_16x16x32_bf16 a[48:51], a[140:143], v[160:163], a[48:51]
  ds_read_b64_tr_b16 a[128:129], v10 offset:12288
  ds_read_b64_tr_b16 a[130:131], v10 offset:14336
  v_mfma_f32_16x16x32_bf16 a[52:55], a[140:143], v[164:167], a[52:55]
  v_mfma_f32_16x16x32_bf16 a[56:59], a[140:143], v[168:171], a[56:59]
  v_mfma_f32_16x16x32_bf16 a[60:63], a[140:143], v[172:175], a[60:63]
  s_waitcnt lgkmcnt(8)
  v_mfma_f32_16x16x32_bf16 a[64:67], a[144:147], v[160:163], a[64:67]
  ds_read_b64_tr_b16 a[132:133], v11 offset:12288
  ds_read_b64_tr_b16 a[134:135], v11 offset:14336
  v_mfma_f32_16x16x32_bf16 a[68:71], a[144:147], v[164:167], a[68:71]
  v_mfma_f32_16x16x32_bf16 a[72:75], a[144:147], v[168:171], a[72:75]
  v_mfma_f32_16x16x32_bf16 a[76:79], a[144:147], v[172:175], a[76:79]
  s_waitcnt lgkmcnt(8)
  v_mfma_f32_16x16x32_bf16 a[80:83], a[148:151], v[160:163], a[80:83]
  ds_read_b64_tr_b16 a[136:137], v12 offset:12288
  ds_read_b64_tr_b16 a[138:139], v12 offset:14336
  v_mfma_f32_16x16x32_bf16 a[84:87], a[148:151], v[164:167], a[84:87]
  v_mfma_f32_16x16x32_bf16 a[88:91], a[148:151], v[168:171], a[88:91]
  v_mfma_f32_16x16x32_bf16 a[92:95], a[148:151], v[172:175], a[92:95]
  s_waitcnt lgkmcnt(8)
  v_mfma_f32_16x16x32_bf16 a[96:99], a[152:155], v[160:163], a[96:99]
  ds_read_b64_tr_b16 a[140:141], v13 offset:12288
  ds_read_b64_tr_b16 a[142:143], v13 offset:14336
  v_mfma_f32_16x16x32_bf16 a[100:103], a[152:155], v[164:167], a[100:103]
  v_mfma_f32_16x16x32_bf16 a[104:107], a[152:155], v[168:171], a[104:107]
  v_mfma_f32_16x16x32_bf16 a[108:111], a[152:155], v[172:175], a[108:111]
  s_waitcnt lgkmcnt(8)
  v_mfma_f32_16x16x32_bf16 a[112:115], a[156:159], v[160:163], a[112:115]
  ds_read_b64_tr_b16 a[144:145], v14 offset:12288
  ds_read_b64_tr_b16 a[146:147], v14 offset:14336
  v_mfma_f32_16x16x32_bf16 a[116:119], a[156:159], v[164:167], a[116:119]
  v_mfma_f32_16x16x32_bf16 a[120:123], a[156:159], v[168:171], a[120:123]
  s_waitcnt vmcnt(12)
  v_mfma_f32_16x16x32_bf16 a[124:127], a[156:159], v[172:175], a[124:127]
  s_waitcnt lgkmcnt(8)
  v_mfma_f32_16x16x32_bf16 a[0:3], a[128:131], v[176:179], a[0:3]
  ds_read_b64_tr_b16 a[148:149], v15 offset:12288
  ds_read_b64_tr_b16 a[150:151], v15 offset:14336
  v_mfma_f32_16x16x32_bf16 a[4:7], a[128:131], v[180:183], a[4:7]
  v_mfma_f32_16x16x32_bf16 a[8:11], a[128:131], v[184:187], a[8:11]
  v_mfma_f32_16x16x32_bf16 a[12:15], a[128:131], v[188:191], a[12:15]
  s_waitcnt lgkmcnt(8)
  v_mfma_f32_16x16x32_bf16 a[16:19], a[132:135], v[176:179], a[16:19]
  ds_read_b64_tr_b16 a[152:153], v16 offset:12288
  ds_read_b64_tr_b16 a[154:155], v16 offset:14336
  v_mfma_f32_16x16x32_bf16 a[20:23], a[132:135], v[180:183], a[20:23]
  v_mfma_f32_16x16x32_bf16 a[24:27], a[132:135], v[184:187], a[24:27]
  v_mfma_f32_16x16x32_bf16 a[28:31], a[132:135], v[188:191], a[28:31]
  s_waitcnt lgkmcnt(8)
  v_mfma_f32_16x16x32_bf16 a[32:35], a[136:139], v[176:179], a[32:35]
  ds_read_b64_tr_b16 a[156:157], v17 offset:12288
  ds_read_b64_tr_b16 a[158:159], v17 offset:14336
  v_mfma_f32_16x16x32_bf16 a[36:39], a[136:139], v[180:183], a[36:39]
  v_mfma_f32_16x16x32_bf16 a[40:43], a[136:139], v[184:187], a[40:43]
  v_mfma_f32_16x16x32_bf16 a[44:47], a[136:139], v[188:191], a[44:47]
  s_waitcnt lgkmcnt(8)
  v_mfma_f32_16x16x32_bf16 a[48:51], a[140:143], v[176:179], a[48:51]
  ds_read_b64_tr_b16 a[128:129], v10 offset:16384
  ds_read_b64_tr_b16 a[130:131], v10 offset:18432
  v_mfma_f32_16x16x32_bf16 a[52:55], a[140:143], v[180:183], a[52:55]
  v_mfma_f32_16x16x32_bf16 a[56:59], a[140:143], v[184:187], a[56:59]
  v_mfma_f32_16x16x32_bf16 a[60:63], a[140:143], v[188:191], a[60:63]
  s_waitcnt lgkmcnt(8)
  v_mfma_f32_16x16x32_bf16 a[64:67], a[144:147], v[176:179], a[64:67]
  ds_read_b64_tr_b16 a[132:133], v11 offset:16384
  ds_read_b64_tr_b16 a[134:135], v11 offset:18432
  v_mfma_f32_16x16x32_bf16 a[68:71], a[144:147], v[180:183], a[68:71]
  v_mfma_f32_16x16x32_bf16 a[72:75], a[144:147], v[184:187], a[72:75]
  v_mfma_f32_16x16x32_bf16 a[76:79], a[144:147], v[188:191], a[76:79]
  s_waitcnt lgkmcnt(8)
  v_mfma_f32_16x16x32_bf16 a[80:83], a[148:151], v[176:179], a[80:83]
  ds_read_b64_tr_b16 a[136:137], v12 offset:16384
  ds_read_b64_tr_b16 a[138:139], v12 offset:18432
  v_mfma_f32_16x16x32_bf16 a[84:87], a[148:151], v[180:183], a[84:87]
  v_mfma_f32_16x16x32_bf16 a[88:91], a[148:151], v[184:187], a[88:91]
  v_mfma_f32_16x16x32_bf16 a[92:95], a[148:151], v[188:191], a[92:95]
  s_waitcnt lgkmcnt(8)
  v_mfma_f32_16x16x32_bf16 a[96:99], a[152:155], v[176:179], a[96:99]
  ds_read_b64_tr_b16 a[140:141], v13 offset:16384
  ds_read_b64_tr_b16 a[142:143], v13 offset:18432
  v_mfma_f32_16x16x32_bf16 a[100:103], a[152:155], v[180:183], a[100:103]
  v_mfma_f32_16x16x32_bf16 a[104:107], a[152:155], v[184:187], a[104:107]
  v_mfma_f32_16x16x32_bf16 a[108:111], a[152:155], v[188:191], a[108:111]
  s_waitcnt lgkmcnt(8)
  v_mfma_f32_16x16x32_bf16 a[112:115], a[156:159], v[176:179], a[112:115]
  ds_read_b64_tr_b16 a[144:145], v14 offset:16384
  ds_read_b64_tr_b16 a[146:147], v14 offset:18432
  v_mfma_f32_16x16x32_bf16 a[116:119], a[156:159], v[180:183], a[116:119]
  s_waitcnt vmcnt(4)
  v_mfma_f32_16x16x32_bf16 a[120:123], a[156:159], v[184:187], a[120:123]
  s_barrier
  v_mfma_f32_16x16x32_bf16 a[124:127], a[156:159], v[188:191], a[124:127]
  s_waitcnt lgkmcnt(8)
  v_mfma_f32_16x16x32_bf16 a[0:3], a[128:131], v[192:195], a[0:3]
  ds_read_b64_tr_b16 a[148:149], v15 offset:16384
  ds_read_b64_tr_b16 a[150:151], v15 offset:18432
  v_mfma_f32_16x16x32_bf16 a[4:7], a[128:131], v[196:199], a[4:7]
  v_mfma_f32_16x16x32_bf16 a[8:11], a[128:131], v[200:203], a[8:11]
  v_mfma_f32_16x16x32_bf16 a[12:15], a[128:131], v[204:207], a[12:15]
  s_waitcnt lgkmcnt(8)
  v_mfma_f32_16x16x32_bf16 a[16:19], a[132:135], v[192:195], a[16:19]
  ds_read_b64_tr_b16 a[152:153], v16 offset:16384
  ds_read_b64_tr_b16 a[154:155], v16 offset:18432
  v_mfma_f32_16x16x32_bf16 a[20:23], a[132:135], v[196:199], a[20:23]
  v_mfma_f32_16x16x32_bf16 a[24:27], a[132:135], v[200:203], a[24:27]
  v_mfma_f32_16x16x32_bf16 a[28:31], a[132:135], v[204:207], a[28:31]
  s_waitcnt lgkmcnt(8)
  v_mfma_f32_16x16x32_bf16 a[32:35], a[136:139], v[192:195], a[32:35]
  ds_read_b64_tr_b16 a[156:157], v17 offset:16384
  ds_read_b64_tr_b16 a[158:159], v17 offset:18432
  v_mfma_f32_16x16x32_bf16 a[36:39], a[136:139], v[196:199], a[36:39]
  v_mfma_f32_16x16x32_bf16 a[40:43], a[136:139], v[200:203], a[40:43]
  v_mfma_f32_16x16x32_bf16 a[44:47], a[136:139], v[204:207], a[44:47]
  s_waitcnt lgkmcnt(8)
  v_mfma_f32_16x16x32_bf16 a[48:51], a[140:143], v[192:195], a[48:51]
  ds_read_b64_tr_b16 a[128:129], v10 offset:20480
  ds_read_b64_tr_b16 a[130:131], v10 offset:22528
  v_mfma_f32_16x16x32_bf16 a[52:55], a[140:143], v[196:199], a[52:55]
  v_mfma_f32_16x16x32_bf16 a[56:59], a[140:143], v[200:203], a[56:59]
  v_mfma_f32_16x16x32_bf16 a[60:63], a[140:143], v[204:207], a[60:63]
  s_waitcnt lgkmcnt(8)
  v_mfma_f32_16x16x32_bf16 a[64:67], a[144:147], v[192:195], a[64:67]
  ds_read_b64_tr_b16 a[132:133], v11 offset:20480
  ds_read_b64_tr_b16 a[134:135], v11 offset:22528
  v_mfma_f32_16x16x32_bf16 a[68:71], a[144:147], v[196:199], a[68:71]
  v_mfma_f32_16x16x32_bf16 a[72:75], a[144:147], v[200:203], a[72:75]
  v_mfma_f32_16x16x32_bf16 a[76:79], a[144:147], v[204:207], a[76:79]
  s_waitcnt lgkmcnt(8)
  v_mfma_f32_16x16x32_bf16 a[80:83], a[148:151], v[192:195], a[80:83]
  ds_read_b64_tr_b16 a[136:137], v12 offset:20480
  ds_read_b64_tr_b16 a[138:139], v12 offset:22528
  v_mfma_f32_16x16x32_bf16 a[84:87], a[148:151], v[196:199], a[84:87]
  v_mfma_f32_16x16x32_bf16 a[88:91], a[148:151], v[200:203], a[88:91]
  v_mfma_f32_16x16x32_bf16 a[92:95], a[148:151], v[204:207], a[92:95]
  s_waitcnt lgkmcnt(8)
  v_mfma_f32_16x16x32_bf16 a[96:99], a[152:155], v[192:195], a[96:99]
  ds_read_b64_tr_b16 a[140:141], v13 offset:20480
  ds_read_b64_tr_b16 a[142:143], v13 offset:22528
  v_mfma_f32_16x16x32_bf16 a[100:103], a[152:155], v[196:199], a[100:103]
  v_mfma_f32_16x16x32_bf16 a[104:107], a[152:155], v[200:203], a[104:107]
  v_mfma_f32_16x16x32_bf16 a[108:111], a[152:155], v[204:207], a[108:111]
  s_waitcnt lgkmcnt(8)
  v_mfma_f32_16x16x32_bf16 a[112:115], a[156:159], v[192:195], a[112:115]
  ds_read_b64_tr_b16 a[144:145], v14 offset:20480
  ds_read_b64_tr_b16 a[146:147], v14 offset:22528
  v_mfma_f32_16x16x32_bf16 a[116:119], a[156:159], v[196:199], a[116:119]
  v_mfma_f32_16x16x32_bf16 a[120:123], a[156:159], v[200:203], a[120:123]
  s_waitcnt vmcnt(0)
  v_mfma_f32_16x16x32_bf16 a[124:127], a[156:159], v[204:207], a[124:127]
  s_waitcnt lgkmcnt(8)
  v_mfma_f32_16x16x32_bf16 a[0:3], a[128:131], v[208:211], a[0:3]
  ds_read_b64_tr_b16 a[148:149], v15 offset:20480
  ds_read_b64_tr_b16 a[150:151], v15 offset:22528
  v_mfma_f32_16x16x32_bf16 a[4:7], a[128:131], v[212:215], a[4:7]
  v_mfma_f32_16x16x32_bf16 a[8:11], a[128:131], v[216:219], a[8:11]
  v_mfma_f32_16x16x32_bf16 a[12:15], a[128:131], v[220:223], a[12:15]
  s_waitcnt lgkmcnt(8)
  v_mfma_f32_16x16x32_bf16 a[16:19], a[132:135], v[208:211], a[16:19]
  ds_read_b64_tr_b16 a[152:153], v16 offset:20480
  ds_read_b64_tr_b16 a[154:155], v16 offset:22528
  v_mfma_f32_16x16x32_bf16 a[20:23], a[132:135], v[212:215], a[20:23]
  v_mfma_f32_16x16x32_bf16 a[24:27], a[132:135], v[216:219], a[24:27]
  v_mfma_f32_16x16x32_bf16 a[28:31], a[132:135], v[220:223], a[28:31]
  s_waitcnt lgkmcnt(8)
  v_mfma_f32_16x16x32_bf16 a[32:35], a[136:139], v[208:211], a[32:35]
  ds_read_b64_tr_b16 a[156:157], v17 offset:20480
  ds_read_b64_tr_b16 a[158:159], v17 offset:22528
  v_mfma_f32_16x16x32_bf16 a[36:39], a[136:139], v[212:215], a[36:39]
  v_mfma_f32_16x16x32_bf16 a[40:43], a[136:139], v[216:219], a[40:43]
  v_mfma_f32_16x16x32_bf16 a[44:47], a[136:139], v[220:223], a[44:47]
  s_waitcnt lgkmcnt(8)
  v_mfma_f32_16x16x32_bf16 a[48:51], a[140:143], v[208:211], a[48:51]
  v_mfma_f32_16x16x32_bf16 a[52:55], a[140:143], v[212:215], a[52:55]
  v_mfma_f32_16x16x32_bf16 a[56:59], a[140:143], v[216:219], a[56:59]
  v_mfma_f32_16x16x32_bf16 a[60:63], a[140:143], v[220:223], a[60:63]
  s_waitcnt lgkmcnt(6)
  v_mfma_f32_16x16x32_bf16 a[64:67], a[144:147], v[208:211], a[64:67]
  v_mfma_f32_16x16x32_bf16 a[68:71], a[144:147], v[212:215], a[68:71]
  v_mfma_f32_16x16x32_bf16 a[72:75], a[144:147], v[216:219], a[72:75]
  v_mfma_f32_16x16x32_bf16 a[76:79], a[144:147], v[220:223], a[76:79]
  s_waitcnt lgkmcnt(4)
  v_mfma_f32_16x16x32_bf16 a[80:83], a[148:151], v[208:211], a[80:83]
  v_mfma_f32_16x16x32_bf16 a[84:87], a[148:151], v[212:215], a[84:87]
  v_mfma_f32_16x16x32_bf16 a[88:91], a[148:151], v[216:219], a[88:91]
  v_mfma_f32_16x16x32_bf16 a[92:95], a[148:151], v[220:223], a[92:95]
  s_waitcnt lgkmcnt(2)
  v_mfma_f32_16x16x32_bf16 a[96:99], a[152:155], v[208:211], a[96:99]
  v_mfma_f32_16x16x32_bf16 a[100:103], a[152:155], v[212:215], a[100:103]
  v_mfma_f32_16x16x32_bf16 a[104:107], a[152:155], v[216:219], a[104:107]
  v_mfma_f32_16x16x32_bf16 a[108:111], a[152:155], v[220:223], a[108:111]
  s_waitcnt lgkmcnt(0)
  v_mfma_f32_16x16x32_bf16 a[112:115], a[156:159], v[208:211], a[112:115]
  v_mfma_f32_16x16x32_bf16 a[116:119], a[156:159], v[212:215], a[116:119]
  v_mfma_f32_16x16x32_bf16 a[120:123], a[156:159], v[216:219], a[120:123]
  v_mfma_f32_16x16x32_bf16 a[124:127], a[156:159], v[220:223], a[124:127]
  s_waitcnt lgkmcnt(0)
  s_barrier
  s_add_u32 s64, s42, 0x5400000
  s_addc_u32 s65, s43, 0
  s_mov_b32 s66, 0x1e0000
  s_mov_b32 s67, 0x20000
  s_mul_i32 s68, s28, 5120
  s_lshr_b32 s70, s2, 3
  s_and_b32 s70, s70, 7
  s_mul_i32 s69, s70, 245760
  s_mul_i32 s70, s28, 61440
  s_add_u32 s69, s69, s70
  s_add_u32 s69, s69, 20480
  v_add_u32 v21, 4096, v20
  s_nop 7
  v_accvgpr_read_b32 v64, a0
  v_accvgpr_read_b32 v68, a64
  v_accvgpr_read_b32 v65, a1
  v_accvgpr_read_b32 v69, a65
  v_accvgpr_read_b32 v66, a2
  v_accvgpr_read_b32 v70, a66
  v_accvgpr_read_b32 v67, a3
  v_accvgpr_read_b32 v71, a67
  v_accvgpr_read_b32 v72, a16
  v_accvgpr_read_b32 v76, a80
  v_accvgpr_read_b32 v73, a17
  v_accvgpr_read_b32 v77, a81
  v_accvgpr_read_b32 v74, a18
  v_accvgpr_read_b32 v78, a82
  v_accvgpr_read_b32 v75, a19
  v_accvgpr_read_b32 v79, a83
  v_max_f32 v64, 0, v64
  v_max_f32 v65, 0, v65
  v_max_f32 v66, 0, v66
  v_max_f32 v67, 0, v67
  v_mul_f32 v64, v64, v68
  v_mul_f32 v65, v65, v69
  v_mul_f32 v66, v66, v70
  v_mul_f32 v67, v67, v71
  v_cvt_pk_bf16_f32 v28, v64, v65
  v_cvt_pk_bf16_f32 v29, v66, v67
  v_max_f32 v72, 0, v72
  v_max_f32 v73, 0, v73
  v_max_f32 v74, 0, v74
  v_max_f32 v75, 0, v75
  v_mul_f32 v72, v72, v76
  v_mul_f32 v73, v73, v77
  v_mul_f32 v74, v74, v78
  v_mul_f32 v75, v75, v79
  v_cvt_pk_bf16_f32 v30, v72, v73
  v_cvt_pk_bf16_f32 v31, v74, v75
  buffer_store_dwordx4 v[28:31], v20, s[20:23], s34 offen offset:0 sc1
  v_accvgpr_read_b32 v80, a32
  v_accvgpr_read_b32 v84, a96
  v_accvgpr_read_b32 v81, a33
  v_accvgpr_read_b32 v85, a97
  s_add_u32 m0, s68, 0
  s_nop 0
  buffer_load_dwordx4 v20, s[64:67], s69 offen offset:0 lds
  buffer_load_dwordx4 v20, s[64:67], s69 offen offset:1024 lds
  buffer_load_dwordx4 v20, s[64:67], s69 offen offset:2048 lds
  buffer_load_dwordx4 v20, s[64:67], s69 offen offset:3072 lds
  v_accvgpr_read_b32 v82, a34
  v_accvgpr_read_b32 v86, a98
  v_accvgpr_read_b32 v83, a35
  v_accvgpr_read_b32 v87, a99
  v_accvgpr_read_b32 v88, a48
  v_accvgpr_read_b32 v92, a112
  v_accvgpr_read_b32 v89, a49
  v_accvgpr_read_b32 v93, a113
  v_accvgpr_read_b32 v90, a50
  v_accvgpr_read_b32 v94, a114
  v_accvgpr_read_b32 v91, a51
  v_accvgpr_read_b32 v95, a115
  v_max_f32 v80, 0, v80
  v_max_f32 v81, 0, v81
  v_max_f32 v82, 0, v82
  v_max_f32 v83, 0, v83
  v_mul_f32 v80, v80, v84
  v_mul_f32 v81, v81, v85
  v_mul_f32 v82, v82, v86
  v_mul_f32 v83, v83, v87
  v_cvt_pk_bf16_f32 v32, v80, v81
  v_cvt_pk_bf16_f32 v33, v82, v83
  v_max_f32 v88, 0, v88
  v_max_f32 v89, 0, v89
  v_max_f32 v90, 0, v90
  v_max_f32 v91, 0, v91
  v_mul_f32 v88, v88, v92
  v_mul_f32 v89, v89, v93
  v_mul_f32 v90, v90, v94
  v_mul_f32 v91, v91, v95
  v_cvt_pk_bf16_f32 v34, v88, v89
  v_cvt_pk_bf16_f32 v35, v90, v91
  s_add_u32 s46, s34, 4096
  buffer_store_dwordx4 v[32:35], v20, s[20:23], s46 offen offset:0 sc1
  v_accvgpr_read_b32 v64, a4
  v_accvgpr_read_b32 v68, a68
  v_accvgpr_read_b32 v65, a5
  v_accvgpr_read_b32 v69, a69
  v_accvgpr_read_b32 v66, a6
  v_accvgpr_read_b32 v70, a70
  v_accvgpr_read_b32 v67, a7
  v_accvgpr_read_b32 v71, a71
  s_add_u32 m0, s68, 4096
  s_nop 0
  buffer_load_dwordx4 v21, s[64:67], s69 offen lds
  s_add_u32 s69, s69, 5120
  v_accvgpr_read_b32 v72, a20
  v_accvgpr_read_b32 v76, a84
  v_accvgpr_read_b32 v73, a21
  v_accvgpr_read_b32 v77, a85
  v_accvgpr_read_b32 v74, a22
  v_accvgpr_read_b32 v78, a86
  v_accvgpr_read_b32 v75, a23
  v_accvgpr_read_b32 v79, a87
  v_max_f32 v64, 0, v64
  v_max_f32 v65, 0, v65
  v_max_f32 v66, 0, v66
  v_max_f32 v67, 0, v67
  v_mul_f32 v64, v64, v68
  v_mul_f32 v65, v65, v69
  v_mul_f32 v66, v66, v70
  v_mul_f32 v67, v67, v71
  v_cvt_pk_bf16_f32 v36, v64, v65
  v_cvt_pk_bf16_f32 v37, v66, v67
  v_max_f32 v72, 0, v72
  v_max_f32 v73, 0, v73
  v_max_f32 v74, 0, v74
  v_max_f32 v75, 0, v75
  v_mul_f32 v72, v72, v76
  v_mul_f32 v73, v73, v77
  v_mul_f32 v74, v74, v78
  v_mul_f32 v75, v75, v79
  v_cvt_pk_bf16_f32 v38, v72, v73
  v_cvt_pk_bf16_f32 v39, v74, v75
  buffer_store_dwordx4 v[36:39], v20, s[20:23], s34 offen offset:1024 sc1
  v_accvgpr_read_b32 v80, a36
  v_accvgpr_read_b32 v84, a100
  v_accvgpr_read_b32 v81, a37
  v_accvgpr_read_b32 v85, a101
  v_accvgpr_read_b32 v82, a38
  v_accvgpr_read_b32 v86, a102
  v_accvgpr_read_b32 v83, a39
  v_accvgpr_read_b32 v87, a103
  v_accvgpr_read_b32 v88, a52
  v_accvgpr_read_b32 v92, a116
  v_accvgpr_read_b32 v89, a53
  v_accvgpr_read_b32 v93, a117
  v_accvgpr_read_b32 v90, a54
  s_add_u32 m0, s68, 20480
  s_nop 0
  buffer_load_dwordx4 v20, s[64:67], s69 offen offset:0 lds
  buffer_load_dwordx4 v20, s[64:67], s69 offen offset:1024 lds
  buffer_load_dwordx4 v20, s[64:67], s69 offen offset:2048 lds
  buffer_load_dwordx4 v20, s[64:67], s69 offen offset:3072 lds
  v_accvgpr_read_b32 v94, a118
  v_accvgpr_read_b32 v91, a55
  v_accvgpr_read_b32 v95, a119
  v_max_f32 v80, 0, v80
  v_max_f32 v81, 0, v81
  v_max_f32 v82, 0, v82
  v_max_f32 v83, 0, v83
  v_mul_f32 v80, v80, v84
  v_mul_f32 v81, v81, v85
  v_mul_f32 v82, v82, v86
  v_mul_f32 v83, v83, v87
  v_cvt_pk_bf16_f32 v40, v80, v81
  v_cvt_pk_bf16_f32 v41, v82, v83
  v_max_f32 v88, 0, v88
  v_max_f32 v89, 0, v89
  v_max_f32 v90, 0, v90
  v_max_f32 v91, 0, v91
  v_mul_f32 v88, v88, v92
  v_mul_f32 v89, v89, v93
  v_mul_f32 v90, v90, v94
  v_mul_f32 v91, v91, v95
  v_cvt_pk_bf16_f32 v42, v88, v89
  v_cvt_pk_bf16_f32 v43, v90, v91
  buffer_store_dwordx4 v[40:43], v20, s[20:23], s46 offen offset:1024 sc1
  v_accvgpr_read_b32 v64, a8
  v_accvgpr_read_b32 v68, a72
  v_accvgpr_read_b32 v65, a9
  v_accvgpr_read_b32 v69, a73
  v_accvgpr_read_b32 v66, a10
  v_accvgpr_read_b32 v70, a74
  v_accvgpr_read_b32 v67, a11
  v_accvgpr_read_b32 v71, a75
  v_accvgpr_read_b32 v72, a24
  v_accvgpr_read_b32 v76, a88
  v_accvgpr_read_b32 v73, a25
  v_accvgpr_read_b32 v77, a89
  v_accvgpr_read_b32 v74, a26
  v_accvgpr_read_b32 v78, a90
  v_accvgpr_read_b32 v75, a27
  v_accvgpr_read_b32 v79, a91
  v_max_f32 v64, 0, v64
  v_max_f32 v65, 0, v65
  s_add_u32 m0, s68, 24576
  s_nop 0
  buffer_load_dwordx4 v21, s[64:67], s69 offen lds
  s_add_u32 s69, s69, 5120
  v_max_f32 v66, 0, v66
  v_max_f32 v67, 0, v67
  v_mul_f32 v64, v64, v68
  v_mul_f32 v65, v65, v69
  v_mul_f32 v66, v66, v70
  v_mul_f32 v67, v67, v71
  v_cvt_pk_bf16_f32 v28, v64, v65
  v_cvt_pk_bf16_f32 v29, v66, v67
  v_max_f32 v72, 0, v72
  v_max_f32 v73, 0, v73
  v_max_f32 v74, 0, v74
  v_max_f32 v75, 0, v75
  v_mul_f32 v72, v72, v76
  v_mul_f32 v73, v73, v77
  v_mul_f32 v74, v74, v78
  v_mul_f32 v75, v75, v79
  v_cvt_pk_bf16_f32 v30, v72, v73
  v_cvt_pk_bf16_f32 v31, v74, v75
  buffer_store_dwordx4 v[28:31], v20, s[20:23], s34 offen offset:2048 sc1
  v_accvgpr_read_b32 v80, a40
  v_accvgpr_read_b32 v84, a104
  v_accvgpr_read_b32 v81, a41
  v_accvgpr_read_b32 v85, a105
  v_accvgpr_read_b32 v82, a42
  v_accvgpr_read_b32 v86, a106
  v_accvgpr_read_b32 v83, a43
  v_accvgpr_read_b32 v87, a107
  v_accvgpr_read_b32 v88, a56
  v_accvgpr_read_b32 v92, a120
  v_accvgpr_read_b32 v89, a57
  v_accvgpr_read_b32 v93, a121
  v_accvgpr_read_b32 v90, a58
  v_accvgpr_read_b32 v94, a122
  v_accvgpr_read_b32 v91, a59
  v_accvgpr_read_b32 v95, a123
  v_max_f32 v80, 0, v80
  v_max_f32 v81, 0, v81
  v_max_f32 v82, 0, v82
  v_max_f32 v83, 0, v83
  v_mul_f32 v80, v80, v84
  v_mul_f32 v81, v81, v85
  v_mul_f32 v82, v82, v86
  s_add_u32 m0, s68, 40960
  s_nop 0
  buffer_load_dwordx4 v20, s[64:67], s69 offen offset:0 lds
  buffer_load_dwordx4 v20, s[64:67], s69 offen offset:1024 lds
  buffer_load_dwordx4 v20, s[64:67], s69 offen offset:2048 lds
  buffer_load_dwordx4 v20, s[64:67], s69 offen offset:3072 lds
  v_mul_f32 v83, v83, v87
  v_cvt_pk_bf16_f32 v32, v80, v81
  v_cvt_pk_bf16_f32 v33, v82, v83
  v_max_f32 v88, 0, v88
  v_max_f32 v89, 0, v89
  v_max_f32 v90, 0, v90
  v_max_f32 v91, 0, v91
  v_mul_f32 v88, v88, v92
  v_mul_f32 v89, v89, v93
  v_mul_f32 v90, v90, v94
  v_mul_f32 v91, v91, v95
  v_cvt_pk_bf16_f32 v34, v88, v89
  v_cvt_pk_bf16_f32 v35, v90, v91
  buffer_store_dwordx4 v[32:35], v20, s[20:23], s46 offen offset:2048 sc1
  v_accvgpr_read_b32 v64, a12
  v_accvgpr_read_b32 v68, a76
  v_accvgpr_read_b32 v65, a13
  v_accvgpr_read_b32 v69, a77
  v_accvgpr_read_b32 v66, a14
  v_accvgpr_read_b32 v70, a78
  v_accvgpr_read_b32 v67, a15
  v_accvgpr_read_b32 v71, a79
  v_accvgpr_read_b32 v72, a28
  v_accvgpr_read_b32 v76, a92
  v_accvgpr_read_b32 v73, a29
  v_accvgpr_read_b32 v77, a93
  v_accvgpr_read_b32 v74, a30
  v_accvgpr_read_b32 v78, a94
  v_accvgpr_read_b32 v75, a31
  v_accvgpr_read_b32 v79, a95
  v_max_f32 v64, 0, v64
  v_max_f32 v65, 0, v65
  v_max_f32 v66, 0, v66
  v_max_f32 v67, 0, v67
  v_mul_f32 v64, v64, v68
  v_mul_f32 v65, v65, v69
  v_mul_f32 v66, v66, v70
  v_mul_f32 v67, v67, v71
  v_cvt_pk_bf16_f32 v36, v64, v65
  v_cvt_pk_bf16_f32 v37, v66, v67
  v_max_f32 v72, 0, v72
  v_max_f32 v73, 0, v73
  s_add_u32 m0, s68, 45056
  s_nop 0
  buffer_load_dwordx4 v21, s[64:67], s69 offen lds
  s_add_u32 s69, s69, 5120
  v_max_f32 v74, 0, v74
  v_max_f32 v75, 0, v75
  v_mul_f32 v72, v72, v76
  v_mul_f32 v73, v73, v77
  v_mul_f32 v74, v74, v78
  v_mul_f32 v75, v75, v79
  v_cvt_pk_bf16_f32 v38, v72, v73
  v_cvt_pk_bf16_f32 v39, v74, v75
  buffer_store_dwordx4 v[36:39], v20, s[20:23], s34 offen offset:3072 sc1
  v_accvgpr_read_b32 v80, a44
  v_accvgpr_read_b32 v84, a108
  v_accvgpr_read_b32 v81, a45
  v_accvgpr_read_b32 v85, a109
  v_accvgpr_read_b32 v82, a46
  v_accvgpr_read_b32 v86, a110
  v_accvgpr_read_b32 v83, a47
  v_accvgpr_read_b32 v87, a111
  v_accvgpr_read_b32 v88, a60
  v_accvgpr_read_b32 v92, a124
  v_accvgpr_read_b32 v89, a61
  v_accvgpr_read_b32 v93, a125
  v_accvgpr_read_b32 v90, a62
  v_accvgpr_read_b32 v94, a126
  v_accvgpr_read_b32 v91, a63
  v_accvgpr_read_b32 v95, a127
  v_max_f32 v80, 0, v80
  v_max_f32 v81, 0, v81
  v_max_f32 v82, 0, v82
  v_max_f32 v83, 0, v83
  v_mul_f32 v80, v80, v84
  v_mul_f32 v81, v81, v85
  v_mul_f32 v82, v82, v86
  v_mul_f32 v83, v83, v87
  v_cvt_pk_bf16_f32 v40, v80, v81
  v_cvt_pk_bf16_f32 v41, v82, v83
  v_max_f32 v88, 0, v88
  v_max_f32 v89, 0, v89
  v_max_f32 v90, 0, v90
  v_max_f32 v91, 0, v91
  v_mul_f32 v88, v88, v92
  v_mul_f32 v89, v89, v93
  v_mul_f32 v90, v90, v94
  v_mul_f32 v91, v91, v95
  v_cvt_pk_bf16_f32 v42, v88, v89
  v_cvt_pk_bf16_f32 v43, v90, v91
  buffer_store_dwordx4 v[40:43], v20, s[20:23], s46 offen offset:3072 sc1
  s_branch L_kd_join5
L_kd_skip5:
  s_mov_b32 s8, s4
  s_mov_b32 s9, s5
  s_mov_b32 s10, 0x1e0000
  s_mov_b32 s11, 0x20000
  s_mov_b32 s12, s6
  s_mov_b32 s13, s7
  s_mov_b32 s14, 0x1e0000
  s_mov_b32 s15, 0x20000
  s_lshr_b32 s16, s2, 3
  s_sub_u32 s16, s16, 24
  s_lshl_b32 s16, s16, 8
  v_add_u32 v3, s16, v0
  v_lshlrev_b32 v3, 7, v3
  s_mov_b32 s17, 0
  buffer_load_dword v4, v3, s[8:11], s17 offen
  buffer_load_dword v5, v3, s[12:15], s17 offen
  s_add_u32 s17, s17, 262144
  buffer_load_dword v4, v3, s[8:11], s17 offen
  buffer_load_dword v5, v3, s[12:15], s17 offen
  s_add_u32 s17, s17, 262144
  buffer_load_dword v4, v3, s[8:11], s17 offen
  buffer_load_dword v5, v3, s[12:15], s17 offen
  s_add_u32 s17, s17, 262144
  buffer_load_dword v4, v3, s[8:11], s17 offen
  buffer_load_dword v5, v3, s[12:15], s17 offen
  s_add_u32 s17, s17, 262144
  buffer_load_dword v4, v3, s[8:11], s17 offen
  buffer_load_dword v5, v3, s[12:15], s17 offen
  s_add_u32 s17, s17, 262144
  buffer_load_dword v4, v3, s[8:11], s17 offen
  buffer_load_dword v5, v3, s[12:15], s17 offen
  s_add_u32 s17, s17, 262144
  buffer_load_dword v4, v3, s[8:11], s17 offen
  buffer_load_dword v5, v3, s[12:15], s17 offen
  s_add_u32 s17, s17, 262144
  buffer_load_dword v4, v3, s[8:11], s17 offen
  buffer_load_dword v5, v3, s[12:15], s17 offen
  s_add_u32 s17, s17, 262144
  s_add_u32 s8, s42, 0x5400000
  s_addc_u32 s9, s43, 0
  s_mov_b32 s10, 0x1e0000
  s_mov_b32 s11, 0x20000
  s_mov_b32 s17, 0
  buffer_load_dword v4, v3, s[8:11], s17 offen
  s_add_u32 s17, s17, 262144
  buffer_load_dword v4, v3, s[8:11], s17 offen
  s_add_u32 s17, s17, 262144
  buffer_load_dword v4, v3, s[8:11], s17 offen
  s_add_u32 s17, s17, 262144
  buffer_load_dword v4, v3, s[8:11], s17 offen
  s_add_u32 s17, s17, 262144
  buffer_load_dword v4, v3, s[8:11], s17 offen
  s_add_u32 s17, s17, 262144
  buffer_load_dword v4, v3, s[8:11], s17 offen
  s_add_u32 s17, s17, 262144
  buffer_load_dword v4, v3, s[8:11], s17 offen
  s_add_u32 s17, s17, 262144
  buffer_load_dword v4, v3, s[8:11], s17 offen
  s_add_u32 s17, s17, 262144
  s_add_u32 s64, s42, 0x5400000
  s_addc_u32 s65, s43, 0
  s_mov_b32 s66, 0x1e0000
  s_mov_b32 s67, 0x20000
  s_mul_i32 s68, s28, 5120
  s_lshr_b32 s70, s2, 3
  s_and_b32 s70, s70, 7
  s_mul_i32 s69, s70, 245760
  s_mul_i32 s70, s28, 61440
  s_add_u32 s69, s69, s70
  s_add_u32 s69, s69, 0
  v_add_u32 v21, 4096, v20
  s_add_u32 m0, s68, 61440
  s_nop 0
  buffer_load_dwordx4 v20, s[64:67], s69 offen offset:0 lds
  buffer_load_dwordx4 v20, s[64:67], s69 offen offset:1024 lds
  buffer_load_dwordx4 v20, s[64:67], s69 offen offset:2048 lds
  buffer_load_dwordx4 v20, s[64:67], s69 offen offset:3072 lds
  s_add_u32 m0, s68, 65536
  s_nop 0
  buffer_load_dwordx4 v21, s[64:67], s69 offen lds
  s_add_u32 s69, s69, 5120
  s_add_u32 m0, s68, 81920
  s_nop 0
  buffer_load_dwordx4 v20, s[64:67], s69 offen offset:0 lds
  buffer_load_dwordx4 v20, s[64:67], s69 offen offset:1024 lds
  buffer_load_dwordx4 v20, s[64:67], s69 offen offset:2048 lds
  buffer_load_dwordx4 v20, s[64:67], s69 offen offset:3072 lds
  s_add_u32 m0, s68, 86016
  s_nop 0
  buffer_load_dwordx4 v21, s[64:67], s69 offen lds
  s_add_u32 s69, s69, 5120
  s_add_u32 m0, s68, 102400
  s_nop 0
  buffer_load_dwordx4 v20, s[64:67], s69 offen offset:0 lds
  buffer_load_dwordx4 v20, s[64:67], s69 offen offset:1024 lds
  buffer_load_dwordx4 v20, s[64:67], s69 offen offset:2048 lds
  buffer_load_dwordx4 v20, s[64:67], s69 offen offset:3072 lds
  s_add_u32 m0, s68, 106496
  s_nop 0
  buffer_load_dwordx4 v21, s[64:67], s69 offen lds
  s_add_u32 s69, s69, 5120
  s_add_u32 m0, s68, 122880
  s_nop 0
  buffer_load_dwordx4 v20, s[64:67], s69 offen offset:0 lds
  buffer_load_dwordx4 v20, s[64:67], s69 offen offset:1024 lds
  buffer_load_dwordx4 v20, s[64:67], s69 offen offset:2048 lds
  buffer_load_dwordx4 v20, s[64:67], s69 offen offset:3072 lds
  s_add_u32 m0, s68, 126976
  s_nop 0
  buffer_load_dwordx4 v21, s[64:67], s69 offen lds
  s_add_u32 s69, s69, 5120
  s_add_u32 m0, s68, 0
  s_nop 0
  buffer_load_dwordx4 v20, s[64:67], s69 offen offset:0 lds
  buffer_load_dwordx4 v20, s[64:67], s69 offen offset:1024 lds
  buffer_load_dwordx4 v20, s[64:67], s69 offen offset:2048 lds
  buffer_load_dwordx4 v20, s[64:67], s69 offen offset:3072 lds
  s_add_u32 m0, s68, 4096
  s_nop 0
  buffer_load_dwordx4 v21, s[64:67], s69 offen lds
  s_add_u32 s69, s69, 5120
  s_add_u32 m0, s68, 20480
  s_nop 0
  buffer_load_dwordx4 v20, s[64:67], s69 offen offset:0 lds
  buffer_load_dwordx4 v20, s[64:67], s69 offen offset:1024 lds
  buffer_load_dwordx4 v20, s[64:67], s69 offen offset:2048 lds
  buffer_load_dwordx4 v20, s[64:67], s69 offen offset:3072 lds
  s_add_u32 m0, s68, 24576
  s_nop 0
  buffer_load_dwordx4 v21, s[64:67], s69 offen lds
  s_add_u32 s69, s69, 5120
  s_add_u32 m0, s68, 40960
  s_nop 0
  buffer_load_dwordx4 v20, s[64:67], s69 offen offset:0 lds
  buffer_load_dwordx4 v20, s[64:67], s69 offen offset:1024 lds
  buffer_load_dwordx4 v20, s[64:67], s69 offen offset:2048 lds
  buffer_load_dwordx4 v20, s[64:67], s69 offen offset:3072 lds
  s_add_u32 m0, s68, 45056
  s_nop 0
  buffer_load_dwordx4 v21, s[64:67], s69 offen lds
  s_add_u32 s69, s69, 5120
L_kd_join5:
  s_mov_b32 s6, s74
  s_mov_b32 s7, s75
  v_lshrrev_b32 v1, 6, v0
  v_and_b32 v2, 63, v0
  v_readfirstlane_b32 s28, v1
  s_add_u32 s8, s42, 0x5400000
  s_addc_u32 s9, s43, 0
  s_mov_b32 s10, 0x1e0000
  s_mov_b32 s11, 0x20000
  s_add_u32 s12, s42, 0x3c00000
  s_addc_u32 s13, s43, 0
  s_mov_b32 s14, 0x600000
  s_mov_b32 s15, 0x20000
  s_add_u32 s16, s42, 0x3400000
  s_addc_u32 s17, s43, 0
  s_mov_b32 s18, 0x280000
  s_mov_b32 s19, 0x20000
  s_mov_b32 s20, s6
  s_mov_b32 s21, s7
  s_mov_b32 s22, 0x280000
  s_mov_b32 s23, 0x20000
  s_add_u32 s24, s42, 0x10000
  s_addc_u32 s25, s43, 0
  s_mov_b32 s26, 0x3c00
  s_mov_b32 s27, 0x20000
  s_and_b32 s44, s2, 7
  s_lshr_b32 s45, s2, 3
  s_lshl_b32 s46, s44, 2
  s_lshr_b32 s47, s45, 3
  s_add_u32 s46, s46, s47
  s_and_b32 s47, s45, 7
  s_mul_i32 s31, s28, 5120
  v_lshlrev_b32 v17, 4, v2
  v_add_u32 v12, 4096, v17
  v_lshrrev_b32 v20, 4, v2
  v_bfe_u32 v21, v2, 2, 2
  v_and_b32 v22, 3, v2
  v_lshlrev_b32 v23, 2, v20
  v_add_u32 v23, v23, v21
  s_mov_b32 s51, 160
  v_mul_lo_u32 v24, s51, v23
  v_lshlrev_b32 v25, 3, v22
  v_add_u32 v24, v24, v25
  v_add_u32 v10, s31, v24
  v_add_u32 v11, 61440, v10
  s_mul_i32 s32, s28, 61440
  s_mul_i32 s51, s47, 245760
  s_add_u32 s32, s32, s51
  s_mul_i32 s33, s46, 196608
  s_mul_i32 s51, s28, 49152
  s_add_u32 s33, s33, s51
  s_add_u32 s32, s32, 35840
  s_waitcnt vmcnt(0) lgkmcnt(0)
  s_barrier
  v_lshrrev_b32 v250, 6, v0
  s_nop 0
  v_readfirstlane_b32 s88, v250
  s_nop 3
  s_cmp_lg_u32 s88, 0
  s_cbranch_scc1 L_xb_join_d1
  v_and_b32 v250, 31, v0
  v_lshlrev_b32 v250, 2, v250
  s_lshl_b32 s89, s100, 7
  v_add_u32 v250, s89, v250
  s_lshl_b32 s90, s101, 2
  s_add_u32 s90, s90, s89
  s_add_u32 s90, s90, 1024
  v_mov_b32 v251, 1
  v_mov_b32 v252, s90
  s_cmp_eq_u32 s95, 1
  s_cbranch_scc0 L_xb_slow_d1
  v_cmp_eq_u32 vcc, 0, v0
  s_and_saveexec_b64 s[92:93], vcc
  buffer_store_dword v251, v252, s[96:99], 0 offen
  s_mov_b64 exec, s[92:93]
  s_branch L_xb_poll_d1
L_xb_slow_d1:
  buffer_wbl2 sc1
  s_waitcnt vmcnt(0)
  v_cmp_eq_u32 vcc, 0, v0
  s_and_saveexec_b64 s[92:93], vcc
  buffer_store_dword v251, v252, s[96:99], 0 offen sc1
  s_mov_b64 exec, s[92:93]
L_xb_poll_d1:
  s_mov_b32 s90, 0
  s_mov_b32 s91, 1024
L_xb_pl_d1:
  buffer_load_dword v251, v250, s[96:99], s91 offen sc1
  s_waitcnt vmcnt(0)
  v_cmp_ne_u32 vcc, 1, v251
  s_add_u32 s90, s90, 1
  s_cmp_ge_u32 s90, 0x20000
  s_cbranch_scc1 L_xb_done_d1
  s_cbranch_vccz L_xb_done_d1
  s_sleep 1
  s_branch L_xb_pl_d1
L_xb_done_d1:
  s_cmp_eq_u32 s95, 1
  s_cbranch_scc1 L_xb_join_d1
  buffer_inv sc1
  s_waitcnt vmcnt(0)
L_xb_join_d1:
  s_barrier
  buffer_load_dwordx4 v[32:35], v17, s[12:15], s33 offen offset:0
  buffer_load_dwordx4 v[36:39], v17, s[12:15], s33 offen offset:1024
  buffer_load_dwordx4 v[40:43], v17, s[12:15], s33 offen offset:2048
  buffer_load_dwordx4 v[44:47], v17, s[12:15], s33 offen offset:3072
  s_add_u32 s33, s33, 4096
  buffer_load_dwordx4 v[48:51], v17, s[12:15], s33 offen offset:0
  buffer_load_dwordx4 v[52:55], v17, s[12:15], s33 offen offset:1024
  buffer_load_dwordx4 v[56:59], v17, s[12:15], s33 offen offset:2048
  buffer_load_dwordx4 v[60:63], v17, s[12:15], s33 offen offset:3072
  s_add_u32 s33, s33, 4096
  buffer_load_dwordx4 v[64:67], v17, s[12:15], s33 offen offset:0
  buffer_load_dwordx4 v[68:71], v17, s[12:15], s33 offen offset:1024
  buffer_load_dwordx4 v[72:75], v17, s[12:15], s33 offen offset:2048
  buffer_load_dwordx4 v[76:79], v17, s[12:15], s33 offen offset:3072
  s_add_u32 s33, s33, 4096
  buffer_load_dwordx4 v[80:83], v17, s[12:15], s33 offen offset:0
  buffer_load_dwordx4 v[84:87], v17, s[12:15], s33 offen offset:1024
  buffer_load_dwordx4 v[88:91], v17, s[12:15], s33 offen offset:2048
  buffer_load_dwordx4 v[92:95], v17, s[12:15], s33 offen offset:3072
  s_add_u32 s33, s33, 4096
  buffer_load_dwordx4 v[96:99], v17, s[12:15], s33 offen offset:0
  buffer_load_dwordx4 v[100:103], v17, s[12:15], s33 offen offset:1024
  buffer_load_dwordx4 v[104:107], v17, s[12:15], s33 offen offset:2048
  buffer_load_dwordx4 v[108:111], v17, s[12:15], s33 offen offset:3072
  s_add_u32 s33, s33, 4096
  buffer_load_dwordx4 v[112:115], v17, s[12:15], s33 offen offset:0
  buffer_load_dwordx4 v[116:119], v17, s[12:15], s33 offen offset:1024
  buffer_load_dwordx4 v[120:123], v17, s[12:15], s33 offen offset:2048
  buffer_load_dwordx4 v[124:127], v17, s[12:15], s33 offen offset:3072
  s_add_u32 s33, s33, 4096
  s_lshl_b32 s48, s46, 2
  s_add_u32 s48, s48, s28
  s_mul_i32 s49, s48, 20480
  s_lshr_b32 s50, s47, 1
  s_mul_i32 s50, s50, 5120
  s_add_u32 s49, s49, s50
  s_and_b32 s51, s47, 1
  s_mov_b32 s58, 2056
  s_cmp_eq_u32 s51, 0
  s_cselect_b32 s52, 0, s58
  s_add_u32 s52, s52, s49
  buffer_load_dwordx2 v[224:225], v17, s[16:19], s52 offen
  s_mov_b32 s58, 3072
  s_cmp_eq_u32 s51, 0
  s_cselect_b32 s52, 8, s58
  s_add_u32 s52, s52, s49
  buffer_load_dwordx2 v[226:227], v17, s[16:19], s52 offen
  s_mov_b32 s58, 3080
  s_cmp_eq_u32 s51, 0
  s_cselect_b32 s52, 1024, s58
  s_add_u32 s52, s52, s49
  buffer_load_dwordx2 v[228:229], v17, s[16:19], s52 offen
  s_mov_b32 s58, 4096
  s_cmp_eq_u32 s51, 0
  s_cselect_b32 s52, 1032, s58
  s_add_u32 s52, s52, s49
  buffer_load_dwordx2 v[230:231], v17, s[16:19], s52 offen
  s_mov_b32 s58, 4104
  s_cmp_eq_u32 s51, 0
  s_cselect_b32 s52, 2048, s58
  s_add_u32 s52, s52, s49
  buffer_load_dwordx2 v[232:233], v17, s[16:19], s52 offen
  v_lshrrev_b32 v22, 4, v2
  v_lshlrev_b32 v22, 4, v22
  s_mul_i32 s53, s47, 320
  s_add_u32 s53, s53, 12800
  buffer_load_dwordx4 v[236:239], v22, s[24:27], s53 offen offset:0
  buffer_load_dwordx4 v[240:243], v22, s[24:27], s53 offen offset:64
  buffer_load_dwordx4 v[244:247], v22, s[24:27], s53 offen offset:128
  buffer_load_dwordx4 v[248:251], v22, s[24:27], s53 offen offset:192
  buffer_load_dwordx4 v[252:255], v22, s[24:27], s53 offen offset:256
  s_waitcnt vmcnt(30)
  ds_read_b64_tr_b16 a[80:81], v11 offset:0
  ds_read_b64_tr_b16 a[82:83], v11 offset:2560
  ds_read_b64_tr_b16 a[84:85], v11 offset:32
  ds_read_b64_tr_b16 a[86:87], v11 offset:2592
  ds_read_b64_tr_b16 a[88:89], v11 offset:64
  ds_read_b64_tr_b16 a[90:91], v11 offset:2624
  ds_read_b64_tr_b16 a[92:93], v11 offset:96
  ds_read_b64_tr_b16 a[94:95], v11 offset:2656
  ds_read_b64_tr_b16 a[96:97], v11 offset:128
  ds_read_b64_tr_b16 a[98:99], v11 offset:2688
  s_waitcnt vmcnt(30)
  s_waitcnt lgkmcnt(8)
  v_mfma_f32_16x16x32_bf16 a[0:3], a[80:83], v[32:35], 0
  ds_read_b64_tr_b16 a[100:101], v11 offset:20480
  ds_read_b64_tr_b16 a[102:103], v11 offset:23040
  v_mfma_f32_16x16x32_bf16 a[4:7], a[80:83], v[36:39], 0
  buffer_load_dwordx4 v[128:131], v17, s[12:15], s33 offen offset:0
  v_mfma_f32_16x16x32_bf16 a[8:11], a[80:83], v[40:43], 0
  v_mfma_f32_16x16x32_bf16 a[12:15], a[80:83], v[44:47], 0
  s_waitcnt lgkmcnt(8)
  v_mfma_f32_16x16x32_bf16 a[16:19], a[84:87], v[32:35], 0
  ds_read_b64_tr_b16 a[104:105], v11 offset:20512
  ds_read_b64_tr_b16 a[106:107], v11 offset:23072
  v_mfma_f32_16x16x32_bf16 a[20:23], a[84:87], v[36:39], 0
  v_mfma_f32_16x16x32_bf16 a[24:27], a[84:87], v[40:43], 0
  buffer_load_dwordx4 v[132:135], v17, s[12:15], s33 offen offset:1024
  v_mfma_f32_16x16x32_bf16 a[28:31], a[84:87], v[44:47], 0
  s_waitcnt lgkmcnt(8)
  v_mfma_f32_16x16x32_bf16 a[32:35], a[88:91], v[32:35], 0
  ds_read_b64_tr_b16 a[108:109], v11 offset:20544
  ds_read_b64_tr_b16 a[110:111], v11 offset:23104
  v_mfma_f32_16x16x32_bf16 a[36:39], a[88:91], v[36:39], 0
  v_mfma_f32_16x16x32_bf16 a[40:43], a[88:91], v[40:43], 0
  v_mfma_f32_16x16x32_bf16 a[44:47], a[88:91], v[44:47], 0
  s_waitcnt lgkmcnt(8)
  buffer_load_dwordx4 v[136:139], v17, s[12:15], s33 offen offset:2048
  v_mfma_f32_16x16x32_bf16 a[48:51], a[92:95], v[32:35], 0
  ds_read_b64_tr_b16 a[80:81], v11 offset:20576
  ds_read_b64_tr_b16 a[82:83], v11 offset:23136
  v_mfma_f32_16x16x32_bf16 a[52:55], a[92:95], v[36:39], 0
  v_mfma_f32_16x16x32_bf16 a[56:59], a[92:95], v[40:43], 0
  v_mfma_f32_16x16x32_bf16 a[60:63], a[92:95], v[44:47], 0
  s_waitcnt lgkmcnt(8)
  v_mfma_f32_16x16x32_bf16 a[64:67], a[96:99], v[32:35], 0
  ds_read_b64_tr_b16 a[84:85], v11 offset:20608
  ds_read_b64_tr_b16 a[86:87], v11 offset:23168
  v_mfma_f32_16x16x32_bf16 a[68:71], a[96:99], v[36:39], 0
  buffer_load_dwordx4 v[140:143], v17, s[12:15], s33 offen offset:3072
  v_mfma_f32_16x16x32_bf16 a[72:75], a[96:99], v[40:43], 0
  s_add_u32 s33, s33, 4096
  v_mfma_f32_16x16x32_bf16 a[76:79], a[96:99], v[44:47], 0
  s_waitcnt vmcnt(30)
  s_waitcnt lgkmcnt(8)
  v_mfma_f32_16x16x32_bf16 a[0:3], a[100:103], v[48:51], a[0:3]
  s_add_u32 m0, s31, 61440
  ds_read_b64_tr_b16 a[88:89], v11 offset:40960
  ds_read_b64_tr_b16 a[90:91], v11 offset:43520
  v_mfma_f32_16x16x32_bf16 a[4:7], a[100:103], v[52:55], a[4:7]
  buffer_load_dwordx4 v17, s[8:11], s32 offen offset:0 lds
  v_mfma_f32_16x16x32_bf16 a[8:11], a[100:103], v[56:59], a[8:11]
  v_mfma_f32_16x16x32_bf16 a[12:15], a[100:103], v[60:63], a[12:15]
  s_waitcnt lgkmcnt(8)
  buffer_load_dwordx4 v17, s[8:11], s32 offen offset:1024 lds
  v_mfma_f32_16x16x32_bf16 a[16:19], a[104:107], v[48:51], a[16:19]
  ds_read_b64_tr_b16 a[92:93], v11 offset:40992
  ds_read_b64_tr_b16 a[94:95], v11 offset:43552
  v_mfma_f32_16x16x32_bf16 a[20:23], a[104:107], v[52:55], a[20:23]
  buffer_load_dwordx4 v17, s[8:11], s32 offen offset:2048 lds
  v_mfma_f32_16x16x32_bf16 a[24:27], a[104:107], v[56:59], a[24:27]
  v_mfma_f32_16x16x32_bf16 a[28:31], a[104:107], v[60:63], a[28:31]
  s_waitcnt lgkmcnt(8)
  buffer_load_dwordx4 v17, s[8:11], s32 offen offset:3072 lds
  v_mfma_f32_16x16x32_bf16 a[32:35], a[108:111], v[48:51], a[32:35]
  s_add_u32 m0, s31, 65536
  ds_read_b64_tr_b16 a[96:97], v11 offset:41024
  ds_read_b64_tr_b16 a[98:99], v11 offset:43584
  v_mfma_f32_16x16x32_bf16 a[36:39], a[108:111], v[52:55], a[36:39]
  buffer_load_dwordx4 v12, s[8:11], s32 offen lds
  v_mfma_f32_16x16x32_bf16 a[40:43], a[108:111], v[56:59], a[40:43]
  s_add_u32 s32, s32, 5120
  v_mfma_f32_16x16x32_bf16 a[44:47], a[108:111], v[60:63], a[44:47]
  s_waitcnt lgkmcnt(8)
  buffer_load_dwordx4 v[144:147], v17, s[12:15], s33 offen offset:0
  v_mfma_f32_16x16x32_bf16 a[48:51], a[80:83], v[48:51], a[48:51]
  ds_read_b64_tr_b16 a[100:101], v11 offset:41056
  ds_read_b64_tr_b16 a[102:103], v11 offset:43616
  v_mfma_f32_16x16x32_bf16 a[52:55], a[80:83], v[52:55], a[52:55]
  buffer_load_dwordx4 v[148:151], v17, s[12:15], s33 offen offset:1024
  v_mfma_f32_16x16x32_bf16 a[56:59], a[80:83], v[56:59], a[56:59]
  v_mfma_f32_16x16x32_bf16 a[60:63], a[80:83], v[60:63], a[60:63]
  s_waitcnt lgkmcnt(8)
  buffer_load_dwordx4 v[152:155], v17, s[12:15], s33 offen offset:2048
  v_mfma_f32_16x16x32_bf16 a[64:67], a[84:87], v[48:51], a[64:67]
  ds_read_b64_tr_b16 a[104:105], v11 offset:41088
  ds_read_b64_tr_b16 a[106:107], v11 offset:43648
  v_mfma_f32_16x16x32_bf16 a[68:71], a[84:87], v[52:55], a[68:71]
  buffer_load_dwordx4 v[156:159], v17, s[12:15], s33 offen offset:3072
  v_mfma_f32_16x16x32_bf16 a[72:75], a[84:87], v[56:59], a[72:75]
  s_add_u32 s33, s33, 4096
  v_mfma_f32_16x16x32_bf16 a[76:79], a[84:87], v[60:63], a[76:79]
  s_waitcnt vmcnt(35)
  s_waitcnt lgkmcnt(8)
  v_mfma_f32_16x16x32_bf16 a[0:3], a[88:91], v[64:67], a[0:3]
  s_add_u32 m0, s31, 81920
  ds_read_b64_tr_b16 a[108:109], v11 offset:61440
  ds_read_b64_tr_b16 a[110:111], v11 offset:64000
  v_mfma_f32_16x16x32_bf16 a[4:7], a[88:91], v[68:71], a[4:7]
  buffer_load_dwordx4 v17, s[8:11], s32 offen offset:0 lds
  v_mfma_f32_16x16x32_bf16 a[8:11], a[88:91], v[72:75], a[8:11]
  buffer_load_dwordx4 v17, s[8:11], s32 offen offset:1024 lds
  v_mfma_f32_16x16x32_bf16 a[12:15], a[88:91], v[76:79], a[12:15]
  s_waitcnt lgkmcnt(8)
  buffer_load_dwordx4 v17, s[8:11], s32 offen offset:2048 lds
  v_mfma_f32_16x16x32_bf16 a[16:19], a[92:95], v[64:67], a[16:19]
  ds_read_b64_tr_b16 a[80:81], v11 offset:61472
  ds_read_b64_tr_b16 a[82:83], v11 offset:64032
  v_mfma_f32_16x16x32_bf16 a[20:23], a[92:95], v[68:71], a[20:23]
  buffer_load_dwordx4 v17, s[8:11], s32 offen offset:3072 lds
  v_mfma_f32_16x16x32_bf16 a[24:27], a[92:95], v[72:75], a[24:27]
  s_add_u32 m0, s31, 86016
  v_mfma_f32_16x16x32_bf16 a[28:31], a[92:95], v[76:79], a[28:31]
  s_waitcnt lgkmcnt(8)
  buffer_load_dwordx4 v12, s[8:11], s32 offen lds
  v_mfma_f32_16x16x32_bf16 a[32:35], a[96:99], v[64:67], a[32:35]
  s_add_u32 s32, s32, 5120
  ds_read_b64_tr_b16 a[84:85], v11 offset:61504
  ds_read_b64_tr_b16 a[86:87], v11 offset:64064
  v_mfma_f32_16x16x32_bf16 a[36:39], a[96:99], v[68:71], a[36:39]
  buffer_load_dwordx4 v[160:163], v17, s[12:15], s33 offen offset:0
  v_mfma_f32_16x16x32_bf16 a[40:43], a[96:99], v[72:75], a[40:43]
  buffer_load_dwordx4 v[164:167], v17, s[12:15], s33 offen offset:1024
  v_mfma_f32_16x16x32_bf16 a[44:47], a[96:99], v[76:79], a[44:47]
  s_waitcnt lgkmcnt(8)
  buffer_load_dwordx4 v[168:171], v17, s[12:15], s33 offen offset:2048
  v_mfma_f32_16x16x32_bf16 a[48:51], a[100:103], v[64:67], a[48:51]
  ds_read_b64_tr_b16 a[88:89], v11 offset:61536
  ds_read_b64_tr_b16 a[90:91], v11 offset:64096
  v_mfma_f32_16x16x32_bf16 a[52:55], a[100:103], v[68:71], a[52:55]
  buffer_load_dwordx4 v[172:175], v17, s[12:15], s33 offen offset:3072
  v_mfma_f32_16x16x32_bf16 a[56:59], a[100:103], v[72:75], a[56:59]
  s_add_u32 s33, s33, 4096
  v_mfma_f32_16x16x32_bf16 a[60:63], a[100:103], v[76:79], a[60:63]
  s_waitcnt lgkmcnt(8)
  v_mfma_f32_16x16x32_bf16 a[64:67], a[104:107], v[64:67], a[64:67]
  ds_read_b64_tr_b16 a[92:93], v11 offset:61568
  ds_read_b64_tr_b16 a[94:95], v11 offset:64128
  v_mfma_f32_16x16x32_bf16 a[68:71], a[104:107], v[68:71], a[68:71]
  v_mfma_f32_16x16x32_bf16 a[72:75], a[104:107], v[72:75], a[72:75]
  s_waitcnt vmcnt(40)
  v_mfma_f32_16x16x32_bf16 a[76:79], a[104:107], v[76:79], a[76:79]
  s_waitcnt lgkmcnt(8)
  v_mfma_f32_16x16x32_bf16 a[0:3], a[108:111], v[80:83], a[0:3]
  s_add_u32 m0, s31, 102400
  ds_read_b64_tr_b16 a[96:97], v10 offset:0
  ds_read_b64_tr_b16 a[98:99], v10 offset:2560
  v_mfma_f32_16x16x32_bf16 a[4:7], a[108:111], v[84:87], a[4:7]
  buffer_load_dwordx4 v17, s[8:11], s32 offen offset:0 lds
  v_mfma_f32_16x16x32_bf16 a[8:11], a[108:111], v[88:91], a[8:11]
  buffer_load_dwordx4 v17, s[8:11], s32 offen offset:1024 lds
  v_mfma_f32_16x16x32_bf16 a[12:15], a[108:111], v[92:95], a[12:15]
  s_waitcnt lgkmcnt(8)
  buffer_load_dwordx4 v17, s[8:11], s32 offen offset:2048 lds
  v_mfma_f32_16x16x32_bf16 a[16:19], a[80:83], v[80:83], a[16:19]
  ds_read_b64_tr_b16 a[100:101], v10 offset:32
  ds_read_b64_tr_b16 a[102:103], v10 offset:2592
  v_mfma_f32_16x16x32_bf16 a[20:23], a[80:83], v[84:87], a[20:23]
  buffer_load_dwordx4 v17, s[8:11], s32 offen offset:3072 lds
  v_mfma_f32_16x16x32_bf16 a[24:27], a[80:83], v[88:91], a[24:27]
  s_add_u32 m0, s31, 106496
  v_mfma_f32_16x16x32_bf16 a[28:31], a[80:83], v[92:95], a[28:31]
  s_waitcnt lgkmcnt(8)
  buffer_load_dwordx4 v12, s[8:11], s32 offen lds
  v_mfma_f32_16x16x32_bf16 a[32:35], a[84:87], v[80:83], a[32:35]
  s_add_u32 s32, s32, 5120
  ds_read_b64_tr_b16 a[104:105], v10 offset:64
  ds_read_b64_tr_b16 a[106:107], v10 offset:2624
  v_mfma_f32_16x16x32_bf16 a[36:39], a[84:87], v[84:87], a[36:39]
  buffer_load_dwordx4 v[176:179], v17, s[12:15], s33 offen offset:0
  v_mfma_f32_16x16x32_bf16 a[40:43], a[84:87], v[88:91], a[40:43]
  buffer_load_dwordx4 v[180:183], v17, s[12:15], s33 offen offset:1024
  v_mfma_f32_16x16x32_bf16 a[44:47], a[84:87], v[92:95], a[44:47]
  s_waitcnt lgkmcnt(8)
  buffer_load_dwordx4 v[184:187], v17, s[12:15], s33 offen offset:2048
  v_mfma_f32_16x16x32_bf16 a[48:51], a[88:91], v[80:83], a[48:51]
  ds_read_b64_tr_b16 a[108:109], v10 offset:96
  ds_read_b64_tr_b16 a[110:111], v10 offset:2656
  v_mfma_f32_16x16x32_bf16 a[52:55], a[88:91], v[84:87], a[52:55]
  buffer_load_dwordx4 v[188:191], v17, s[12:15], s33 offen offset:3072
  v_mfma_f32_16x16x32_bf16 a[56:59], a[88:91], v[88:91], a[56:59]
  s_add_u32 s33, s33, 4096
  v_mfma_f32_16x16x32_bf16 a[60:63], a[88:91], v[92:95], a[60:63]
  s_waitcnt lgkmcnt(8)
  v_mfma_f32_16x16x32_bf16 a[64:67], a[92:95], v[80:83], a[64:67]
  ds_read_b64_tr_b16 a[80:81], v10 offset:128
  ds_read_b64_tr_b16 a[82:83], v10 offset:2688
  v_mfma_f32_16x16x32_bf16 a[68:71], a[92:95], v[84:87], a[68:71]
  v_mfma_f32_16x16x32_bf16 a[72:75], a[92:95], v[88:91], a[72:75]
  s_waitcnt vmcnt(45)
  v_mfma_f32_16x16x32_bf16 a[76:79], a[92:95], v[92:95], a[76:79]
  s_waitcnt lgkmcnt(8)
  v_mfma_f32_16x16x32_bf16 a[0:3], a[96:99], v[96:99], a[0:3]
  s_add_u32 m0, s31, 122880
  ds_read_b64_tr_b16 a[84:85], v10 offset:20480
  ds_read_b64_tr_b16 a[86:87], v10 offset:23040
  v_mfma_f32_16x16x32_bf16 a[4:7], a[96:99], v[100:103], a[4:7]
  buffer_load_dwordx4 v17, s[8:11], s32 offen offset:0 lds
  v_mfma_f32_16x16x32_bf16 a[8:11], a[96:99], v[104:107], a[8:11]
  buffer_load_dwordx4 v17, s[8:11], s32 offen offset:1024 lds
  v_mfma_f32_16x16x32_bf16 a[12:15], a[96:99], v[108:111], a[12:15]
  s_waitcnt lgkmcnt(8)
  buffer_load_dwordx4 v17, s[8:11], s32 offen offset:2048 lds
  v_mfma_f32_16x16x32_bf16 a[16:19], a[100:103], v[96:99], a[16:19]
  ds_read_b64_tr_b16 a[88:89], v10 offset:20512
  ds_read_b64_tr_b16 a[90:91], v10 offset:23072
  v_mfma_f32_16x16x32_bf16 a[20:23], a[100:103], v[100:103], a[20:23]
  buffer_load_dwordx4 v17, s[8:11], s32 offen offset:3072 lds
  v_mfma_f32_16x16x32_bf16 a[24:27], a[100:103], v[104:107], a[24:27]
  s_add_u32 m0, s31, 126976
  v_mfma_f32_16x16x32_bf16 a[28:31], a[100:103], v[108:111], a[28:31]
  s_waitcnt lgkmcnt(8)
  buffer_load_dwordx4 v12, s[8:11], s32 offen lds
  v_mfma_f32_16x16x32_bf16 a[32:35], a[104:107], v[96:99], a[32:35]
  s_add_u32 s32, s32, 5120
  ds_read_b64_tr_b16 a[92:93], v10 offset:20544
  ds_read_b64_tr_b16 a[94:95], v10 offset:23104
  v_mfma_f32_16x16x32_bf16 a[36:39], a[104:107], v[100:103], a[36:39]
  buffer_load_dwordx4 v[192:195], v17, s[12:15], s33 offen offset:0
  v_mfma_f32_16x16x32_bf16 a[40:43], a[104:107], v[104:107], a[40:43]
  buffer_load_dwordx4 v[196:199], v17, s[12:15], s33 offen offset:1024
  v_mfma_f32_16x16x32_bf16 a[44:47], a[104:107], v[108:111], a[44:47]
  s_waitcnt lgkmcnt(8)
  buffer_load_dwordx4 v[200:203], v17, s[12:15], s33 offen offset:2048
  v_mfma_f32_16x16x32_bf16 a[48:51], a[108:111], v[96:99], a[48:51]
  ds_read_b64_tr_b16 a[96:97], v10 offset:20576
  ds_read_b64_tr_b16 a[98:99], v10 offset:23136
  v_mfma_f32_16x16x32_bf16 a[52:55], a[108:111], v[100:103], a[52:55]
  buffer_load_dwordx4 v[204:207], v17, s[12:15], s33 offen offset:3072
  v_mfma_f32_16x16x32_bf16 a[56:59], a[108:111], v[104:107], a[56:59]
  s_add_u32 s33, s33, 4096
  v_mfma_f32_16x16x32_bf16 a[60:63], a[108:111], v[108:111], a[60:63]
  s_waitcnt lgkmcnt(8)
  v_mfma_f32_16x16x32_bf16 a[64:67], a[80:83], v[96:99], a[64:67]
  ds_read_b64_tr_b16 a[100:101], v10 offset:20608
  ds_read_b64_tr_b16 a[102:103], v10 offset:23168
  v_mfma_f32_16x16x32_bf16 a[68:71], a[80:83], v[100:103], a[68:71]
  v_mfma_f32_16x16x32_bf16 a[72:75], a[80:83], v[104:107], a[72:75]
  s_waitcnt vmcnt(50)
  v_mfma_f32_16x16x32_bf16 a[76:79], a[80:83], v[108:111], a[76:79]
  s_waitcnt lgkmcnt(8)
  v_mfma_f32_16x16x32_bf16 a[0:3], a[84:87], v[112:115], a[0:3]
  s_add_u32 m0, s31, 0
  ds_read_b64_tr_b16 a[104:105], v10 offset:40960
  ds_read_b64_tr_b16 a[106:107], v10 offset:43520
  v_mfma_f32_16x16x32_bf16 a[4:7], a[84:87], v[116:119], a[4:7]
  buffer_load_dwordx4 v17, s[8:11], s32 offen offset:0 lds
  v_mfma_f32_16x16x32_bf16 a[8:11], a[84:87], v[120:123], a[8:11]
  buffer_load_dwordx4 v17, s[8:11], s32 offen offset:1024 lds
  v_mfma_f32_16x16x32_bf16 a[12:15], a[84:87], v[124:127], a[12:15]
  s_waitcnt lgkmcnt(8)
  buffer_load_dwordx4 v17, s[8:11], s32 offen offset:2048 lds
  v_mfma_f32_16x16x32_bf16 a[16:19], a[88:91], v[112:115], a[16:19]
  ds_read_b64_tr_b16 a[108:109], v10 offset:40992
  ds_read_b64_tr_b16 a[110:111], v10 offset:43552
  v_mfma_f32_16x16x32_bf16 a[20:23], a[88:91], v[116:119], a[20:23]
  buffer_load_dwordx4 v17, s[8:11], s32 offen offset:3072 lds
  v_mfma_f32_16x16x32_bf16 a[24:27], a[88:91], v[120:123], a[24:27]
  s_add_u32 m0, s31, 4096
  v_mfma_f32_16x16x32_bf16 a[28:31], a[88:91], v[124:127], a[28:31]
  s_waitcnt lgkmcnt(8)
  buffer_load_dwordx4 v12, s[8:11], s32 offen lds
  v_mfma_f32_16x16x32_bf16 a[32:35], a[92:95], v[112:115], a[32:35]
  s_add_u32 s32, s32, 5120
  ds_read_b64_tr_b16 a[80:81], v10 offset:41024
  ds_read_b64_tr_b16 a[82:83], v10 offset:43584
  v_mfma_f32_16x16x32_bf16 a[36:39], a[92:95], v[116:119], a[36:39]
  buffer_load_dwordx4 v[208:211], v17, s[12:15], s33 offen offset:0
  v_mfma_f32_16x16x32_bf16 a[40:43], a[92:95], v[120:123], a[40:43]
  buffer_load_dwordx4 v[212:215], v17, s[12:15], s33 offen offset:1024
  v_mfma_f32_16x16x32_bf16 a[44:47], a[92:95], v[124:127], a[44:47]
  s_waitcnt lgkmcnt(8)
  buffer_load_dwordx4 v[216:219], v17, s[12:15], s33 offen offset:2048
  v_mfma_f32_16x16x32_bf16 a[48:51], a[96:99], v[112:115], a[48:51]
  ds_read_b64_tr_b16 a[84:85], v10 offset:41056
  ds_read_b64_tr_b16 a[86:87], v10 offset:43616
  v_mfma_f32_16x16x32_bf16 a[52:55], a[96:99], v[116:119], a[52:55]
  buffer_load_dwordx4 v[220:223], v17, s[12:15], s33 offen offset:3072
  v_mfma_f32_16x16x32_bf16 a[56:59], a[96:99], v[120:123], a[56:59]
  s_add_u32 s33, s33, 4096
  v_mfma_f32_16x16x32_bf16 a[60:63], a[96:99], v[124:127], a[60:63]
  s_waitcnt lgkmcnt(8)
  v_mfma_f32_16x16x32_bf16 a[64:67], a[100:103], v[112:115], a[64:67]
  ds_read_b64_tr_b16 a[88:89], v10 offset:41088
  ds_read_b64_tr_b16 a[90:91], v10 offset:43648
  v_mfma_f32_16x16x32_bf16 a[68:71], a[100:103], v[116:119], a[68:71]
  v_mfma_f32_16x16x32_bf16 a[72:75], a[100:103], v[120:123], a[72:75]
  s_waitcnt vmcnt(40)
  v_mfma_f32_16x16x32_bf16 a[76:79], a[100:103], v[124:127], a[76:79]
  s_waitcnt lgkmcnt(8)
  v_mfma_f32_16x16x32_bf16 a[0:3], a[104:107], v[128:131], a[0:3]
  ds_read_b64_tr_b16 a[92:93], v11 offset:0
  ds_read_b64_tr_b16 a[94:95], v11 offset:2560
  v_mfma_f32_16x16x32_bf16 a[4:7], a[104:107], v[132:135], a[4:7]
  v_mfma_f32_16x16x32_bf16 a[8:11], a[104:107], v[136:139], a[8:11]
  v_mfma_f32_16x16x32_bf16 a[12:15], a[104:107], v[140:143], a[12:15]
  s_waitcnt lgkmcnt(8)
  v_mfma_f32_16x16x32_bf16 a[16:19], a[108:111], v[128:131], a[16:19]
  ds_read_b64_tr_b16 a[96:97], v11 offset:32
  ds_read_b64_tr_b16 a[98:99], v11 offset:2592
  v_mfma_f32_16x16x32_bf16 a[20:23], a[108:111], v[132:135], a[20:23]
  v_mfma_f32_16x16x32_bf16 a[24:27], a[108:111], v[136:139], a[24:27]
  v_mfma_f32_16x16x32_bf16 a[28:31], a[108:111], v[140:143], a[28:31]
  s_waitcnt lgkmcnt(8)
  v_mfma_f32_16x16x32_bf16 a[32:35], a[80:83], v[128:131], a[32:35]
  ds_read_b64_tr_b16 a[100:101], v11 offset:64
  ds_read_b64_tr_b16 a[102:103], v11 offset:2624
  v_mfma_f32_16x16x32_bf16 a[36:39], a[80:83], v[132:135], a[36:39]
  v_mfma_f32_16x16x32_bf16 a[40:43], a[80:83], v[136:139], a[40:43]
  v_mfma_f32_16x16x32_bf16 a[44:47], a[80:83], v[140:143], a[44:47]
  s_waitcnt lgkmcnt(8)
  v_mfma_f32_16x16x32_bf16 a[48:51], a[84:87], v[128:131], a[48:51]
  ds_read_b64_tr_b16 a[104:105], v11 offset:96
  ds_read_b64_tr_b16 a[106:107], v11 offset:2656
  v_mfma_f32_16x16x32_bf16 a[52:55], a[84:87], v[132:135], a[52:55]
  v_mfma_f32_16x16x32_bf16 a[56:59], a[84:87], v[136:139], a[56:59]
  v_mfma_f32_16x16x32_bf16 a[60:63], a[84:87], v[140:143], a[60:63]
  s_waitcnt lgkmcnt(8)
  v_mfma_f32_16x16x32_bf16 a[64:67], a[88:91], v[128:131], a[64:67]
  ds_read_b64_tr_b16 a[108:109], v11 offset:128
  ds_read_b64_tr_b16 a[110:111], v11 offset:2688
  v_mfma_f32_16x16x32_bf16 a[68:71], a[88:91], v[132:135], a[68:71]
  v_mfma_f32_16x16x32_bf16 a[72:75], a[88:91], v[136:139], a[72:75]
  s_waitcnt vmcnt(31)
  v_mfma_f32_16x16x32_bf16 a[76:79], a[88:91], v[140:143], a[76:79]
  s_waitcnt lgkmcnt(8)
  v_mfma_f32_16x16x32_bf16 a[0:3], a[92:95], v[144:147], a[0:3]
  ds_read_b64_tr_b16 a[80:81], v11 offset:20480
  ds_read_b64_tr_b16 a[82:83], v11 offset:23040
  v_mfma_f32_16x16x32_bf16 a[4:7], a[92:95], v[148:151], a[4:7]
  v_mfma_f32_16x16x32_bf16 a[8:11], a[92:95], v[152:155], a[8:11]
  v_mfma_f32_16x16x32_bf16 a[12:15], a[92:95], v[156:159], a[12:15]
  s_waitcnt lgkmcnt(8)
  v_mfma_f32_16x16x32_bf16 a[16:19], a[96:99], v[144:147], a[16:19]
  ds_read_b64_tr_b16 a[84:85], v11 offset:20512
  ds_read_b64_tr_b16 a[86:87], v11 offset:23072
  v_mfma_f32_16x16x32_bf16 a[20:23], a[96:99], v[148:151], a[20:23]
  v_mfma_f32_16x16x32_bf16 a[24:27], a[96:99], v[152:155], a[24:27]
  v_mfma_f32_16x16x32_bf16 a[28:31], a[96:99], v[156:159], a[28:31]
  s_waitcnt lgkmcnt(8)
  v_mfma_f32_16x16x32_bf16 a[32:35], a[100:103], v[144:147], a[32:35]
  ds_read_b64_tr_b16 a[88:89], v11 offset:20544
  ds_read_b64_tr_b16 a[90:91], v11 offset:23104
  v_mfma_f32_16x16x32_bf16 a[36:39], a[100:103], v[148:151], a[36:39]
  v_mfma_f32_16x16x32_bf16 a[40:43], a[100:103], v[152:155], a[40:43]
  v_mfma_f32_16x16x32_bf16 a[44:47], a[100:103], v[156:159], a[44:47]
  s_waitcnt lgkmcnt(8)
  v_mfma_f32_16x16x32_bf16 a[48:51], a[104:107], v[144:147], a[48:51]
  ds_read_b64_tr_b16 a[92:93], v11 offset:20576
  ds_read_b64_tr_b16 a[94:95], v11 offset:23136
  v_mfma_f32_16x16x32_bf16 a[52:55], a[104:107], v[148:151], a[52:55]
  v_mfma_f32_16x16x32_bf16 a[56:59], a[104:107], v[152:155], a[56:59]
  v_mfma_f32_16x16x32_bf16 a[60:63], a[104:107], v[156:159], a[60:63]
  s_waitcnt lgkmcnt(8)
  v_mfma_f32_16x16x32_bf16 a[64:67], a[108:111], v[144:147], a[64:67]
  ds_read_b64_tr_b16 a[96:97], v11 offset:20608
  ds_read_b64_tr_b16 a[98:99], v11 offset:23168
  v_mfma_f32_16x16x32_bf16 a[68:71], a[108:111], v[148:151], a[68:71]
  v_mfma_f32_16x16x32_bf16 a[72:75], a[108:111], v[152:155], a[72:75]
  s_waitcnt vmcnt(22)
  v_mfma_f32_16x16x32_bf16 a[76:79], a[108:111], v[156:159], a[76:79]
  s_waitcnt lgkmcnt(8)
  v_mfma_f32_16x16x32_bf16 a[0:3], a[80:83], v[160:163], a[0:3]
  ds_read_b64_tr_b16 a[100:101], v11 offset:40960
  ds_read_b64_tr_b16 a[102:103], v11 offset:43520
  v_mfma_f32_16x16x32_bf16 a[4:7], a[80:83], v[164:167], a[4:7]
  v_mfma_f32_16x16x32_bf16 a[8:11], a[80:83], v[168:171], a[8:11]
  v_mfma_f32_16x16x32_bf16 a[12:15], a[80:83], v[172:175], a[12:15]
  s_waitcnt lgkmcnt(8)
  v_mfma_f32_16x16x32_bf16 a[16:19], a[84:87], v[160:163], a[16:19]
  ds_read_b64_tr_b16 a[104:105], v11 offset:40992
  ds_read_b64_tr_b16 a[106:107], v11 offset:43552
  v_mfma_f32_16x16x32_bf16 a[20:23], a[84:87], v[164:167], a[20:23]
  v_mfma_f32_16x16x32_bf16 a[24:27], a[84:87], v[168:171], a[24:27]
  v_mfma_f32_16x16x32_bf16 a[28:31], a[84:87], v[172:175], a[28:31]
  s_waitcnt lgkmcnt(8)
  v_mfma_f32_16x16x32_bf16 a[32:35], a[88:91], v[160:163], a[32:35]
  ds_read_b64_tr_b16 a[108:109], v11 offset:41024
  ds_read_b64_tr_b16 a[110:111], v11 offset:43584
  v_mfma_f32_16x16x32_bf16 a[36:39], a[88:91], v[164:167], a[36:39]
  v_mfma_f32_16x16x32_bf16 a[40:43], a[88:91], v[168:171], a[40:43]
  v_mfma_f32_16x16x32_bf16 a[44:47], a[88:91], v[172:175], a[44:47]
  s_waitcnt lgkmcnt(8)
  v_mfma_f32_16x16x32_bf16 a[48:51], a[92:95], v[160:163], a[48:51]
  ds_read_b64_tr_b16 a[80:81], v11 offset:41056
  ds_read_b64_tr_b16 a[82:83], v11 offset:43616
  v_mfma_f32_16x16x32_bf16 a[52:55], a[92:95], v[164:167], a[52:55]
  v_mfma_f32_16x16x32_bf16 a[56:59], a[92:95], v[168:171], a[56:59]
  v_mfma_f32_16x16x32_bf16 a[60:63], a[92:95], v[172:175], a[60:63]
  s_waitcnt lgkmcnt(8)
  v_mfma_f32_16x16x32_bf16 a[64:67], a[96:99], v[160:163], a[64:67]
  ds_read_b64_tr_b16 a[84:85], v11 offset:41088
  ds_read_b64_tr_b16 a[86:87], v11 offset:43648
  v_mfma_f32_16x16x32_bf16 a[68:71], a[96:99], v[164:167], a[68:71]
  v_mfma_f32_16x16x32_bf16 a[72:75], a[96:99], v[168:171], a[72:75]
  s_waitcnt vmcnt(13)
  v_mfma_f32_16x16x32_bf16 a[76:79], a[96:99], v[172:175], a[76:79]
  s_waitcnt lgkmcnt(8)
  v_mfma_f32_16x16x32_bf16 a[0:3], a[100:103], v[176:179], a[0:3]
  ds_read_b64_tr_b16 a[88:89], v11 offset:61440
  ds_read_b64_tr_b16 a[90:91], v11 offset:64000
  v_mfma_f32_16x16x32_bf16 a[4:7], a[100:103], v[180:183], a[4:7]
  v_mfma_f32_16x16x32_bf16 a[8:11], a[100:103], v[184:187], a[8:11]
  v_mfma_f32_16x16x32_bf16 a[12:15], a[100:103], v[188:191], a[12:15]
  s_waitcnt lgkmcnt(8)
  v_mfma_f32_16x16x32_bf16 a[16:19], a[104:107], v[176:179], a[16:19]
  ds_read_b64_tr_b16 a[92:93], v11 offset:61472
  ds_read_b64_tr_b16 a[94:95], v11 offset:64032
  v_mfma_f32_16x16x32_bf16 a[20:23], a[104:107], v[180:183], a[20:23]
  v_mfma_f32_16x16x32_bf16 a[24:27], a[104:107], v[184:187], a[24:27]
  v_mfma_f32_16x16x32_bf16 a[28:31], a[104:107], v[188:191], a[28:31]
  s_waitcnt lgkmcnt(8)
  v_mfma_f32_16x16x32_bf16 a[32:35], a[108:111], v[176:179], a[32:35]
  ds_read_b64_tr_b16 a[96:97], v11 offset:61504
  ds_read_b64_tr_b16 a[98:99], v11 offset:64064
  v_mfma_f32_16x16x32_bf16 a[36:39], a[108:111], v[180:183], a[36:39]
  v_mfma_f32_16x16x32_bf16 a[40:43], a[108:111], v[184:187], a[40:43]
  v_mfma_f32_16x16x32_bf16 a[44:47], a[108:111], v[188:191], a[44:47]
  s_waitcnt lgkmcnt(8)
  v_mfma_f32_16x16x32_bf16 a[48:51], a[80:83], v[176:179], a[48:51]
  ds_read_b64_tr_b16 a[100:101], v11 offset:61536
  ds_read_b64_tr_b16 a[102:103], v11 offset:64096
  v_mfma_f32_16x16x32_bf16 a[52:55], a[80:83], v[180:183], a[52:55]
  v_mfma_f32_16x16x32_bf16 a[56:59], a[80:83], v[184:187], a[56:59]
  v_mfma_f32_16x16x32_bf16 a[60:63], a[80:83], v[188:191], a[60:63]
  s_waitcnt lgkmcnt(8)
  v_mfma_f32_16x16x32_bf16 a[64:67], a[84:87], v[176:179], a[64:67]
  ds_read_b64_tr_b16 a[104:105], v11 offset:61568
  ds_read_b64_tr_b16 a[106:107], v11 offset:64128
  v_mfma_f32_16x16x32_bf16 a[68:71], a[84:87], v[180:183], a[68:71]
  v_mfma_f32_16x16x32_bf16 a[72:75], a[84:87], v[184:187], a[72:75]
  s_waitcnt vmcnt(4)
  v_mfma_f32_16x16x32_bf16 a[76:79], a[84:87], v[188:191], a[76:79]
  s_waitcnt lgkmcnt(8)
  v_mfma_f32_16x16x32_bf16 a[0:3], a[88:91], v[192:195], a[0:3]
  ds_read_b64_tr_b16 a[108:109], v10 offset:0
  ds_read_b64_tr_b16 a[110:111], v10 offset:2560
  v_mfma_f32_16x16x32_bf16 a[4:7], a[88:91], v[196:199], a[4:7]
  v_mfma_f32_16x16x32_bf16 a[8:11], a[88:91], v[200:203], a[8:11]
  v_mfma_f32_16x16x32_bf16 a[12:15], a[88:91], v[204:207], a[12:15]
  s_waitcnt lgkmcnt(8)
  v_mfma_f32_16x16x32_bf16 a[16:19], a[92:95], v[192:195], a[16:19]
  ds_read_b64_tr_b16 a[80:81], v10 offset:32
  ds_read_b64_tr_b16 a[82:83], v10 offset:2592
  v_mfma_f32_16x16x32_bf16 a[20:23], a[92:95], v[196:199], a[20:23]
  v_mfma_f32_16x16x32_bf16 a[24:27], a[92:95], v[200:203], a[24:27]
  v_mfma_f32_16x16x32_bf16 a[28:31], a[92:95], v[204:207], a[28:31]
  s_waitcnt lgkmcnt(8)
  v_mfma_f32_16x16x32_bf16 a[32:35], a[96:99], v[192:195], a[32:35]
  ds_read_b64_tr_b16 a[84:85], v10 offset:64
  ds_read_b64_tr_b16 a[86:87], v10 offset:2624
  v_mfma_f32_16x16x32_bf16 a[36:39], a[96:99], v[196:199], a[36:39]
  v_mfma_f32_16x16x32_bf16 a[40:43], a[96:99], v[200:203], a[40:43]
  v_mfma_f32_16x16x32_bf16 a[44:47], a[96:99], v[204:207], a[44:47]
  s_waitcnt lgkmcnt(8)
  v_mfma_f32_16x16x32_bf16 a[48:51], a[100:103], v[192:195], a[48:51]
  ds_read_b64_tr_b16 a[88:89], v10 offset:96
  ds_read_b64_tr_b16 a[90:91], v10 offset:2656
  v_mfma_f32_16x16x32_bf16 a[52:55], a[100:103], v[196:199], a[52:55]
  v_mfma_f32_16x16x32_bf16 a[56:59], a[100:103], v[200:203], a[56:59]
  v_mfma_f32_16x16x32_bf16 a[60:63], a[100:103], v[204:207], a[60:63]
  s_waitcnt lgkmcnt(8)
  v_mfma_f32_16x16x32_bf16 a[64:67], a[104:107], v[192:195], a[64:67]
  ds_read_b64_tr_b16 a[92:93], v10 offset:128
  ds_read_b64_tr_b16 a[94:95], v10 offset:2688
  v_mfma_f32_16x16x32_bf16 a[68:71], a[104:107], v[196:199], a[68:71]
  v_mfma_f32_16x16x32_bf16 a[72:75], a[104:107], v[200:203], a[72:75]
  s_waitcnt vmcnt(0)
  v_mfma_f32_16x16x32_bf16 a[76:79], a[104:107], v[204:207], a[76:79]
  s_waitcnt lgkmcnt(8)
  v_mfma_f32_16x16x32_bf16 a[0:3], a[108:111], v[208:211], a[0:3]
  v_mfma_f32_16x16x32_bf16 a[4:7], a[108:111], v[212:215], a[4:7]
  v_mfma_f32_16x16x32_bf16 a[8:11], a[108:111], v[216:219], a[8:11]
  v_mfma_f32_16x16x32_bf16 a[12:15], a[108:111], v[220:223], a[12:15]
  s_waitcnt lgkmcnt(6)
  v_mfma_f32_16x16x32_bf16 a[16:19], a[80:83], v[208:211], a[16:19]
  v_mfma_f32_16x16x32_bf16 a[20:23], a[80:83], v[212:215], a[20:23]
  v_mfma_f32_16x16x32_bf16 a[24:27], a[80:83], v[216:219], a[24:27]
  v_mfma_f32_16x16x32_bf16 a[28:31], a[80:83], v[220:223], a[28:31]
  s_waitcnt lgkmcnt(4)
  v_mfma_f32_16x16x32_bf16 a[32:35], a[84:87], v[208:211], a[32:35]
  v_mfma_f32_16x16x32_bf16 a[36:39], a[84:87], v[212:215], a[36:39]
  v_mfma_f32_16x16x32_bf16 a[40:43], a[84:87], v[216:219], a[40:43]
  v_mfma_f32_16x16x32_bf16 a[44:47], a[84:87], v[220:223], a[44:47]
  s_waitcnt lgkmcnt(2)
  v_mfma_f32_16x16x32_bf16 a[48:51], a[88:91], v[208:211], a[48:51]
  v_mfma_f32_16x16x32_bf16 a[52:55], a[88:91], v[212:215], a[52:55]
  v_mfma_f32_16x16x32_bf16 a[56:59], a[88:91], v[216:219], a[56:59]
  v_mfma_f32_16x16x32_bf16 a[60:63], a[88:91], v[220:223], a[60:63]
  s_waitcnt lgkmcnt(0)
  v_mfma_f32_16x16x32_bf16 a[64:67], a[92:95], v[208:211], a[64:67]
  v_mfma_f32_16x16x32_bf16 a[68:71], a[92:95], v[212:215], a[68:71]
  v_mfma_f32_16x16x32_bf16 a[72:75], a[92:95], v[216:219], a[72:75]
  v_mfma_f32_16x16x32_bf16 a[76:79], a[92:95], v[220:223], a[76:79]
  s_nop 7
  s_waitcnt lgkmcnt(0)
  s_barrier
  s_mul_i32 s54, s28, 20480
  v_add_u32 v23, s54, v17
  ds_write_b128 v23, a[0:3] offset:0
  ds_write_b128 v23, a[16:19] offset:1024
  ds_write_b128 v23, a[32:35] offset:2048
  ds_write_b128 v23, a[48:51] offset:3072
  ds_write_b128 v23, a[64:67] offset:4096
  ds_write_b128 v23, a[4:7] offset:5120
  ds_write_b128 v23, a[20:23] offset:6144
  ds_write_b128 v23, a[36:39] offset:7168
  ds_write_b128 v23, a[52:55] offset:8192
  ds_write_b128 v23, a[68:71] offset:9216
  ds_write_b128 v23, a[8:11] offset:10240
  ds_write_b128 v23, a[24:27] offset:11264
  ds_write_b128 v23, a[40:43] offset:12288
  ds_write_b128 v23, a[56:59] offset:13312
  ds_write_b128 v23, a[72:75] offset:14336
  ds_write_b128 v23, a[12:15] offset:15360
  ds_write_b128 v23, a[28:31] offset:16384
  ds_write_b128 v23, a[44:47] offset:17408
  ds_write_b128 v23, a[60:63] offset:18432
  ds_write_b128 v23, a[76:79] offset:19456
  s_waitcnt lgkmcnt(0)
  s_barrier
  s_mul_i32 s54, s28, 5120
  v_add_u32 v23, s54, v17
  ds_read_b128 v[140:143], v23 offset:0
  ds_read_b128 v[144:147], v23 offset:1024
  ds_read_b128 v[148:151], v23 offset:2048
  ds_read_b128 v[152:155], v23 offset:3072
  ds_read_b128 v[156:159], v23 offset:4096
  ds_read_b128 v[160:163], v23 offset:20480
  ds_read_b128 v[164:167], v23 offset:21504
  ds_read_b128 v[168:171], v23 offset:22528
  ds_read_b128 v[172:175], v23 offset:23552
  ds_read_b128 v[176:179], v23 offset:24576
  ds_read_b128 v[180:183], v23 offset:40960
  ds_read_b128 v[184:187], v23 offset:41984
  ds_read_b128 v[188:191], v23 offset:43008
  ds_read_b128 v[192:195], v23 offset:44032
  ds_read_b128 v[196:199], v23 offset:45056
  v_add_u32 v24, 61440, v23
  ds_read_b128 v[200:203], v24 offset:0
  ds_read_b128 v[204:207], v24 offset:1024
  ds_read_b128 v[208:211], v24 offset:2048
  ds_read_b128 v[212:215], v24 offset:3072
  ds_read_b128 v[216:219], v24 offset:4096
  s_waitcnt vmcnt(0) lgkmcnt(0)
  v_and_b32 v25, 15, v2
  s_mov_b32 s55, 1280
  v_mul_lo_u32 v25, s55, v25
  v_lshrrev_b32 v26, 4, v2
  v_lshlrev_b32 v26, 3, v26
  v_add_u32 v25, v25, v26
  s_mul_i32 s56, s48, 20480
  s_mul_i32 s57, s47, 160
  s_add_u32 s56, s56, s57
  v_add_f32 v140, v140, v160
  v_add_f32 v180, v180, v200
  v_add_f32 v140, v140, v180
  v_add_f32 v141, v141, v161
  v_add_f32 v181, v181, v201
  v_add_f32 v141, v141, v181
  v_add_f32 v142, v142, v162
  v_add_f32 v182, v182, v202
  v_add_f32 v142, v142, v182
  v_add_f32 v143, v143, v163
  v_add_f32 v183, v183, v203
  v_add_f32 v143, v143, v183
  v_lshlrev_b32 v30, 16, v224
  v_and_b32 v31, 0xffff0000, v224
  v_lshlrev_b32 v32, 16, v225
  v_and_b32 v33, 0xffff0000, v225
  v_fma_f32 v30, v140, v236, v30
  v_fma_f32 v31, v141, v237, v31
  v_fma_f32 v32, v142, v238, v32
  v_fma_f32 v33, v143, v239, v33
  v_cvt_pk_bf16_f32 v34, v30, v31
  v_cvt_pk_bf16_f32 v35, v32, v33
  buffer_store_dwordx2 v[34:35], v25, s[20:23], s56 offen offset:0
  v_add_f32 v144, v144, v164
  v_add_f32 v184, v184, v204
  v_add_f32 v144, v144, v184
  v_add_f32 v145, v145, v165
  v_add_f32 v185, v185, v205
  v_add_f32 v145, v145, v185
  v_add_f32 v146, v146, v166
  v_add_f32 v186, v186, v206
  v_add_f32 v146, v146, v186
  v_add_f32 v147, v147, v167
  v_add_f32 v187, v187, v207
  v_add_f32 v147, v147, v187
  v_lshlrev_b32 v30, 16, v226
  v_and_b32 v31, 0xffff0000, v226
  v_lshlrev_b32 v32, 16, v227
  v_and_b32 v33, 0xffff0000, v227
  v_fma_f32 v30, v144, v240, v30
  v_fma_f32 v31, v145, v241, v31
  v_fma_f32 v32, v146, v242, v32
  v_fma_f32 v33, v147, v243, v33
  v_cvt_pk_bf16_f32 v36, v30, v31
  v_cvt_pk_bf16_f32 v37, v32, v33
  buffer_store_dwordx2 v[36:37], v25, s[20:23], s56 offen offset:32
  v_add_f32 v148, v148, v168
  v_add_f32 v188, v188, v208
  v_add_f32 v148, v148, v188
  v_add_f32 v149, v149, v169
  v_add_f32 v189, v189, v209
  v_add_f32 v149, v149, v189
  v_add_f32 v150, v150, v170
  v_add_f32 v190, v190, v210
  v_add_f32 v150, v150, v190
  v_add_f32 v151, v151, v171
  v_add_f32 v191, v191, v211
  v_add_f32 v151, v151, v191
  v_lshlrev_b32 v30, 16, v228
  v_and_b32 v31, 0xffff0000, v228
  v_lshlrev_b32 v32, 16, v229
  v_and_b32 v33, 0xffff0000, v229
  v_fma_f32 v30, v148, v244, v30
  v_fma_f32 v31, v149, v245, v31
  v_fma_f32 v32, v150, v246, v32
  v_fma_f32 v33, v151, v247, v33
  v_cvt_pk_bf16_f32 v34, v30, v31
  v_cvt_pk_bf16_f32 v35, v32, v33
  buffer_store_dwordx2 v[34:35], v25, s[20:23], s56 offen offset:64
  v_add_f32 v152, v152, v172
  v_add_f32 v192, v192, v212
  v_add_f32 v152, v152, v192
  v_add_f32 v153, v153, v173
  v_add_f32 v193, v193, v213
  v_add_f32 v153, v153, v193
  v_add_f32 v154, v154, v174
  v_add_f32 v194, v194, v214
  v_add_f32 v154, v154, v194
  v_add_f32 v155, v155, v175
  v_add_f32 v195, v195, v215
  v_add_f32 v155, v155, v195
  v_lshlrev_b32 v30, 16, v230
  v_and_b32 v31, 0xffff0000, v230
  v_lshlrev_b32 v32, 16, v231
  v_and_b32 v33, 0xffff0000, v231
  v_fma_f32 v30, v152, v248, v30
  v_fma_f32 v31, v153, v249, v31
  v_fma_f32 v32, v154, v250, v32
  v_fma_f32 v33, v155, v251, v33
  v_cvt_pk_bf16_f32 v36, v30, v31
  v_cvt_pk_bf16_f32 v37, v32, v33
  buffer_store_dwordx2 v[36:37], v25, s[20:23], s56 offen offset:96
  v_add_f32 v156, v156, v176
  v_add_f32 v196, v196, v216
  v_add_f32 v156, v156, v196
  v_add_f32 v157, v157, v177
  v_add_f32 v197, v197, v217
  v_add_f32 v157, v157, v197
  v_add_f32 v158, v158, v178
  v_add_f32 v198, v198, v218
  v_add_f32 v158, v158, v198
  v_add_f32 v159, v159, v179
  v_add_f32 v199, v199, v219
  v_add_f32 v159, v159, v199
  v_lshlrev_b32 v30, 16, v232
  v_and_b32 v31, 0xffff0000, v232
  v_lshlrev_b32 v32, 16, v233
  v_and_b32 v33, 0xffff0000, v233
  v_fma_f32 v30, v156, v252, v30
  v_fma_f32 v31, v157, v253, v31
  v_fma_f32 v32, v158, v254, v32
  v_fma_f32 v33, v159, v255, v33
  v_cvt_pk_bf16_f32 v34, v30, v31
  v_cvt_pk_bf16_f32 v35, v32, v33
  buffer_store_dwordx2 v[34:35], v25, s[20:23], s56 offen offset:128
  s_branch L_end_k2_kernel
L_k2_slow:
  s_mov_b32 s37, 1
  s_waitcnt vmcnt(0) lgkmcnt(0)
  s_and_b32 s44, s28, 1
  s_lshl_b32 s44, s44, 1
  s_lshr_b32 s45, s28, 1
  s_lshl_b32 s45, s45, 3
  s_add_u32 s44, s44, s45
  s_mul_i32 s44, s44, 12288
  s_sub_u32 s45, s44, 98304
  v_add_u32 v96, s45, v200
  v_add_u32 v97, s45, v201
  s_add_u32 s45, s44, 12288
  v_add_u32 v98, s45, v192
  v_add_u32 v99, s45, v193
  v_add_u32 v100, s45, v194
  v_add_u32 v101, s45, v195
  s_mul_i32 s46, s29, 786432
  s_add_u32 s46, s46, 589824
  s_mul_i32 s47, s28, 3072
  s_sub_u32 s46, s46, s47
  v_mov_b32 v102, 0xff7fffff
  v_mov_b32 v176, 0
  v_mov_b32 v103, 0xff7fffff
  v_mov_b32 v177, 0
  v_mov_b32 v104, 0xff7fffff
  v_mov_b32 v178, 0
  v_mov_b32 v105, 0xff7fffff
  v_mov_b32 v179, 0
  v_accvgpr_write_b32 a0, 0
  v_accvgpr_write_b32 a1, 0
  v_accvgpr_write_b32 a2, 0
  v_accvgpr_write_b32 a3, 0
  v_accvgpr_write_b32 a4, 0
  v_accvgpr_write_b32 a5, 0
  v_accvgpr_write_b32 a6, 0
  v_accvgpr_write_b32 a7, 0
  v_accvgpr_write_b32 a8, 0
  v_accvgpr_write_b32 a9, 0
  v_accvgpr_write_b32 a10, 0
  v_accvgpr_write_b32 a11, 0
  v_accvgpr_write_b32 a12, 0
  v_accvgpr_write_b32 a13, 0
  v_accvgpr_write_b32 a14, 0
  v_accvgpr_write_b32 a15, 0
  v_accvgpr_write_b32 a16, 0
  v_accvgpr_write_b32 a17, 0
  v_accvgpr_write_b32 a18, 0
  v_accvgpr_write_b32 a19, 0
  v_accvgpr_write_b32 a20, 0
  v_accvgpr_write_b32 a21, 0
  v_accvgpr_write_b32 a22, 0
  v_accvgpr_write_b32 a23, 0
  v_accvgpr_write_b32 a24, 0
  v_accvgpr_write_b32 a25, 0
  v_accvgpr_write_b32 a26, 0
  v_accvgpr_write_b32 a27, 0
  v_accvgpr_write_b32 a28, 0
  v_accvgpr_write_b32 a29, 0
  v_accvgpr_write_b32 a30, 0
  v_accvgpr_write_b32 a31, 0
  v_accvgpr_write_b32 a32, 0
  v_accvgpr_write_b32 a33, 0
  v_accvgpr_write_b32 a34, 0
  v_accvgpr_write_b32 a35, 0
  v_accvgpr_write_b32 a36, 0
  v_accvgpr_write_b32 a37, 0
  v_accvgpr_write_b32 a38, 0
  v_accvgpr_write_b32 a39, 0
  v_accvgpr_write_b32 a40, 0
  v_accvgpr_write_b32 a41, 0
  v_accvgpr_write_b32 a42, 0
  v_accvgpr_write_b32 a43, 0
  v_accvgpr_write_b32 a44, 0
  v_accvgpr_write_b32 a45, 0
  v_accvgpr_write_b32 a46, 0
  v_accvgpr_write_b32 a47, 0
  v_accvgpr_write_b32 a48, 0
  v_accvgpr_write_b32 a49, 0
  v_accvgpr_write_b32 a50, 0
  v_accvgpr_write_b32 a51, 0
  v_accvgpr_write_b32 a52, 0
  v_accvgpr_write_b32 a53, 0
  v_accvgpr_write_b32 a54, 0
  v_accvgpr_write_b32 a55, 0
  v_accvgpr_write_b32 a56, 0
  v_accvgpr_write_b32 a57, 0
  v_accvgpr_write_b32 a58, 0
  v_accvgpr_write_b32 a59, 0
  v_accvgpr_write_b32 a60, 0
  v_accvgpr_write_b32 a61, 0
  v_accvgpr_write_b32 a62, 0
  v_accvgpr_write_b32 a63, 0
  v_accvgpr_write_b32 a64, 0
  v_accvgpr_write_b32 a65, 0
  v_accvgpr_write_b32 a66, 0
  v_accvgpr_write_b32 a67, 0
  v_accvgpr_write_b32 a68, 0
  v_accvgpr_write_b32 a69, 0
  v_accvgpr_write_b32 a70, 0
  v_accvgpr_write_b32 a71, 0
  v_accvgpr_write_b32 a72, 0
  v_accvgpr_write_b32 a73, 0
  v_accvgpr_write_b32 a74, 0
  v_accvgpr_write_b32 a75, 0
  v_accvgpr_write_b32 a76, 0
  v_accvgpr_write_b32 a77, 0
  v_accvgpr_write_b32 a78, 0
  v_accvgpr_write_b32 a79, 0
  v_accvgpr_write_b32 a80, 0
  v_accvgpr_write_b32 a81, 0
  v_accvgpr_write_b32 a82, 0
  v_accvgpr_write_b32 a83, 0
  v_accvgpr_write_b32 a84, 0
  v_accvgpr_write_b32 a85, 0
  v_accvgpr_write_b32 a86, 0
  v_accvgpr_write_b32 a87, 0
  v_accvgpr_write_b32 a88, 0
  v_accvgpr_write_b32 a89, 0
  v_accvgpr_write_b32 a90, 0
  v_accvgpr_write_b32 a91, 0
  v_accvgpr_write_b32 a92, 0
  v_accvgpr_write_b32 a93, 0
  v_accvgpr_write_b32 a94, 0
  v_accvgpr_write_b32 a95, 0
  v_accvgpr_write_b32 a96, 0
  v_accvgpr_write_b32 a97, 0
  v_accvgpr_write_b32 a98, 0
  v_accvgpr_write_b32 a99, 0
  v_accvgpr_write_b32 a100, 0
  v_accvgpr_write_b32 a101, 0
  v_accvgpr_write_b32 a102, 0
  v_accvgpr_write_b32 a103, 0
  v_accvgpr_write_b32 a104, 0
  v_accvgpr_write_b32 a105, 0
  v_accvgpr_write_b32 a106, 0
  v_accvgpr_write_b32 a107, 0
  v_accvgpr_write_b32 a108, 0
  v_accvgpr_write_b32 a109, 0
  v_accvgpr_write_b32 a110, 0
  v_accvgpr_write_b32 a111, 0
  v_accvgpr_write_b32 a112, 0
  v_accvgpr_write_b32 a113, 0
  v_accvgpr_write_b32 a114, 0
  v_accvgpr_write_b32 a115, 0
  v_accvgpr_write_b32 a116, 0
  v_accvgpr_write_b32 a117, 0
  v_accvgpr_write_b32 a118, 0
  v_accvgpr_write_b32 a119, 0
  v_accvgpr_write_b32 a120, 0
  v_accvgpr_write_b32 a121, 0
  v_accvgpr_write_b32 a122, 0
  v_accvgpr_write_b32 a123, 0
  v_accvgpr_write_b32 a124, 0
  v_accvgpr_write_b32 a125, 0
  v_accvgpr_write_b32 a126, 0
  v_accvgpr_write_b32 a127, 0
  v_accvgpr_write_b32 a128, 0
  v_accvgpr_write_b32 a129, 0
  v_accvgpr_write_b32 a130, 0
  v_accvgpr_write_b32 a131, 0
  v_accvgpr_write_b32 a132, 0
  v_accvgpr_write_b32 a133, 0
  v_accvgpr_write_b32 a134, 0
  v_accvgpr_write_b32 a135, 0
  v_accvgpr_write_b32 a136, 0
  v_accvgpr_write_b32 a137, 0
  v_accvgpr_write_b32 a138, 0
  v_accvgpr_write_b32 a139, 0
  v_accvgpr_write_b32 a140, 0
  v_accvgpr_write_b32 a141, 0
  v_accvgpr_write_b32 a142, 0
  v_accvgpr_write_b32 a143, 0
  v_accvgpr_write_b32 a144, 0
  v_accvgpr_write_b32 a145, 0
  v_accvgpr_write_b32 a146, 0
  v_accvgpr_write_b32 a147, 0
  v_accvgpr_write_b32 a148, 0
  v_accvgpr_write_b32 a149, 0
  v_accvgpr_write_b32 a150, 0
  v_accvgpr_write_b32 a151, 0
  v_accvgpr_write_b32 a152, 0
  v_accvgpr_write_b32 a153, 0
  v_accvgpr_write_b32 a154, 0
  v_accvgpr_write_b32 a155, 0
  v_accvgpr_write_b32 a156, 0
  v_accvgpr_write_b32 a157, 0
  v_accvgpr_write_b32 a158, 0
  v_accvgpr_write_b32 a159, 0
  v_accvgpr_write_b32 a160, 0
  v_accvgpr_write_b32 a161, 0
  v_accvgpr_write_b32 a162, 0
  v_accvgpr_write_b32 a163, 0
  v_accvgpr_write_b32 a164, 0
  v_accvgpr_write_b32 a165, 0
  v_accvgpr_write_b32 a166, 0
  v_accvgpr_write_b32 a167, 0
  v_accvgpr_write_b32 a168, 0
  v_accvgpr_write_b32 a169, 0
  v_accvgpr_write_b32 a170, 0
  v_accvgpr_write_b32 a171, 0
  v_accvgpr_write_b32 a172, 0
  v_accvgpr_write_b32 a173, 0
  v_accvgpr_write_b32 a174, 0
  v_accvgpr_write_b32 a175, 0
  v_accvgpr_write_b32 a176, 0
  v_accvgpr_write_b32 a177, 0
  v_accvgpr_write_b32 a178, 0
  v_accvgpr_write_b32 a179, 0
  v_accvgpr_write_b32 a180, 0
  v_accvgpr_write_b32 a181, 0
  v_accvgpr_write_b32 a182, 0
  v_accvgpr_write_b32 a183, 0
  v_accvgpr_write_b32 a184, 0
  v_accvgpr_write_b32 a185, 0
  v_accvgpr_write_b32 a186, 0
  v_accvgpr_write_b32 a187, 0
  v_accvgpr_write_b32 a188, 0
  v_accvgpr_write_b32 a189, 0
  v_accvgpr_write_b32 a190, 0
  v_accvgpr_write_b32 a191, 0
  s_mov_b32 s48, 16
L_k2_slow_loop:
  s_add_u32 m0, s44, 0
  s_add_u32 s47, s46, 0
  buffer_load_dwordx4 v205, s[12:15], s47 offen offset:0 lds
  buffer_load_dwordx4 v206, s[12:15], s47 offen offset:1024 lds
  buffer_load_dwordx4 v207, s[12:15], s47 offen offset:2048 lds
  s_add_u32 m0, s44, 3072
  s_add_u32 s47, s46, 3072
  buffer_load_dwordx4 v205, s[12:15], s47 offen offset:0 lds
  buffer_load_dwordx4 v206, s[12:15], s47 offen offset:1024 lds
  buffer_load_dwordx4 v207, s[12:15], s47 offen offset:2048 lds
  s_add_u32 m0, s44, 6144
  s_add_u32 s47, s46, 6144
  buffer_load_dwordx4 v205, s[12:15], s47 offen offset:0 lds
  buffer_load_dwordx4 v206, s[12:15], s47 offen offset:1024 lds
  buffer_load_dwordx4 v207, s[12:15], s47 offen offset:2048 lds
  s_add_u32 m0, s44, 9216
  s_add_u32 s47, s46, 9216
  buffer_load_dwordx4 v205, s[12:15], s47 offen offset:0 lds
  buffer_load_dwordx4 v206, s[12:15], s47 offen offset:1024 lds
  buffer_load_dwordx4 v207, s[12:15], s47 offen offset:2048 lds
  s_add_u32 m0, s44, 12288
  s_add_u32 s47, s46, 0
  buffer_load_dwordx4 v205, s[16:19], s47 offen offset:0 lds
  buffer_load_dwordx4 v206, s[16:19], s47 offen offset:1024 lds
  buffer_load_dwordx4 v207, s[16:19], s47 offen offset:2048 lds
  s_add_u32 m0, s44, 15360
  s_add_u32 s47, s46, 3072
  buffer_load_dwordx4 v205, s[16:19], s47 offen offset:0 lds
  buffer_load_dwordx4 v206, s[16:19], s47 offen offset:1024 lds
  buffer_load_dwordx4 v207, s[16:19], s47 offen offset:2048 lds
  s_add_u32 m0, s44, 18432
  s_add_u32 s47, s46, 6144
  buffer_load_dwordx4 v205, s[16:19], s47 offen offset:0 lds
  buffer_load_dwordx4 v206, s[16:19], s47 offen offset:1024 lds
  buffer_load_dwordx4 v207, s[16:19], s47 offen offset:2048 lds
  s_add_u32 m0, s44, 21504
  s_add_u32 s47, s46, 9216
  buffer_load_dwordx4 v205, s[16:19], s47 offen offset:0 lds
  buffer_load_dwordx4 v206, s[16:19], s47 offen offset:1024 lds
  buffer_load_dwordx4 v207, s[16:19], s47 offen offset:2048 lds
  s_add_u32 s46, s46, 12288
  s_waitcnt vmcnt(0)
  ds_read_b128 a[192:195], v96 offset:0
  ds_read_b128 a[196:199], v97 offset:0
  ds_read_b128 a[200:203], v96 offset:128
  ds_read_b128 a[204:207], v97 offset:128
  ds_read_b128 a[208:211], v96 offset:256
  ds_read_b128 a[212:215], v97 offset:256
  ds_read_b128 a[216:219], v96 offset:6144
  ds_read_b128 a[220:223], v97 offset:6144
  ds_read_b128 a[224:227], v96 offset:6272
  ds_read_b128 a[228:231], v97 offset:6272
  ds_read_b128 a[232:235], v96 offset:6400
  ds_read_b128 a[236:239], v97 offset:6400
  s_waitcnt lgkmcnt(0)
  v_mfma_f32_16x16x32_bf16 v[224:227], a[192:195], v[0:3], 0
  v_mfma_f32_16x16x32_bf16 v[228:231], a[192:195], v[4:7], 0
  v_mfma_f32_16x16x32_bf16 v[232:235], a[192:195], v[8:11], 0
  v_mfma_f32_16x16x32_bf16 v[236:239], a[192:195], v[12:15], 0
  v_mfma_f32_16x16x32_bf16 v[224:227], a[196:199], v[16:19], v[224:227]
  v_mfma_f32_16x16x32_bf16 v[228:231], a[196:199], v[20:23], v[228:231]
  v_mfma_f32_16x16x32_bf16 v[232:235], a[196:199], v[24:27], v[232:235]
  v_mfma_f32_16x16x32_bf16 v[236:239], a[196:199], v[28:31], v[236:239]
  v_mfma_f32_16x16x32_bf16 v[224:227], a[200:203], v[32:35], v[224:227]
  v_mfma_f32_16x16x32_bf16 v[228:231], a[200:203], v[36:39], v[228:231]
  v_mfma_f32_16x16x32_bf16 v[232:235], a[200:203], v[40:43], v[232:235]
  v_mfma_f32_16x16x32_bf16 v[236:239], a[200:203], v[44:47], v[236:239]
  v_mfma_f32_16x16x32_bf16 v[224:227], a[204:207], v[48:51], v[224:227]
  v_mfma_f32_16x16x32_bf16 v[228:231], a[204:207], v[52:55], v[228:231]
  v_mfma_f32_16x16x32_bf16 v[232:235], a[204:207], v[56:59], v[232:235]
  v_mfma_f32_16x16x32_bf16 v[236:239], a[204:207], v[60:63], v[236:239]
  v_mfma_f32_16x16x32_bf16 v[224:227], a[208:211], v[64:67], v[224:227]
  v_mfma_f32_16x16x32_bf16 v[228:231], a[208:211], v[68:71], v[228:231]
  v_mfma_f32_16x16x32_bf16 v[232:235], a[208:211], v[72:75], v[232:235]
  v_mfma_f32_16x16x32_bf16 v[236:239], a[208:211], v[76:79], v[236:239]
  v_mfma_f32_16x16x32_bf16 v[224:227], a[212:215], v[80:83], v[224:227]
  v_mfma_f32_16x16x32_bf16 v[228:231], a[212:215], v[84:87], v[228:231]
  v_mfma_f32_16x16x32_bf16 v[232:235], a[212:215], v[88:91], v[232:235]
  v_mfma_f32_16x16x32_bf16 v[236:239], a[212:215], v[92:95], v[236:239]
  v_mfma_f32_16x16x32_bf16 v[240:243], a[216:219], v[0:3], 0
  v_mfma_f32_16x16x32_bf16 v[244:247], a[216:219], v[4:7], 0
  v_mfma_f32_16x16x32_bf16 v[248:251], a[216:219], v[8:11], 0
  v_mfma_f32_16x16x32_bf16 v[252:255], a[216:219], v[12:15], 0
  v_mfma_f32_16x16x32_bf16 v[240:243], a[220:223], v[16:19], v[240:243]
  v_mfma_f32_16x16x32_bf16 v[244:247], a[220:223], v[20:23], v[244:247]
  v_mfma_f32_16x16x32_bf16 v[248:251], a[220:223], v[24:27], v[248:251]
  v_mfma_f32_16x16x32_bf16 v[252:255], a[220:223], v[28:31], v[252:255]
  v_mfma_f32_16x16x32_bf16 v[240:243], a[224:227], v[32:35], v[240:243]
  v_mfma_f32_16x16x32_bf16 v[244:247], a[224:227], v[36:39], v[244:247]
  v_mfma_f32_16x16x32_bf16 v[248:251], a[224:227], v[40:43], v[248:251]
  v_mfma_f32_16x16x32_bf16 v[252:255], a[224:227], v[44:47], v[252:255]
  v_mfma_f32_16x16x32_bf16 v[240:243], a[228:231], v[48:51], v[240:243]
  v_mfma_f32_16x16x32_bf16 v[244:247], a[228:231], v[52:55], v[244:247]
  v_mfma_f32_16x16x32_bf16 v[248:251], a[228:231], v[56:59], v[248:251]
  v_mfma_f32_16x16x32_bf16 v[252:255], a[228:231], v[60:63], v[252:255]
  v_mfma_f32_16x16x32_bf16 v[240:243], a[232:235], v[64:67], v[240:243]
  v_mfma_f32_16x16x32_bf16 v[244:247], a[232:235], v[68:71], v[244:247]
  v_mfma_f32_16x16x32_bf16 v[248:251], a[232:235], v[72:75], v[248:251]
  v_mfma_f32_16x16x32_bf16 v[252:255], a[232:235], v[76:79], v[252:255]
  v_mfma_f32_16x16x32_bf16 v[240:243], a[236:239], v[80:83], v[240:243]
  v_mfma_f32_16x16x32_bf16 v[244:247], a[236:239], v[84:87], v[244:247]
  v_mfma_f32_16x16x32_bf16 v[248:251], a[236:239], v[88:91], v[248:251]
  v_mfma_f32_16x16x32_bf16 v[252:255], a[236:239], v[92:95], v[252:255]
  s_nop 7
  s_nop 7
  ds_read_b64_tr_b16 a[192:193], v98 offset:0
  ds_read_b64_tr_b16 a[194:195], v98 offset:6144
  ds_read_b64_tr_b16 a[196:197], v99 offset:0
  ds_read_b64_tr_b16 a[198:199], v99 offset:6144
  ds_read_b64_tr_b16 a[200:201], v100 offset:0
  ds_read_b64_tr_b16 a[202:203], v100 offset:6144
  ds_read_b64_tr_b16 a[204:205], v101 offset:0
  ds_read_b64_tr_b16 a[206:207], v101 offset:6144
  ds_read_b64_tr_b16 a[208:209], v98 offset:128
  ds_read_b64_tr_b16 a[210:211], v98 offset:6272
  ds_read_b64_tr_b16 a[212:213], v99 offset:128
  ds_read_b64_tr_b16 a[214:215], v99 offset:6272
  ds_read_b64_tr_b16 a[216:217], v100 offset:128
  ds_read_b64_tr_b16 a[218:219], v100 offset:6272
  ds_read_b64_tr_b16 a[220:221], v101 offset:128
  ds_read_b64_tr_b16 a[222:223], v101 offset:6272
  ds_read_b64_tr_b16 a[224:225], v98 offset:256
  ds_read_b64_tr_b16 a[226:227], v98 offset:6400
  ds_read_b64_tr_b16 a[228:229], v99 offset:256
  ds_read_b64_tr_b16 a[230:231], v99 offset:6400
  ds_read_b64_tr_b16 a[232:233], v100 offset:256
  ds_read_b64_tr_b16 a[234:235], v100 offset:6400
  ds_read_b64_tr_b16 a[236:237], v101 offset:256
  ds_read_b64_tr_b16 a[238:239], v101 offset:6400
  v_max3_f32 v182, v224, v225, v226
  v_max3_f32 v182, v182, v227, v240
  v_max3_f32 v182, v182, v241, v242
  v_max_f32 v182, v182, v243
  v_mov_b32 v180, v182
  s_nop 1
  v_permlane32_swap_b32 v182, v180
  v_max_f32 v182, v182, v180
  v_mov_b32 v180, v182
  s_nop 1
  v_permlane16_swap_b32 v182, v180
  v_max_f32 v182, v182, v180
  v_max_f32 v182, v182, v102
  v_sub_f32 v186, v102, v182
  v_exp_f32 v186, v186
  v_mov_b32 v102, v182
  v_max3_f32 v183, v228, v229, v230
  v_max3_f32 v183, v183, v231, v244
  v_max3_f32 v183, v183, v245, v246
  v_max_f32 v183, v183, v247
  v_mov_b32 v180, v183
  s_nop 1
  v_permlane32_swap_b32 v183, v180
  v_max_f32 v183, v183, v180
  v_mov_b32 v180, v183
  s_nop 1
  v_permlane16_swap_b32 v183, v180
  v_max_f32 v183, v183, v180
  v_max_f32 v183, v183, v103
  v_sub_f32 v187, v103, v183
  v_exp_f32 v187, v187
  v_mov_b32 v103, v183
  v_max3_f32 v184, v232, v233, v234
  v_max3_f32 v184, v184, v235, v248
  v_max3_f32 v184, v184, v249, v250
  v_max_f32 v184, v184, v251
  v_mov_b32 v180, v184
  s_nop 1
  v_permlane32_swap_b32 v184, v180
  v_max_f32 v184, v184, v180
  v_mov_b32 v180, v184
  s_nop 1
  v_permlane16_swap_b32 v184, v180
  v_max_f32 v184, v184, v180
  v_max_f32 v184, v184, v104
  v_sub_f32 v188, v104, v184
  v_exp_f32 v188, v188
  v_mov_b32 v104, v184
  v_max3_f32 v185, v236, v237, v238
  v_max3_f32 v185, v185, v239, v252
  v_max3_f32 v185, v185, v253, v254
  v_max_f32 v185, v185, v255
  v_mov_b32 v180, v185
  s_nop 1
  v_permlane32_swap_b32 v185, v180
  v_max_f32 v185, v185, v180
  v_mov_b32 v180, v185
  s_nop 1
  v_permlane16_swap_b32 v185, v180
  v_max_f32 v185, v185, v180
  v_max_f32 v185, v185, v105
  v_sub_f32 v189, v105, v185
  v_exp_f32 v189, v189
  v_mov_b32 v105, v185
  s_nop 1
  v_mul_f32 v176, v176, v186
  v_sub_f32 v224, v224, v102
  v_sub_f32 v225, v225, v102
  v_sub_f32 v226, v226, v102
  v_sub_f32 v227, v227, v102
  v_sub_f32 v240, v240, v102
  v_sub_f32 v241, v241, v102
  v_sub_f32 v242, v242, v102
  v_sub_f32 v243, v243, v102
  v_exp_f32 v224, v224
  v_exp_f32 v225, v225
  v_exp_f32 v226, v226
  v_exp_f32 v227, v227
  v_exp_f32 v240, v240
  v_exp_f32 v241, v241
  v_exp_f32 v242, v242
  v_exp_f32 v243, v243
  s_nop 0
  v_add_f32 v176, v176, v224
  v_add_f32 v176, v176, v225
  v_add_f32 v176, v176, v226
  v_add_f32 v176, v176, v227
  v_cvt_pk_bf16_f32 v128, v224, v225
  v_cvt_pk_bf16_f32 v129, v226, v227
  v_add_f32 v176, v176, v240
  v_add_f32 v176, v176, v241
  v_add_f32 v176, v176, v242
  v_add_f32 v176, v176, v243
  v_cvt_pk_bf16_f32 v130, v240, v241
  v_cvt_pk_bf16_f32 v131, v242, v243
  v_mul_f32 v177, v177, v187
  v_sub_f32 v228, v228, v103
  v_sub_f32 v229, v229, v103
  v_sub_f32 v230, v230, v103
  v_sub_f32 v231, v231, v103
  v_sub_f32 v244, v244, v103
  v_sub_f32 v245, v245, v103
  v_sub_f32 v246, v246, v103
  v_sub_f32 v247, v247, v103
  v_exp_f32 v228, v228
  v_exp_f32 v229, v229
  v_exp_f32 v230, v230
  v_exp_f32 v231, v231
  v_exp_f32 v244, v244
  v_exp_f32 v245, v245
  v_exp_f32 v246, v246
  v_exp_f32 v247, v247
  s_nop 0
  v_add_f32 v177, v177, v228
  v_add_f32 v177, v177, v229
  v_add_f32 v177, v177, v230
  v_add_f32 v177, v177, v231
  v_cvt_pk_bf16_f32 v132, v228, v229
  v_cvt_pk_bf16_f32 v133, v230, v231
  v_add_f32 v177, v177, v244
  v_add_f32 v177, v177, v245
  v_add_f32 v177, v177, v246
  v_add_f32 v177, v177, v247
  v_cvt_pk_bf16_f32 v134, v244, v245
  v_cvt_pk_bf16_f32 v135, v246, v247
  v_mul_f32 v178, v178, v188
  v_sub_f32 v232, v232, v104
  v_sub_f32 v233, v233, v104
  v_sub_f32 v234, v234, v104
  v_sub_f32 v235, v235, v104
  v_sub_f32 v248, v248, v104
  v_sub_f32 v249, v249, v104
  v_sub_f32 v250, v250, v104
  v_sub_f32 v251, v251, v104
  v_exp_f32 v232, v232
  v_exp_f32 v233, v233
  v_exp_f32 v234, v234
  v_exp_f32 v235, v235
  v_exp_f32 v248, v248
  v_exp_f32 v249, v249
  v_exp_f32 v250, v250
  v_exp_f32 v251, v251
  s_nop 0
  v_add_f32 v178, v178, v232
  v_add_f32 v178, v178, v233
  v_add_f32 v178, v178, v234
  v_add_f32 v178, v178, v235
  v_cvt_pk_bf16_f32 v136, v232, v233
  v_cvt_pk_bf16_f32 v137, v234, v235
  v_add_f32 v178, v178, v248
  v_add_f32 v178, v178, v249
  v_add_f32 v178, v178, v250
  v_add_f32 v178, v178, v251
  v_cvt_pk_bf16_f32 v138, v248, v249
  v_cvt_pk_bf16_f32 v139, v250, v251
  v_mul_f32 v179, v179, v189
  v_sub_f32 v236, v236, v105
  v_sub_f32 v237, v237, v105
  v_sub_f32 v238, v238, v105
  v_sub_f32 v239, v239, v105
  v_sub_f32 v252, v252, v105
  v_sub_f32 v253, v253, v105
  v_sub_f32 v254, v254, v105
  v_sub_f32 v255, v255, v105
  v_exp_f32 v236, v236
  v_exp_f32 v237, v237
  v_exp_f32 v238, v238
  v_exp_f32 v239, v239
  v_exp_f32 v252, v252
  v_exp_f32 v253, v253
  v_exp_f32 v254, v254
  v_exp_f32 v255, v255
  s_nop 0
  v_add_f32 v179, v179, v236
  v_add_f32 v179, v179, v237
  v_add_f32 v179, v179, v238
  v_add_f32 v179, v179, v239
  v_cvt_pk_bf16_f32 v140, v236, v237
  v_cvt_pk_bf16_f32 v141, v238, v239
  v_add_f32 v179, v179, v252
  v_add_f32 v179, v179, v253
  v_add_f32 v179, v179, v254
  v_add_f32 v179, v179, v255
  v_cvt_pk_bf16_f32 v142, v252, v253
  v_cvt_pk_bf16_f32 v143, v254, v255
  v_accvgpr_read_b32 v108, a0
  v_accvgpr_read_b32 v109, a1
  v_accvgpr_read_b32 v110, a2
  v_accvgpr_read_b32 v111, a3
  v_mul_f32 v108, v108, v186
  v_mul_f32 v109, v109, v186
  v_mul_f32 v110, v110, v186
  v_mul_f32 v111, v111, v186
  v_accvgpr_write_b32 a0, v108
  v_accvgpr_write_b32 a1, v109
  v_accvgpr_write_b32 a2, v110
  v_accvgpr_write_b32 a3, v111
  v_accvgpr_read_b32 v108, a4
  v_accvgpr_read_b32 v109, a5
  v_accvgpr_read_b32 v110, a6
  v_accvgpr_read_b32 v111, a7
  v_mul_f32 v108, v108, v187
  v_mul_f32 v109, v109, v187
  v_mul_f32 v110, v110, v187
  v_mul_f32 v111, v111, v187
  v_accvgpr_write_b32 a4, v108
  v_accvgpr_write_b32 a5, v109
  v_accvgpr_write_b32 a6, v110
  v_accvgpr_write_b32 a7, v111
  v_accvgpr_read_b32 v108, a8
  v_accvgpr_read_b32 v109, a9
  v_accvgpr_read_b32 v110, a10
  v_accvgpr_read_b32 v111, a11
  v_mul_f32 v108, v108, v188
  v_mul_f32 v109, v109, v188
  v_mul_f32 v110, v110, v188
  v_mul_f32 v111, v111, v188
  v_accvgpr_write_b32 a8, v108
  v_accvgpr_write_b32 a9, v109
  v_accvgpr_write_b32 a10, v110
  v_accvgpr_write_b32 a11, v111
  v_accvgpr_read_b32 v108, a12
  v_accvgpr_read_b32 v109, a13
  v_accvgpr_read_b32 v110, a14
  v_accvgpr_read_b32 v111, a15
  v_mul_f32 v108, v108, v189
  v_mul_f32 v109, v109, v189
  v_mul_f32 v110, v110, v189
  v_mul_f32 v111, v111, v189
  v_accvgpr_write_b32 a12, v108
  v_accvgpr_write_b32 a13, v109
  v_accvgpr_write_b32 a14, v110
  v_accvgpr_write_b32 a15, v111
  v_accvgpr_read_b32 v108, a16
  v_accvgpr_read_b32 v109, a17
  v_accvgpr_read_b32 v110, a18
  v_accvgpr_read_b32 v111, a19
  v_mul_f32 v108, v108, v186
  v_mul_f32 v109, v109, v186
  v_mul_f32 v110, v110, v186
  v_mul_f32 v111, v111, v186
  v_accvgpr_write_b32 a16, v108
  v_accvgpr_write_b32 a17, v109
  v_accvgpr_write_b32 a18, v110
  v_accvgpr_write_b32 a19, v111
  v_accvgpr_read_b32 v108, a20
  v_accvgpr_read_b32 v109, a21
  v_accvgpr_read_b32 v110, a22
  v_accvgpr_read_b32 v111, a23
  v_mul_f32 v108, v108, v187
  v_mul_f32 v109, v109, v187
  v_mul_f32 v110, v110, v187
  v_mul_f32 v111, v111, v187
  v_accvgpr_write_b32 a20, v108
  v_accvgpr_write_b32 a21, v109
  v_accvgpr_write_b32 a22, v110
  v_accvgpr_write_b32 a23, v111
  v_accvgpr_read_b32 v108, a24
  v_accvgpr_read_b32 v109, a25
  v_accvgpr_read_b32 v110, a26
  v_accvgpr_read_b32 v111, a27
  v_mul_f32 v108, v108, v188
  v_mul_f32 v109, v109, v188
  v_mul_f32 v110, v110, v188
  v_mul_f32 v111, v111, v188
  v_accvgpr_write_b32 a24, v108
  v_accvgpr_write_b32 a25, v109
  v_accvgpr_write_b32 a26, v110
  v_accvgpr_write_b32 a27, v111
  v_accvgpr_read_b32 v108, a28
  v_accvgpr_read_b32 v109, a29
  v_accvgpr_read_b32 v110, a30
  v_accvgpr_read_b32 v111, a31
  v_mul_f32 v108, v108, v189
  v_mul_f32 v109, v109, v189
  v_mul_f32 v110, v110, v189
  v_mul_f32 v111, v111, v189
  v_accvgpr_write_b32 a28, v108
  v_accvgpr_write_b32 a29, v109
  v_accvgpr_write_b32 a30, v110
  v_accvgpr_write_b32 a31, v111
  v_accvgpr_read_b32 v108, a32
  v_accvgpr_read_b32 v109, a33
  v_accvgpr_read_b32 v110, a34
  v_accvgpr_read_b32 v111, a35
  v_mul_f32 v108, v108, v186
  v_mul_f32 v109, v109, v186
  v_mul_f32 v110, v110, v186
  v_mul_f32 v111, v111, v186
  v_accvgpr_write_b32 a32, v108
  v_accvgpr_write_b32 a33, v109
  v_accvgpr_write_b32 a34, v110
  v_accvgpr_write_b32 a35, v111
  v_accvgpr_read_b32 v108, a36
  v_accvgpr_read_b32 v109, a37
  v_accvgpr_read_b32 v110, a38
  v_accvgpr_read_b32 v111, a39
  v_mul_f32 v108, v108, v187
  v_mul_f32 v109, v109, v187
  v_mul_f32 v110, v110, v187
  v_mul_f32 v111, v111, v187
  v_accvgpr_write_b32 a36, v108
  v_accvgpr_write_b32 a37, v109
  v_accvgpr_write_b32 a38, v110
  v_accvgpr_write_b32 a39, v111
  v_accvgpr_read_b32 v108, a40
  v_accvgpr_read_b32 v109, a41
  v_accvgpr_read_b32 v110, a42
  v_accvgpr_read_b32 v111, a43
  v_mul_f32 v108, v108, v188
  v_mul_f32 v109, v109, v188
  v_mul_f32 v110, v110, v188
  v_mul_f32 v111, v111, v188
  v_accvgpr_write_b32 a40, v108
  v_accvgpr_write_b32 a41, v109
  v_accvgpr_write_b32 a42, v110
  v_accvgpr_write_b32 a43, v111
  v_accvgpr_read_b32 v108, a44
  v_accvgpr_read_b32 v109, a45
  v_accvgpr_read_b32 v110, a46
  v_accvgpr_read_b32 v111, a47
  v_mul_f32 v108, v108, v189
  v_mul_f32 v109, v109, v189
  v_mul_f32 v110, v110, v189
  v_mul_f32 v111, v111, v189
  v_accvgpr_write_b32 a44, v108
  v_accvgpr_write_b32 a45, v109
  v_accvgpr_write_b32 a46, v110
  v_accvgpr_write_b32 a47, v111
  v_accvgpr_read_b32 v108, a48
  v_accvgpr_read_b32 v109, a49
  v_accvgpr_read_b32 v110, a50
  v_accvgpr_read_b32 v111, a51
  v_mul_f32 v108, v108, v186
  v_mul_f32 v109, v109, v186
  v_mul_f32 v110, v110, v186
  v_mul_f32 v111, v111, v186
  v_accvgpr_write_b32 a48, v108
  v_accvgpr_write_b32 a49, v109
  v_accvgpr_write_b32 a50, v110
  v_accvgpr_write_b32 a51, v111
  v_accvgpr_read_b32 v108, a52
  v_accvgpr_read_b32 v109, a53
  v_accvgpr_read_b32 v110, a54
  v_accvgpr_read_b32 v111, a55
  v_mul_f32 v108, v108, v187
  v_mul_f32 v109, v109, v187
  v_mul_f32 v110, v110, v187
  v_mul_f32 v111, v111, v187
  v_accvgpr_write_b32 a52, v108
  v_accvgpr_write_b32 a53, v109
  v_accvgpr_write_b32 a54, v110
  v_accvgpr_write_b32 a55, v111
  v_accvgpr_read_b32 v108, a56
  v_accvgpr_read_b32 v109, a57
  v_accvgpr_read_b32 v110, a58
  v_accvgpr_read_b32 v111, a59
  v_mul_f32 v108, v108, v188
  v_mul_f32 v109, v109, v188
  v_mul_f32 v110, v110, v188
  v_mul_f32 v111, v111, v188
  v_accvgpr_write_b32 a56, v108
  v_accvgpr_write_b32 a57, v109
  v_accvgpr_write_b32 a58, v110
  v_accvgpr_write_b32 a59, v111
  v_accvgpr_read_b32 v108, a60
  v_accvgpr_read_b32 v109, a61
  v_accvgpr_read_b32 v110, a62
  v_accvgpr_read_b32 v111, a63
  v_mul_f32 v108, v108, v189
  v_mul_f32 v109, v109, v189
  v_mul_f32 v110, v110, v189
  v_mul_f32 v111, v111, v189
  v_accvgpr_write_b32 a60, v108
  v_accvgpr_write_b32 a61, v109
  v_accvgpr_write_b32 a62, v110
  v_accvgpr_write_b32 a63, v111
  v_accvgpr_read_b32 v108, a64
  v_accvgpr_read_b32 v109, a65
  v_accvgpr_read_b32 v110, a66
  v_accvgpr_read_b32 v111, a67
  v_mul_f32 v108, v108, v186
  v_mul_f32 v109, v109, v186
  v_mul_f32 v110, v110, v186
  v_mul_f32 v111, v111, v186
  v_accvgpr_write_b32 a64, v108
  v_accvgpr_write_b32 a65, v109
  v_accvgpr_write_b32 a66, v110
  v_accvgpr_write_b32 a67, v111
  v_accvgpr_read_b32 v108, a68
  v_accvgpr_read_b32 v109, a69
  v_accvgpr_read_b32 v110, a70
  v_accvgpr_read_b32 v111, a71
  v_mul_f32 v108, v108, v187
  v_mul_f32 v109, v109, v187
  v_mul_f32 v110, v110, v187
  v_mul_f32 v111, v111, v187
  v_accvgpr_write_b32 a68, v108
  v_accvgpr_write_b32 a69, v109
  v_accvgpr_write_b32 a70, v110
  v_accvgpr_write_b32 a71, v111
  v_accvgpr_read_b32 v108, a72
  v_accvgpr_read_b32 v109, a73
  v_accvgpr_read_b32 v110, a74
  v_accvgpr_read_b32 v111, a75
  v_mul_f32 v108, v108, v188
  v_mul_f32 v109, v109, v188
  v_mul_f32 v110, v110, v188
  v_mul_f32 v111, v111, v188
  v_accvgpr_write_b32 a72, v108
  v_accvgpr_write_b32 a73, v109
  v_accvgpr_write_b32 a74, v110
  v_accvgpr_write_b32 a75, v111
  v_accvgpr_read_b32 v108, a76
  v_accvgpr_read_b32 v109, a77
  v_accvgpr_read_b32 v110, a78
  v_accvgpr_read_b32 v111, a79
  v_mul_f32 v108, v108, v189
  v_mul_f32 v109, v109, v189
  v_mul_f32 v110, v110, v189
  v_mul_f32 v111, v111, v189
  v_accvgpr_write_b32 a76, v108
  v_accvgpr_write_b32 a77, v109
  v_accvgpr_write_b32 a78, v110
  v_accvgpr_write_b32 a79, v111
  v_accvgpr_read_b32 v108, a80
  v_accvgpr_read_b32 v109, a81
  v_accvgpr_read_b32 v110, a82
  v_accvgpr_read_b32 v111, a83
  v_mul_f32 v108, v108, v186
  v_mul_f32 v109, v109, v186
  v_mul_f32 v110, v110, v186
  v_mul_f32 v111, v111, v186
  v_accvgpr_write_b32 a80, v108
  v_accvgpr_write_b32 a81, v109
  v_accvgpr_write_b32 a82, v110
  v_accvgpr_write_b32 a83, v111
  v_accvgpr_read_b32 v108, a84
  v_accvgpr_read_b32 v109, a85
  v_accvgpr_read_b32 v110, a86
  v_accvgpr_read_b32 v111, a87
  v_mul_f32 v108, v108, v187
  v_mul_f32 v109, v109, v187
  v_mul_f32 v110, v110, v187
  v_mul_f32 v111, v111, v187
  v_accvgpr_write_b32 a84, v108
  v_accvgpr_write_b32 a85, v109
  v_accvgpr_write_b32 a86, v110
  v_accvgpr_write_b32 a87, v111
  v_accvgpr_read_b32 v108, a88
  v_accvgpr_read_b32 v109, a89
  v_accvgpr_read_b32 v110, a90
  v_accvgpr_read_b32 v111, a91
  v_mul_f32 v108, v108, v188
  v_mul_f32 v109, v109, v188
  v_mul_f32 v110, v110, v188
  v_mul_f32 v111, v111, v188
  v_accvgpr_write_b32 a88, v108
  v_accvgpr_write_b32 a89, v109
  v_accvgpr_write_b32 a90, v110
  v_accvgpr_write_b32 a91, v111
  v_accvgpr_read_b32 v108, a92
  v_accvgpr_read_b32 v109, a93
  v_accvgpr_read_b32 v110, a94
  v_accvgpr_read_b32 v111, a95
  v_mul_f32 v108, v108, v189
  v_mul_f32 v109, v109, v189
  v_mul_f32 v110, v110, v189
  v_mul_f32 v111, v111, v189
  v_accvgpr_write_b32 a92, v108
  v_accvgpr_write_b32 a93, v109
  v_accvgpr_write_b32 a94, v110
  v_accvgpr_write_b32 a95, v111
  v_accvgpr_read_b32 v108, a96
  v_accvgpr_read_b32 v109, a97
  v_accvgpr_read_b32 v110, a98
  v_accvgpr_read_b32 v111, a99
  v_mul_f32 v108, v108, v186
  v_mul_f32 v109, v109, v186
  v_mul_f32 v110, v110, v186
  v_mul_f32 v111, v111, v186
  v_accvgpr_write_b32 a96, v108
  v_accvgpr_write_b32 a97, v109
  v_accvgpr_write_b32 a98, v110
  v_accvgpr_write_b32 a99, v111
  v_accvgpr_read_b32 v108, a100
  v_accvgpr_read_b32 v109, a101
  v_accvgpr_read_b32 v110, a102
  v_accvgpr_read_b32 v111, a103
  v_mul_f32 v108, v108, v187
  v_mul_f32 v109, v109, v187
  v_mul_f32 v110, v110, v187
  v_mul_f32 v111, v111, v187
  v_accvgpr_write_b32 a100, v108
  v_accvgpr_write_b32 a101, v109
  v_accvgpr_write_b32 a102, v110
  v_accvgpr_write_b32 a103, v111
  v_accvgpr_read_b32 v108, a104
  v_accvgpr_read_b32 v109, a105
  v_accvgpr_read_b32 v110, a106
  v_accvgpr_read_b32 v111, a107
  v_mul_f32 v108, v108, v188
  v_mul_f32 v109, v109, v188
  v_mul_f32 v110, v110, v188
  v_mul_f32 v111, v111, v188
  v_accvgpr_write_b32 a104, v108
  v_accvgpr_write_b32 a105, v109
  v_accvgpr_write_b32 a106, v110
  v_accvgpr_write_b32 a107, v111
  v_accvgpr_read_b32 v108, a108
  v_accvgpr_read_b32 v109, a109
  v_accvgpr_read_b32 v110, a110
  v_accvgpr_read_b32 v111, a111
  v_mul_f32 v108, v108, v189
  v_mul_f32 v109, v109, v189
  v_mul_f32 v110, v110, v189
  v_mul_f32 v111, v111, v189
  v_accvgpr_write_b32 a108, v108
  v_accvgpr_write_b32 a109, v109
  v_accvgpr_write_b32 a110, v110
  v_accvgpr_write_b32 a111, v111
  v_accvgpr_read_b32 v108, a112
  v_accvgpr_read_b32 v109, a113
  v_accvgpr_read_b32 v110, a114
  v_accvgpr_read_b32 v111, a115
  v_mul_f32 v108, v108, v186
  v_mul_f32 v109, v109, v186
  v_mul_f32 v110, v110, v186
  v_mul_f32 v111, v111, v186
  v_accvgpr_write_b32 a112, v108
  v_accvgpr_write_b32 a113, v109
  v_accvgpr_write_b32 a114, v110
  v_accvgpr_write_b32 a115, v111
  v_accvgpr_read_b32 v108, a116
  v_accvgpr_read_b32 v109, a117
  v_accvgpr_read_b32 v110, a118
  v_accvgpr_read_b32 v111, a119
  v_mul_f32 v108, v108, v187
  v_mul_f32 v109, v109, v187
  v_mul_f32 v110, v110, v187
  v_mul_f32 v111, v111, v187
  v_accvgpr_write_b32 a116, v108
  v_accvgpr_write_b32 a117, v109
  v_accvgpr_write_b32 a118, v110
  v_accvgpr_write_b32 a119, v111
  v_accvgpr_read_b32 v108, a120
  v_accvgpr_read_b32 v109, a121
  v_accvgpr_read_b32 v110, a122
  v_accvgpr_read_b32 v111, a123
  v_mul_f32 v108, v108, v188
  v_mul_f32 v109, v109, v188
  v_mul_f32 v110, v110, v188
  v_mul_f32 v111, v111, v188
  v_accvgpr_write_b32 a120, v108
  v_accvgpr_write_b32 a121, v109
  v_accvgpr_write_b32 a122, v110
  v_accvgpr_write_b32 a123, v111
  v_accvgpr_read_b32 v108, a124
  v_accvgpr_read_b32 v109, a125
  v_accvgpr_read_b32 v110, a126
  v_accvgpr_read_b32 v111, a127
  v_mul_f32 v108, v108, v189
  v_mul_f32 v109, v109, v189
  v_mul_f32 v110, v110, v189
  v_mul_f32 v111, v111, v189
  v_accvgpr_write_b32 a124, v108
  v_accvgpr_write_b32 a125, v109
  v_accvgpr_write_b32 a126, v110
  v_accvgpr_write_b32 a127, v111
  v_accvgpr_read_b32 v108, a128
  v_accvgpr_read_b32 v109, a129
  v_accvgpr_read_b32 v110, a130
  v_accvgpr_read_b32 v111, a131
  v_mul_f32 v108, v108, v186
  v_mul_f32 v109, v109, v186
  v_mul_f32 v110, v110, v186
  v_mul_f32 v111, v111, v186
  v_accvgpr_write_b32 a128, v108
  v_accvgpr_write_b32 a129, v109
  v_accvgpr_write_b32 a130, v110
  v_accvgpr_write_b32 a131, v111
  v_accvgpr_read_b32 v108, a132
  v_accvgpr_read_b32 v109, a133
  v_accvgpr_read_b32 v110, a134
  v_accvgpr_read_b32 v111, a135
  v_mul_f32 v108, v108, v187
  v_mul_f32 v109, v109, v187
  v_mul_f32 v110, v110, v187
  v_mul_f32 v111, v111, v187
  v_accvgpr_write_b32 a132, v108
  v_accvgpr_write_b32 a133, v109
  v_accvgpr_write_b32 a134, v110
  v_accvgpr_write_b32 a135, v111
  v_accvgpr_read_b32 v108, a136
  v_accvgpr_read_b32 v109, a137
  v_accvgpr_read_b32 v110, a138
  v_accvgpr_read_b32 v111, a139
  v_mul_f32 v108, v108, v188
  v_mul_f32 v109, v109, v188
  v_mul_f32 v110, v110, v188
  v_mul_f32 v111, v111, v188
  v_accvgpr_write_b32 a136, v108
  v_accvgpr_write_b32 a137, v109
  v_accvgpr_write_b32 a138, v110
  v_accvgpr_write_b32 a139, v111
  v_accvgpr_read_b32 v108, a140
  v_accvgpr_read_b32 v109, a141
  v_accvgpr_read_b32 v110, a142
  v_accvgpr_read_b32 v111, a143
  v_mul_f32 v108, v108, v189
  v_mul_f32 v109, v109, v189
  v_mul_f32 v110, v110, v189
  v_mul_f32 v111, v111, v189
  v_accvgpr_write_b32 a140, v108
  v_accvgpr_write_b32 a141, v109
  v_accvgpr_write_b32 a142, v110
  v_accvgpr_write_b32 a143, v111
  v_accvgpr_read_b32 v108, a144
  v_accvgpr_read_b32 v109, a145
  v_accvgpr_read_b32 v110, a146
  v_accvgpr_read_b32 v111, a147
  v_mul_f32 v108, v108, v186
  v_mul_f32 v109, v109, v186
  v_mul_f32 v110, v110, v186
  v_mul_f32 v111, v111, v186
  v_accvgpr_write_b32 a144, v108
  v_accvgpr_write_b32 a145, v109
  v_accvgpr_write_b32 a146, v110
  v_accvgpr_write_b32 a147, v111
  v_accvgpr_read_b32 v108, a148
  v_accvgpr_read_b32 v109, a149
  v_accvgpr_read_b32 v110, a150
  v_accvgpr_read_b32 v111, a151
  v_mul_f32 v108, v108, v187
  v_mul_f32 v109, v109, v187
  v_mul_f32 v110, v110, v187
  v_mul_f32 v111, v111, v187
  v_accvgpr_write_b32 a148, v108
  v_accvgpr_write_b32 a149, v109
  v_accvgpr_write_b32 a150, v110
  v_accvgpr_write_b32 a151, v111
  v_accvgpr_read_b32 v108, a152
  v_accvgpr_read_b32 v109, a153
  v_accvgpr_read_b32 v110, a154
  v_accvgpr_read_b32 v111, a155
  v_mul_f32 v108, v108, v188
  v_mul_f32 v109, v109, v188
  v_mul_f32 v110, v110, v188
  v_mul_f32 v111, v111, v188
  v_accvgpr_write_b32 a152, v108
  v_accvgpr_write_b32 a153, v109
  v_accvgpr_write_b32 a154, v110
  v_accvgpr_write_b32 a155, v111
  v_accvgpr_read_b32 v108, a156
  v_accvgpr_read_b32 v109, a157
  v_accvgpr_read_b32 v110, a158
  v_accvgpr_read_b32 v111, a159
  v_mul_f32 v108, v108, v189
  v_mul_f32 v109, v109, v189
  v_mul_f32 v110, v110, v189
  v_mul_f32 v111, v111, v189
  v_accvgpr_write_b32 a156, v108
  v_accvgpr_write_b32 a157, v109
  v_accvgpr_write_b32 a158, v110
  v_accvgpr_write_b32 a159, v111
  v_accvgpr_read_b32 v108, a160
  v_accvgpr_read_b32 v109, a161
  v_accvgpr_read_b32 v110, a162
  v_accvgpr_read_b32 v111, a163
  v_mul_f32 v108, v108, v186
  v_mul_f32 v109, v109, v186
  v_mul_f32 v110, v110, v186
  v_mul_f32 v111, v111, v186
  v_accvgpr_write_b32 a160, v108
  v_accvgpr_write_b32 a161, v109
  v_accvgpr_write_b32 a162, v110
  v_accvgpr_write_b32 a163, v111
  v_accvgpr_read_b32 v108, a164
  v_accvgpr_read_b32 v109, a165
  v_accvgpr_read_b32 v110, a166
  v_accvgpr_read_b32 v111, a167
  v_mul_f32 v108, v108, v187
  v_mul_f32 v109, v109, v187
  v_mul_f32 v110, v110, v187
  v_mul_f32 v111, v111, v187
  v_accvgpr_write_b32 a164, v108
  v_accvgpr_write_b32 a165, v109
  v_accvgpr_write_b32 a166, v110
  v_accvgpr_write_b32 a167, v111
  v_accvgpr_read_b32 v108, a168
  v_accvgpr_read_b32 v109, a169
  v_accvgpr_read_b32 v110, a170
  v_accvgpr_read_b32 v111, a171
  v_mul_f32 v108, v108, v188
  v_mul_f32 v109, v109, v188
  v_mul_f32 v110, v110, v188
  v_mul_f32 v111, v111, v188
  v_accvgpr_write_b32 a168, v108
  v_accvgpr_write_b32 a169, v109
  v_accvgpr_write_b32 a170, v110
  v_accvgpr_write_b32 a171, v111
  v_accvgpr_read_b32 v108, a172
  v_accvgpr_read_b32 v109, a173
  v_accvgpr_read_b32 v110, a174
  v_accvgpr_read_b32 v111, a175
  v_mul_f32 v108, v108, v189
  v_mul_f32 v109, v109, v189
  v_mul_f32 v110, v110, v189
  v_mul_f32 v111, v111, v189
  v_accvgpr_write_b32 a172, v108
  v_accvgpr_write_b32 a173, v109
  v_accvgpr_write_b32 a174, v110
  v_accvgpr_write_b32 a175, v111
  v_accvgpr_read_b32 v108, a176
  v_accvgpr_read_b32 v109, a177
  v_accvgpr_read_b32 v110, a178
  v_accvgpr_read_b32 v111, a179
  v_mul_f32 v108, v108, v186
  v_mul_f32 v109, v109, v186
  v_mul_f32 v110, v110, v186
  v_mul_f32 v111, v111, v186
  v_accvgpr_write_b32 a176, v108
  v_accvgpr_write_b32 a177, v109
  v_accvgpr_write_b32 a178, v110
  v_accvgpr_write_b32 a179, v111
  v_accvgpr_read_b32 v108, a180
  v_accvgpr_read_b32 v109, a181
  v_accvgpr_read_b32 v110, a182
  v_accvgpr_read_b32 v111, a183
  v_mul_f32 v108, v108, v187
  v_mul_f32 v109, v109, v187
  v_mul_f32 v110, v110, v187
  v_mul_f32 v111, v111, v187
  v_accvgpr_write_b32 a180, v108
  v_accvgpr_write_b32 a181, v109
  v_accvgpr_write_b32 a182, v110
  v_accvgpr_write_b32 a183, v111
  v_accvgpr_read_b32 v108, a184
  v_accvgpr_read_b32 v109, a185
  v_accvgpr_read_b32 v110, a186
  v_accvgpr_read_b32 v111, a187
  v_mul_f32 v108, v108, v188
  v_mul_f32 v109, v109, v188
  v_mul_f32 v110, v110, v188
  v_mul_f32 v111, v111, v188
  v_accvgpr_write_b32 a184, v108
  v_accvgpr_write_b32 a185, v109
  v_accvgpr_write_b32 a186, v110
  v_accvgpr_write_b32 a187, v111
  v_accvgpr_read_b32 v108, a188
  v_accvgpr_read_b32 v109, a189
  v_accvgpr_read_b32 v110, a190
  v_accvgpr_read_b32 v111, a191
  v_mul_f32 v108, v108, v189
  v_mul_f32 v109, v109, v189
  v_mul_f32 v110, v110, v189
  v_mul_f32 v111, v111, v189
  v_accvgpr_write_b32 a188, v108
  v_accvgpr_write_b32 a189, v109
  v_accvgpr_write_b32 a190, v110
  v_accvgpr_write_b32 a191, v111
  s_waitcnt lgkmcnt(0)
  s_nop 1
  v_mfma_f32_16x16x32_bf16 a[0:3], a[192:195], v[128:131], a[0:3]
  v_mfma_f32_16x16x32_bf16 a[4:7], a[192:195], v[132:135], a[4:7]
  v_mfma_f32_16x16x32_bf16 a[8:11], a[192:195], v[136:139], a[8:11]
  v_mfma_f32_16x16x32_bf16 a[12:15], a[192:195], v[140:143], a[12:15]
  v_mfma_f32_16x16x32_bf16 a[16:19], a[196:199], v[128:131], a[16:19]
  v_mfma_f32_16x16x32_bf16 a[20:23], a[196:199], v[132:135], a[20:23]
  v_mfma_f32_16x16x32_bf16 a[24:27], a[196:199], v[136:139], a[24:27]
  v_mfma_f32_16x16x32_bf16 a[28:31], a[196:199], v[140:143], a[28:31]
  v_mfma_f32_16x16x32_bf16 a[32:35], a[200:203], v[128:131], a[32:35]
  v_mfma_f32_16x16x32_bf16 a[36:39], a[200:203], v[132:135], a[36:39]
  v_mfma_f32_16x16x32_bf16 a[40:43], a[200:203], v[136:139], a[40:43]
  v_mfma_f32_16x16x32_bf16 a[44:47], a[200:203], v[140:143], a[44:47]
  v_mfma_f32_16x16x32_bf16 a[48:51], a[204:207], v[128:131], a[48:51]
  v_mfma_f32_16x16x32_bf16 a[52:55], a[204:207], v[132:135], a[52:55]
  v_mfma_f32_16x16x32_bf16 a[56:59], a[204:207], v[136:139], a[56:59]
  v_mfma_f32_16x16x32_bf16 a[60:63], a[204:207], v[140:143], a[60:63]
  v_mfma_f32_16x16x32_bf16 a[64:67], a[208:211], v[128:131], a[64:67]
  v_mfma_f32_16x16x32_bf16 a[68:71], a[208:211], v[132:135], a[68:71]
  v_mfma_f32_16x16x32_bf16 a[72:75], a[208:211], v[136:139], a[72:75]
  v_mfma_f32_16x16x32_bf16 a[76:79], a[208:211], v[140:143], a[76:79]
  v_mfma_f32_16x16x32_bf16 a[80:83], a[212:215], v[128:131], a[80:83]
  v_mfma_f32_16x16x32_bf16 a[84:87], a[212:215], v[132:135], a[84:87]
  v_mfma_f32_16x16x32_bf16 a[88:91], a[212:215], v[136:139], a[88:91]
  v_mfma_f32_16x16x32_bf16 a[92:95], a[212:215], v[140:143], a[92:95]
  v_mfma_f32_16x16x32_bf16 a[96:99], a[216:219], v[128:131], a[96:99]
  v_mfma_f32_16x16x32_bf16 a[100:103], a[216:219], v[132:135], a[100:103]
  v_mfma_f32_16x16x32_bf16 a[104:107], a[216:219], v[136:139], a[104:107]
  v_mfma_f32_16x16x32_bf16 a[108:111], a[216:219], v[140:143], a[108:111]
  v_mfma_f32_16x16x32_bf16 a[112:115], a[220:223], v[128:131], a[112:115]
  v_mfma_f32_16x16x32_bf16 a[116:119], a[220:223], v[132:135], a[116:119]
  v_mfma_f32_16x16x32_bf16 a[120:123], a[220:223], v[136:139], a[120:123]
  v_mfma_f32_16x16x32_bf16 a[124:127], a[220:223], v[140:143], a[124:127]
  v_mfma_f32_16x16x32_bf16 a[128:131], a[224:227], v[128:131], a[128:131]
  v_mfma_f32_16x16x32_bf16 a[132:135], a[224:227], v[132:135], a[132:135]
  v_mfma_f32_16x16x32_bf16 a[136:139], a[224:227], v[136:139], a[136:139]
  v_mfma_f32_16x16x32_bf16 a[140:143], a[224:227], v[140:143], a[140:143]
  v_mfma_f32_16x16x32_bf16 a[144:147], a[228:231], v[128:131], a[144:147]
  v_mfma_f32_16x16x32_bf16 a[148:151], a[228:231], v[132:135], a[148:151]
  v_mfma_f32_16x16x32_bf16 a[152:155], a[228:231], v[136:139], a[152:155]
  v_mfma_f32_16x16x32_bf16 a[156:159], a[228:231], v[140:143], a[156:159]
  v_mfma_f32_16x16x32_bf16 a[160:163], a[232:235], v[128:131], a[160:163]
  v_mfma_f32_16x16x32_bf16 a[164:167], a[232:235], v[132:135], a[164:167]
  v_mfma_f32_16x16x32_bf16 a[168:171], a[232:235], v[136:139], a[168:171]
  v_mfma_f32_16x16x32_bf16 a[172:175], a[232:235], v[140:143], a[172:175]
  v_mfma_f32_16x16x32_bf16 a[176:179], a[236:239], v[128:131], a[176:179]
  v_mfma_f32_16x16x32_bf16 a[180:183], a[236:239], v[132:135], a[180:183]
  v_mfma_f32_16x16x32_bf16 a[184:187], a[236:239], v[136:139], a[184:187]
  v_mfma_f32_16x16x32_bf16 a[188:191], a[236:239], v[140:143], a[188:191]
  s_nop 7
  s_nop 7
  s_sub_u32 s48, s48, 1
  s_cmp_lg_u32 s48, 0
  s_cbranch_scc0 L_k2_slow_done
  s_branch L_k2_slow_loop
L_k2_slow_done:
  s_branch L_k2_epi
L_end_k2_kernel:
  s_endpgm
L_code_end:
  s_endpgm
.section .rodata,"a"
.p2align 6
L_desc_k0_kernel:
.amdhsa_kernel k0_kernel
  .amdhsa_next_free_vgpr 64
  .amdhsa_next_free_sgpr 96
  .amdhsa_accum_offset 64
  .amdhsa_group_segment_fixed_size 0
  .amdhsa_kernarg_size 112
  .amdhsa_user_sgpr_count 2
  .amdhsa_user_sgpr_kernarg_segment_ptr 1
  .amdhsa_system_sgpr_workgroup_id_x 1
.end_amdhsa_kernel
.text
.section .rodata,"a"
.p2align 6
L_desc_k1_kernel:
.amdhsa_kernel k1_kernel
  .amdhsa_next_free_vgpr 128
  .amdhsa_next_free_sgpr 96
  .amdhsa_accum_offset 128
  .amdhsa_group_segment_fixed_size 0
  .amdhsa_kernarg_size 112
  .amdhsa_user_sgpr_count 2
  .amdhsa_user_sgpr_kernarg_segment_ptr 1
  .amdhsa_system_sgpr_workgroup_id_x 1
.end_amdhsa_kernel
.text
.section .rodata,"a"
.p2align 6
L_desc_k2_kernel:
.amdhsa_kernel k2_kernel
  .amdhsa_next_free_vgpr 512
  .amdhsa_next_free_sgpr 102
  .amdhsa_accum_offset 256
  .amdhsa_group_segment_fixed_size 0
  .amdhsa_kernarg_size 112
  .amdhsa_user_sgpr_count 2
  .amdhsa_user_sgpr_kernarg_segment_ptr 1
  .amdhsa_system_sgpr_workgroup_id_x 1
.end_amdhsa_kernel
.text
```
